```python
import torch

def _softmax(x, axis=-1):
    return torch.softmax(x, dim=axis)
def _gelu(x):
    return torch.nn.functional.gelu(x, approximate="tanh")
def _silu(x):
    return torch.nn.functional.silu(x)
def _sigmoid(x):
    return torch.sigmoid(x)
def _layernorm(x, axis=-1, eps=1e-5):
    m = x.mean(dim=axis, keepdim=True)
    v = x.var(dim=axis, keepdim=True, unbiased=False)
    return (x - m) / torch.sqrt(v + eps)
def _scatter_add(tgt, idx, src, axis=0):
    return tgt.clone().index_add_(axis, idx, src)
def _segment_sum(src, seg, n):
    out = torch.zeros((n,) + src.shape[1:], dtype=src.dtype)
    return out.index_add_(0, seg, src)
def _pad(x, pw):
    flat = tuple(v for pair in reversed(pw) for v in pair)
    return torch.nn.functional.pad(x, flat)

kernel_name = 'parallel_sum__sliding_block__glu_gated_reglu__prompt'

def setup_inputs():

    _w = (lambda a: (lambda t: t.to(torch.bfloat16) if t.is_floating_point() else t)(torch.as_tensor(a)))
    def _A_setup():
        B, S, D = 1, 2048, 512
        return {
            "x": _w((lambda *s: torch.randn(*s, dtype=torch.bfloat16) * 0.05)(B, S, D)),
            "wqkv": _w((lambda *s: torch.randn(*s, dtype=torch.bfloat16) * 0.05)(D, 3 * D)),
            "wo": _w((lambda *s: torch.randn(*s, dtype=torch.bfloat16) * 0.05)(D, D)),
        }
    _A_in = _A_setup()

    def _B_setup():
        B, S, D, F = 1, 2048, 512, 1376
        return {
            "x": _w((lambda *s: torch.randn(*s, dtype=torch.bfloat16) * 0.05)(B, S, D)),
            "W_gate": _w((lambda *s: torch.randn(*s, dtype=torch.bfloat16) * 0.8)(D, F) * (2.0 / D) ** 0.5),
            "W_up": _w((lambda *s: torch.randn(*s, dtype=torch.bfloat16) * 0.8)(D, F) * (2.0 / D) ** 0.5),
            "W_down": _w((lambda *s: torch.randn(*s, dtype=torch.bfloat16) * 0.8)(F, D) * (1.0 / F) ** 0.5),
        }
    _B_in = _B_setup()

    return {
        "A_x": _A_in["x"],
        "A_wqkv": _A_in["wqkv"],
        "A_wo": _A_in["wo"],
        "B_x": _B_in["x"],
        "B_W_gate": _B_in["W_gate"],
        "B_W_up": _B_in["W_up"],
        "B_W_down": _B_in["W_down"],
    }

def reference(A_x, A_wqkv, A_wo, B_x, B_W_gate, B_W_up, B_W_down):
    def _A_ref(x, wqkv, wo):
        B, S, D = x.shape
        H = 32; Dh = D // H; W = 256
        qkv = (lambda x, *d: x.permute(*d))((x @ wqkv).reshape(B, S, 3, H, Dh), 2, 0, 3, 1, 4)
        q, k, v = qkv[0], qkv[1], qkv[2]
        scores = torch.einsum("bhqd,bhkd->bhqk", q, k) * (Dh ** -0.5)
        idx = torch.arange(S)
        mask = (idx[:, None] - idx[None, :] >= 0) & (idx[:, None] - idx[None, :] < W)
        scores = torch.where(mask[None, None], scores, -1e9)
        p = _softmax(scores, axis=-1)
        o = torch.einsum("bhqk,bhkd->bhqd", p, v)
        return (lambda x, *d: x.permute(*d))(o, 0, 2, 1, 3).reshape(B, S, D) @ wo

    def _B_ref(x, W_gate, W_up, W_down):
        gate = torch.einsum("bsd,df->bsf", x, W_gate)
        up = torch.einsum("bsd,df->bsf", x, W_up)
        gate = gate * (lambda x, dt: x.to(dt))(gate > 0, gate.dtype)
        h = gate * up
        return torch.einsum("bsf,fd->bsd", h, W_down)

    x = A_x
    xn = _layernorm(x, axis=-1)
    return x + _A_ref(xn, A_wqkv, A_wo) + _B_ref(xn, B_W_gate, B_W_up, B_W_down)
```

```asm
; @launch grid=(256,1,1) block=(512,1,1) lds=163840
.amdgcn_target "amdgcn-amd-amdhsa--gfx950"
.text
.globl parallel_sum__sliding_block__glu_gated_reglu__prompt_kernel
.p2align 8
.type parallel_sum__sliding_block__glu_gated_reglu__prompt_kernel,@function
parallel_sum__sliding_block__glu_gated_reglu__prompt_kernel:
    s_cmp_ge_u32 s2, 256
    s_cbranch_scc1 fz_end
    s_load_dwordx4 s[4:7], s[0:1], 0
    s_load_dwordx4 s[12:15], s[0:1], 32
    s_load_dwordx4 s[20:23], s[0:1], 64
    s_load_dwordx2 s[8:9], s[0:1], 16
    s_load_dwordx4 s[16:19], s[0:1], 48
    s_and_b32 s3, s2, 7
    s_lshr_b32 s31, s2, 3
    s_lshl_b32 s24, s3, 1
    s_and_b32 s40, s31, 1
    s_add_u32 s24, s24, s40
    s_lshr_b32 s25, s31, 1
    s_lshl_b32 s27, s3, 2
    s_and_b32 s40, s31, 3
    s_add_u32 s27, s27, s40
    s_lshr_b32 s28, s31, 2
    s_mov_b32 s10, s3
    s_mov_b32 s11, s31
    v_lshrrev_b32 v1, 6, v0
    v_and_b32 v0, 63, v0
    s_nop 0
    v_readfirstlane_b32 s26, v1
    s_nop 3
    s_cmp_ge_u32 s26, 4
    s_cbranch_scc1 fz_loader
    s_lshl_b32 s40, s24, 7
    s_lshl_b32 s41, s25, 3
    s_add_u32 s40, s40, s41
    s_lshl_b32 s41, s26, 1
    s_add_u32 s40, s40, s41
    s_lshl_b32 s40, s40, 10
    v_lshlrev_b32 v8, 4, v0
    s_waitcnt lgkmcnt(0)
    s_mov_b32 s36, s4
    s_mov_b32 s37, s5
    s_mov_b32 s38, 0x200000
    s_mov_b32 s39, 0x00020000
    buffer_load_dwordx4 v[44:47], v8, s[36:39], s40 offen
    buffer_load_dwordx4 v[48:51], v8, s[36:39], s40 offen offset:1024
    s_cmp_lg_u32 s26, 0
    s_cbranch_scc1 fz_npc
    s_getpc_b64 s[40:41]
fz_pcb:
    s_sub_u32 s40, s40, fz_pcb-parallel_sum__sliding_block__glu_gated_reglu__prompt_kernel
    s_subb_u32 s41, s41, 0
    v_min_u32 v1, 19, v0
    v_lshlrev_b32 v1, 7, v1
    s_mul_i32 s42, s31, 2560
    v_add_u32 v1, s42, v1
    v_min_u32 v1, fz_end-parallel_sum__sliding_block__glu_gated_reglu__prompt_kernel, v1
    global_load_dword v255, v1, s[40:41]
fz_npc:
    s_cmp_lg_u32 s26, 1
    s_cbranch_scc1 fz_npd1
    s_mov_b32 s52, s6
    s_mov_b32 s53, s7
    s_mov_b32 s54, 0x180000
    s_mov_b32 s55, 0x00020000
    s_mul_i32 s67, s2, 4608
    s_add_u32 s67, s67, 393216
    v_lshlrev_b32 v22, 7, v0
    v_min_u32 v22, 4480, v22
    buffer_load_dword v21, v22, s[52:55], s67 offen
fz_npd1:
    s_cmp_lg_u32 s26, 2
    s_cbranch_scc1 fz_npd2
    s_mov_b32 s52, s12
    s_mov_b32 s53, s13
    s_mov_b32 s54, 0x158000
    s_mov_b32 s55, 0x00020000
    s_mul_i32 s67, s2, 4224
    s_add_u32 s67, s67, 352256
    v_lshlrev_b32 v22, 7, v0
    v_min_u32 v22, 4096, v22
    buffer_load_dword v21, v22, s[52:55], s67 offen
fz_npd2:
    s_cmp_lg_u32 s26, 3
    s_cbranch_scc1 fz_npd3
    s_mov_b32 s52, s14
    s_mov_b32 s53, s15
    s_mov_b32 s54, 0x158000
    s_mov_b32 s55, 0x00020000
    s_mul_i32 s67, s2, 4224
    s_add_u32 s67, s67, 352256
    v_lshlrev_b32 v22, 7, v0
    v_min_u32 v22, 4096, v22
    buffer_load_dword v21, v22, s[52:55], s67 offen
fz_npd3:
    s_add_u32 s32, s22, 0xe00000
    s_addc_u32 s33, s23, 0
    s_mov_b32 s34, 0xa0000
    s_mov_b32 s35, 0x00020000
    s_load_dword s30, s[32:33], 0
    s_and_b32 s42, s26, 1
    s_lshr_b32 s43, s26, 1
    v_and_b32 v1, 15, v0
    v_lshrrev_b32 v2, 4, v0
    v_lshrrev_b32 v3, 1, v1
    v_xor_b32 v3, v3, v2
    v_lshlrev_b32 v3, 4, v3
    s_lshl_b32 s40, s42, 13
    v_lshl_add_u32 v3, v1, 7, v3
    s_add_u32 s40, s40, 4096
    v_add_u32 v9, s40, v3
    v_xor_b32 v10, 64, v9
    s_cmp_lt_u32 s25, 10
    s_movk_i32 s44, 544
    s_movk_i32 s45, 256
    s_cselect_b32 s44, 288, s44
    s_cselect_b32 s45, 128, s45
    s_mul_i32 s41, s43, s45
    v_lshrrev_b32 v4, 2, v0
    v_mul_u32_u24 v4, s44, v4
    v_and_b32 v5, 3, v0
    v_lshl_add_u32 v4, v5, 3, v4
    s_add_u32 s40, s41, 20480
    v_add_u32 v11, s40, v4
    v_add_u32 v12, 53248, v9
    v_add_u32 v13, 53248, v10
    v_add_u32 v14, 53248, v11
    v_add_u32 v15, 106496, v9
    v_add_u32 v16, 106496, v10
    v_add_u32 v17, 106496, v11
    s_lshl_b32 s40, s42, 8
    v_lshl_add_u32 v3, v1, 2, s40
    v_lshl_add_u32 v6, v2, 4, s40
    s_lshl_b32 s40, s41, 1
    v_lshl_add_u32 v4, v2, 4, s40
    v_lshl_add_u32 v5, v1, 2, s40
    s_lshl_b32 s40, s24, 4
    s_add_u32 s40, s40, s25
    s_lshl_b32 s40, s40, 2
    s_add_u32 s40, s40, s26
    s_lshl_b32 s46, s40, 7
    s_add_u32 s31, s46, 262144
    s_mov_b32 s44, 0x3b000000
    s_mov_b32 s45, 0x3727c5ac
    v_and_b32 v22, 1, v2
    v_lshrrev_b32 v23, 1, v2
    s_cmp_lt_u32 s25, 10
    s_cbranch_scc1 fz_setF
    s_mov_b32 s48, s22
    s_mov_b32 s49, s23
    s_mov_b32 s50, 0x600000
    s_mov_b32 s51, 0x00020000
    v_lshl_add_u32 v7, v22, 4, v1
    v_lshlrev_b32 v7, 5, v7
    v_lshl_add_u32 v7, v23, 4, v7
    s_sub_u32 s60, s25, 10
    s_lshl_b32 s60, s60, 1
    s_add_u32 s60, s60, s43
    s_mul_i32 s60, s60, 524288
    s_lshl_b32 s40, s24, 12
    s_add_u32 s60, s60, s40
    s_lshl_b32 s40, s42, 11
    s_add_u32 s60, s60, s40
    s_cmp_lt_u32 s25, 12
    s_cselect_b32 s66, 0x3eb8aa3b, 1.0
    s_branch fz_setD
fz_setF:
    s_add_u32 s48, s22, 0x1200000
    s_addc_u32 s49, s23, 0
    s_mov_b32 s50, 0x560000
    s_mov_b32 s51, 0x00020000
    v_lshl_add_u32 v7, v23, 4, v1
    v_lshlrev_b32 v7, 4, v7
    v_lshl_add_u32 v7, v22, 10, v7
    s_mul_i32 s40, s25, 9
    s_lshl_b32 s41, s43, 2
    s_add_u32 s40, s40, s41
    s_lshl_b32 s41, s24, 13
    s_lshl_b32 s3, s42, 12
    s_add_u32 s41, s41, s3
    s_add_u32 s3, s40, 0
    s_lshr_b32 s60, s3, 1
    s_mul_i32 s60, s60, 131072
    s_and_b32 s3, s3, 1
    s_lshl_b32 s3, s3, 9
    s_add_u32 s60, s60, s3
    s_add_u32 s60, s60, s41
    s_add_u32 s3, s40, 1
    s_lshr_b32 s61, s3, 1
    s_mul_i32 s61, s61, 131072
    s_and_b32 s3, s3, 1
    s_lshl_b32 s3, s3, 9
    s_add_u32 s61, s61, s3
    s_add_u32 s61, s61, s41
    s_add_u32 s3, s40, 2
    s_lshr_b32 s62, s3, 1
    s_mul_i32 s62, s62, 131072
    s_and_b32 s3, s3, 1
    s_lshl_b32 s3, s3, 9
    s_add_u32 s62, s62, s3
    s_add_u32 s62, s62, s41
    s_add_u32 s3, s40, 3
    s_lshr_b32 s63, s3, 1
    s_mul_i32 s63, s63, 131072
    s_and_b32 s3, s3, 1
    s_lshl_b32 s3, s3, 9
    s_add_u32 s63, s63, s3
    s_add_u32 s63, s63, s41
    s_add_u32 s3, s40, 4
    s_lshr_b32 s64, s3, 1
    s_mul_i32 s64, s64, 131072
    s_and_b32 s3, s3, 1
    s_lshl_b32 s3, s3, 9
    s_add_u32 s64, s64, s3
    s_add_u32 s64, s64, s41
fz_setD:
    s_waitcnt vmcnt(0)
    v_lshlrev_b32 v52, 16, v44
    v_and_b32 v53, 0xffff0000, v44
    v_lshlrev_b32 v54, 16, v45
    v_and_b32 v55, 0xffff0000, v45
    v_lshlrev_b32 v56, 16, v46
    v_and_b32 v57, 0xffff0000, v46
    v_lshlrev_b32 v58, 16, v47
    v_and_b32 v59, 0xffff0000, v47
    v_lshlrev_b32 v60, 16, v48
    v_and_b32 v61, 0xffff0000, v48
    v_lshlrev_b32 v62, 16, v49
    v_and_b32 v63, 0xffff0000, v49
    v_lshlrev_b32 v64, 16, v50
    v_and_b32 v65, 0xffff0000, v50
    v_lshlrev_b32 v66, 16, v51
    v_and_b32 v67, 0xffff0000, v51
    v_add_f32 v68, v52, v53
    v_add_f32 v69, v60, v61
    v_add_f32 v68, v68, v54
    v_add_f32 v69, v69, v62
    v_add_f32 v68, v68, v55
    v_add_f32 v69, v69, v63
    v_add_f32 v68, v68, v56
    v_add_f32 v69, v69, v64
    v_add_f32 v68, v68, v57
    v_add_f32 v69, v69, v65
    v_add_f32 v68, v68, v58
    v_add_f32 v69, v69, v66
    v_add_f32 v68, v68, v59
    v_add_f32 v69, v69, v67
    s_nop 0
    v_add_f32_dpp v68, v68, v68 quad_perm:[1,0,3,2] row_mask:0xf bank_mask:0xf
    v_add_f32_dpp v69, v69, v69 quad_perm:[1,0,3,2] row_mask:0xf bank_mask:0xf
    s_nop 0
    v_add_f32_dpp v68, v68, v68 quad_perm:[2,3,0,1] row_mask:0xf bank_mask:0xf
    v_add_f32_dpp v69, v69, v69 quad_perm:[2,3,0,1] row_mask:0xf bank_mask:0xf
    s_nop 0
    v_add_f32_dpp v68, v68, v68 row_half_mirror row_mask:0xf bank_mask:0xf
    v_add_f32_dpp v69, v69, v69 row_half_mirror row_mask:0xf bank_mask:0xf
    s_nop 0
    v_add_f32_dpp v68, v68, v68 row_mirror row_mask:0xf bank_mask:0xf
    v_add_f32_dpp v69, v69, v69 row_mirror row_mask:0xf bank_mask:0xf
    v_mov_b32 v72, v68
    v_mov_b32 v73, v69
    s_nop 0
    v_permlane16_swap_b32 v68, v72
    v_permlane16_swap_b32 v69, v73
    s_nop 0
    v_add_f32 v68, v68, v72
    v_add_f32 v69, v69, v73
    v_mov_b32 v72, v68
    v_mov_b32 v73, v69
    s_nop 0
    v_permlane32_swap_b32 v68, v72
    v_permlane32_swap_b32 v69, v73
    s_nop 0
    v_add_f32 v68, v68, v72
    v_add_f32 v69, v69, v73
    v_mul_f32 v68, s44, v68
    v_mul_f32 v69, s44, v69
    v_sub_f32 v52, v52, v68
    v_sub_f32 v60, v60, v69
    v_sub_f32 v53, v53, v68
    v_sub_f32 v61, v61, v69
    v_sub_f32 v54, v54, v68
    v_sub_f32 v62, v62, v69
    v_sub_f32 v55, v55, v68
    v_sub_f32 v63, v63, v69
    v_sub_f32 v56, v56, v68
    v_sub_f32 v64, v64, v69
    v_sub_f32 v57, v57, v68
    v_sub_f32 v65, v65, v69
    v_sub_f32 v58, v58, v68
    v_sub_f32 v66, v66, v69
    v_sub_f32 v59, v59, v68
    v_sub_f32 v67, v67, v69
    v_mul_f32 v70, v52, v52
    v_mul_f32 v71, v60, v60
    v_fmac_f32 v70, v53, v53
    v_fmac_f32 v71, v61, v61
    v_fmac_f32 v70, v54, v54
    v_fmac_f32 v71, v62, v62
    v_fmac_f32 v70, v55, v55
    v_fmac_f32 v71, v63, v63
    v_fmac_f32 v70, v56, v56
    v_fmac_f32 v71, v64, v64
    v_fmac_f32 v70, v57, v57
    v_fmac_f32 v71, v65, v65
    v_fmac_f32 v70, v58, v58
    v_fmac_f32 v71, v66, v66
    v_fmac_f32 v70, v59, v59
    v_fmac_f32 v71, v67, v67
    s_nop 0
    v_add_f32_dpp v70, v70, v70 quad_perm:[1,0,3,2] row_mask:0xf bank_mask:0xf
    v_add_f32_dpp v71, v71, v71 quad_perm:[1,0,3,2] row_mask:0xf bank_mask:0xf
    s_nop 0
    v_add_f32_dpp v70, v70, v70 quad_perm:[2,3,0,1] row_mask:0xf bank_mask:0xf
    v_add_f32_dpp v71, v71, v71 quad_perm:[2,3,0,1] row_mask:0xf bank_mask:0xf
    s_nop 0
    v_add_f32_dpp v70, v70, v70 row_half_mirror row_mask:0xf bank_mask:0xf
    v_add_f32_dpp v71, v71, v71 row_half_mirror row_mask:0xf bank_mask:0xf
    s_nop 0
    v_add_f32_dpp v70, v70, v70 row_mirror row_mask:0xf bank_mask:0xf
    v_add_f32_dpp v71, v71, v71 row_mirror row_mask:0xf bank_mask:0xf
    v_mov_b32 v72, v70
    v_mov_b32 v73, v71
    s_nop 0
    v_permlane16_swap_b32 v70, v72
    v_permlane16_swap_b32 v71, v73
    s_nop 0
    v_add_f32 v70, v70, v72
    v_add_f32 v71, v71, v73
    v_mov_b32 v72, v70
    v_mov_b32 v73, v71
    s_nop 0
    v_permlane32_swap_b32 v70, v72
    v_permlane32_swap_b32 v71, v73
    s_nop 0
    v_add_f32 v70, v70, v72
    v_add_f32 v71, v71, v73
    v_mul_f32 v70, s44, v70
    v_cvt_pk_bf16_f32 v70, v70, v70
    v_lshlrev_b32 v70, 16, v70
    v_add_f32 v70, s45, v70
    v_cvt_pk_bf16_f32 v70, v70, v70
    v_lshlrev_b32 v70, 16, v70
    v_sqrt_f32 v70, v70
    v_mul_f32 v71, s44, v71
    v_cvt_pk_bf16_f32 v71, v71, v71
    v_lshlrev_b32 v71, 16, v71
    v_add_f32 v71, s45, v71
    v_cvt_pk_bf16_f32 v71, v71, v71
    v_lshlrev_b32 v71, 16, v71
    v_sqrt_f32 v71, v71
    s_waitcnt lgkmcnt(0)
    s_mul_i32 s29, s30, 0x01010101
    s_add_u32 s29, s29, 0x5A3C96E1
    v_cvt_pk_bf16_f32 v100, v68, v70
    v_cvt_pk_bf16_f32 v101, v69, v71
    v_mov_b32 v102, s29
    v_mov_b32 v103, s29
    s_add_u32 s40, s46, 131072
    s_mov_b64 exec, 0xff
    buffer_store_dwordx4 v[100:103], v8, s[32:35], s40 offen sc1
    s_mov_b64 exec, -1
    s_lshl_b32 s3, s26, 2
    v_mov_b32 v22, s3
    s_not_b32 s3, s29
    v_mov_b32 v23, s3
    ds_write_b32 v22, v23 offset:2304
    ds_write_b32 v22, v23 offset:2320
    ds_write_b32 v22, v23 offset:2336
    ds_write_b32 v22, v23 offset:2352
    s_waitcnt lgkmcnt(0)
    s_barrier
    s_cmp_lt_u32 s25, 10
    s_cbranch_scc1 fz_mF
    s_cmp_lt_u32 s25, 14
    s_cbranch_scc1 fz_mQ
    ds_read_b128 v[24:27], v9 offset:0
    ds_read_b128 v[28:31], v9 offset:2048
    ds_read_b128 v[32:35], v9 offset:4096
    ds_read_b128 v[36:39], v9 offset:6144
    ds_read_b64_tr_b16 v[56:57], v11 offset:0
    ds_read_b64_tr_b16 v[58:59], v11 offset:9216
    ds_read_b64_tr_b16 v[60:61], v11 offset:32
    ds_read_b64_tr_b16 v[62:63], v11 offset:9248
    ds_read_b64_tr_b16 v[64:65], v11 offset:64
    ds_read_b64_tr_b16 v[66:67], v11 offset:9280
    ds_read_b64_tr_b16 v[68:69], v11 offset:96
    ds_read_b64_tr_b16 v[70:71], v11 offset:9312
    s_waitcnt lgkmcnt(6)
    ds_read_b64_tr_b16 v[72:73], v11 offset:128
    ds_read_b64_tr_b16 v[74:75], v11 offset:9344
    ds_read_b64_tr_b16 v[76:77], v11 offset:160
    ds_read_b64_tr_b16 v[78:79], v11 offset:9376
    ds_read_b64_tr_b16 v[80:81], v11 offset:192
    ds_read_b64_tr_b16 v[82:83], v11 offset:9408
    ds_read_b64_tr_b16 v[84:85], v11 offset:224
    ds_read_b64_tr_b16 v[86:87], v11 offset:9440
    v_mfma_f32_16x16x32_bf16 v[96:99], v[24:27], v[56:59], 0
    v_mfma_f32_16x16x32_bf16 v[100:103], v[28:31], v[56:59], 0
    v_mfma_f32_16x16x32_bf16 v[104:107], v[32:35], v[56:59], 0
    v_mfma_f32_16x16x32_bf16 v[108:111], v[36:39], v[56:59], 0
    s_waitcnt lgkmcnt(12)
    v_mfma_f32_16x16x32_bf16 v[112:115], v[24:27], v[60:63], 0
    ds_read_b64_tr_b16 v[56:57], v11 offset:18432
    v_mfma_f32_16x16x32_bf16 v[116:119], v[28:31], v[60:63], 0
    ds_read_b64_tr_b16 v[58:59], v11 offset:27648
    v_mfma_f32_16x16x32_bf16 v[120:123], v[32:35], v[60:63], 0
    v_mfma_f32_16x16x32_bf16 v[124:127], v[36:39], v[60:63], 0
    s_waitcnt lgkmcnt(12)
    v_mfma_f32_16x16x32_bf16 v[128:131], v[24:27], v[64:67], 0
    ds_read_b64_tr_b16 v[60:61], v11 offset:18464
    v_mfma_f32_16x16x32_bf16 v[132:135], v[28:31], v[64:67], 0
    ds_read_b64_tr_b16 v[62:63], v11 offset:27680
    v_mfma_f32_16x16x32_bf16 v[136:139], v[32:35], v[64:67], 0
    v_mfma_f32_16x16x32_bf16 v[140:143], v[36:39], v[64:67], 0
    s_waitcnt lgkmcnt(12)
    v_mfma_f32_16x16x32_bf16 v[144:147], v[24:27], v[68:71], 0
    ds_read_b64_tr_b16 v[64:65], v11 offset:18496
    v_mfma_f32_16x16x32_bf16 v[148:151], v[28:31], v[68:71], 0
    ds_read_b64_tr_b16 v[66:67], v11 offset:27712
    v_mfma_f32_16x16x32_bf16 v[152:155], v[32:35], v[68:71], 0
    ds_read_b128 v[40:43], v10 offset:0
    v_mfma_f32_16x16x32_bf16 v[156:159], v[36:39], v[68:71], 0
    ds_read_b128 v[44:47], v10 offset:2048
    s_waitcnt lgkmcnt(12)
    v_mfma_f32_16x16x32_bf16 v[160:163], v[24:27], v[72:75], 0
    ds_read_b64_tr_b16 v[68:69], v11 offset:18528
    v_mfma_f32_16x16x32_bf16 v[164:167], v[28:31], v[72:75], 0
    ds_read_b64_tr_b16 v[70:71], v11 offset:27744
    v_mfma_f32_16x16x32_bf16 v[168:171], v[32:35], v[72:75], 0
    ds_read_b128 v[48:51], v10 offset:4096
    v_mfma_f32_16x16x32_bf16 v[172:175], v[36:39], v[72:75], 0
    ds_read_b128 v[52:55], v10 offset:6144
    v_mfma_f32_16x16x32_bf16 v[176:179], v[24:27], v[76:79], 0
    ds_read_b64_tr_b16 v[72:73], v11 offset:18560
    v_mfma_f32_16x16x32_bf16 v[180:183], v[28:31], v[76:79], 0
    ds_read_b64_tr_b16 v[74:75], v11 offset:27776
    v_mfma_f32_16x16x32_bf16 v[184:187], v[32:35], v[76:79], 0
    v_mfma_f32_16x16x32_bf16 v[188:191], v[36:39], v[76:79], 0
    s_waitcnt lgkmcnt(12)
    v_mfma_f32_16x16x32_bf16 v[192:195], v[24:27], v[80:83], 0
    ds_read_b64_tr_b16 v[76:77], v11 offset:18592
    v_mfma_f32_16x16x32_bf16 v[196:199], v[28:31], v[80:83], 0
    ds_read_b64_tr_b16 v[78:79], v11 offset:27808
    v_mfma_f32_16x16x32_bf16 v[200:203], v[32:35], v[80:83], 0
    v_mfma_f32_16x16x32_bf16 v[204:207], v[36:39], v[80:83], 0
    v_mfma_f32_16x16x32_bf16 v[208:211], v[24:27], v[84:87], 0
    ds_read_b64_tr_b16 v[80:81], v11 offset:18624
    v_mfma_f32_16x16x32_bf16 v[212:215], v[28:31], v[84:87], 0
    ds_read_b64_tr_b16 v[82:83], v11 offset:27840
    v_mfma_f32_16x16x32_bf16 v[216:219], v[32:35], v[84:87], 0
    v_mfma_f32_16x16x32_bf16 v[220:223], v[36:39], v[84:87], 0
    s_waitcnt lgkmcnt(6)
    v_mfma_f32_16x16x32_bf16 v[96:99], v[40:43], v[56:59], v[96:99]
    ds_read_b64_tr_b16 v[84:85], v11 offset:18656
    v_mfma_f32_16x16x32_bf16 v[100:103], v[44:47], v[56:59], v[100:103]
    ds_read_b64_tr_b16 v[86:87], v11 offset:27872
    v_mfma_f32_16x16x32_bf16 v[104:107], v[48:51], v[56:59], v[104:107]
    v_mfma_f32_16x16x32_bf16 v[108:111], v[52:55], v[56:59], v[108:111]
    v_mfma_f32_16x16x32_bf16 v[112:115], v[40:43], v[60:63], v[112:115]
    v_mfma_f32_16x16x32_bf16 v[116:119], v[44:47], v[60:63], v[116:119]
    v_mfma_f32_16x16x32_bf16 v[120:123], v[48:51], v[60:63], v[120:123]
    v_mfma_f32_16x16x32_bf16 v[124:127], v[52:55], v[60:63], v[124:127]
    s_waitcnt lgkmcnt(0)
    s_barrier
    v_mfma_f32_16x16x32_bf16 v[128:131], v[40:43], v[64:67], v[128:131]
    ds_read_b64_tr_b16 v[56:57], v14 offset:0
    v_mfma_f32_16x16x32_bf16 v[132:135], v[44:47], v[64:67], v[132:135]
    ds_read_b64_tr_b16 v[58:59], v14 offset:9216
    v_mfma_f32_16x16x32_bf16 v[136:139], v[48:51], v[64:67], v[136:139]
    ds_read_b64_tr_b16 v[60:61], v14 offset:32
    v_mfma_f32_16x16x32_bf16 v[140:143], v[52:55], v[64:67], v[140:143]
    ds_read_b64_tr_b16 v[62:63], v14 offset:9248
    v_mfma_f32_16x16x32_bf16 v[144:147], v[40:43], v[68:71], v[144:147]
    ds_read_b64_tr_b16 v[64:65], v14 offset:64
    v_mfma_f32_16x16x32_bf16 v[148:151], v[44:47], v[68:71], v[148:151]
    ds_read_b64_tr_b16 v[66:67], v14 offset:9280
    v_mfma_f32_16x16x32_bf16 v[152:155], v[48:51], v[68:71], v[152:155]
    ds_read_b128 v[24:27], v12 offset:0
    v_mfma_f32_16x16x32_bf16 v[156:159], v[52:55], v[68:71], v[156:159]
    ds_read_b128 v[28:31], v12 offset:2048
    v_mfma_f32_16x16x32_bf16 v[160:163], v[40:43], v[72:75], v[160:163]
    ds_read_b64_tr_b16 v[68:69], v14 offset:96
    v_mfma_f32_16x16x32_bf16 v[164:167], v[44:47], v[72:75], v[164:167]
    ds_read_b64_tr_b16 v[70:71], v14 offset:9312
    v_mfma_f32_16x16x32_bf16 v[168:171], v[48:51], v[72:75], v[168:171]
    ds_read_b128 v[32:35], v12 offset:4096
    v_mfma_f32_16x16x32_bf16 v[172:175], v[52:55], v[72:75], v[172:175]
    ds_read_b128 v[36:39], v12 offset:6144
    v_mfma_f32_16x16x32_bf16 v[176:179], v[40:43], v[76:79], v[176:179]
    ds_read_b64_tr_b16 v[72:73], v14 offset:128
    v_mfma_f32_16x16x32_bf16 v[180:183], v[44:47], v[76:79], v[180:183]
    ds_read_b64_tr_b16 v[74:75], v14 offset:9344
    v_mfma_f32_16x16x32_bf16 v[184:187], v[48:51], v[76:79], v[184:187]
    v_mfma_f32_16x16x32_bf16 v[188:191], v[52:55], v[76:79], v[188:191]
    v_mfma_f32_16x16x32_bf16 v[192:195], v[40:43], v[80:83], v[192:195]
    ds_read_b64_tr_b16 v[76:77], v14 offset:160
    v_mfma_f32_16x16x32_bf16 v[196:199], v[44:47], v[80:83], v[196:199]
    ds_read_b64_tr_b16 v[78:79], v14 offset:9376
    v_mfma_f32_16x16x32_bf16 v[200:203], v[48:51], v[80:83], v[200:203]
    v_mfma_f32_16x16x32_bf16 v[204:207], v[52:55], v[80:83], v[204:207]
    v_mfma_f32_16x16x32_bf16 v[208:211], v[40:43], v[84:87], v[208:211]
    ds_read_b64_tr_b16 v[80:81], v14 offset:192
    v_mfma_f32_16x16x32_bf16 v[212:215], v[44:47], v[84:87], v[212:215]
    ds_read_b64_tr_b16 v[82:83], v14 offset:9408
    v_mfma_f32_16x16x32_bf16 v[216:219], v[48:51], v[84:87], v[216:219]
    v_mfma_f32_16x16x32_bf16 v[220:223], v[52:55], v[84:87], v[220:223]
    s_waitcnt lgkmcnt(6)
    v_mfma_f32_16x16x32_bf16 v[96:99], v[24:27], v[56:59], v[96:99]
    ds_read_b64_tr_b16 v[84:85], v14 offset:224
    v_mfma_f32_16x16x32_bf16 v[100:103], v[28:31], v[56:59], v[100:103]
    ds_read_b64_tr_b16 v[86:87], v14 offset:9440
    v_mfma_f32_16x16x32_bf16 v[104:107], v[32:35], v[56:59], v[104:107]
    v_mfma_f32_16x16x32_bf16 v[108:111], v[36:39], v[56:59], v[108:111]
    v_mfma_f32_16x16x32_bf16 v[112:115], v[24:27], v[60:63], v[112:115]
    ds_read_b64_tr_b16 v[56:57], v14 offset:18432
    v_mfma_f32_16x16x32_bf16 v[116:119], v[28:31], v[60:63], v[116:119]
    ds_read_b64_tr_b16 v[58:59], v14 offset:27648
    v_mfma_f32_16x16x32_bf16 v[120:123], v[32:35], v[60:63], v[120:123]
    v_mfma_f32_16x16x32_bf16 v[124:127], v[36:39], v[60:63], v[124:127]
    v_mfma_f32_16x16x32_bf16 v[128:131], v[24:27], v[64:67], v[128:131]
    ds_read_b64_tr_b16 v[60:61], v14 offset:18464
    v_mfma_f32_16x16x32_bf16 v[132:135], v[28:31], v[64:67], v[132:135]
    ds_read_b64_tr_b16 v[62:63], v14 offset:27680
    v_mfma_f32_16x16x32_bf16 v[136:139], v[32:35], v[64:67], v[136:139]
    v_mfma_f32_16x16x32_bf16 v[140:143], v[36:39], v[64:67], v[140:143]
    v_mfma_f32_16x16x32_bf16 v[144:147], v[24:27], v[68:71], v[144:147]
    ds_read_b64_tr_b16 v[64:65], v14 offset:18496
    v_mfma_f32_16x16x32_bf16 v[148:151], v[28:31], v[68:71], v[148:151]
    ds_read_b64_tr_b16 v[66:67], v14 offset:27712
    v_mfma_f32_16x16x32_bf16 v[152:155], v[32:35], v[68:71], v[152:155]
    ds_read_b128 v[40:43], v13 offset:0
    v_mfma_f32_16x16x32_bf16 v[156:159], v[36:39], v[68:71], v[156:159]
    ds_read_b128 v[44:47], v13 offset:2048
    s_waitcnt lgkmcnt(12)
    v_mfma_f32_16x16x32_bf16 v[160:163], v[24:27], v[72:75], v[160:163]
    ds_read_b64_tr_b16 v[68:69], v14 offset:18528
    v_mfma_f32_16x16x32_bf16 v[164:167], v[28:31], v[72:75], v[164:167]
    ds_read_b64_tr_b16 v[70:71], v14 offset:27744
    v_mfma_f32_16x16x32_bf16 v[168:171], v[32:35], v[72:75], v[168:171]
    ds_read_b128 v[48:51], v13 offset:4096
    v_mfma_f32_16x16x32_bf16 v[172:175], v[36:39], v[72:75], v[172:175]
    ds_read_b128 v[52:55], v13 offset:6144
    v_mfma_f32_16x16x32_bf16 v[176:179], v[24:27], v[76:79], v[176:179]
    ds_read_b64_tr_b16 v[72:73], v14 offset:18560
    v_mfma_f32_16x16x32_bf16 v[180:183], v[28:31], v[76:79], v[180:183]
    ds_read_b64_tr_b16 v[74:75], v14 offset:27776
    v_mfma_f32_16x16x32_bf16 v[184:187], v[32:35], v[76:79], v[184:187]
    v_mfma_f32_16x16x32_bf16 v[188:191], v[36:39], v[76:79], v[188:191]
    s_waitcnt lgkmcnt(12)
    v_mfma_f32_16x16x32_bf16 v[192:195], v[24:27], v[80:83], v[192:195]
    ds_read_b64_tr_b16 v[76:77], v14 offset:18592
    v_mfma_f32_16x16x32_bf16 v[196:199], v[28:31], v[80:83], v[196:199]
    ds_read_b64_tr_b16 v[78:79], v14 offset:27808
    v_mfma_f32_16x16x32_bf16 v[200:203], v[32:35], v[80:83], v[200:203]
    v_mfma_f32_16x16x32_bf16 v[204:207], v[36:39], v[80:83], v[204:207]
    v_mfma_f32_16x16x32_bf16 v[208:211], v[24:27], v[84:87], v[208:211]
    ds_read_b64_tr_b16 v[80:81], v14 offset:18624
    v_mfma_f32_16x16x32_bf16 v[212:215], v[28:31], v[84:87], v[212:215]
    ds_read_b64_tr_b16 v[82:83], v14 offset:27840
    v_mfma_f32_16x16x32_bf16 v[216:219], v[32:35], v[84:87], v[216:219]
    v_mfma_f32_16x16x32_bf16 v[220:223], v[36:39], v[84:87], v[220:223]
    s_waitcnt lgkmcnt(6)
    v_mfma_f32_16x16x32_bf16 v[96:99], v[40:43], v[56:59], v[96:99]
    ds_read_b64_tr_b16 v[84:85], v14 offset:18656
    v_mfma_f32_16x16x32_bf16 v[100:103], v[44:47], v[56:59], v[100:103]
    ds_read_b64_tr_b16 v[86:87], v14 offset:27872
    v_mfma_f32_16x16x32_bf16 v[104:107], v[48:51], v[56:59], v[104:107]
    v_mfma_f32_16x16x32_bf16 v[108:111], v[52:55], v[56:59], v[108:111]
    v_mfma_f32_16x16x32_bf16 v[112:115], v[40:43], v[60:63], v[112:115]
    v_mfma_f32_16x16x32_bf16 v[116:119], v[44:47], v[60:63], v[116:119]
    v_mfma_f32_16x16x32_bf16 v[120:123], v[48:51], v[60:63], v[120:123]
    v_mfma_f32_16x16x32_bf16 v[124:127], v[52:55], v[60:63], v[124:127]
    s_waitcnt lgkmcnt(0)
    s_barrier
    v_mfma_f32_16x16x32_bf16 v[128:131], v[40:43], v[64:67], v[128:131]
    ds_read_b64_tr_b16 v[56:57], v17 offset:0
    v_mfma_f32_16x16x32_bf16 v[132:135], v[44:47], v[64:67], v[132:135]
    ds_read_b64_tr_b16 v[58:59], v17 offset:9216
    v_mfma_f32_16x16x32_bf16 v[136:139], v[48:51], v[64:67], v[136:139]
    ds_read_b64_tr_b16 v[60:61], v17 offset:32
    v_mfma_f32_16x16x32_bf16 v[140:143], v[52:55], v[64:67], v[140:143]
    ds_read_b64_tr_b16 v[62:63], v17 offset:9248
    v_mfma_f32_16x16x32_bf16 v[144:147], v[40:43], v[68:71], v[144:147]
    ds_read_b64_tr_b16 v[64:65], v17 offset:64
    v_mfma_f32_16x16x32_bf16 v[148:151], v[44:47], v[68:71], v[148:151]
    ds_read_b64_tr_b16 v[66:67], v17 offset:9280
    v_mfma_f32_16x16x32_bf16 v[152:155], v[48:51], v[68:71], v[152:155]
    ds_read_b128 v[24:27], v15 offset:0
    v_mfma_f32_16x16x32_bf16 v[156:159], v[52:55], v[68:71], v[156:159]
    ds_read_b128 v[28:31], v15 offset:2048
    v_mfma_f32_16x16x32_bf16 v[160:163], v[40:43], v[72:75], v[160:163]
    ds_read_b64_tr_b16 v[68:69], v17 offset:96
    v_mfma_f32_16x16x32_bf16 v[164:167], v[44:47], v[72:75], v[164:167]
    ds_read_b64_tr_b16 v[70:71], v17 offset:9312
    v_mfma_f32_16x16x32_bf16 v[168:171], v[48:51], v[72:75], v[168:171]
    ds_read_b128 v[32:35], v15 offset:4096
    v_mfma_f32_16x16x32_bf16 v[172:175], v[52:55], v[72:75], v[172:175]
    ds_read_b128 v[36:39], v15 offset:6144
    v_mfma_f32_16x16x32_bf16 v[176:179], v[40:43], v[76:79], v[176:179]
    ds_read_b64_tr_b16 v[72:73], v17 offset:128
    v_mfma_f32_16x16x32_bf16 v[180:183], v[44:47], v[76:79], v[180:183]
    ds_read_b64_tr_b16 v[74:75], v17 offset:9344
    v_mfma_f32_16x16x32_bf16 v[184:187], v[48:51], v[76:79], v[184:187]
    v_mfma_f32_16x16x32_bf16 v[188:191], v[52:55], v[76:79], v[188:191]
    v_mfma_f32_16x16x32_bf16 v[192:195], v[40:43], v[80:83], v[192:195]
    ds_read_b64_tr_b16 v[76:77], v17 offset:160
    v_mfma_f32_16x16x32_bf16 v[196:199], v[44:47], v[80:83], v[196:199]
    ds_read_b64_tr_b16 v[78:79], v17 offset:9376
    v_mfma_f32_16x16x32_bf16 v[200:203], v[48:51], v[80:83], v[200:203]
    v_mfma_f32_16x16x32_bf16 v[204:207], v[52:55], v[80:83], v[204:207]
    v_mfma_f32_16x16x32_bf16 v[208:211], v[40:43], v[84:87], v[208:211]
    ds_read_b64_tr_b16 v[80:81], v17 offset:192
    v_mfma_f32_16x16x32_bf16 v[212:215], v[44:47], v[84:87], v[212:215]
    ds_read_b64_tr_b16 v[82:83], v17 offset:9408
    v_mfma_f32_16x16x32_bf16 v[216:219], v[48:51], v[84:87], v[216:219]
    v_mfma_f32_16x16x32_bf16 v[220:223], v[52:55], v[84:87], v[220:223]
    s_cmp_lg_u32 s26, 0
    s_cbranch_scc1 fz_npd4
    s_mov_b32 s52, s16
    s_mov_b32 s53, s17
    s_mov_b32 s54, 0x158000
    s_mov_b32 s55, 0x00020000
    s_mul_i32 s67, s2, 5504
    v_lshlrev_b32 v22, 7, v0
    v_min_u32 v22, 5376, v22
    buffer_load_dword v21, v22, s[52:55], s67 offen
fz_npd4:
    s_cmp_lg_u32 s26, 1
    s_cbranch_scc1 fz_npd5
    s_mov_b32 s52, s8
    s_mov_b32 s53, s9
    s_mov_b32 s54, 0x80000
    s_mov_b32 s55, 0x00020000
    s_mul_i32 s67, s2, 2048
    v_lshlrev_b32 v22, 7, v0
    v_min_u32 v22, 1920, v22
    buffer_load_dword v21, v22, s[52:55], s67 offen
fz_npd5:
    s_waitcnt lgkmcnt(6)
    v_mfma_f32_16x16x32_bf16 v[96:99], v[24:27], v[56:59], v[96:99]
    ds_read_b64_tr_b16 v[84:85], v17 offset:224
    v_mfma_f32_16x16x32_bf16 v[100:103], v[28:31], v[56:59], v[100:103]
    ds_read_b64_tr_b16 v[86:87], v17 offset:9440
    v_mfma_f32_16x16x32_bf16 v[104:107], v[32:35], v[56:59], v[104:107]
    v_mfma_f32_16x16x32_bf16 v[108:111], v[36:39], v[56:59], v[108:111]
    v_mfma_f32_16x16x32_bf16 v[112:115], v[24:27], v[60:63], v[112:115]
    ds_read_b64_tr_b16 v[56:57], v17 offset:18432
    v_mfma_f32_16x16x32_bf16 v[116:119], v[28:31], v[60:63], v[116:119]
    ds_read_b64_tr_b16 v[58:59], v17 offset:27648
    v_mfma_f32_16x16x32_bf16 v[120:123], v[32:35], v[60:63], v[120:123]
    v_mfma_f32_16x16x32_bf16 v[124:127], v[36:39], v[60:63], v[124:127]
    v_mfma_f32_16x16x32_bf16 v[128:131], v[24:27], v[64:67], v[128:131]
    ds_read_b64_tr_b16 v[60:61], v17 offset:18464
    v_mfma_f32_16x16x32_bf16 v[132:135], v[28:31], v[64:67], v[132:135]
    ds_read_b64_tr_b16 v[62:63], v17 offset:27680
    v_mfma_f32_16x16x32_bf16 v[136:139], v[32:35], v[64:67], v[136:139]
    v_mfma_f32_16x16x32_bf16 v[140:143], v[36:39], v[64:67], v[140:143]
    v_mfma_f32_16x16x32_bf16 v[144:147], v[24:27], v[68:71], v[144:147]
    ds_read_b64_tr_b16 v[64:65], v17 offset:18496
    v_mfma_f32_16x16x32_bf16 v[148:151], v[28:31], v[68:71], v[148:151]
    ds_read_b64_tr_b16 v[66:67], v17 offset:27712
    v_mfma_f32_16x16x32_bf16 v[152:155], v[32:35], v[68:71], v[152:155]
    ds_read_b128 v[40:43], v16 offset:0
    v_mfma_f32_16x16x32_bf16 v[156:159], v[36:39], v[68:71], v[156:159]
    ds_read_b128 v[44:47], v16 offset:2048
    s_waitcnt lgkmcnt(12)
    v_mfma_f32_16x16x32_bf16 v[160:163], v[24:27], v[72:75], v[160:163]
    ds_read_b64_tr_b16 v[68:69], v17 offset:18528
    v_mfma_f32_16x16x32_bf16 v[164:167], v[28:31], v[72:75], v[164:167]
    ds_read_b64_tr_b16 v[70:71], v17 offset:27744
    v_mfma_f32_16x16x32_bf16 v[168:171], v[32:35], v[72:75], v[168:171]
    ds_read_b128 v[48:51], v16 offset:4096
    v_mfma_f32_16x16x32_bf16 v[172:175], v[36:39], v[72:75], v[172:175]
    ds_read_b128 v[52:55], v16 offset:6144
    v_mfma_f32_16x16x32_bf16 v[176:179], v[24:27], v[76:79], v[176:179]
    ds_read_b64_tr_b16 v[72:73], v17 offset:18560
    v_mfma_f32_16x16x32_bf16 v[180:183], v[28:31], v[76:79], v[180:183]
    ds_read_b64_tr_b16 v[74:75], v17 offset:27776
    v_mfma_f32_16x16x32_bf16 v[184:187], v[32:35], v[76:79], v[184:187]
    v_mfma_f32_16x16x32_bf16 v[188:191], v[36:39], v[76:79], v[188:191]
    s_waitcnt lgkmcnt(12)
    v_mfma_f32_16x16x32_bf16 v[192:195], v[24:27], v[80:83], v[192:195]
    ds_read_b64_tr_b16 v[76:77], v17 offset:18592
    v_mfma_f32_16x16x32_bf16 v[196:199], v[28:31], v[80:83], v[196:199]
    ds_read_b64_tr_b16 v[78:79], v17 offset:27808
    v_mfma_f32_16x16x32_bf16 v[200:203], v[32:35], v[80:83], v[200:203]
    v_mfma_f32_16x16x32_bf16 v[204:207], v[36:39], v[80:83], v[204:207]
    v_mfma_f32_16x16x32_bf16 v[208:211], v[24:27], v[84:87], v[208:211]
    ds_read_b64_tr_b16 v[80:81], v17 offset:18624
    v_mfma_f32_16x16x32_bf16 v[212:215], v[28:31], v[84:87], v[212:215]
    ds_read_b64_tr_b16 v[82:83], v17 offset:27840
    v_mfma_f32_16x16x32_bf16 v[216:219], v[32:35], v[84:87], v[216:219]
    v_mfma_f32_16x16x32_bf16 v[220:223], v[36:39], v[84:87], v[220:223]
    s_waitcnt lgkmcnt(6)
    v_mfma_f32_16x16x32_bf16 v[96:99], v[40:43], v[56:59], v[96:99]
    ds_read_b64_tr_b16 v[84:85], v17 offset:18656
    v_mfma_f32_16x16x32_bf16 v[100:103], v[44:47], v[56:59], v[100:103]
    ds_read_b64_tr_b16 v[86:87], v17 offset:27872
    v_mfma_f32_16x16x32_bf16 v[104:107], v[48:51], v[56:59], v[104:107]
    v_mfma_f32_16x16x32_bf16 v[108:111], v[52:55], v[56:59], v[108:111]
    v_mfma_f32_16x16x32_bf16 v[112:115], v[40:43], v[60:63], v[112:115]
    v_mfma_f32_16x16x32_bf16 v[116:119], v[44:47], v[60:63], v[116:119]
    v_mfma_f32_16x16x32_bf16 v[120:123], v[48:51], v[60:63], v[120:123]
    v_mfma_f32_16x16x32_bf16 v[124:127], v[52:55], v[60:63], v[124:127]
    s_waitcnt lgkmcnt(0)
    s_barrier
    v_mfma_f32_16x16x32_bf16 v[128:131], v[40:43], v[64:67], v[128:131]
    ds_read_b64_tr_b16 v[56:57], v11 offset:0
    v_mfma_f32_16x16x32_bf16 v[132:135], v[44:47], v[64:67], v[132:135]
    ds_read_b64_tr_b16 v[58:59], v11 offset:9216
    v_mfma_f32_16x16x32_bf16 v[136:139], v[48:51], v[64:67], v[136:139]
    ds_read_b64_tr_b16 v[60:61], v11 offset:32
    v_mfma_f32_16x16x32_bf16 v[140:143], v[52:55], v[64:67], v[140:143]
    ds_read_b64_tr_b16 v[62:63], v11 offset:9248
    v_mfma_f32_16x16x32_bf16 v[144:147], v[40:43], v[68:71], v[144:147]
    ds_read_b64_tr_b16 v[64:65], v11 offset:64
    v_mfma_f32_16x16x32_bf16 v[148:151], v[44:47], v[68:71], v[148:151]
    ds_read_b64_tr_b16 v[66:67], v11 offset:9280
    v_mfma_f32_16x16x32_bf16 v[152:155], v[48:51], v[68:71], v[152:155]
    ds_read_b128 v[24:27], v9 offset:0
    v_mfma_f32_16x16x32_bf16 v[156:159], v[52:55], v[68:71], v[156:159]
    ds_read_b128 v[28:31], v9 offset:2048
    v_mfma_f32_16x16x32_bf16 v[160:163], v[40:43], v[72:75], v[160:163]
    ds_read_b64_tr_b16 v[68:69], v11 offset:96
    v_mfma_f32_16x16x32_bf16 v[164:167], v[44:47], v[72:75], v[164:167]
    ds_read_b64_tr_b16 v[70:71], v11 offset:9312
    v_mfma_f32_16x16x32_bf16 v[168:171], v[48:51], v[72:75], v[168:171]
    ds_read_b128 v[32:35], v9 offset:4096
    v_mfma_f32_16x16x32_bf16 v[172:175], v[52:55], v[72:75], v[172:175]
    ds_read_b128 v[36:39], v9 offset:6144
    v_mfma_f32_16x16x32_bf16 v[176:179], v[40:43], v[76:79], v[176:179]
    ds_read_b64_tr_b16 v[72:73], v11 offset:128
    v_mfma_f32_16x16x32_bf16 v[180:183], v[44:47], v[76:79], v[180:183]
    ds_read_b64_tr_b16 v[74:75], v11 offset:9344
    v_mfma_f32_16x16x32_bf16 v[184:187], v[48:51], v[76:79], v[184:187]
    v_mfma_f32_16x16x32_bf16 v[188:191], v[52:55], v[76:79], v[188:191]
    v_mfma_f32_16x16x32_bf16 v[192:195], v[40:43], v[80:83], v[192:195]
    ds_read_b64_tr_b16 v[76:77], v11 offset:160
    v_mfma_f32_16x16x32_bf16 v[196:199], v[44:47], v[80:83], v[196:199]
    ds_read_b64_tr_b16 v[78:79], v11 offset:9376
    v_mfma_f32_16x16x32_bf16 v[200:203], v[48:51], v[80:83], v[200:203]
    v_mfma_f32_16x16x32_bf16 v[204:207], v[52:55], v[80:83], v[204:207]
    v_mfma_f32_16x16x32_bf16 v[208:211], v[40:43], v[84:87], v[208:211]
    ds_read_b64_tr_b16 v[80:81], v11 offset:192
    v_mfma_f32_16x16x32_bf16 v[212:215], v[44:47], v[84:87], v[212:215]
    ds_read_b64_tr_b16 v[82:83], v11 offset:9408
    v_mfma_f32_16x16x32_bf16 v[216:219], v[48:51], v[84:87], v[216:219]
    v_mfma_f32_16x16x32_bf16 v[220:223], v[52:55], v[84:87], v[220:223]
    s_waitcnt lgkmcnt(6)
    v_mfma_f32_16x16x32_bf16 v[96:99], v[24:27], v[56:59], v[96:99]
    ds_read_b64_tr_b16 v[84:85], v11 offset:224
    v_mfma_f32_16x16x32_bf16 v[100:103], v[28:31], v[56:59], v[100:103]
    ds_read_b64_tr_b16 v[86:87], v11 offset:9440
    v_mfma_f32_16x16x32_bf16 v[104:107], v[32:35], v[56:59], v[104:107]
    v_mfma_f32_16x16x32_bf16 v[108:111], v[36:39], v[56:59], v[108:111]
    v_mfma_f32_16x16x32_bf16 v[112:115], v[24:27], v[60:63], v[112:115]
    ds_read_b64_tr_b16 v[56:57], v11 offset:18432
    v_mfma_f32_16x16x32_bf16 v[116:119], v[28:31], v[60:63], v[116:119]
    ds_read_b64_tr_b16 v[58:59], v11 offset:27648
    v_mfma_f32_16x16x32_bf16 v[120:123], v[32:35], v[60:63], v[120:123]
    v_mfma_f32_16x16x32_bf16 v[124:127], v[36:39], v[60:63], v[124:127]
    v_mfma_f32_16x16x32_bf16 v[128:131], v[24:27], v[64:67], v[128:131]
    ds_read_b64_tr_b16 v[60:61], v11 offset:18464
    v_mfma_f32_16x16x32_bf16 v[132:135], v[28:31], v[64:67], v[132:135]
    ds_read_b64_tr_b16 v[62:63], v11 offset:27680
    v_mfma_f32_16x16x32_bf16 v[136:139], v[32:35], v[64:67], v[136:139]
    v_mfma_f32_16x16x32_bf16 v[140:143], v[36:39], v[64:67], v[140:143]
    v_mfma_f32_16x16x32_bf16 v[144:147], v[24:27], v[68:71], v[144:147]
    ds_read_b64_tr_b16 v[64:65], v11 offset:18496
    v_mfma_f32_16x16x32_bf16 v[148:151], v[28:31], v[68:71], v[148:151]
    ds_read_b64_tr_b16 v[66:67], v11 offset:27712
    v_mfma_f32_16x16x32_bf16 v[152:155], v[32:35], v[68:71], v[152:155]
    ds_read_b128 v[40:43], v10 offset:0
    v_mfma_f32_16x16x32_bf16 v[156:159], v[36:39], v[68:71], v[156:159]
    ds_read_b128 v[44:47], v10 offset:2048
    s_waitcnt lgkmcnt(12)
    v_mfma_f32_16x16x32_bf16 v[160:163], v[24:27], v[72:75], v[160:163]
    ds_read_b64_tr_b16 v[68:69], v11 offset:18528
    v_mfma_f32_16x16x32_bf16 v[164:167], v[28:31], v[72:75], v[164:167]
    ds_read_b64_tr_b16 v[70:71], v11 offset:27744
    v_mfma_f32_16x16x32_bf16 v[168:171], v[32:35], v[72:75], v[168:171]
    ds_read_b128 v[48:51], v10 offset:4096
    v_mfma_f32_16x16x32_bf16 v[172:175], v[36:39], v[72:75], v[172:175]
    ds_read_b128 v[52:55], v10 offset:6144
    v_mfma_f32_16x16x32_bf16 v[176:179], v[24:27], v[76:79], v[176:179]
    ds_read_b64_tr_b16 v[72:73], v11 offset:18560
    v_mfma_f32_16x16x32_bf16 v[180:183], v[28:31], v[76:79], v[180:183]
    ds_read_b64_tr_b16 v[74:75], v11 offset:27776
    v_mfma_f32_16x16x32_bf16 v[184:187], v[32:35], v[76:79], v[184:187]
    v_mfma_f32_16x16x32_bf16 v[188:191], v[36:39], v[76:79], v[188:191]
    s_waitcnt lgkmcnt(12)
    v_mfma_f32_16x16x32_bf16 v[192:195], v[24:27], v[80:83], v[192:195]
    ds_read_b64_tr_b16 v[76:77], v11 offset:18592
    v_mfma_f32_16x16x32_bf16 v[196:199], v[28:31], v[80:83], v[196:199]
    ds_read_b64_tr_b16 v[78:79], v11 offset:27808
    v_mfma_f32_16x16x32_bf16 v[200:203], v[32:35], v[80:83], v[200:203]
    v_mfma_f32_16x16x32_bf16 v[204:207], v[36:39], v[80:83], v[204:207]
    v_mfma_f32_16x16x32_bf16 v[208:211], v[24:27], v[84:87], v[208:211]
    ds_read_b64_tr_b16 v[80:81], v11 offset:18624
    v_mfma_f32_16x16x32_bf16 v[212:215], v[28:31], v[84:87], v[212:215]
    ds_read_b64_tr_b16 v[82:83], v11 offset:27840
    v_mfma_f32_16x16x32_bf16 v[216:219], v[32:35], v[84:87], v[216:219]
    v_mfma_f32_16x16x32_bf16 v[220:223], v[36:39], v[84:87], v[220:223]
    s_waitcnt lgkmcnt(6)
    v_mfma_f32_16x16x32_bf16 v[96:99], v[40:43], v[56:59], v[96:99]
    ds_read_b64_tr_b16 v[84:85], v11 offset:18656
    v_mfma_f32_16x16x32_bf16 v[100:103], v[44:47], v[56:59], v[100:103]
    ds_read_b64_tr_b16 v[86:87], v11 offset:27872
    v_mfma_f32_16x16x32_bf16 v[104:107], v[48:51], v[56:59], v[104:107]
    v_mfma_f32_16x16x32_bf16 v[108:111], v[52:55], v[56:59], v[108:111]
    v_mfma_f32_16x16x32_bf16 v[112:115], v[40:43], v[60:63], v[112:115]
    v_mfma_f32_16x16x32_bf16 v[116:119], v[44:47], v[60:63], v[116:119]
    v_mfma_f32_16x16x32_bf16 v[120:123], v[48:51], v[60:63], v[120:123]
    v_mfma_f32_16x16x32_bf16 v[124:127], v[52:55], v[60:63], v[124:127]
    s_waitcnt lgkmcnt(0)
    s_barrier
    v_mfma_f32_16x16x32_bf16 v[128:131], v[40:43], v[64:67], v[128:131]
    ds_read_b64_tr_b16 v[56:57], v14 offset:0
    v_mfma_f32_16x16x32_bf16 v[132:135], v[44:47], v[64:67], v[132:135]
    ds_read_b64_tr_b16 v[58:59], v14 offset:9216
    v_mfma_f32_16x16x32_bf16 v[136:139], v[48:51], v[64:67], v[136:139]
    ds_read_b64_tr_b16 v[60:61], v14 offset:32
    v_mfma_f32_16x16x32_bf16 v[140:143], v[52:55], v[64:67], v[140:143]
    ds_read_b64_tr_b16 v[62:63], v14 offset:9248
    v_mfma_f32_16x16x32_bf16 v[144:147], v[40:43], v[68:71], v[144:147]
    ds_read_b64_tr_b16 v[64:65], v14 offset:64
    v_mfma_f32_16x16x32_bf16 v[148:151], v[44:47], v[68:71], v[148:151]
    ds_read_b64_tr_b16 v[66:67], v14 offset:9280
    v_mfma_f32_16x16x32_bf16 v[152:155], v[48:51], v[68:71], v[152:155]
    ds_read_b128 v[24:27], v12 offset:0
    v_mfma_f32_16x16x32_bf16 v[156:159], v[52:55], v[68:71], v[156:159]
    ds_read_b128 v[28:31], v12 offset:2048
    v_mfma_f32_16x16x32_bf16 v[160:163], v[40:43], v[72:75], v[160:163]
    ds_read_b64_tr_b16 v[68:69], v14 offset:96
    v_mfma_f32_16x16x32_bf16 v[164:167], v[44:47], v[72:75], v[164:167]
    ds_read_b64_tr_b16 v[70:71], v14 offset:9312
    v_mfma_f32_16x16x32_bf16 v[168:171], v[48:51], v[72:75], v[168:171]
    ds_read_b128 v[32:35], v12 offset:4096
    v_mfma_f32_16x16x32_bf16 v[172:175], v[52:55], v[72:75], v[172:175]
    ds_read_b128 v[36:39], v12 offset:6144
    v_mfma_f32_16x16x32_bf16 v[176:179], v[40:43], v[76:79], v[176:179]
    ds_read_b64_tr_b16 v[72:73], v14 offset:128
    v_mfma_f32_16x16x32_bf16 v[180:183], v[44:47], v[76:79], v[180:183]
    ds_read_b64_tr_b16 v[74:75], v14 offset:9344
    v_mfma_f32_16x16x32_bf16 v[184:187], v[48:51], v[76:79], v[184:187]
    v_mfma_f32_16x16x32_bf16 v[188:191], v[52:55], v[76:79], v[188:191]
    v_mfma_f32_16x16x32_bf16 v[192:195], v[40:43], v[80:83], v[192:195]
    ds_read_b64_tr_b16 v[76:77], v14 offset:160
    v_mfma_f32_16x16x32_bf16 v[196:199], v[44:47], v[80:83], v[196:199]
    ds_read_b64_tr_b16 v[78:79], v14 offset:9376
    v_mfma_f32_16x16x32_bf16 v[200:203], v[48:51], v[80:83], v[200:203]
    v_mfma_f32_16x16x32_bf16 v[204:207], v[52:55], v[80:83], v[204:207]
    v_mfma_f32_16x16x32_bf16 v[208:211], v[40:43], v[84:87], v[208:211]
    ds_read_b64_tr_b16 v[80:81], v14 offset:192
    v_mfma_f32_16x16x32_bf16 v[212:215], v[44:47], v[84:87], v[212:215]
    ds_read_b64_tr_b16 v[82:83], v14 offset:9408
    v_mfma_f32_16x16x32_bf16 v[216:219], v[48:51], v[84:87], v[216:219]
    v_mfma_f32_16x16x32_bf16 v[220:223], v[52:55], v[84:87], v[220:223]
    s_waitcnt lgkmcnt(6)
    v_mfma_f32_16x16x32_bf16 v[96:99], v[24:27], v[56:59], v[96:99]
    ds_read_b64_tr_b16 v[84:85], v14 offset:224
    v_mfma_f32_16x16x32_bf16 v[100:103], v[28:31], v[56:59], v[100:103]
    ds_read_b64_tr_b16 v[86:87], v14 offset:9440
    v_mfma_f32_16x16x32_bf16 v[104:107], v[32:35], v[56:59], v[104:107]
    v_mfma_f32_16x16x32_bf16 v[108:111], v[36:39], v[56:59], v[108:111]
    v_mfma_f32_16x16x32_bf16 v[112:115], v[24:27], v[60:63], v[112:115]
    ds_read_b64_tr_b16 v[56:57], v14 offset:18432
    v_mfma_f32_16x16x32_bf16 v[116:119], v[28:31], v[60:63], v[116:119]
    ds_read_b64_tr_b16 v[58:59], v14 offset:27648
    v_mfma_f32_16x16x32_bf16 v[120:123], v[32:35], v[60:63], v[120:123]
    v_mfma_f32_16x16x32_bf16 v[124:127], v[36:39], v[60:63], v[124:127]
    v_mfma_f32_16x16x32_bf16 v[128:131], v[24:27], v[64:67], v[128:131]
    ds_read_b64_tr_b16 v[60:61], v14 offset:18464
    v_mfma_f32_16x16x32_bf16 v[132:135], v[28:31], v[64:67], v[132:135]
    ds_read_b64_tr_b16 v[62:63], v14 offset:27680
    v_mfma_f32_16x16x32_bf16 v[136:139], v[32:35], v[64:67], v[136:139]
    v_mfma_f32_16x16x32_bf16 v[140:143], v[36:39], v[64:67], v[140:143]
    v_mfma_f32_16x16x32_bf16 v[144:147], v[24:27], v[68:71], v[144:147]
    ds_read_b64_tr_b16 v[64:65], v14 offset:18496
    v_mfma_f32_16x16x32_bf16 v[148:151], v[28:31], v[68:71], v[148:151]
    ds_read_b64_tr_b16 v[66:67], v14 offset:27712
    v_mfma_f32_16x16x32_bf16 v[152:155], v[32:35], v[68:71], v[152:155]
    ds_read_b128 v[40:43], v13 offset:0
    v_mfma_f32_16x16x32_bf16 v[156:159], v[36:39], v[68:71], v[156:159]
    ds_read_b128 v[44:47], v13 offset:2048
    s_waitcnt lgkmcnt(12)
    v_mfma_f32_16x16x32_bf16 v[160:163], v[24:27], v[72:75], v[160:163]
    ds_read_b64_tr_b16 v[68:69], v14 offset:18528
    v_mfma_f32_16x16x32_bf16 v[164:167], v[28:31], v[72:75], v[164:167]
    ds_read_b64_tr_b16 v[70:71], v14 offset:27744
    v_mfma_f32_16x16x32_bf16 v[168:171], v[32:35], v[72:75], v[168:171]
    ds_read_b128 v[48:51], v13 offset:4096
    v_mfma_f32_16x16x32_bf16 v[172:175], v[36:39], v[72:75], v[172:175]
    ds_read_b128 v[52:55], v13 offset:6144
    v_mfma_f32_16x16x32_bf16 v[176:179], v[24:27], v[76:79], v[176:179]
    ds_read_b64_tr_b16 v[72:73], v14 offset:18560
    v_mfma_f32_16x16x32_bf16 v[180:183], v[28:31], v[76:79], v[180:183]
    ds_read_b64_tr_b16 v[74:75], v14 offset:27776
    v_mfma_f32_16x16x32_bf16 v[184:187], v[32:35], v[76:79], v[184:187]
    v_mfma_f32_16x16x32_bf16 v[188:191], v[36:39], v[76:79], v[188:191]
    s_waitcnt lgkmcnt(12)
    v_mfma_f32_16x16x32_bf16 v[192:195], v[24:27], v[80:83], v[192:195]
    ds_read_b64_tr_b16 v[76:77], v14 offset:18592
    v_mfma_f32_16x16x32_bf16 v[196:199], v[28:31], v[80:83], v[196:199]
    ds_read_b64_tr_b16 v[78:79], v14 offset:27808
    v_mfma_f32_16x16x32_bf16 v[200:203], v[32:35], v[80:83], v[200:203]
    v_mfma_f32_16x16x32_bf16 v[204:207], v[36:39], v[80:83], v[204:207]
    v_mfma_f32_16x16x32_bf16 v[208:211], v[24:27], v[84:87], v[208:211]
    ds_read_b64_tr_b16 v[80:81], v14 offset:18624
    v_mfma_f32_16x16x32_bf16 v[212:215], v[28:31], v[84:87], v[212:215]
    ds_read_b64_tr_b16 v[82:83], v14 offset:27840
    v_mfma_f32_16x16x32_bf16 v[216:219], v[32:35], v[84:87], v[216:219]
    v_mfma_f32_16x16x32_bf16 v[220:223], v[36:39], v[84:87], v[220:223]
    s_waitcnt lgkmcnt(6)
    v_mfma_f32_16x16x32_bf16 v[96:99], v[40:43], v[56:59], v[96:99]
    ds_read_b64_tr_b16 v[84:85], v14 offset:18656
    v_mfma_f32_16x16x32_bf16 v[100:103], v[44:47], v[56:59], v[100:103]
    ds_read_b64_tr_b16 v[86:87], v14 offset:27872
    v_mfma_f32_16x16x32_bf16 v[104:107], v[48:51], v[56:59], v[104:107]
    v_mfma_f32_16x16x32_bf16 v[108:111], v[52:55], v[56:59], v[108:111]
    v_mfma_f32_16x16x32_bf16 v[112:115], v[40:43], v[60:63], v[112:115]
    v_mfma_f32_16x16x32_bf16 v[116:119], v[44:47], v[60:63], v[116:119]
    v_mfma_f32_16x16x32_bf16 v[120:123], v[48:51], v[60:63], v[120:123]
    v_mfma_f32_16x16x32_bf16 v[124:127], v[52:55], v[60:63], v[124:127]
    s_waitcnt lgkmcnt(0)
    s_barrier
    v_mfma_f32_16x16x32_bf16 v[128:131], v[40:43], v[64:67], v[128:131]
    ds_read_b64_tr_b16 v[56:57], v17 offset:0
    v_mfma_f32_16x16x32_bf16 v[132:135], v[44:47], v[64:67], v[132:135]
    ds_read_b64_tr_b16 v[58:59], v17 offset:9216
    v_mfma_f32_16x16x32_bf16 v[136:139], v[48:51], v[64:67], v[136:139]
    ds_read_b64_tr_b16 v[60:61], v17 offset:32
    v_mfma_f32_16x16x32_bf16 v[140:143], v[52:55], v[64:67], v[140:143]
    ds_read_b64_tr_b16 v[62:63], v17 offset:9248
    v_mfma_f32_16x16x32_bf16 v[144:147], v[40:43], v[68:71], v[144:147]
    ds_read_b64_tr_b16 v[64:65], v17 offset:64
    v_mfma_f32_16x16x32_bf16 v[148:151], v[44:47], v[68:71], v[148:151]
    ds_read_b64_tr_b16 v[66:67], v17 offset:9280
    v_mfma_f32_16x16x32_bf16 v[152:155], v[48:51], v[68:71], v[152:155]
    ds_read_b128 v[24:27], v15 offset:0
    v_mfma_f32_16x16x32_bf16 v[156:159], v[52:55], v[68:71], v[156:159]
    ds_read_b128 v[28:31], v15 offset:2048
    v_mfma_f32_16x16x32_bf16 v[160:163], v[40:43], v[72:75], v[160:163]
    ds_read_b64_tr_b16 v[68:69], v17 offset:96
    v_mfma_f32_16x16x32_bf16 v[164:167], v[44:47], v[72:75], v[164:167]
    ds_read_b64_tr_b16 v[70:71], v17 offset:9312
    v_mfma_f32_16x16x32_bf16 v[168:171], v[48:51], v[72:75], v[168:171]
    ds_read_b128 v[32:35], v15 offset:4096
    v_mfma_f32_16x16x32_bf16 v[172:175], v[52:55], v[72:75], v[172:175]
    ds_read_b128 v[36:39], v15 offset:6144
    v_mfma_f32_16x16x32_bf16 v[176:179], v[40:43], v[76:79], v[176:179]
    ds_read_b64_tr_b16 v[72:73], v17 offset:128
    v_mfma_f32_16x16x32_bf16 v[180:183], v[44:47], v[76:79], v[180:183]
    ds_read_b64_tr_b16 v[74:75], v17 offset:9344
    v_mfma_f32_16x16x32_bf16 v[184:187], v[48:51], v[76:79], v[184:187]
    v_mfma_f32_16x16x32_bf16 v[188:191], v[52:55], v[76:79], v[188:191]
    v_mfma_f32_16x16x32_bf16 v[192:195], v[40:43], v[80:83], v[192:195]
    ds_read_b64_tr_b16 v[76:77], v17 offset:160
    v_mfma_f32_16x16x32_bf16 v[196:199], v[44:47], v[80:83], v[196:199]
    ds_read_b64_tr_b16 v[78:79], v17 offset:9376
    v_mfma_f32_16x16x32_bf16 v[200:203], v[48:51], v[80:83], v[200:203]
    v_mfma_f32_16x16x32_bf16 v[204:207], v[52:55], v[80:83], v[204:207]
    v_mfma_f32_16x16x32_bf16 v[208:211], v[40:43], v[84:87], v[208:211]
    ds_read_b64_tr_b16 v[80:81], v17 offset:192
    v_mfma_f32_16x16x32_bf16 v[212:215], v[44:47], v[84:87], v[212:215]
    ds_read_b64_tr_b16 v[82:83], v17 offset:9408
    v_mfma_f32_16x16x32_bf16 v[216:219], v[48:51], v[84:87], v[216:219]
    v_mfma_f32_16x16x32_bf16 v[220:223], v[52:55], v[84:87], v[220:223]
    s_waitcnt lgkmcnt(6)
    v_mfma_f32_16x16x32_bf16 v[96:99], v[24:27], v[56:59], v[96:99]
    ds_read_b64_tr_b16 v[84:85], v17 offset:224
    v_mfma_f32_16x16x32_bf16 v[100:103], v[28:31], v[56:59], v[100:103]
    ds_read_b64_tr_b16 v[86:87], v17 offset:9440
    v_mfma_f32_16x16x32_bf16 v[104:107], v[32:35], v[56:59], v[104:107]
    v_mfma_f32_16x16x32_bf16 v[108:111], v[36:39], v[56:59], v[108:111]
    v_mfma_f32_16x16x32_bf16 v[112:115], v[24:27], v[60:63], v[112:115]
    ds_read_b64_tr_b16 v[56:57], v17 offset:18432
    v_mfma_f32_16x16x32_bf16 v[116:119], v[28:31], v[60:63], v[116:119]
    ds_read_b64_tr_b16 v[58:59], v17 offset:27648
    v_mfma_f32_16x16x32_bf16 v[120:123], v[32:35], v[60:63], v[120:123]
    v_mfma_f32_16x16x32_bf16 v[124:127], v[36:39], v[60:63], v[124:127]
    v_mfma_f32_16x16x32_bf16 v[128:131], v[24:27], v[64:67], v[128:131]
    ds_read_b64_tr_b16 v[60:61], v17 offset:18464
    v_mfma_f32_16x16x32_bf16 v[132:135], v[28:31], v[64:67], v[132:135]
    ds_read_b64_tr_b16 v[62:63], v17 offset:27680
    v_mfma_f32_16x16x32_bf16 v[136:139], v[32:35], v[64:67], v[136:139]
    v_mfma_f32_16x16x32_bf16 v[140:143], v[36:39], v[64:67], v[140:143]
    v_mfma_f32_16x16x32_bf16 v[144:147], v[24:27], v[68:71], v[144:147]
    ds_read_b64_tr_b16 v[64:65], v17 offset:18496
    v_mfma_f32_16x16x32_bf16 v[148:151], v[28:31], v[68:71], v[148:151]
    ds_read_b64_tr_b16 v[66:67], v17 offset:27712
    v_mfma_f32_16x16x32_bf16 v[152:155], v[32:35], v[68:71], v[152:155]
    ds_read_b128 v[40:43], v16 offset:0
    v_mfma_f32_16x16x32_bf16 v[156:159], v[36:39], v[68:71], v[156:159]
    ds_read_b128 v[44:47], v16 offset:2048
    s_waitcnt lgkmcnt(12)
    v_mfma_f32_16x16x32_bf16 v[160:163], v[24:27], v[72:75], v[160:163]
    ds_read_b64_tr_b16 v[68:69], v17 offset:18528
    v_mfma_f32_16x16x32_bf16 v[164:167], v[28:31], v[72:75], v[164:167]
    ds_read_b64_tr_b16 v[70:71], v17 offset:27744
    v_mfma_f32_16x16x32_bf16 v[168:171], v[32:35], v[72:75], v[168:171]
    ds_read_b128 v[48:51], v16 offset:4096
    v_mfma_f32_16x16x32_bf16 v[172:175], v[36:39], v[72:75], v[172:175]
    ds_read_b128 v[52:55], v16 offset:6144
    v_mfma_f32_16x16x32_bf16 v[176:179], v[24:27], v[76:79], v[176:179]
    ds_read_b64_tr_b16 v[72:73], v17 offset:18560
    v_mfma_f32_16x16x32_bf16 v[180:183], v[28:31], v[76:79], v[180:183]
    ds_read_b64_tr_b16 v[74:75], v17 offset:27776
    v_mfma_f32_16x16x32_bf16 v[184:187], v[32:35], v[76:79], v[184:187]
    v_mfma_f32_16x16x32_bf16 v[188:191], v[36:39], v[76:79], v[188:191]
    s_waitcnt lgkmcnt(12)
    v_mfma_f32_16x16x32_bf16 v[192:195], v[24:27], v[80:83], v[192:195]
    ds_read_b64_tr_b16 v[76:77], v17 offset:18592
    v_mfma_f32_16x16x32_bf16 v[196:199], v[28:31], v[80:83], v[196:199]
    ds_read_b64_tr_b16 v[78:79], v17 offset:27808
    v_mfma_f32_16x16x32_bf16 v[200:203], v[32:35], v[80:83], v[200:203]
    v_mfma_f32_16x16x32_bf16 v[204:207], v[36:39], v[80:83], v[204:207]
    v_mfma_f32_16x16x32_bf16 v[208:211], v[24:27], v[84:87], v[208:211]
    ds_read_b64_tr_b16 v[80:81], v17 offset:18624
    v_mfma_f32_16x16x32_bf16 v[212:215], v[28:31], v[84:87], v[212:215]
    ds_read_b64_tr_b16 v[82:83], v17 offset:27840
    v_mfma_f32_16x16x32_bf16 v[216:219], v[32:35], v[84:87], v[216:219]
    v_mfma_f32_16x16x32_bf16 v[220:223], v[36:39], v[84:87], v[220:223]
    s_waitcnt lgkmcnt(6)
    v_mfma_f32_16x16x32_bf16 v[96:99], v[40:43], v[56:59], v[96:99]
    ds_read_b64_tr_b16 v[84:85], v17 offset:18656
    v_mfma_f32_16x16x32_bf16 v[100:103], v[44:47], v[56:59], v[100:103]
    ds_read_b64_tr_b16 v[86:87], v17 offset:27872
    v_mfma_f32_16x16x32_bf16 v[104:107], v[48:51], v[56:59], v[104:107]
    v_mfma_f32_16x16x32_bf16 v[108:111], v[52:55], v[56:59], v[108:111]
    v_mfma_f32_16x16x32_bf16 v[112:115], v[40:43], v[60:63], v[112:115]
    v_mfma_f32_16x16x32_bf16 v[116:119], v[44:47], v[60:63], v[116:119]
    v_mfma_f32_16x16x32_bf16 v[120:123], v[48:51], v[60:63], v[120:123]
    v_mfma_f32_16x16x32_bf16 v[124:127], v[52:55], v[60:63], v[124:127]
    s_waitcnt lgkmcnt(0)
    s_barrier
    v_mfma_f32_16x16x32_bf16 v[128:131], v[40:43], v[64:67], v[128:131]
    ds_read_b64_tr_b16 v[56:57], v11 offset:0
    v_mfma_f32_16x16x32_bf16 v[132:135], v[44:47], v[64:67], v[132:135]
    ds_read_b64_tr_b16 v[58:59], v11 offset:9216
    v_mfma_f32_16x16x32_bf16 v[136:139], v[48:51], v[64:67], v[136:139]
    ds_read_b64_tr_b16 v[60:61], v11 offset:32
    v_mfma_f32_16x16x32_bf16 v[140:143], v[52:55], v[64:67], v[140:143]
    ds_read_b64_tr_b16 v[62:63], v11 offset:9248
    v_mfma_f32_16x16x32_bf16 v[144:147], v[40:43], v[68:71], v[144:147]
    ds_read_b64_tr_b16 v[64:65], v11 offset:64
    v_mfma_f32_16x16x32_bf16 v[148:151], v[44:47], v[68:71], v[148:151]
    ds_read_b64_tr_b16 v[66:67], v11 offset:9280
    v_mfma_f32_16x16x32_bf16 v[152:155], v[48:51], v[68:71], v[152:155]
    ds_read_b128 v[24:27], v9 offset:0
    v_mfma_f32_16x16x32_bf16 v[156:159], v[52:55], v[68:71], v[156:159]
    ds_read_b128 v[28:31], v9 offset:2048
    v_mfma_f32_16x16x32_bf16 v[160:163], v[40:43], v[72:75], v[160:163]
    ds_read_b64_tr_b16 v[68:69], v11 offset:96
    v_mfma_f32_16x16x32_bf16 v[164:167], v[44:47], v[72:75], v[164:167]
    ds_read_b64_tr_b16 v[70:71], v11 offset:9312
    v_mfma_f32_16x16x32_bf16 v[168:171], v[48:51], v[72:75], v[168:171]
    ds_read_b128 v[32:35], v9 offset:4096
    v_mfma_f32_16x16x32_bf16 v[172:175], v[52:55], v[72:75], v[172:175]
    ds_read_b128 v[36:39], v9 offset:6144
    v_mfma_f32_16x16x32_bf16 v[176:179], v[40:43], v[76:79], v[176:179]
    ds_read_b64_tr_b16 v[72:73], v11 offset:128
    v_mfma_f32_16x16x32_bf16 v[180:183], v[44:47], v[76:79], v[180:183]
    ds_read_b64_tr_b16 v[74:75], v11 offset:9344
    v_mfma_f32_16x16x32_bf16 v[184:187], v[48:51], v[76:79], v[184:187]
    v_mfma_f32_16x16x32_bf16 v[188:191], v[52:55], v[76:79], v[188:191]
    v_mfma_f32_16x16x32_bf16 v[192:195], v[40:43], v[80:83], v[192:195]
    ds_read_b64_tr_b16 v[76:77], v11 offset:160
    v_mfma_f32_16x16x32_bf16 v[196:199], v[44:47], v[80:83], v[196:199]
    ds_read_b64_tr_b16 v[78:79], v11 offset:9376
    v_mfma_f32_16x16x32_bf16 v[200:203], v[48:51], v[80:83], v[200:203]
    v_mfma_f32_16x16x32_bf16 v[204:207], v[52:55], v[80:83], v[204:207]
    v_mfma_f32_16x16x32_bf16 v[208:211], v[40:43], v[84:87], v[208:211]
    ds_read_b64_tr_b16 v[80:81], v11 offset:192
    v_mfma_f32_16x16x32_bf16 v[212:215], v[44:47], v[84:87], v[212:215]
    ds_read_b64_tr_b16 v[82:83], v11 offset:9408
    v_mfma_f32_16x16x32_bf16 v[216:219], v[48:51], v[84:87], v[216:219]
    v_mfma_f32_16x16x32_bf16 v[220:223], v[52:55], v[84:87], v[220:223]
    s_waitcnt lgkmcnt(6)
    v_mfma_f32_16x16x32_bf16 v[96:99], v[24:27], v[56:59], v[96:99]
    ds_read_b64_tr_b16 v[84:85], v11 offset:224
    v_mfma_f32_16x16x32_bf16 v[100:103], v[28:31], v[56:59], v[100:103]
    ds_read_b64_tr_b16 v[86:87], v11 offset:9440
    v_mfma_f32_16x16x32_bf16 v[104:107], v[32:35], v[56:59], v[104:107]
    v_mfma_f32_16x16x32_bf16 v[108:111], v[36:39], v[56:59], v[108:111]
    v_mfma_f32_16x16x32_bf16 v[112:115], v[24:27], v[60:63], v[112:115]
    ds_read_b64_tr_b16 v[56:57], v11 offset:18432
    v_mfma_f32_16x16x32_bf16 v[116:119], v[28:31], v[60:63], v[116:119]
    ds_read_b64_tr_b16 v[58:59], v11 offset:27648
    v_mfma_f32_16x16x32_bf16 v[120:123], v[32:35], v[60:63], v[120:123]
    v_mfma_f32_16x16x32_bf16 v[124:127], v[36:39], v[60:63], v[124:127]
    v_mfma_f32_16x16x32_bf16 v[128:131], v[24:27], v[64:67], v[128:131]
    ds_read_b64_tr_b16 v[60:61], v11 offset:18464
    v_mfma_f32_16x16x32_bf16 v[132:135], v[28:31], v[64:67], v[132:135]
    ds_read_b64_tr_b16 v[62:63], v11 offset:27680
    v_mfma_f32_16x16x32_bf16 v[136:139], v[32:35], v[64:67], v[136:139]
    v_mfma_f32_16x16x32_bf16 v[140:143], v[36:39], v[64:67], v[140:143]
    v_mfma_f32_16x16x32_bf16 v[144:147], v[24:27], v[68:71], v[144:147]
    ds_read_b64_tr_b16 v[64:65], v11 offset:18496
    v_mfma_f32_16x16x32_bf16 v[148:151], v[28:31], v[68:71], v[148:151]
    ds_read_b64_tr_b16 v[66:67], v11 offset:27712
    v_mfma_f32_16x16x32_bf16 v[152:155], v[32:35], v[68:71], v[152:155]
    ds_read_b128 v[40:43], v10 offset:0
    v_mfma_f32_16x16x32_bf16 v[156:159], v[36:39], v[68:71], v[156:159]
    ds_read_b128 v[44:47], v10 offset:2048
    s_waitcnt lgkmcnt(12)
    v_mfma_f32_16x16x32_bf16 v[160:163], v[24:27], v[72:75], v[160:163]
    ds_read_b64_tr_b16 v[68:69], v11 offset:18528
    v_mfma_f32_16x16x32_bf16 v[164:167], v[28:31], v[72:75], v[164:167]
    ds_read_b64_tr_b16 v[70:71], v11 offset:27744
    v_mfma_f32_16x16x32_bf16 v[168:171], v[32:35], v[72:75], v[168:171]
    ds_read_b128 v[48:51], v10 offset:4096
    v_mfma_f32_16x16x32_bf16 v[172:175], v[36:39], v[72:75], v[172:175]
    ds_read_b128 v[52:55], v10 offset:6144
    v_mfma_f32_16x16x32_bf16 v[176:179], v[24:27], v[76:79], v[176:179]
    ds_read_b64_tr_b16 v[72:73], v11 offset:18560
    v_mfma_f32_16x16x32_bf16 v[180:183], v[28:31], v[76:79], v[180:183]
    ds_read_b64_tr_b16 v[74:75], v11 offset:27776
    v_mfma_f32_16x16x32_bf16 v[184:187], v[32:35], v[76:79], v[184:187]
    v_mfma_f32_16x16x32_bf16 v[188:191], v[36:39], v[76:79], v[188:191]
    s_waitcnt lgkmcnt(12)
    v_mfma_f32_16x16x32_bf16 v[192:195], v[24:27], v[80:83], v[192:195]
    ds_read_b64_tr_b16 v[76:77], v11 offset:18592
    v_mfma_f32_16x16x32_bf16 v[196:199], v[28:31], v[80:83], v[196:199]
    ds_read_b64_tr_b16 v[78:79], v11 offset:27808
    v_mfma_f32_16x16x32_bf16 v[200:203], v[32:35], v[80:83], v[200:203]
    v_mfma_f32_16x16x32_bf16 v[204:207], v[36:39], v[80:83], v[204:207]
    v_mfma_f32_16x16x32_bf16 v[208:211], v[24:27], v[84:87], v[208:211]
    ds_read_b64_tr_b16 v[80:81], v11 offset:18624
    v_mfma_f32_16x16x32_bf16 v[212:215], v[28:31], v[84:87], v[212:215]
    ds_read_b64_tr_b16 v[82:83], v11 offset:27840
    v_mfma_f32_16x16x32_bf16 v[216:219], v[32:35], v[84:87], v[216:219]
    v_mfma_f32_16x16x32_bf16 v[220:223], v[36:39], v[84:87], v[220:223]
    s_waitcnt lgkmcnt(6)
    v_mfma_f32_16x16x32_bf16 v[96:99], v[40:43], v[56:59], v[96:99]
    ds_read_b64_tr_b16 v[84:85], v11 offset:18656
    v_mfma_f32_16x16x32_bf16 v[100:103], v[44:47], v[56:59], v[100:103]
    ds_read_b64_tr_b16 v[86:87], v11 offset:27872
    v_mfma_f32_16x16x32_bf16 v[104:107], v[48:51], v[56:59], v[104:107]
    v_mfma_f32_16x16x32_bf16 v[108:111], v[52:55], v[56:59], v[108:111]
    v_mfma_f32_16x16x32_bf16 v[112:115], v[40:43], v[60:63], v[112:115]
    v_mfma_f32_16x16x32_bf16 v[116:119], v[44:47], v[60:63], v[116:119]
    v_mfma_f32_16x16x32_bf16 v[120:123], v[48:51], v[60:63], v[120:123]
    v_mfma_f32_16x16x32_bf16 v[124:127], v[52:55], v[60:63], v[124:127]
    s_waitcnt lgkmcnt(0)
    s_barrier
    v_mfma_f32_16x16x32_bf16 v[128:131], v[40:43], v[64:67], v[128:131]
    ds_read_b64_tr_b16 v[56:57], v14 offset:0
    v_mfma_f32_16x16x32_bf16 v[132:135], v[44:47], v[64:67], v[132:135]
    ds_read_b64_tr_b16 v[58:59], v14 offset:9216
    v_mfma_f32_16x16x32_bf16 v[136:139], v[48:51], v[64:67], v[136:139]
    ds_read_b64_tr_b16 v[60:61], v14 offset:32
    v_mfma_f32_16x16x32_bf16 v[140:143], v[52:55], v[64:67], v[140:143]
    ds_read_b64_tr_b16 v[62:63], v14 offset:9248
    v_mfma_f32_16x16x32_bf16 v[144:147], v[40:43], v[68:71], v[144:147]
    ds_read_b64_tr_b16 v[64:65], v14 offset:64
    v_mfma_f32_16x16x32_bf16 v[148:151], v[44:47], v[68:71], v[148:151]
    ds_read_b64_tr_b16 v[66:67], v14 offset:9280
    v_mfma_f32_16x16x32_bf16 v[152:155], v[48:51], v[68:71], v[152:155]
    ds_read_b128 v[24:27], v12 offset:0
    v_mfma_f32_16x16x32_bf16 v[156:159], v[52:55], v[68:71], v[156:159]
    ds_read_b128 v[28:31], v12 offset:2048
    v_mfma_f32_16x16x32_bf16 v[160:163], v[40:43], v[72:75], v[160:163]
    ds_read_b64_tr_b16 v[68:69], v14 offset:96
    v_mfma_f32_16x16x32_bf16 v[164:167], v[44:47], v[72:75], v[164:167]
    ds_read_b64_tr_b16 v[70:71], v14 offset:9312
    v_mfma_f32_16x16x32_bf16 v[168:171], v[48:51], v[72:75], v[168:171]
    ds_read_b128 v[32:35], v12 offset:4096
    v_mfma_f32_16x16x32_bf16 v[172:175], v[52:55], v[72:75], v[172:175]
    ds_read_b128 v[36:39], v12 offset:6144
    v_mfma_f32_16x16x32_bf16 v[176:179], v[40:43], v[76:79], v[176:179]
    ds_read_b64_tr_b16 v[72:73], v14 offset:128
    v_mfma_f32_16x16x32_bf16 v[180:183], v[44:47], v[76:79], v[180:183]
    ds_read_b64_tr_b16 v[74:75], v14 offset:9344
    v_mfma_f32_16x16x32_bf16 v[184:187], v[48:51], v[76:79], v[184:187]
    v_mfma_f32_16x16x32_bf16 v[188:191], v[52:55], v[76:79], v[188:191]
    v_mfma_f32_16x16x32_bf16 v[192:195], v[40:43], v[80:83], v[192:195]
    ds_read_b64_tr_b16 v[76:77], v14 offset:160
    v_mfma_f32_16x16x32_bf16 v[196:199], v[44:47], v[80:83], v[196:199]
    ds_read_b64_tr_b16 v[78:79], v14 offset:9376
    v_mfma_f32_16x16x32_bf16 v[200:203], v[48:51], v[80:83], v[200:203]
    v_mfma_f32_16x16x32_bf16 v[204:207], v[52:55], v[80:83], v[204:207]
    v_mfma_f32_16x16x32_bf16 v[208:211], v[40:43], v[84:87], v[208:211]
    ds_read_b64_tr_b16 v[80:81], v14 offset:192
    v_mfma_f32_16x16x32_bf16 v[212:215], v[44:47], v[84:87], v[212:215]
    ds_read_b64_tr_b16 v[82:83], v14 offset:9408
    v_mfma_f32_16x16x32_bf16 v[216:219], v[48:51], v[84:87], v[216:219]
    v_mfma_f32_16x16x32_bf16 v[220:223], v[52:55], v[84:87], v[220:223]
    s_waitcnt lgkmcnt(6)
    v_mfma_f32_16x16x32_bf16 v[96:99], v[24:27], v[56:59], v[96:99]
    ds_read_b64_tr_b16 v[84:85], v14 offset:224
    v_mfma_f32_16x16x32_bf16 v[100:103], v[28:31], v[56:59], v[100:103]
    ds_read_b64_tr_b16 v[86:87], v14 offset:9440
    v_mfma_f32_16x16x32_bf16 v[104:107], v[32:35], v[56:59], v[104:107]
    v_mfma_f32_16x16x32_bf16 v[108:111], v[36:39], v[56:59], v[108:111]
    v_mfma_f32_16x16x32_bf16 v[112:115], v[24:27], v[60:63], v[112:115]
    ds_read_b64_tr_b16 v[56:57], v14 offset:18432
    v_mfma_f32_16x16x32_bf16 v[116:119], v[28:31], v[60:63], v[116:119]
    ds_read_b64_tr_b16 v[58:59], v14 offset:27648
    v_mfma_f32_16x16x32_bf16 v[120:123], v[32:35], v[60:63], v[120:123]
    v_mfma_f32_16x16x32_bf16 v[124:127], v[36:39], v[60:63], v[124:127]
    v_mfma_f32_16x16x32_bf16 v[128:131], v[24:27], v[64:67], v[128:131]
    ds_read_b64_tr_b16 v[60:61], v14 offset:18464
    v_mfma_f32_16x16x32_bf16 v[132:135], v[28:31], v[64:67], v[132:135]
    ds_read_b64_tr_b16 v[62:63], v14 offset:27680
    v_mfma_f32_16x16x32_bf16 v[136:139], v[32:35], v[64:67], v[136:139]
    v_mfma_f32_16x16x32_bf16 v[140:143], v[36:39], v[64:67], v[140:143]
    v_mfma_f32_16x16x32_bf16 v[144:147], v[24:27], v[68:71], v[144:147]
    ds_read_b64_tr_b16 v[64:65], v14 offset:18496
    v_mfma_f32_16x16x32_bf16 v[148:151], v[28:31], v[68:71], v[148:151]
    ds_read_b64_tr_b16 v[66:67], v14 offset:27712
    v_mfma_f32_16x16x32_bf16 v[152:155], v[32:35], v[68:71], v[152:155]
    ds_read_b128 v[40:43], v13 offset:0
    v_mfma_f32_16x16x32_bf16 v[156:159], v[36:39], v[68:71], v[156:159]
    ds_read_b128 v[44:47], v13 offset:2048
    s_waitcnt lgkmcnt(12)
    v_mfma_f32_16x16x32_bf16 v[160:163], v[24:27], v[72:75], v[160:163]
    ds_read_b64_tr_b16 v[68:69], v14 offset:18528
    v_mfma_f32_16x16x32_bf16 v[164:167], v[28:31], v[72:75], v[164:167]
    ds_read_b64_tr_b16 v[70:71], v14 offset:27744
    v_mfma_f32_16x16x32_bf16 v[168:171], v[32:35], v[72:75], v[168:171]
    ds_read_b128 v[48:51], v13 offset:4096
    v_mfma_f32_16x16x32_bf16 v[172:175], v[36:39], v[72:75], v[172:175]
    ds_read_b128 v[52:55], v13 offset:6144
    v_mfma_f32_16x16x32_bf16 v[176:179], v[24:27], v[76:79], v[176:179]
    ds_read_b64_tr_b16 v[72:73], v14 offset:18560
    v_mfma_f32_16x16x32_bf16 v[180:183], v[28:31], v[76:79], v[180:183]
    ds_read_b64_tr_b16 v[74:75], v14 offset:27776
    v_mfma_f32_16x16x32_bf16 v[184:187], v[32:35], v[76:79], v[184:187]
    v_mfma_f32_16x16x32_bf16 v[188:191], v[36:39], v[76:79], v[188:191]
    s_waitcnt lgkmcnt(12)
    v_mfma_f32_16x16x32_bf16 v[192:195], v[24:27], v[80:83], v[192:195]
    ds_read_b64_tr_b16 v[76:77], v14 offset:18592
    v_mfma_f32_16x16x32_bf16 v[196:199], v[28:31], v[80:83], v[196:199]
    ds_read_b64_tr_b16 v[78:79], v14 offset:27808
    v_mfma_f32_16x16x32_bf16 v[200:203], v[32:35], v[80:83], v[200:203]
    v_mfma_f32_16x16x32_bf16 v[204:207], v[36:39], v[80:83], v[204:207]
    v_mfma_f32_16x16x32_bf16 v[208:211], v[24:27], v[84:87], v[208:211]
    ds_read_b64_tr_b16 v[80:81], v14 offset:18624
    v_mfma_f32_16x16x32_bf16 v[212:215], v[28:31], v[84:87], v[212:215]
    ds_read_b64_tr_b16 v[82:83], v14 offset:27840
    v_mfma_f32_16x16x32_bf16 v[216:219], v[32:35], v[84:87], v[216:219]
    v_mfma_f32_16x16x32_bf16 v[220:223], v[36:39], v[84:87], v[220:223]
    s_waitcnt lgkmcnt(6)
    v_mfma_f32_16x16x32_bf16 v[96:99], v[40:43], v[56:59], v[96:99]
    ds_read_b64_tr_b16 v[84:85], v14 offset:18656
    v_mfma_f32_16x16x32_bf16 v[100:103], v[44:47], v[56:59], v[100:103]
    ds_read_b64_tr_b16 v[86:87], v14 offset:27872
    v_mfma_f32_16x16x32_bf16 v[104:107], v[48:51], v[56:59], v[104:107]
    v_mfma_f32_16x16x32_bf16 v[108:111], v[52:55], v[56:59], v[108:111]
    v_mfma_f32_16x16x32_bf16 v[112:115], v[40:43], v[60:63], v[112:115]
    v_mfma_f32_16x16x32_bf16 v[116:119], v[44:47], v[60:63], v[116:119]
    v_mfma_f32_16x16x32_bf16 v[120:123], v[48:51], v[60:63], v[120:123]
    v_mfma_f32_16x16x32_bf16 v[124:127], v[52:55], v[60:63], v[124:127]
    s_waitcnt lgkmcnt(0)
    s_barrier
    v_mfma_f32_16x16x32_bf16 v[128:131], v[40:43], v[64:67], v[128:131]
    ds_read_b32 v56, v5 offset:1024
    v_mfma_f32_16x16x32_bf16 v[132:135], v[44:47], v[64:67], v[132:135]
    ds_read_b32 v60, v5 offset:1088
    v_mfma_f32_16x16x32_bf16 v[136:139], v[48:51], v[64:67], v[136:139]
    ds_read_b128 v[224:227], v6 offset:0
    v_mfma_f32_16x16x32_bf16 v[140:143], v[52:55], v[64:67], v[140:143]
    ds_read_b128 v[228:231], v6 offset:512
    v_mfma_f32_16x16x32_bf16 v[144:147], v[40:43], v[68:71], v[144:147]
    ds_read_b32 v64, v5 offset:1152
    v_mfma_f32_16x16x32_bf16 v[148:151], v[44:47], v[68:71], v[148:151]
    ds_read_b128 v[232:235], v6 offset:64
    v_mfma_f32_16x16x32_bf16 v[152:155], v[48:51], v[68:71], v[152:155]
    ds_read_b128 v[236:239], v6 offset:576
    v_mfma_f32_16x16x32_bf16 v[156:159], v[52:55], v[68:71], v[156:159]
    v_mfma_f32_16x16x32_bf16 v[160:163], v[40:43], v[72:75], v[160:163]
    ds_read_b32 v68, v5 offset:1216
    v_mfma_f32_16x16x32_bf16 v[164:167], v[44:47], v[72:75], v[164:167]
    ds_read_b128 v[240:243], v6 offset:128
    v_mfma_f32_16x16x32_bf16 v[168:171], v[48:51], v[72:75], v[168:171]
    ds_read_b128 v[244:247], v6 offset:640
    v_mfma_f32_16x16x32_bf16 v[172:175], v[52:55], v[72:75], v[172:175]
    v_mfma_f32_16x16x32_bf16 v[176:179], v[40:43], v[76:79], v[176:179]
    ds_read_b32 v72, v5 offset:1280
    v_mfma_f32_16x16x32_bf16 v[180:183], v[44:47], v[76:79], v[180:183]
    ds_read_b128 v[248:251], v6 offset:192
    v_mfma_f32_16x16x32_bf16 v[184:187], v[48:51], v[76:79], v[184:187]
    ds_read_b128 v[252:255], v6 offset:704
    v_mfma_f32_16x16x32_bf16 v[188:191], v[52:55], v[76:79], v[188:191]
    v_mfma_f32_16x16x32_bf16 v[192:195], v[40:43], v[80:83], v[192:195]
    ds_read_b32 v76, v5 offset:1344
    v_mfma_f32_16x16x32_bf16 v[196:199], v[44:47], v[80:83], v[196:199]
    v_mfma_f32_16x16x32_bf16 v[200:203], v[48:51], v[80:83], v[200:203]
    v_mfma_f32_16x16x32_bf16 v[204:207], v[52:55], v[80:83], v[204:207]
    v_mfma_f32_16x16x32_bf16 v[208:211], v[40:43], v[84:87], v[208:211]
    ds_read_b32 v80, v5 offset:1408
    v_mfma_f32_16x16x32_bf16 v[212:215], v[44:47], v[84:87], v[212:215]
    v_mfma_f32_16x16x32_bf16 v[216:219], v[48:51], v[84:87], v[216:219]
    v_mfma_f32_16x16x32_bf16 v[220:223], v[52:55], v[84:87], v[220:223]
    ds_read_b32 v84, v5 offset:1472
    s_waitcnt lgkmcnt(3)
    v_pk_fma_f32 v[96:97], v[224:225], v[56:57], v[96:97] op_sel_hi:[1,0,1]
    v_pk_fma_f32 v[98:99], v[226:227], v[56:57], v[98:99] op_sel_hi:[1,0,1]
    v_pk_mul_f32 v[96:97], v[96:97], v[228:229]
    v_pk_mul_f32 v[98:99], v[98:99], v[230:231]
    v_pk_fma_f32 v[100:101], v[232:233], v[56:57], v[100:101] op_sel_hi:[1,0,1]
    v_pk_fma_f32 v[102:103], v[234:235], v[56:57], v[102:103] op_sel_hi:[1,0,1]
    v_pk_mul_f32 v[100:101], v[100:101], v[236:237]
    v_pk_mul_f32 v[102:103], v[102:103], v[238:239]
    v_cvt_pk_bf16_f32 v96, v96, v97
    v_cvt_pk_bf16_f32 v97, v98, v99
    v_cvt_pk_bf16_f32 v98, v100, v101
    v_cvt_pk_bf16_f32 v99, v102, v103
    s_nop 0
    v_permlane16_swap_b32 v96, v98
    v_permlane16_swap_b32 v97, v99
    buffer_store_dwordx4 v[96:99], v7, s[48:51], s60 offen offset:0 sc1
    v_pk_fma_f32 v[104:105], v[240:241], v[56:57], v[104:105] op_sel_hi:[1,0,1]
    v_pk_fma_f32 v[106:107], v[242:243], v[56:57], v[106:107] op_sel_hi:[1,0,1]
    v_pk_mul_f32 v[104:105], v[104:105], v[244:245]
    v_pk_mul_f32 v[106:107], v[106:107], v[246:247]
    v_pk_fma_f32 v[108:109], v[248:249], v[56:57], v[108:109] op_sel_hi:[1,0,1]
    v_pk_fma_f32 v[110:111], v[250:251], v[56:57], v[110:111] op_sel_hi:[1,0,1]
    v_pk_mul_f32 v[108:109], v[108:109], v[252:253]
    v_pk_mul_f32 v[110:111], v[110:111], v[254:255]
    v_cvt_pk_bf16_f32 v104, v104, v105
    v_cvt_pk_bf16_f32 v105, v106, v107
    v_cvt_pk_bf16_f32 v106, v108, v109
    v_cvt_pk_bf16_f32 v107, v110, v111
    s_nop 0
    v_permlane16_swap_b32 v104, v106
    v_permlane16_swap_b32 v105, v107
    buffer_store_dwordx4 v[104:107], v7, s[48:51], s60 offen offset:1024 sc1
    s_add_u32 s60, s60, 65536
    v_pk_fma_f32 v[112:113], v[224:225], v[60:61], v[112:113] op_sel_hi:[1,0,1]
    v_pk_fma_f32 v[114:115], v[226:227], v[60:61], v[114:115] op_sel_hi:[1,0,1]
    v_pk_mul_f32 v[112:113], v[112:113], v[228:229]
    v_pk_mul_f32 v[114:115], v[114:115], v[230:231]
    v_pk_fma_f32 v[116:117], v[232:233], v[60:61], v[116:117] op_sel_hi:[1,0,1]
    v_pk_fma_f32 v[118:119], v[234:235], v[60:61], v[118:119] op_sel_hi:[1,0,1]
    v_pk_mul_f32 v[116:117], v[116:117], v[236:237]
    v_pk_mul_f32 v[118:119], v[118:119], v[238:239]
    v_cvt_pk_bf16_f32 v112, v112, v113
    v_cvt_pk_bf16_f32 v113, v114, v115
    v_cvt_pk_bf16_f32 v114, v116, v117
    v_cvt_pk_bf16_f32 v115, v118, v119
    s_nop 0
    v_permlane16_swap_b32 v112, v114
    v_permlane16_swap_b32 v113, v115
    buffer_store_dwordx4 v[112:115], v7, s[48:51], s60 offen offset:0 sc1
    v_pk_fma_f32 v[120:121], v[240:241], v[60:61], v[120:121] op_sel_hi:[1,0,1]
    v_pk_fma_f32 v[122:123], v[242:243], v[60:61], v[122:123] op_sel_hi:[1,0,1]
    v_pk_mul_f32 v[120:121], v[120:121], v[244:245]
    v_pk_mul_f32 v[122:123], v[122:123], v[246:247]
    v_pk_fma_f32 v[124:125], v[248:249], v[60:61], v[124:125] op_sel_hi:[1,0,1]
    v_pk_fma_f32 v[126:127], v[250:251], v[60:61], v[126:127] op_sel_hi:[1,0,1]
    v_pk_mul_f32 v[124:125], v[124:125], v[252:253]
    v_pk_mul_f32 v[126:127], v[126:127], v[254:255]
    v_cvt_pk_bf16_f32 v120, v120, v121
    v_cvt_pk_bf16_f32 v121, v122, v123
    v_cvt_pk_bf16_f32 v122, v124, v125
    v_cvt_pk_bf16_f32 v123, v126, v127
    s_nop 0
    v_permlane16_swap_b32 v120, v122
    v_permlane16_swap_b32 v121, v123
    buffer_store_dwordx4 v[120:123], v7, s[48:51], s60 offen offset:1024 sc1
    s_add_u32 s60, s60, 65536
    v_pk_fma_f32 v[128:129], v[224:225], v[64:65], v[128:129] op_sel_hi:[1,0,1]
    v_pk_fma_f32 v[130:131], v[226:227], v[64:65], v[130:131] op_sel_hi:[1,0,1]
    v_pk_mul_f32 v[128:129], v[128:129], v[228:229]
    v_pk_mul_f32 v[130:131], v[130:131], v[230:231]
    v_pk_fma_f32 v[132:133], v[232:233], v[64:65], v[132:133] op_sel_hi:[1,0,1]
    v_pk_fma_f32 v[134:135], v[234:235], v[64:65], v[134:135] op_sel_hi:[1,0,1]
    v_pk_mul_f32 v[132:133], v[132:133], v[236:237]
    v_pk_mul_f32 v[134:135], v[134:135], v[238:239]
    v_cvt_pk_bf16_f32 v128, v128, v129
    v_cvt_pk_bf16_f32 v129, v130, v131
    v_cvt_pk_bf16_f32 v130, v132, v133
    v_cvt_pk_bf16_f32 v131, v134, v135
    s_nop 0
    v_permlane16_swap_b32 v128, v130
    v_permlane16_swap_b32 v129, v131
    buffer_store_dwordx4 v[128:131], v7, s[48:51], s60 offen offset:0 sc1
    v_pk_fma_f32 v[136:137], v[240:241], v[64:65], v[136:137] op_sel_hi:[1,0,1]
    v_pk_fma_f32 v[138:139], v[242:243], v[64:65], v[138:139] op_sel_hi:[1,0,1]
    v_pk_mul_f32 v[136:137], v[136:137], v[244:245]
    v_pk_mul_f32 v[138:139], v[138:139], v[246:247]
    v_pk_fma_f32 v[140:141], v[248:249], v[64:65], v[140:141] op_sel_hi:[1,0,1]
    v_pk_fma_f32 v[142:143], v[250:251], v[64:65], v[142:143] op_sel_hi:[1,0,1]
    v_pk_mul_f32 v[140:141], v[140:141], v[252:253]
    v_pk_mul_f32 v[142:143], v[142:143], v[254:255]
    v_cvt_pk_bf16_f32 v136, v136, v137
    v_cvt_pk_bf16_f32 v137, v138, v139
    v_cvt_pk_bf16_f32 v138, v140, v141
    v_cvt_pk_bf16_f32 v139, v142, v143
    s_nop 0
    v_permlane16_swap_b32 v136, v138
    v_permlane16_swap_b32 v137, v139
    buffer_store_dwordx4 v[136:139], v7, s[48:51], s60 offen offset:1024 sc1
    s_add_u32 s60, s60, 65536
    v_pk_fma_f32 v[144:145], v[224:225], v[68:69], v[144:145] op_sel_hi:[1,0,1]
    v_pk_fma_f32 v[146:147], v[226:227], v[68:69], v[146:147] op_sel_hi:[1,0,1]
    v_pk_mul_f32 v[144:145], v[144:145], v[228:229]
    v_pk_mul_f32 v[146:147], v[146:147], v[230:231]
    v_pk_fma_f32 v[148:149], v[232:233], v[68:69], v[148:149] op_sel_hi:[1,0,1]
    v_pk_fma_f32 v[150:151], v[234:235], v[68:69], v[150:151] op_sel_hi:[1,0,1]
    v_pk_mul_f32 v[148:149], v[148:149], v[236:237]
    v_pk_mul_f32 v[150:151], v[150:151], v[238:239]
    v_cvt_pk_bf16_f32 v144, v144, v145
    v_cvt_pk_bf16_f32 v145, v146, v147
    v_cvt_pk_bf16_f32 v146, v148, v149
    v_cvt_pk_bf16_f32 v147, v150, v151
    s_nop 0
    v_permlane16_swap_b32 v144, v146
    v_permlane16_swap_b32 v145, v147
    buffer_store_dwordx4 v[144:147], v7, s[48:51], s60 offen offset:0 sc1
    v_pk_fma_f32 v[152:153], v[240:241], v[68:69], v[152:153] op_sel_hi:[1,0,1]
    v_pk_fma_f32 v[154:155], v[242:243], v[68:69], v[154:155] op_sel_hi:[1,0,1]
    v_pk_mul_f32 v[152:153], v[152:153], v[244:245]
    v_pk_mul_f32 v[154:155], v[154:155], v[246:247]
    v_pk_fma_f32 v[156:157], v[248:249], v[68:69], v[156:157] op_sel_hi:[1,0,1]
    v_pk_fma_f32 v[158:159], v[250:251], v[68:69], v[158:159] op_sel_hi:[1,0,1]
    v_pk_mul_f32 v[156:157], v[156:157], v[252:253]
    v_pk_mul_f32 v[158:159], v[158:159], v[254:255]
    v_cvt_pk_bf16_f32 v152, v152, v153
    v_cvt_pk_bf16_f32 v153, v154, v155
    v_cvt_pk_bf16_f32 v154, v156, v157
    v_cvt_pk_bf16_f32 v155, v158, v159
    s_nop 0
    v_permlane16_swap_b32 v152, v154
    v_permlane16_swap_b32 v153, v155
    buffer_store_dwordx4 v[152:155], v7, s[48:51], s60 offen offset:1024 sc1
    s_add_u32 s60, s60, 65536
    v_pk_fma_f32 v[160:161], v[224:225], v[72:73], v[160:161] op_sel_hi:[1,0,1]
    v_pk_fma_f32 v[162:163], v[226:227], v[72:73], v[162:163] op_sel_hi:[1,0,1]
    v_pk_mul_f32 v[160:161], v[160:161], v[228:229]
    v_pk_mul_f32 v[162:163], v[162:163], v[230:231]
    v_pk_fma_f32 v[164:165], v[232:233], v[72:73], v[164:165] op_sel_hi:[1,0,1]
    v_pk_fma_f32 v[166:167], v[234:235], v[72:73], v[166:167] op_sel_hi:[1,0,1]
    v_pk_mul_f32 v[164:165], v[164:165], v[236:237]
    v_pk_mul_f32 v[166:167], v[166:167], v[238:239]
    v_cvt_pk_bf16_f32 v160, v160, v161
    v_cvt_pk_bf16_f32 v161, v162, v163
    v_cvt_pk_bf16_f32 v162, v164, v165
    v_cvt_pk_bf16_f32 v163, v166, v167
    s_nop 0
    v_permlane16_swap_b32 v160, v162
    v_permlane16_swap_b32 v161, v163
    buffer_store_dwordx4 v[160:163], v7, s[48:51], s60 offen offset:0 sc1
    v_pk_fma_f32 v[168:169], v[240:241], v[72:73], v[168:169] op_sel_hi:[1,0,1]
    v_pk_fma_f32 v[170:171], v[242:243], v[72:73], v[170:171] op_sel_hi:[1,0,1]
    v_pk_mul_f32 v[168:169], v[168:169], v[244:245]
    v_pk_mul_f32 v[170:171], v[170:171], v[246:247]
    v_pk_fma_f32 v[172:173], v[248:249], v[72:73], v[172:173] op_sel_hi:[1,0,1]
    v_pk_fma_f32 v[174:175], v[250:251], v[72:73], v[174:175] op_sel_hi:[1,0,1]
    v_pk_mul_f32 v[172:173], v[172:173], v[252:253]
    v_pk_mul_f32 v[174:175], v[174:175], v[254:255]
    v_cvt_pk_bf16_f32 v168, v168, v169
    v_cvt_pk_bf16_f32 v169, v170, v171
    v_cvt_pk_bf16_f32 v170, v172, v173
    v_cvt_pk_bf16_f32 v171, v174, v175
    s_nop 0
    v_permlane16_swap_b32 v168, v170
    v_permlane16_swap_b32 v169, v171
    buffer_store_dwordx4 v[168:171], v7, s[48:51], s60 offen offset:1024 sc1
    s_add_u32 s60, s60, 65536
    s_waitcnt lgkmcnt(2)
    v_pk_fma_f32 v[176:177], v[224:225], v[76:77], v[176:177] op_sel_hi:[1,0,1]
    v_pk_fma_f32 v[178:179], v[226:227], v[76:77], v[178:179] op_sel_hi:[1,0,1]
    v_pk_mul_f32 v[176:177], v[176:177], v[228:229]
    v_pk_mul_f32 v[178:179], v[178:179], v[230:231]
    v_pk_fma_f32 v[180:181], v[232:233], v[76:77], v[180:181] op_sel_hi:[1,0,1]
    v_pk_fma_f32 v[182:183], v[234:235], v[76:77], v[182:183] op_sel_hi:[1,0,1]
    v_pk_mul_f32 v[180:181], v[180:181], v[236:237]
    v_pk_mul_f32 v[182:183], v[182:183], v[238:239]
    v_cvt_pk_bf16_f32 v176, v176, v177
    v_cvt_pk_bf16_f32 v177, v178, v179
    v_cvt_pk_bf16_f32 v178, v180, v181
    v_cvt_pk_bf16_f32 v179, v182, v183
    s_nop 0
    v_permlane16_swap_b32 v176, v178
    v_permlane16_swap_b32 v177, v179
    buffer_store_dwordx4 v[176:179], v7, s[48:51], s60 offen offset:0 sc1
    v_pk_fma_f32 v[184:185], v[240:241], v[76:77], v[184:185] op_sel_hi:[1,0,1]
    v_pk_fma_f32 v[186:187], v[242:243], v[76:77], v[186:187] op_sel_hi:[1,0,1]
    v_pk_mul_f32 v[184:185], v[184:185], v[244:245]
    v_pk_mul_f32 v[186:187], v[186:187], v[246:247]
    v_pk_fma_f32 v[188:189], v[248:249], v[76:77], v[188:189] op_sel_hi:[1,0,1]
    v_pk_fma_f32 v[190:191], v[250:251], v[76:77], v[190:191] op_sel_hi:[1,0,1]
    v_pk_mul_f32 v[188:189], v[188:189], v[252:253]
    v_pk_mul_f32 v[190:191], v[190:191], v[254:255]
    v_cvt_pk_bf16_f32 v184, v184, v185
    v_cvt_pk_bf16_f32 v185, v186, v187
    v_cvt_pk_bf16_f32 v186, v188, v189
    v_cvt_pk_bf16_f32 v187, v190, v191
    s_nop 0
    v_permlane16_swap_b32 v184, v186
    v_permlane16_swap_b32 v185, v187
    buffer_store_dwordx4 v[184:187], v7, s[48:51], s60 offen offset:1024 sc1
    s_add_u32 s60, s60, 65536
    s_waitcnt lgkmcnt(1)
    v_pk_fma_f32 v[192:193], v[224:225], v[80:81], v[192:193] op_sel_hi:[1,0,1]
    v_pk_fma_f32 v[194:195], v[226:227], v[80:81], v[194:195] op_sel_hi:[1,0,1]
    v_pk_mul_f32 v[192:193], v[192:193], v[228:229]
    v_pk_mul_f32 v[194:195], v[194:195], v[230:231]
    v_pk_fma_f32 v[196:197], v[232:233], v[80:81], v[196:197] op_sel_hi:[1,0,1]
    v_pk_fma_f32 v[198:199], v[234:235], v[80:81], v[198:199] op_sel_hi:[1,0,1]
    v_pk_mul_f32 v[196:197], v[196:197], v[236:237]
    v_pk_mul_f32 v[198:199], v[198:199], v[238:239]
    v_cvt_pk_bf16_f32 v192, v192, v193
    v_cvt_pk_bf16_f32 v193, v194, v195
    v_cvt_pk_bf16_f32 v194, v196, v197
    v_cvt_pk_bf16_f32 v195, v198, v199
    s_nop 0
    v_permlane16_swap_b32 v192, v194
    v_permlane16_swap_b32 v193, v195
    buffer_store_dwordx4 v[192:195], v7, s[48:51], s60 offen offset:0 sc1
    v_pk_fma_f32 v[200:201], v[240:241], v[80:81], v[200:201] op_sel_hi:[1,0,1]
    v_pk_fma_f32 v[202:203], v[242:243], v[80:81], v[202:203] op_sel_hi:[1,0,1]
    v_pk_mul_f32 v[200:201], v[200:201], v[244:245]
    v_pk_mul_f32 v[202:203], v[202:203], v[246:247]
    v_pk_fma_f32 v[204:205], v[248:249], v[80:81], v[204:205] op_sel_hi:[1,0,1]
    v_pk_fma_f32 v[206:207], v[250:251], v[80:81], v[206:207] op_sel_hi:[1,0,1]
    v_pk_mul_f32 v[204:205], v[204:205], v[252:253]
    v_pk_mul_f32 v[206:207], v[206:207], v[254:255]
    v_cvt_pk_bf16_f32 v200, v200, v201
    v_cvt_pk_bf16_f32 v201, v202, v203
    v_cvt_pk_bf16_f32 v202, v204, v205
    v_cvt_pk_bf16_f32 v203, v206, v207
    s_nop 0
    v_permlane16_swap_b32 v200, v202
    v_permlane16_swap_b32 v201, v203
    buffer_store_dwordx4 v[200:203], v7, s[48:51], s60 offen offset:1024 sc1
    s_add_u32 s60, s60, 65536
    s_waitcnt lgkmcnt(0)
    v_pk_fma_f32 v[208:209], v[224:225], v[84:85], v[208:209] op_sel_hi:[1,0,1]
    v_pk_fma_f32 v[210:211], v[226:227], v[84:85], v[210:211] op_sel_hi:[1,0,1]
    v_pk_mul_f32 v[208:209], v[208:209], v[228:229]
    v_pk_mul_f32 v[210:211], v[210:211], v[230:231]
    v_pk_fma_f32 v[212:213], v[232:233], v[84:85], v[212:213] op_sel_hi:[1,0,1]
    v_pk_fma_f32 v[214:215], v[234:235], v[84:85], v[214:215] op_sel_hi:[1,0,1]
    v_pk_mul_f32 v[212:213], v[212:213], v[236:237]
    v_pk_mul_f32 v[214:215], v[214:215], v[238:239]
    v_cvt_pk_bf16_f32 v208, v208, v209
    v_cvt_pk_bf16_f32 v209, v210, v211
    v_cvt_pk_bf16_f32 v210, v212, v213
    v_cvt_pk_bf16_f32 v211, v214, v215
    s_nop 0
    v_permlane16_swap_b32 v208, v210
    v_permlane16_swap_b32 v209, v211
    buffer_store_dwordx4 v[208:211], v7, s[48:51], s60 offen offset:0 sc1
    v_pk_fma_f32 v[216:217], v[240:241], v[84:85], v[216:217] op_sel_hi:[1,0,1]
    v_pk_fma_f32 v[218:219], v[242:243], v[84:85], v[218:219] op_sel_hi:[1,0,1]
    v_pk_mul_f32 v[216:217], v[216:217], v[244:245]
    v_pk_mul_f32 v[218:219], v[218:219], v[246:247]
    v_pk_fma_f32 v[220:221], v[248:249], v[84:85], v[220:221] op_sel_hi:[1,0,1]
    v_pk_fma_f32 v[222:223], v[250:251], v[84:85], v[222:223] op_sel_hi:[1,0,1]
    v_pk_mul_f32 v[220:221], v[220:221], v[252:253]
    v_pk_mul_f32 v[222:223], v[222:223], v[254:255]
    v_cvt_pk_bf16_f32 v216, v216, v217
    v_cvt_pk_bf16_f32 v217, v218, v219
    v_cvt_pk_bf16_f32 v218, v220, v221
    v_cvt_pk_bf16_f32 v219, v222, v223
    s_nop 0
    v_permlane16_swap_b32 v216, v218
    v_permlane16_swap_b32 v217, v219
    buffer_store_dwordx4 v[216:219], v7, s[48:51], s60 offen offset:1024 sc1
    s_add_u32 s60, s60, 65536
    s_branch fz_mdone
fz_mQ:
    ds_read_b128 v[24:27], v9 offset:0
    ds_read_b128 v[28:31], v9 offset:2048
    ds_read_b128 v[32:35], v9 offset:4096
    ds_read_b128 v[36:39], v9 offset:6144
    ds_read_b64_tr_b16 v[56:57], v11 offset:0
    ds_read_b64_tr_b16 v[58:59], v11 offset:9216
    ds_read_b64_tr_b16 v[60:61], v11 offset:32
    ds_read_b64_tr_b16 v[62:63], v11 offset:9248
    ds_read_b64_tr_b16 v[64:65], v11 offset:64
    ds_read_b64_tr_b16 v[66:67], v11 offset:9280
    ds_read_b64_tr_b16 v[68:69], v11 offset:96
    ds_read_b64_tr_b16 v[70:71], v11 offset:9312
    s_waitcnt lgkmcnt(6)
    ds_read_b64_tr_b16 v[72:73], v11 offset:128
    ds_read_b64_tr_b16 v[74:75], v11 offset:9344
    ds_read_b64_tr_b16 v[76:77], v11 offset:160
    ds_read_b64_tr_b16 v[78:79], v11 offset:9376
    ds_read_b64_tr_b16 v[80:81], v11 offset:192
    ds_read_b64_tr_b16 v[82:83], v11 offset:9408
    ds_read_b64_tr_b16 v[84:85], v11 offset:224
    ds_read_b64_tr_b16 v[86:87], v11 offset:9440
    v_mfma_f32_16x16x32_bf16 v[96:99], v[56:59], v[24:27], 0
    v_mfma_f32_16x16x32_bf16 v[100:103], v[56:59], v[28:31], 0
    v_mfma_f32_16x16x32_bf16 v[104:107], v[56:59], v[32:35], 0
    v_mfma_f32_16x16x32_bf16 v[108:111], v[56:59], v[36:39], 0
    s_waitcnt lgkmcnt(12)
    v_mfma_f32_16x16x32_bf16 v[112:115], v[60:63], v[24:27], 0
    ds_read_b64_tr_b16 v[56:57], v11 offset:18432
    v_mfma_f32_16x16x32_bf16 v[116:119], v[60:63], v[28:31], 0
    ds_read_b64_tr_b16 v[58:59], v11 offset:27648
    v_mfma_f32_16x16x32_bf16 v[120:123], v[60:63], v[32:35], 0
    v_mfma_f32_16x16x32_bf16 v[124:127], v[60:63], v[36:39], 0
    s_waitcnt lgkmcnt(12)
    v_mfma_f32_16x16x32_bf16 v[128:131], v[64:67], v[24:27], 0
    ds_read_b64_tr_b16 v[60:61], v11 offset:18464
    v_mfma_f32_16x16x32_bf16 v[132:135], v[64:67], v[28:31], 0
    ds_read_b64_tr_b16 v[62:63], v11 offset:27680
    v_mfma_f32_16x16x32_bf16 v[136:139], v[64:67], v[32:35], 0
    v_mfma_f32_16x16x32_bf16 v[140:143], v[64:67], v[36:39], 0
    s_waitcnt lgkmcnt(12)
    v_mfma_f32_16x16x32_bf16 v[144:147], v[68:71], v[24:27], 0
    ds_read_b64_tr_b16 v[64:65], v11 offset:18496
    v_mfma_f32_16x16x32_bf16 v[148:151], v[68:71], v[28:31], 0
    ds_read_b64_tr_b16 v[66:67], v11 offset:27712
    v_mfma_f32_16x16x32_bf16 v[152:155], v[68:71], v[32:35], 0
    ds_read_b128 v[40:43], v10 offset:0
    v_mfma_f32_16x16x32_bf16 v[156:159], v[68:71], v[36:39], 0
    ds_read_b128 v[44:47], v10 offset:2048
    s_waitcnt lgkmcnt(12)
    v_mfma_f32_16x16x32_bf16 v[160:163], v[72:75], v[24:27], 0
    ds_read_b64_tr_b16 v[68:69], v11 offset:18528
    v_mfma_f32_16x16x32_bf16 v[164:167], v[72:75], v[28:31], 0
    ds_read_b64_tr_b16 v[70:71], v11 offset:27744
    v_mfma_f32_16x16x32_bf16 v[168:171], v[72:75], v[32:35], 0
    ds_read_b128 v[48:51], v10 offset:4096
    v_mfma_f32_16x16x32_bf16 v[172:175], v[72:75], v[36:39], 0
    ds_read_b128 v[52:55], v10 offset:6144
    v_mfma_f32_16x16x32_bf16 v[176:179], v[76:79], v[24:27], 0
    ds_read_b64_tr_b16 v[72:73], v11 offset:18560
    v_mfma_f32_16x16x32_bf16 v[180:183], v[76:79], v[28:31], 0
    ds_read_b64_tr_b16 v[74:75], v11 offset:27776
    v_mfma_f32_16x16x32_bf16 v[184:187], v[76:79], v[32:35], 0
    v_mfma_f32_16x16x32_bf16 v[188:191], v[76:79], v[36:39], 0
    s_waitcnt lgkmcnt(12)
    v_mfma_f32_16x16x32_bf16 v[192:195], v[80:83], v[24:27], 0
    ds_read_b64_tr_b16 v[76:77], v11 offset:18592
    v_mfma_f32_16x16x32_bf16 v[196:199], v[80:83], v[28:31], 0
    ds_read_b64_tr_b16 v[78:79], v11 offset:27808
    v_mfma_f32_16x16x32_bf16 v[200:203], v[80:83], v[32:35], 0
    v_mfma_f32_16x16x32_bf16 v[204:207], v[80:83], v[36:39], 0
    v_mfma_f32_16x16x32_bf16 v[208:211], v[84:87], v[24:27], 0
    ds_read_b64_tr_b16 v[80:81], v11 offset:18624
    v_mfma_f32_16x16x32_bf16 v[212:215], v[84:87], v[28:31], 0
    ds_read_b64_tr_b16 v[82:83], v11 offset:27840
    v_mfma_f32_16x16x32_bf16 v[216:219], v[84:87], v[32:35], 0
    v_mfma_f32_16x16x32_bf16 v[220:223], v[84:87], v[36:39], 0
    s_waitcnt lgkmcnt(6)
    v_mfma_f32_16x16x32_bf16 v[96:99], v[56:59], v[40:43], v[96:99]
    ds_read_b64_tr_b16 v[84:85], v11 offset:18656
    v_mfma_f32_16x16x32_bf16 v[100:103], v[56:59], v[44:47], v[100:103]
    ds_read_b64_tr_b16 v[86:87], v11 offset:27872
    v_mfma_f32_16x16x32_bf16 v[104:107], v[56:59], v[48:51], v[104:107]
    v_mfma_f32_16x16x32_bf16 v[108:111], v[56:59], v[52:55], v[108:111]
    v_mfma_f32_16x16x32_bf16 v[112:115], v[60:63], v[40:43], v[112:115]
    v_mfma_f32_16x16x32_bf16 v[116:119], v[60:63], v[44:47], v[116:119]
    v_mfma_f32_16x16x32_bf16 v[120:123], v[60:63], v[48:51], v[120:123]
    v_mfma_f32_16x16x32_bf16 v[124:127], v[60:63], v[52:55], v[124:127]
    s_waitcnt lgkmcnt(0)
    s_barrier
    v_mfma_f32_16x16x32_bf16 v[128:131], v[64:67], v[40:43], v[128:131]
    ds_read_b64_tr_b16 v[56:57], v14 offset:0
    v_mfma_f32_16x16x32_bf16 v[132:135], v[64:67], v[44:47], v[132:135]
    ds_read_b64_tr_b16 v[58:59], v14 offset:9216
    v_mfma_f32_16x16x32_bf16 v[136:139], v[64:67], v[48:51], v[136:139]
    ds_read_b64_tr_b16 v[60:61], v14 offset:32
    v_mfma_f32_16x16x32_bf16 v[140:143], v[64:67], v[52:55], v[140:143]
    ds_read_b64_tr_b16 v[62:63], v14 offset:9248
    v_mfma_f32_16x16x32_bf16 v[144:147], v[68:71], v[40:43], v[144:147]
    ds_read_b64_tr_b16 v[64:65], v14 offset:64
    v_mfma_f32_16x16x32_bf16 v[148:151], v[68:71], v[44:47], v[148:151]
    ds_read_b64_tr_b16 v[66:67], v14 offset:9280
    v_mfma_f32_16x16x32_bf16 v[152:155], v[68:71], v[48:51], v[152:155]
    ds_read_b128 v[24:27], v12 offset:0
    v_mfma_f32_16x16x32_bf16 v[156:159], v[68:71], v[52:55], v[156:159]
    ds_read_b128 v[28:31], v12 offset:2048
    v_mfma_f32_16x16x32_bf16 v[160:163], v[72:75], v[40:43], v[160:163]
    ds_read_b64_tr_b16 v[68:69], v14 offset:96
    v_mfma_f32_16x16x32_bf16 v[164:167], v[72:75], v[44:47], v[164:167]
    ds_read_b64_tr_b16 v[70:71], v14 offset:9312
    v_mfma_f32_16x16x32_bf16 v[168:171], v[72:75], v[48:51], v[168:171]
    ds_read_b128 v[32:35], v12 offset:4096
    v_mfma_f32_16x16x32_bf16 v[172:175], v[72:75], v[52:55], v[172:175]
    ds_read_b128 v[36:39], v12 offset:6144
    v_mfma_f32_16x16x32_bf16 v[176:179], v[76:79], v[40:43], v[176:179]
    ds_read_b64_tr_b16 v[72:73], v14 offset:128
    v_mfma_f32_16x16x32_bf16 v[180:183], v[76:79], v[44:47], v[180:183]
    ds_read_b64_tr_b16 v[74:75], v14 offset:9344
    v_mfma_f32_16x16x32_bf16 v[184:187], v[76:79], v[48:51], v[184:187]
    v_mfma_f32_16x16x32_bf16 v[188:191], v[76:79], v[52:55], v[188:191]
    v_mfma_f32_16x16x32_bf16 v[192:195], v[80:83], v[40:43], v[192:195]
    ds_read_b64_tr_b16 v[76:77], v14 offset:160
    v_mfma_f32_16x16x32_bf16 v[196:199], v[80:83], v[44:47], v[196:199]
    ds_read_b64_tr_b16 v[78:79], v14 offset:9376
    v_mfma_f32_16x16x32_bf16 v[200:203], v[80:83], v[48:51], v[200:203]
    v_mfma_f32_16x16x32_bf16 v[204:207], v[80:83], v[52:55], v[204:207]
    v_mfma_f32_16x16x32_bf16 v[208:211], v[84:87], v[40:43], v[208:211]
    ds_read_b64_tr_b16 v[80:81], v14 offset:192
    v_mfma_f32_16x16x32_bf16 v[212:215], v[84:87], v[44:47], v[212:215]
    ds_read_b64_tr_b16 v[82:83], v14 offset:9408
    v_mfma_f32_16x16x32_bf16 v[216:219], v[84:87], v[48:51], v[216:219]
    v_mfma_f32_16x16x32_bf16 v[220:223], v[84:87], v[52:55], v[220:223]
    s_waitcnt lgkmcnt(6)
    v_mfma_f32_16x16x32_bf16 v[96:99], v[56:59], v[24:27], v[96:99]
    ds_read_b64_tr_b16 v[84:85], v14 offset:224
    v_mfma_f32_16x16x32_bf16 v[100:103], v[56:59], v[28:31], v[100:103]
    ds_read_b64_tr_b16 v[86:87], v14 offset:9440
    v_mfma_f32_16x16x32_bf16 v[104:107], v[56:59], v[32:35], v[104:107]
    v_mfma_f32_16x16x32_bf16 v[108:111], v[56:59], v[36:39], v[108:111]
    v_mfma_f32_16x16x32_bf16 v[112:115], v[60:63], v[24:27], v[112:115]
    ds_read_b64_tr_b16 v[56:57], v14 offset:18432
    v_mfma_f32_16x16x32_bf16 v[116:119], v[60:63], v[28:31], v[116:119]
    ds_read_b64_tr_b16 v[58:59], v14 offset:27648
    v_mfma_f32_16x16x32_bf16 v[120:123], v[60:63], v[32:35], v[120:123]
    v_mfma_f32_16x16x32_bf16 v[124:127], v[60:63], v[36:39], v[124:127]
    v_mfma_f32_16x16x32_bf16 v[128:131], v[64:67], v[24:27], v[128:131]
    ds_read_b64_tr_b16 v[60:61], v14 offset:18464
    v_mfma_f32_16x16x32_bf16 v[132:135], v[64:67], v[28:31], v[132:135]
    ds_read_b64_tr_b16 v[62:63], v14 offset:27680
    v_mfma_f32_16x16x32_bf16 v[136:139], v[64:67], v[32:35], v[136:139]
    v_mfma_f32_16x16x32_bf16 v[140:143], v[64:67], v[36:39], v[140:143]
    v_mfma_f32_16x16x32_bf16 v[144:147], v[68:71], v[24:27], v[144:147]
    ds_read_b64_tr_b16 v[64:65], v14 offset:18496
    v_mfma_f32_16x16x32_bf16 v[148:151], v[68:71], v[28:31], v[148:151]
    ds_read_b64_tr_b16 v[66:67], v14 offset:27712
    v_mfma_f32_16x16x32_bf16 v[152:155], v[68:71], v[32:35], v[152:155]
    ds_read_b128 v[40:43], v13 offset:0
    v_mfma_f32_16x16x32_bf16 v[156:159], v[68:71], v[36:39], v[156:159]
    ds_read_b128 v[44:47], v13 offset:2048
    s_waitcnt lgkmcnt(12)
    v_mfma_f32_16x16x32_bf16 v[160:163], v[72:75], v[24:27], v[160:163]
    ds_read_b64_tr_b16 v[68:69], v14 offset:18528
    v_mfma_f32_16x16x32_bf16 v[164:167], v[72:75], v[28:31], v[164:167]
    ds_read_b64_tr_b16 v[70:71], v14 offset:27744
    v_mfma_f32_16x16x32_bf16 v[168:171], v[72:75], v[32:35], v[168:171]
    ds_read_b128 v[48:51], v13 offset:4096
    v_mfma_f32_16x16x32_bf16 v[172:175], v[72:75], v[36:39], v[172:175]
    ds_read_b128 v[52:55], v13 offset:6144
    v_mfma_f32_16x16x32_bf16 v[176:179], v[76:79], v[24:27], v[176:179]
    ds_read_b64_tr_b16 v[72:73], v14 offset:18560
    v_mfma_f32_16x16x32_bf16 v[180:183], v[76:79], v[28:31], v[180:183]
    ds_read_b64_tr_b16 v[74:75], v14 offset:27776
    v_mfma_f32_16x16x32_bf16 v[184:187], v[76:79], v[32:35], v[184:187]
    v_mfma_f32_16x16x32_bf16 v[188:191], v[76:79], v[36:39], v[188:191]
    s_waitcnt lgkmcnt(12)
    v_mfma_f32_16x16x32_bf16 v[192:195], v[80:83], v[24:27], v[192:195]
    ds_read_b64_tr_b16 v[76:77], v14 offset:18592
    v_mfma_f32_16x16x32_bf16 v[196:199], v[80:83], v[28:31], v[196:199]
    ds_read_b64_tr_b16 v[78:79], v14 offset:27808
    v_mfma_f32_16x16x32_bf16 v[200:203], v[80:83], v[32:35], v[200:203]
    v_mfma_f32_16x16x32_bf16 v[204:207], v[80:83], v[36:39], v[204:207]
    v_mfma_f32_16x16x32_bf16 v[208:211], v[84:87], v[24:27], v[208:211]
    ds_read_b64_tr_b16 v[80:81], v14 offset:18624
    v_mfma_f32_16x16x32_bf16 v[212:215], v[84:87], v[28:31], v[212:215]
    ds_read_b64_tr_b16 v[82:83], v14 offset:27840
    v_mfma_f32_16x16x32_bf16 v[216:219], v[84:87], v[32:35], v[216:219]
    v_mfma_f32_16x16x32_bf16 v[220:223], v[84:87], v[36:39], v[220:223]
    s_waitcnt lgkmcnt(6)
    v_mfma_f32_16x16x32_bf16 v[96:99], v[56:59], v[40:43], v[96:99]
    ds_read_b64_tr_b16 v[84:85], v14 offset:18656
    v_mfma_f32_16x16x32_bf16 v[100:103], v[56:59], v[44:47], v[100:103]
    ds_read_b64_tr_b16 v[86:87], v14 offset:27872
    v_mfma_f32_16x16x32_bf16 v[104:107], v[56:59], v[48:51], v[104:107]
    v_mfma_f32_16x16x32_bf16 v[108:111], v[56:59], v[52:55], v[108:111]
    v_mfma_f32_16x16x32_bf16 v[112:115], v[60:63], v[40:43], v[112:115]
    v_mfma_f32_16x16x32_bf16 v[116:119], v[60:63], v[44:47], v[116:119]
    v_mfma_f32_16x16x32_bf16 v[120:123], v[60:63], v[48:51], v[120:123]
    v_mfma_f32_16x16x32_bf16 v[124:127], v[60:63], v[52:55], v[124:127]
    s_waitcnt lgkmcnt(0)
    s_barrier
    v_mfma_f32_16x16x32_bf16 v[128:131], v[64:67], v[40:43], v[128:131]
    ds_read_b64_tr_b16 v[56:57], v17 offset:0
    v_mfma_f32_16x16x32_bf16 v[132:135], v[64:67], v[44:47], v[132:135]
    ds_read_b64_tr_b16 v[58:59], v17 offset:9216
    v_mfma_f32_16x16x32_bf16 v[136:139], v[64:67], v[48:51], v[136:139]
    ds_read_b64_tr_b16 v[60:61], v17 offset:32
    v_mfma_f32_16x16x32_bf16 v[140:143], v[64:67], v[52:55], v[140:143]
    ds_read_b64_tr_b16 v[62:63], v17 offset:9248
    v_mfma_f32_16x16x32_bf16 v[144:147], v[68:71], v[40:43], v[144:147]
    ds_read_b64_tr_b16 v[64:65], v17 offset:64
    v_mfma_f32_16x16x32_bf16 v[148:151], v[68:71], v[44:47], v[148:151]
    ds_read_b64_tr_b16 v[66:67], v17 offset:9280
    v_mfma_f32_16x16x32_bf16 v[152:155], v[68:71], v[48:51], v[152:155]
    ds_read_b128 v[24:27], v15 offset:0
    v_mfma_f32_16x16x32_bf16 v[156:159], v[68:71], v[52:55], v[156:159]
    ds_read_b128 v[28:31], v15 offset:2048
    v_mfma_f32_16x16x32_bf16 v[160:163], v[72:75], v[40:43], v[160:163]
    ds_read_b64_tr_b16 v[68:69], v17 offset:96
    v_mfma_f32_16x16x32_bf16 v[164:167], v[72:75], v[44:47], v[164:167]
    ds_read_b64_tr_b16 v[70:71], v17 offset:9312
    v_mfma_f32_16x16x32_bf16 v[168:171], v[72:75], v[48:51], v[168:171]
    ds_read_b128 v[32:35], v15 offset:4096
    v_mfma_f32_16x16x32_bf16 v[172:175], v[72:75], v[52:55], v[172:175]
    ds_read_b128 v[36:39], v15 offset:6144
    v_mfma_f32_16x16x32_bf16 v[176:179], v[76:79], v[40:43], v[176:179]
    ds_read_b64_tr_b16 v[72:73], v17 offset:128
    v_mfma_f32_16x16x32_bf16 v[180:183], v[76:79], v[44:47], v[180:183]
    ds_read_b64_tr_b16 v[74:75], v17 offset:9344
    v_mfma_f32_16x16x32_bf16 v[184:187], v[76:79], v[48:51], v[184:187]
    v_mfma_f32_16x16x32_bf16 v[188:191], v[76:79], v[52:55], v[188:191]
    v_mfma_f32_16x16x32_bf16 v[192:195], v[80:83], v[40:43], v[192:195]
    ds_read_b64_tr_b16 v[76:77], v17 offset:160
    v_mfma_f32_16x16x32_bf16 v[196:199], v[80:83], v[44:47], v[196:199]
    ds_read_b64_tr_b16 v[78:79], v17 offset:9376
    v_mfma_f32_16x16x32_bf16 v[200:203], v[80:83], v[48:51], v[200:203]
    v_mfma_f32_16x16x32_bf16 v[204:207], v[80:83], v[52:55], v[204:207]
    v_mfma_f32_16x16x32_bf16 v[208:211], v[84:87], v[40:43], v[208:211]
    ds_read_b64_tr_b16 v[80:81], v17 offset:192
    v_mfma_f32_16x16x32_bf16 v[212:215], v[84:87], v[44:47], v[212:215]
    ds_read_b64_tr_b16 v[82:83], v17 offset:9408
    v_mfma_f32_16x16x32_bf16 v[216:219], v[84:87], v[48:51], v[216:219]
    v_mfma_f32_16x16x32_bf16 v[220:223], v[84:87], v[52:55], v[220:223]
    s_cmp_lg_u32 s26, 0
    s_cbranch_scc1 fz_npd6
    s_mov_b32 s52, s16
    s_mov_b32 s53, s17
    s_mov_b32 s54, 0x158000
    s_mov_b32 s55, 0x00020000
    s_mul_i32 s67, s2, 5504
    v_lshlrev_b32 v22, 7, v0
    v_min_u32 v22, 5376, v22
    buffer_load_dword v21, v22, s[52:55], s67 offen
fz_npd6:
    s_cmp_lg_u32 s26, 1
    s_cbranch_scc1 fz_npd7
    s_mov_b32 s52, s8
    s_mov_b32 s53, s9
    s_mov_b32 s54, 0x80000
    s_mov_b32 s55, 0x00020000
    s_mul_i32 s67, s2, 2048
    v_lshlrev_b32 v22, 7, v0
    v_min_u32 v22, 1920, v22
    buffer_load_dword v21, v22, s[52:55], s67 offen
fz_npd7:
    s_waitcnt lgkmcnt(6)
    v_mfma_f32_16x16x32_bf16 v[96:99], v[56:59], v[24:27], v[96:99]
    ds_read_b64_tr_b16 v[84:85], v17 offset:224
    v_mfma_f32_16x16x32_bf16 v[100:103], v[56:59], v[28:31], v[100:103]
    ds_read_b64_tr_b16 v[86:87], v17 offset:9440
    v_mfma_f32_16x16x32_bf16 v[104:107], v[56:59], v[32:35], v[104:107]
    v_mfma_f32_16x16x32_bf16 v[108:111], v[56:59], v[36:39], v[108:111]
    v_mfma_f32_16x16x32_bf16 v[112:115], v[60:63], v[24:27], v[112:115]
    ds_read_b64_tr_b16 v[56:57], v17 offset:18432
    v_mfma_f32_16x16x32_bf16 v[116:119], v[60:63], v[28:31], v[116:119]
    ds_read_b64_tr_b16 v[58:59], v17 offset:27648
    v_mfma_f32_16x16x32_bf16 v[120:123], v[60:63], v[32:35], v[120:123]
    v_mfma_f32_16x16x32_bf16 v[124:127], v[60:63], v[36:39], v[124:127]
    v_mfma_f32_16x16x32_bf16 v[128:131], v[64:67], v[24:27], v[128:131]
    ds_read_b64_tr_b16 v[60:61], v17 offset:18464
    v_mfma_f32_16x16x32_bf16 v[132:135], v[64:67], v[28:31], v[132:135]
    ds_read_b64_tr_b16 v[62:63], v17 offset:27680
    v_mfma_f32_16x16x32_bf16 v[136:139], v[64:67], v[32:35], v[136:139]
    v_mfma_f32_16x16x32_bf16 v[140:143], v[64:67], v[36:39], v[140:143]
    v_mfma_f32_16x16x32_bf16 v[144:147], v[68:71], v[24:27], v[144:147]
    ds_read_b64_tr_b16 v[64:65], v17 offset:18496
    v_mfma_f32_16x16x32_bf16 v[148:151], v[68:71], v[28:31], v[148:151]
    ds_read_b64_tr_b16 v[66:67], v17 offset:27712
    v_mfma_f32_16x16x32_bf16 v[152:155], v[68:71], v[32:35], v[152:155]
    ds_read_b128 v[40:43], v16 offset:0
    v_mfma_f32_16x16x32_bf16 v[156:159], v[68:71], v[36:39], v[156:159]
    ds_read_b128 v[44:47], v16 offset:2048
    s_waitcnt lgkmcnt(12)
    v_mfma_f32_16x16x32_bf16 v[160:163], v[72:75], v[24:27], v[160:163]
    ds_read_b64_tr_b16 v[68:69], v17 offset:18528
    v_mfma_f32_16x16x32_bf16 v[164:167], v[72:75], v[28:31], v[164:167]
    ds_read_b64_tr_b16 v[70:71], v17 offset:27744
    v_mfma_f32_16x16x32_bf16 v[168:171], v[72:75], v[32:35], v[168:171]
    ds_read_b128 v[48:51], v16 offset:4096
    v_mfma_f32_16x16x32_bf16 v[172:175], v[72:75], v[36:39], v[172:175]
    ds_read_b128 v[52:55], v16 offset:6144
    v_mfma_f32_16x16x32_bf16 v[176:179], v[76:79], v[24:27], v[176:179]
    ds_read_b64_tr_b16 v[72:73], v17 offset:18560
    v_mfma_f32_16x16x32_bf16 v[180:183], v[76:79], v[28:31], v[180:183]
    ds_read_b64_tr_b16 v[74:75], v17 offset:27776
    v_mfma_f32_16x16x32_bf16 v[184:187], v[76:79], v[32:35], v[184:187]
    v_mfma_f32_16x16x32_bf16 v[188:191], v[76:79], v[36:39], v[188:191]
    s_waitcnt lgkmcnt(12)
    v_mfma_f32_16x16x32_bf16 v[192:195], v[80:83], v[24:27], v[192:195]
    ds_read_b64_tr_b16 v[76:77], v17 offset:18592
    v_mfma_f32_16x16x32_bf16 v[196:199], v[80:83], v[28:31], v[196:199]
    ds_read_b64_tr_b16 v[78:79], v17 offset:27808
    v_mfma_f32_16x16x32_bf16 v[200:203], v[80:83], v[32:35], v[200:203]
    v_mfma_f32_16x16x32_bf16 v[204:207], v[80:83], v[36:39], v[204:207]
    v_mfma_f32_16x16x32_bf16 v[208:211], v[84:87], v[24:27], v[208:211]
    ds_read_b64_tr_b16 v[80:81], v17 offset:18624
    v_mfma_f32_16x16x32_bf16 v[212:215], v[84:87], v[28:31], v[212:215]
    ds_read_b64_tr_b16 v[82:83], v17 offset:27840
    v_mfma_f32_16x16x32_bf16 v[216:219], v[84:87], v[32:35], v[216:219]
    v_mfma_f32_16x16x32_bf16 v[220:223], v[84:87], v[36:39], v[220:223]
    s_waitcnt lgkmcnt(6)
    v_mfma_f32_16x16x32_bf16 v[96:99], v[56:59], v[40:43], v[96:99]
    ds_read_b64_tr_b16 v[84:85], v17 offset:18656
    v_mfma_f32_16x16x32_bf16 v[100:103], v[56:59], v[44:47], v[100:103]
    ds_read_b64_tr_b16 v[86:87], v17 offset:27872
    v_mfma_f32_16x16x32_bf16 v[104:107], v[56:59], v[48:51], v[104:107]
    v_mfma_f32_16x16x32_bf16 v[108:111], v[56:59], v[52:55], v[108:111]
    v_mfma_f32_16x16x32_bf16 v[112:115], v[60:63], v[40:43], v[112:115]
    v_mfma_f32_16x16x32_bf16 v[116:119], v[60:63], v[44:47], v[116:119]
    v_mfma_f32_16x16x32_bf16 v[120:123], v[60:63], v[48:51], v[120:123]
    v_mfma_f32_16x16x32_bf16 v[124:127], v[60:63], v[52:55], v[124:127]
    s_waitcnt lgkmcnt(0)
    s_barrier
    v_mfma_f32_16x16x32_bf16 v[128:131], v[64:67], v[40:43], v[128:131]
    ds_read_b64_tr_b16 v[56:57], v11 offset:0
    v_mfma_f32_16x16x32_bf16 v[132:135], v[64:67], v[44:47], v[132:135]
    ds_read_b64_tr_b16 v[58:59], v11 offset:9216
    v_mfma_f32_16x16x32_bf16 v[136:139], v[64:67], v[48:51], v[136:139]
    ds_read_b64_tr_b16 v[60:61], v11 offset:32
    v_mfma_f32_16x16x32_bf16 v[140:143], v[64:67], v[52:55], v[140:143]
    ds_read_b64_tr_b16 v[62:63], v11 offset:9248
    v_mfma_f32_16x16x32_bf16 v[144:147], v[68:71], v[40:43], v[144:147]
    ds_read_b64_tr_b16 v[64:65], v11 offset:64
    v_mfma_f32_16x16x32_bf16 v[148:151], v[68:71], v[44:47], v[148:151]
    ds_read_b64_tr_b16 v[66:67], v11 offset:9280
    v_mfma_f32_16x16x32_bf16 v[152:155], v[68:71], v[48:51], v[152:155]
    ds_read_b128 v[24:27], v9 offset:0
    v_mfma_f32_16x16x32_bf16 v[156:159], v[68:71], v[52:55], v[156:159]
    ds_read_b128 v[28:31], v9 offset:2048
    v_mfma_f32_16x16x32_bf16 v[160:163], v[72:75], v[40:43], v[160:163]
    ds_read_b64_tr_b16 v[68:69], v11 offset:96
    v_mfma_f32_16x16x32_bf16 v[164:167], v[72:75], v[44:47], v[164:167]
    ds_read_b64_tr_b16 v[70:71], v11 offset:9312
    v_mfma_f32_16x16x32_bf16 v[168:171], v[72:75], v[48:51], v[168:171]
    ds_read_b128 v[32:35], v9 offset:4096
    v_mfma_f32_16x16x32_bf16 v[172:175], v[72:75], v[52:55], v[172:175]
    ds_read_b128 v[36:39], v9 offset:6144
    v_mfma_f32_16x16x32_bf16 v[176:179], v[76:79], v[40:43], v[176:179]
    ds_read_b64_tr_b16 v[72:73], v11 offset:128
    v_mfma_f32_16x16x32_bf16 v[180:183], v[76:79], v[44:47], v[180:183]
    ds_read_b64_tr_b16 v[74:75], v11 offset:9344
    v_mfma_f32_16x16x32_bf16 v[184:187], v[76:79], v[48:51], v[184:187]
    v_mfma_f32_16x16x32_bf16 v[188:191], v[76:79], v[52:55], v[188:191]
    v_mfma_f32_16x16x32_bf16 v[192:195], v[80:83], v[40:43], v[192:195]
    ds_read_b64_tr_b16 v[76:77], v11 offset:160
    v_mfma_f32_16x16x32_bf16 v[196:199], v[80:83], v[44:47], v[196:199]
    ds_read_b64_tr_b16 v[78:79], v11 offset:9376
    v_mfma_f32_16x16x32_bf16 v[200:203], v[80:83], v[48:51], v[200:203]
    v_mfma_f32_16x16x32_bf16 v[204:207], v[80:83], v[52:55], v[204:207]
    v_mfma_f32_16x16x32_bf16 v[208:211], v[84:87], v[40:43], v[208:211]
    ds_read_b64_tr_b16 v[80:81], v11 offset:192
    v_mfma_f32_16x16x32_bf16 v[212:215], v[84:87], v[44:47], v[212:215]
    ds_read_b64_tr_b16 v[82:83], v11 offset:9408
    v_mfma_f32_16x16x32_bf16 v[216:219], v[84:87], v[48:51], v[216:219]
    v_mfma_f32_16x16x32_bf16 v[220:223], v[84:87], v[52:55], v[220:223]
    s_waitcnt lgkmcnt(6)
    v_mfma_f32_16x16x32_bf16 v[96:99], v[56:59], v[24:27], v[96:99]
    ds_read_b64_tr_b16 v[84:85], v11 offset:224
    v_mfma_f32_16x16x32_bf16 v[100:103], v[56:59], v[28:31], v[100:103]
    ds_read_b64_tr_b16 v[86:87], v11 offset:9440
    v_mfma_f32_16x16x32_bf16 v[104:107], v[56:59], v[32:35], v[104:107]
    v_mfma_f32_16x16x32_bf16 v[108:111], v[56:59], v[36:39], v[108:111]
    v_mfma_f32_16x16x32_bf16 v[112:115], v[60:63], v[24:27], v[112:115]
    ds_read_b64_tr_b16 v[56:57], v11 offset:18432
    v_mfma_f32_16x16x32_bf16 v[116:119], v[60:63], v[28:31], v[116:119]
    ds_read_b64_tr_b16 v[58:59], v11 offset:27648
    v_mfma_f32_16x16x32_bf16 v[120:123], v[60:63], v[32:35], v[120:123]
    v_mfma_f32_16x16x32_bf16 v[124:127], v[60:63], v[36:39], v[124:127]
    v_mfma_f32_16x16x32_bf16 v[128:131], v[64:67], v[24:27], v[128:131]
    ds_read_b64_tr_b16 v[60:61], v11 offset:18464
    v_mfma_f32_16x16x32_bf16 v[132:135], v[64:67], v[28:31], v[132:135]
    ds_read_b64_tr_b16 v[62:63], v11 offset:27680
    v_mfma_f32_16x16x32_bf16 v[136:139], v[64:67], v[32:35], v[136:139]
    v_mfma_f32_16x16x32_bf16 v[140:143], v[64:67], v[36:39], v[140:143]
    v_mfma_f32_16x16x32_bf16 v[144:147], v[68:71], v[24:27], v[144:147]
    ds_read_b64_tr_b16 v[64:65], v11 offset:18496
    v_mfma_f32_16x16x32_bf16 v[148:151], v[68:71], v[28:31], v[148:151]
    ds_read_b64_tr_b16 v[66:67], v11 offset:27712
    v_mfma_f32_16x16x32_bf16 v[152:155], v[68:71], v[32:35], v[152:155]
    ds_read_b128 v[40:43], v10 offset:0
    v_mfma_f32_16x16x32_bf16 v[156:159], v[68:71], v[36:39], v[156:159]
    ds_read_b128 v[44:47], v10 offset:2048
    s_waitcnt lgkmcnt(12)
    v_mfma_f32_16x16x32_bf16 v[160:163], v[72:75], v[24:27], v[160:163]
    ds_read_b64_tr_b16 v[68:69], v11 offset:18528
    v_mfma_f32_16x16x32_bf16 v[164:167], v[72:75], v[28:31], v[164:167]
    ds_read_b64_tr_b16 v[70:71], v11 offset:27744
    v_mfma_f32_16x16x32_bf16 v[168:171], v[72:75], v[32:35], v[168:171]
    ds_read_b128 v[48:51], v10 offset:4096
    v_mfma_f32_16x16x32_bf16 v[172:175], v[72:75], v[36:39], v[172:175]
    ds_read_b128 v[52:55], v10 offset:6144
    v_mfma_f32_16x16x32_bf16 v[176:179], v[76:79], v[24:27], v[176:179]
    ds_read_b64_tr_b16 v[72:73], v11 offset:18560
    v_mfma_f32_16x16x32_bf16 v[180:183], v[76:79], v[28:31], v[180:183]
    ds_read_b64_tr_b16 v[74:75], v11 offset:27776
    v_mfma_f32_16x16x32_bf16 v[184:187], v[76:79], v[32:35], v[184:187]
    v_mfma_f32_16x16x32_bf16 v[188:191], v[76:79], v[36:39], v[188:191]
    s_waitcnt lgkmcnt(12)
    v_mfma_f32_16x16x32_bf16 v[192:195], v[80:83], v[24:27], v[192:195]
    ds_read_b64_tr_b16 v[76:77], v11 offset:18592
    v_mfma_f32_16x16x32_bf16 v[196:199], v[80:83], v[28:31], v[196:199]
    ds_read_b64_tr_b16 v[78:79], v11 offset:27808
    v_mfma_f32_16x16x32_bf16 v[200:203], v[80:83], v[32:35], v[200:203]
    v_mfma_f32_16x16x32_bf16 v[204:207], v[80:83], v[36:39], v[204:207]
    v_mfma_f32_16x16x32_bf16 v[208:211], v[84:87], v[24:27], v[208:211]
    ds_read_b64_tr_b16 v[80:81], v11 offset:18624
    v_mfma_f32_16x16x32_bf16 v[212:215], v[84:87], v[28:31], v[212:215]
    ds_read_b64_tr_b16 v[82:83], v11 offset:27840
    v_mfma_f32_16x16x32_bf16 v[216:219], v[84:87], v[32:35], v[216:219]
    v_mfma_f32_16x16x32_bf16 v[220:223], v[84:87], v[36:39], v[220:223]
    s_waitcnt lgkmcnt(6)
    v_mfma_f32_16x16x32_bf16 v[96:99], v[56:59], v[40:43], v[96:99]
    ds_read_b64_tr_b16 v[84:85], v11 offset:18656
    v_mfma_f32_16x16x32_bf16 v[100:103], v[56:59], v[44:47], v[100:103]
    ds_read_b64_tr_b16 v[86:87], v11 offset:27872
    v_mfma_f32_16x16x32_bf16 v[104:107], v[56:59], v[48:51], v[104:107]
    v_mfma_f32_16x16x32_bf16 v[108:111], v[56:59], v[52:55], v[108:111]
    v_mfma_f32_16x16x32_bf16 v[112:115], v[60:63], v[40:43], v[112:115]
    v_mfma_f32_16x16x32_bf16 v[116:119], v[60:63], v[44:47], v[116:119]
    v_mfma_f32_16x16x32_bf16 v[120:123], v[60:63], v[48:51], v[120:123]
    v_mfma_f32_16x16x32_bf16 v[124:127], v[60:63], v[52:55], v[124:127]
    s_waitcnt lgkmcnt(0)
    s_barrier
    v_mfma_f32_16x16x32_bf16 v[128:131], v[64:67], v[40:43], v[128:131]
    ds_read_b64_tr_b16 v[56:57], v14 offset:0
    v_mfma_f32_16x16x32_bf16 v[132:135], v[64:67], v[44:47], v[132:135]
    ds_read_b64_tr_b16 v[58:59], v14 offset:9216
    v_mfma_f32_16x16x32_bf16 v[136:139], v[64:67], v[48:51], v[136:139]
    ds_read_b64_tr_b16 v[60:61], v14 offset:32
    v_mfma_f32_16x16x32_bf16 v[140:143], v[64:67], v[52:55], v[140:143]
    ds_read_b64_tr_b16 v[62:63], v14 offset:9248
    v_mfma_f32_16x16x32_bf16 v[144:147], v[68:71], v[40:43], v[144:147]
    ds_read_b64_tr_b16 v[64:65], v14 offset:64
    v_mfma_f32_16x16x32_bf16 v[148:151], v[68:71], v[44:47], v[148:151]
    ds_read_b64_tr_b16 v[66:67], v14 offset:9280
    v_mfma_f32_16x16x32_bf16 v[152:155], v[68:71], v[48:51], v[152:155]
    ds_read_b128 v[24:27], v12 offset:0
    v_mfma_f32_16x16x32_bf16 v[156:159], v[68:71], v[52:55], v[156:159]
    ds_read_b128 v[28:31], v12 offset:2048
    v_mfma_f32_16x16x32_bf16 v[160:163], v[72:75], v[40:43], v[160:163]
    ds_read_b64_tr_b16 v[68:69], v14 offset:96
    v_mfma_f32_16x16x32_bf16 v[164:167], v[72:75], v[44:47], v[164:167]
    ds_read_b64_tr_b16 v[70:71], v14 offset:9312
    v_mfma_f32_16x16x32_bf16 v[168:171], v[72:75], v[48:51], v[168:171]
    ds_read_b128 v[32:35], v12 offset:4096
    v_mfma_f32_16x16x32_bf16 v[172:175], v[72:75], v[52:55], v[172:175]
    ds_read_b128 v[36:39], v12 offset:6144
    v_mfma_f32_16x16x32_bf16 v[176:179], v[76:79], v[40:43], v[176:179]
    ds_read_b64_tr_b16 v[72:73], v14 offset:128
    v_mfma_f32_16x16x32_bf16 v[180:183], v[76:79], v[44:47], v[180:183]
    ds_read_b64_tr_b16 v[74:75], v14 offset:9344
    v_mfma_f32_16x16x32_bf16 v[184:187], v[76:79], v[48:51], v[184:187]
    v_mfma_f32_16x16x32_bf16 v[188:191], v[76:79], v[52:55], v[188:191]
    v_mfma_f32_16x16x32_bf16 v[192:195], v[80:83], v[40:43], v[192:195]
    ds_read_b64_tr_b16 v[76:77], v14 offset:160
    v_mfma_f32_16x16x32_bf16 v[196:199], v[80:83], v[44:47], v[196:199]
    ds_read_b64_tr_b16 v[78:79], v14 offset:9376
    v_mfma_f32_16x16x32_bf16 v[200:203], v[80:83], v[48:51], v[200:203]
    v_mfma_f32_16x16x32_bf16 v[204:207], v[80:83], v[52:55], v[204:207]
    v_mfma_f32_16x16x32_bf16 v[208:211], v[84:87], v[40:43], v[208:211]
    ds_read_b64_tr_b16 v[80:81], v14 offset:192
    v_mfma_f32_16x16x32_bf16 v[212:215], v[84:87], v[44:47], v[212:215]
    ds_read_b64_tr_b16 v[82:83], v14 offset:9408
    v_mfma_f32_16x16x32_bf16 v[216:219], v[84:87], v[48:51], v[216:219]
    v_mfma_f32_16x16x32_bf16 v[220:223], v[84:87], v[52:55], v[220:223]
    s_waitcnt lgkmcnt(6)
    v_mfma_f32_16x16x32_bf16 v[96:99], v[56:59], v[24:27], v[96:99]
    ds_read_b64_tr_b16 v[84:85], v14 offset:224
    v_mfma_f32_16x16x32_bf16 v[100:103], v[56:59], v[28:31], v[100:103]
    ds_read_b64_tr_b16 v[86:87], v14 offset:9440
    v_mfma_f32_16x16x32_bf16 v[104:107], v[56:59], v[32:35], v[104:107]
    v_mfma_f32_16x16x32_bf16 v[108:111], v[56:59], v[36:39], v[108:111]
    v_mfma_f32_16x16x32_bf16 v[112:115], v[60:63], v[24:27], v[112:115]
    ds_read_b64_tr_b16 v[56:57], v14 offset:18432
    v_mfma_f32_16x16x32_bf16 v[116:119], v[60:63], v[28:31], v[116:119]
    ds_read_b64_tr_b16 v[58:59], v14 offset:27648
    v_mfma_f32_16x16x32_bf16 v[120:123], v[60:63], v[32:35], v[120:123]
    v_mfma_f32_16x16x32_bf16 v[124:127], v[60:63], v[36:39], v[124:127]
    v_mfma_f32_16x16x32_bf16 v[128:131], v[64:67], v[24:27], v[128:131]
    ds_read_b64_tr_b16 v[60:61], v14 offset:18464
    v_mfma_f32_16x16x32_bf16 v[132:135], v[64:67], v[28:31], v[132:135]
    ds_read_b64_tr_b16 v[62:63], v14 offset:27680
    v_mfma_f32_16x16x32_bf16 v[136:139], v[64:67], v[32:35], v[136:139]
    v_mfma_f32_16x16x32_bf16 v[140:143], v[64:67], v[36:39], v[140:143]
    v_mfma_f32_16x16x32_bf16 v[144:147], v[68:71], v[24:27], v[144:147]
    ds_read_b64_tr_b16 v[64:65], v14 offset:18496
    v_mfma_f32_16x16x32_bf16 v[148:151], v[68:71], v[28:31], v[148:151]
    ds_read_b64_tr_b16 v[66:67], v14 offset:27712
    v_mfma_f32_16x16x32_bf16 v[152:155], v[68:71], v[32:35], v[152:155]
    ds_read_b128 v[40:43], v13 offset:0
    v_mfma_f32_16x16x32_bf16 v[156:159], v[68:71], v[36:39], v[156:159]
    ds_read_b128 v[44:47], v13 offset:2048
    s_waitcnt lgkmcnt(12)
    v_mfma_f32_16x16x32_bf16 v[160:163], v[72:75], v[24:27], v[160:163]
    ds_read_b64_tr_b16 v[68:69], v14 offset:18528
    v_mfma_f32_16x16x32_bf16 v[164:167], v[72:75], v[28:31], v[164:167]
    ds_read_b64_tr_b16 v[70:71], v14 offset:27744
    v_mfma_f32_16x16x32_bf16 v[168:171], v[72:75], v[32:35], v[168:171]
    ds_read_b128 v[48:51], v13 offset:4096
    v_mfma_f32_16x16x32_bf16 v[172:175], v[72:75], v[36:39], v[172:175]
    ds_read_b128 v[52:55], v13 offset:6144
    v_mfma_f32_16x16x32_bf16 v[176:179], v[76:79], v[24:27], v[176:179]
    ds_read_b64_tr_b16 v[72:73], v14 offset:18560
    v_mfma_f32_16x16x32_bf16 v[180:183], v[76:79], v[28:31], v[180:183]
    ds_read_b64_tr_b16 v[74:75], v14 offset:27776
    v_mfma_f32_16x16x32_bf16 v[184:187], v[76:79], v[32:35], v[184:187]
    v_mfma_f32_16x16x32_bf16 v[188:191], v[76:79], v[36:39], v[188:191]
    s_waitcnt lgkmcnt(12)
    v_mfma_f32_16x16x32_bf16 v[192:195], v[80:83], v[24:27], v[192:195]
    ds_read_b64_tr_b16 v[76:77], v14 offset:18592
    v_mfma_f32_16x16x32_bf16 v[196:199], v[80:83], v[28:31], v[196:199]
    ds_read_b64_tr_b16 v[78:79], v14 offset:27808
    v_mfma_f32_16x16x32_bf16 v[200:203], v[80:83], v[32:35], v[200:203]
    v_mfma_f32_16x16x32_bf16 v[204:207], v[80:83], v[36:39], v[204:207]
    v_mfma_f32_16x16x32_bf16 v[208:211], v[84:87], v[24:27], v[208:211]
    ds_read_b64_tr_b16 v[80:81], v14 offset:18624
    v_mfma_f32_16x16x32_bf16 v[212:215], v[84:87], v[28:31], v[212:215]
    ds_read_b64_tr_b16 v[82:83], v14 offset:27840
    v_mfma_f32_16x16x32_bf16 v[216:219], v[84:87], v[32:35], v[216:219]
    v_mfma_f32_16x16x32_bf16 v[220:223], v[84:87], v[36:39], v[220:223]
    s_waitcnt lgkmcnt(6)
    v_mfma_f32_16x16x32_bf16 v[96:99], v[56:59], v[40:43], v[96:99]
    ds_read_b64_tr_b16 v[84:85], v14 offset:18656
    v_mfma_f32_16x16x32_bf16 v[100:103], v[56:59], v[44:47], v[100:103]
    ds_read_b64_tr_b16 v[86:87], v14 offset:27872
    v_mfma_f32_16x16x32_bf16 v[104:107], v[56:59], v[48:51], v[104:107]
    v_mfma_f32_16x16x32_bf16 v[108:111], v[56:59], v[52:55], v[108:111]
    v_mfma_f32_16x16x32_bf16 v[112:115], v[60:63], v[40:43], v[112:115]
    v_mfma_f32_16x16x32_bf16 v[116:119], v[60:63], v[44:47], v[116:119]
    v_mfma_f32_16x16x32_bf16 v[120:123], v[60:63], v[48:51], v[120:123]
    v_mfma_f32_16x16x32_bf16 v[124:127], v[60:63], v[52:55], v[124:127]
    s_waitcnt lgkmcnt(0)
    s_barrier
    v_mfma_f32_16x16x32_bf16 v[128:131], v[64:67], v[40:43], v[128:131]
    ds_read_b64_tr_b16 v[56:57], v17 offset:0
    v_mfma_f32_16x16x32_bf16 v[132:135], v[64:67], v[44:47], v[132:135]
    ds_read_b64_tr_b16 v[58:59], v17 offset:9216
    v_mfma_f32_16x16x32_bf16 v[136:139], v[64:67], v[48:51], v[136:139]
    ds_read_b64_tr_b16 v[60:61], v17 offset:32
    v_mfma_f32_16x16x32_bf16 v[140:143], v[64:67], v[52:55], v[140:143]
    ds_read_b64_tr_b16 v[62:63], v17 offset:9248
    v_mfma_f32_16x16x32_bf16 v[144:147], v[68:71], v[40:43], v[144:147]
    ds_read_b64_tr_b16 v[64:65], v17 offset:64
    v_mfma_f32_16x16x32_bf16 v[148:151], v[68:71], v[44:47], v[148:151]
    ds_read_b64_tr_b16 v[66:67], v17 offset:9280
    v_mfma_f32_16x16x32_bf16 v[152:155], v[68:71], v[48:51], v[152:155]
    ds_read_b128 v[24:27], v15 offset:0
    v_mfma_f32_16x16x32_bf16 v[156:159], v[68:71], v[52:55], v[156:159]
    ds_read_b128 v[28:31], v15 offset:2048
    v_mfma_f32_16x16x32_bf16 v[160:163], v[72:75], v[40:43], v[160:163]
    ds_read_b64_tr_b16 v[68:69], v17 offset:96
    v_mfma_f32_16x16x32_bf16 v[164:167], v[72:75], v[44:47], v[164:167]
    ds_read_b64_tr_b16 v[70:71], v17 offset:9312
    v_mfma_f32_16x16x32_bf16 v[168:171], v[72:75], v[48:51], v[168:171]
    ds_read_b128 v[32:35], v15 offset:4096
    v_mfma_f32_16x16x32_bf16 v[172:175], v[72:75], v[52:55], v[172:175]
    ds_read_b128 v[36:39], v15 offset:6144
    v_mfma_f32_16x16x32_bf16 v[176:179], v[76:79], v[40:43], v[176:179]
    ds_read_b64_tr_b16 v[72:73], v17 offset:128
    v_mfma_f32_16x16x32_bf16 v[180:183], v[76:79], v[44:47], v[180:183]
    ds_read_b64_tr_b16 v[74:75], v17 offset:9344
    v_mfma_f32_16x16x32_bf16 v[184:187], v[76:79], v[48:51], v[184:187]
    v_mfma_f32_16x16x32_bf16 v[188:191], v[76:79], v[52:55], v[188:191]
    v_mfma_f32_16x16x32_bf16 v[192:195], v[80:83], v[40:43], v[192:195]
    ds_read_b64_tr_b16 v[76:77], v17 offset:160
    v_mfma_f32_16x16x32_bf16 v[196:199], v[80:83], v[44:47], v[196:199]
    ds_read_b64_tr_b16 v[78:79], v17 offset:9376
    v_mfma_f32_16x16x32_bf16 v[200:203], v[80:83], v[48:51], v[200:203]
    v_mfma_f32_16x16x32_bf16 v[204:207], v[80:83], v[52:55], v[204:207]
    v_mfma_f32_16x16x32_bf16 v[208:211], v[84:87], v[40:43], v[208:211]
    ds_read_b64_tr_b16 v[80:81], v17 offset:192
    v_mfma_f32_16x16x32_bf16 v[212:215], v[84:87], v[44:47], v[212:215]
    ds_read_b64_tr_b16 v[82:83], v17 offset:9408
    v_mfma_f32_16x16x32_bf16 v[216:219], v[84:87], v[48:51], v[216:219]
    v_mfma_f32_16x16x32_bf16 v[220:223], v[84:87], v[52:55], v[220:223]
    s_waitcnt lgkmcnt(6)
    v_mfma_f32_16x16x32_bf16 v[96:99], v[56:59], v[24:27], v[96:99]
    ds_read_b64_tr_b16 v[84:85], v17 offset:224
    v_mfma_f32_16x16x32_bf16 v[100:103], v[56:59], v[28:31], v[100:103]
    ds_read_b64_tr_b16 v[86:87], v17 offset:9440
    v_mfma_f32_16x16x32_bf16 v[104:107], v[56:59], v[32:35], v[104:107]
    v_mfma_f32_16x16x32_bf16 v[108:111], v[56:59], v[36:39], v[108:111]
    v_mfma_f32_16x16x32_bf16 v[112:115], v[60:63], v[24:27], v[112:115]
    ds_read_b64_tr_b16 v[56:57], v17 offset:18432
    v_mfma_f32_16x16x32_bf16 v[116:119], v[60:63], v[28:31], v[116:119]
    ds_read_b64_tr_b16 v[58:59], v17 offset:27648
    v_mfma_f32_16x16x32_bf16 v[120:123], v[60:63], v[32:35], v[120:123]
    v_mfma_f32_16x16x32_bf16 v[124:127], v[60:63], v[36:39], v[124:127]
    v_mfma_f32_16x16x32_bf16 v[128:131], v[64:67], v[24:27], v[128:131]
    ds_read_b64_tr_b16 v[60:61], v17 offset:18464
    v_mfma_f32_16x16x32_bf16 v[132:135], v[64:67], v[28:31], v[132:135]
    ds_read_b64_tr_b16 v[62:63], v17 offset:27680
    v_mfma_f32_16x16x32_bf16 v[136:139], v[64:67], v[32:35], v[136:139]
    v_mfma_f32_16x16x32_bf16 v[140:143], v[64:67], v[36:39], v[140:143]
    v_mfma_f32_16x16x32_bf16 v[144:147], v[68:71], v[24:27], v[144:147]
    ds_read_b64_tr_b16 v[64:65], v17 offset:18496
    v_mfma_f32_16x16x32_bf16 v[148:151], v[68:71], v[28:31], v[148:151]
    ds_read_b64_tr_b16 v[66:67], v17 offset:27712
    v_mfma_f32_16x16x32_bf16 v[152:155], v[68:71], v[32:35], v[152:155]
    ds_read_b128 v[40:43], v16 offset:0
    v_mfma_f32_16x16x32_bf16 v[156:159], v[68:71], v[36:39], v[156:159]
    ds_read_b128 v[44:47], v16 offset:2048
    s_waitcnt lgkmcnt(12)
    v_mfma_f32_16x16x32_bf16 v[160:163], v[72:75], v[24:27], v[160:163]
    ds_read_b64_tr_b16 v[68:69], v17 offset:18528
    v_mfma_f32_16x16x32_bf16 v[164:167], v[72:75], v[28:31], v[164:167]
    ds_read_b64_tr_b16 v[70:71], v17 offset:27744
    v_mfma_f32_16x16x32_bf16 v[168:171], v[72:75], v[32:35], v[168:171]
    ds_read_b128 v[48:51], v16 offset:4096
    v_mfma_f32_16x16x32_bf16 v[172:175], v[72:75], v[36:39], v[172:175]
    ds_read_b128 v[52:55], v16 offset:6144
    v_mfma_f32_16x16x32_bf16 v[176:179], v[76:79], v[24:27], v[176:179]
    ds_read_b64_tr_b16 v[72:73], v17 offset:18560
    v_mfma_f32_16x16x32_bf16 v[180:183], v[76:79], v[28:31], v[180:183]
    ds_read_b64_tr_b16 v[74:75], v17 offset:27776
    v_mfma_f32_16x16x32_bf16 v[184:187], v[76:79], v[32:35], v[184:187]
    v_mfma_f32_16x16x32_bf16 v[188:191], v[76:79], v[36:39], v[188:191]
    s_waitcnt lgkmcnt(12)
    v_mfma_f32_16x16x32_bf16 v[192:195], v[80:83], v[24:27], v[192:195]
    ds_read_b64_tr_b16 v[76:77], v17 offset:18592
    v_mfma_f32_16x16x32_bf16 v[196:199], v[80:83], v[28:31], v[196:199]
    ds_read_b64_tr_b16 v[78:79], v17 offset:27808
    v_mfma_f32_16x16x32_bf16 v[200:203], v[80:83], v[32:35], v[200:203]
    v_mfma_f32_16x16x32_bf16 v[204:207], v[80:83], v[36:39], v[204:207]
    v_mfma_f32_16x16x32_bf16 v[208:211], v[84:87], v[24:27], v[208:211]
    ds_read_b64_tr_b16 v[80:81], v17 offset:18624
    v_mfma_f32_16x16x32_bf16 v[212:215], v[84:87], v[28:31], v[212:215]
    ds_read_b64_tr_b16 v[82:83], v17 offset:27840
    v_mfma_f32_16x16x32_bf16 v[216:219], v[84:87], v[32:35], v[216:219]
    v_mfma_f32_16x16x32_bf16 v[220:223], v[84:87], v[36:39], v[220:223]
    s_waitcnt lgkmcnt(6)
    v_mfma_f32_16x16x32_bf16 v[96:99], v[56:59], v[40:43], v[96:99]
    ds_read_b64_tr_b16 v[84:85], v17 offset:18656
    v_mfma_f32_16x16x32_bf16 v[100:103], v[56:59], v[44:47], v[100:103]
    ds_read_b64_tr_b16 v[86:87], v17 offset:27872
    v_mfma_f32_16x16x32_bf16 v[104:107], v[56:59], v[48:51], v[104:107]
    v_mfma_f32_16x16x32_bf16 v[108:111], v[56:59], v[52:55], v[108:111]
    v_mfma_f32_16x16x32_bf16 v[112:115], v[60:63], v[40:43], v[112:115]
    v_mfma_f32_16x16x32_bf16 v[116:119], v[60:63], v[44:47], v[116:119]
    v_mfma_f32_16x16x32_bf16 v[120:123], v[60:63], v[48:51], v[120:123]
    v_mfma_f32_16x16x32_bf16 v[124:127], v[60:63], v[52:55], v[124:127]
    s_waitcnt lgkmcnt(0)
    s_barrier
    v_mfma_f32_16x16x32_bf16 v[128:131], v[64:67], v[40:43], v[128:131]
    ds_read_b64_tr_b16 v[56:57], v11 offset:0
    v_mfma_f32_16x16x32_bf16 v[132:135], v[64:67], v[44:47], v[132:135]
    ds_read_b64_tr_b16 v[58:59], v11 offset:9216
    v_mfma_f32_16x16x32_bf16 v[136:139], v[64:67], v[48:51], v[136:139]
    ds_read_b64_tr_b16 v[60:61], v11 offset:32
    v_mfma_f32_16x16x32_bf16 v[140:143], v[64:67], v[52:55], v[140:143]
    ds_read_b64_tr_b16 v[62:63], v11 offset:9248
    v_mfma_f32_16x16x32_bf16 v[144:147], v[68:71], v[40:43], v[144:147]
    ds_read_b64_tr_b16 v[64:65], v11 offset:64
    v_mfma_f32_16x16x32_bf16 v[148:151], v[68:71], v[44:47], v[148:151]
    ds_read_b64_tr_b16 v[66:67], v11 offset:9280
    v_mfma_f32_16x16x32_bf16 v[152:155], v[68:71], v[48:51], v[152:155]
    ds_read_b128 v[24:27], v9 offset:0
    v_mfma_f32_16x16x32_bf16 v[156:159], v[68:71], v[52:55], v[156:159]
    ds_read_b128 v[28:31], v9 offset:2048
    v_mfma_f32_16x16x32_bf16 v[160:163], v[72:75], v[40:43], v[160:163]
    ds_read_b64_tr_b16 v[68:69], v11 offset:96
    v_mfma_f32_16x16x32_bf16 v[164:167], v[72:75], v[44:47], v[164:167]
    ds_read_b64_tr_b16 v[70:71], v11 offset:9312
    v_mfma_f32_16x16x32_bf16 v[168:171], v[72:75], v[48:51], v[168:171]
    ds_read_b128 v[32:35], v9 offset:4096
    v_mfma_f32_16x16x32_bf16 v[172:175], v[72:75], v[52:55], v[172:175]
    ds_read_b128 v[36:39], v9 offset:6144
    v_mfma_f32_16x16x32_bf16 v[176:179], v[76:79], v[40:43], v[176:179]
    ds_read_b64_tr_b16 v[72:73], v11 offset:128
    v_mfma_f32_16x16x32_bf16 v[180:183], v[76:79], v[44:47], v[180:183]
    ds_read_b64_tr_b16 v[74:75], v11 offset:9344
    v_mfma_f32_16x16x32_bf16 v[184:187], v[76:79], v[48:51], v[184:187]
    v_mfma_f32_16x16x32_bf16 v[188:191], v[76:79], v[52:55], v[188:191]
    v_mfma_f32_16x16x32_bf16 v[192:195], v[80:83], v[40:43], v[192:195]
    ds_read_b64_tr_b16 v[76:77], v11 offset:160
    v_mfma_f32_16x16x32_bf16 v[196:199], v[80:83], v[44:47], v[196:199]
    ds_read_b64_tr_b16 v[78:79], v11 offset:9376
    v_mfma_f32_16x16x32_bf16 v[200:203], v[80:83], v[48:51], v[200:203]
    v_mfma_f32_16x16x32_bf16 v[204:207], v[80:83], v[52:55], v[204:207]
    v_mfma_f32_16x16x32_bf16 v[208:211], v[84:87], v[40:43], v[208:211]
    ds_read_b64_tr_b16 v[80:81], v11 offset:192
    v_mfma_f32_16x16x32_bf16 v[212:215], v[84:87], v[44:47], v[212:215]
    ds_read_b64_tr_b16 v[82:83], v11 offset:9408
    v_mfma_f32_16x16x32_bf16 v[216:219], v[84:87], v[48:51], v[216:219]
    v_mfma_f32_16x16x32_bf16 v[220:223], v[84:87], v[52:55], v[220:223]
    s_waitcnt lgkmcnt(6)
    v_mfma_f32_16x16x32_bf16 v[96:99], v[56:59], v[24:27], v[96:99]
    ds_read_b64_tr_b16 v[84:85], v11 offset:224
    v_mfma_f32_16x16x32_bf16 v[100:103], v[56:59], v[28:31], v[100:103]
    ds_read_b64_tr_b16 v[86:87], v11 offset:9440
    v_mfma_f32_16x16x32_bf16 v[104:107], v[56:59], v[32:35], v[104:107]
    v_mfma_f32_16x16x32_bf16 v[108:111], v[56:59], v[36:39], v[108:111]
    v_mfma_f32_16x16x32_bf16 v[112:115], v[60:63], v[24:27], v[112:115]
    ds_read_b64_tr_b16 v[56:57], v11 offset:18432
    v_mfma_f32_16x16x32_bf16 v[116:119], v[60:63], v[28:31], v[116:119]
    ds_read_b64_tr_b16 v[58:59], v11 offset:27648
    v_mfma_f32_16x16x32_bf16 v[120:123], v[60:63], v[32:35], v[120:123]
    v_mfma_f32_16x16x32_bf16 v[124:127], v[60:63], v[36:39], v[124:127]
    v_mfma_f32_16x16x32_bf16 v[128:131], v[64:67], v[24:27], v[128:131]
    ds_read_b64_tr_b16 v[60:61], v11 offset:18464
    v_mfma_f32_16x16x32_bf16 v[132:135], v[64:67], v[28:31], v[132:135]
    ds_read_b64_tr_b16 v[62:63], v11 offset:27680
    v_mfma_f32_16x16x32_bf16 v[136:139], v[64:67], v[32:35], v[136:139]
    v_mfma_f32_16x16x32_bf16 v[140:143], v[64:67], v[36:39], v[140:143]
    v_mfma_f32_16x16x32_bf16 v[144:147], v[68:71], v[24:27], v[144:147]
    ds_read_b64_tr_b16 v[64:65], v11 offset:18496
    v_mfma_f32_16x16x32_bf16 v[148:151], v[68:71], v[28:31], v[148:151]
    ds_read_b64_tr_b16 v[66:67], v11 offset:27712
    v_mfma_f32_16x16x32_bf16 v[152:155], v[68:71], v[32:35], v[152:155]
    ds_read_b128 v[40:43], v10 offset:0
    v_mfma_f32_16x16x32_bf16 v[156:159], v[68:71], v[36:39], v[156:159]
    ds_read_b128 v[44:47], v10 offset:2048
    s_waitcnt lgkmcnt(12)
    v_mfma_f32_16x16x32_bf16 v[160:163], v[72:75], v[24:27], v[160:163]
    ds_read_b64_tr_b16 v[68:69], v11 offset:18528
    v_mfma_f32_16x16x32_bf16 v[164:167], v[72:75], v[28:31], v[164:167]
    ds_read_b64_tr_b16 v[70:71], v11 offset:27744
    v_mfma_f32_16x16x32_bf16 v[168:171], v[72:75], v[32:35], v[168:171]
    ds_read_b128 v[48:51], v10 offset:4096
    v_mfma_f32_16x16x32_bf16 v[172:175], v[72:75], v[36:39], v[172:175]
    ds_read_b128 v[52:55], v10 offset:6144
    v_mfma_f32_16x16x32_bf16 v[176:179], v[76:79], v[24:27], v[176:179]
    ds_read_b64_tr_b16 v[72:73], v11 offset:18560
    v_mfma_f32_16x16x32_bf16 v[180:183], v[76:79], v[28:31], v[180:183]
    ds_read_b64_tr_b16 v[74:75], v11 offset:27776
    v_mfma_f32_16x16x32_bf16 v[184:187], v[76:79], v[32:35], v[184:187]
    v_mfma_f32_16x16x32_bf16 v[188:191], v[76:79], v[36:39], v[188:191]
    s_waitcnt lgkmcnt(12)
    v_mfma_f32_16x16x32_bf16 v[192:195], v[80:83], v[24:27], v[192:195]
    ds_read_b64_tr_b16 v[76:77], v11 offset:18592
    v_mfma_f32_16x16x32_bf16 v[196:199], v[80:83], v[28:31], v[196:199]
    ds_read_b64_tr_b16 v[78:79], v11 offset:27808
    v_mfma_f32_16x16x32_bf16 v[200:203], v[80:83], v[32:35], v[200:203]
    v_mfma_f32_16x16x32_bf16 v[204:207], v[80:83], v[36:39], v[204:207]
    v_mfma_f32_16x16x32_bf16 v[208:211], v[84:87], v[24:27], v[208:211]
    ds_read_b64_tr_b16 v[80:81], v11 offset:18624
    v_mfma_f32_16x16x32_bf16 v[212:215], v[84:87], v[28:31], v[212:215]
    ds_read_b64_tr_b16 v[82:83], v11 offset:27840
    v_mfma_f32_16x16x32_bf16 v[216:219], v[84:87], v[32:35], v[216:219]
    v_mfma_f32_16x16x32_bf16 v[220:223], v[84:87], v[36:39], v[220:223]
    s_waitcnt lgkmcnt(6)
    v_mfma_f32_16x16x32_bf16 v[96:99], v[56:59], v[40:43], v[96:99]
    ds_read_b64_tr_b16 v[84:85], v11 offset:18656
    v_mfma_f32_16x16x32_bf16 v[100:103], v[56:59], v[44:47], v[100:103]
    ds_read_b64_tr_b16 v[86:87], v11 offset:27872
    v_mfma_f32_16x16x32_bf16 v[104:107], v[56:59], v[48:51], v[104:107]
    v_mfma_f32_16x16x32_bf16 v[108:111], v[56:59], v[52:55], v[108:111]
    v_mfma_f32_16x16x32_bf16 v[112:115], v[60:63], v[40:43], v[112:115]
    v_mfma_f32_16x16x32_bf16 v[116:119], v[60:63], v[44:47], v[116:119]
    v_mfma_f32_16x16x32_bf16 v[120:123], v[60:63], v[48:51], v[120:123]
    v_mfma_f32_16x16x32_bf16 v[124:127], v[60:63], v[52:55], v[124:127]
    s_waitcnt lgkmcnt(0)
    s_barrier
    v_mfma_f32_16x16x32_bf16 v[128:131], v[64:67], v[40:43], v[128:131]
    ds_read_b64_tr_b16 v[56:57], v14 offset:0
    v_mfma_f32_16x16x32_bf16 v[132:135], v[64:67], v[44:47], v[132:135]
    ds_read_b64_tr_b16 v[58:59], v14 offset:9216
    v_mfma_f32_16x16x32_bf16 v[136:139], v[64:67], v[48:51], v[136:139]
    ds_read_b64_tr_b16 v[60:61], v14 offset:32
    v_mfma_f32_16x16x32_bf16 v[140:143], v[64:67], v[52:55], v[140:143]
    ds_read_b64_tr_b16 v[62:63], v14 offset:9248
    v_mfma_f32_16x16x32_bf16 v[144:147], v[68:71], v[40:43], v[144:147]
    ds_read_b64_tr_b16 v[64:65], v14 offset:64
    v_mfma_f32_16x16x32_bf16 v[148:151], v[68:71], v[44:47], v[148:151]
    ds_read_b64_tr_b16 v[66:67], v14 offset:9280
    v_mfma_f32_16x16x32_bf16 v[152:155], v[68:71], v[48:51], v[152:155]
    ds_read_b128 v[24:27], v12 offset:0
    v_mfma_f32_16x16x32_bf16 v[156:159], v[68:71], v[52:55], v[156:159]
    ds_read_b128 v[28:31], v12 offset:2048
    v_mfma_f32_16x16x32_bf16 v[160:163], v[72:75], v[40:43], v[160:163]
    ds_read_b64_tr_b16 v[68:69], v14 offset:96
    v_mfma_f32_16x16x32_bf16 v[164:167], v[72:75], v[44:47], v[164:167]
    ds_read_b64_tr_b16 v[70:71], v14 offset:9312
    v_mfma_f32_16x16x32_bf16 v[168:171], v[72:75], v[48:51], v[168:171]
    ds_read_b128 v[32:35], v12 offset:4096
    v_mfma_f32_16x16x32_bf16 v[172:175], v[72:75], v[52:55], v[172:175]
    ds_read_b128 v[36:39], v12 offset:6144
    v_mfma_f32_16x16x32_bf16 v[176:179], v[76:79], v[40:43], v[176:179]
    ds_read_b64_tr_b16 v[72:73], v14 offset:128
    v_mfma_f32_16x16x32_bf16 v[180:183], v[76:79], v[44:47], v[180:183]
    ds_read_b64_tr_b16 v[74:75], v14 offset:9344
    v_mfma_f32_16x16x32_bf16 v[184:187], v[76:79], v[48:51], v[184:187]
    v_mfma_f32_16x16x32_bf16 v[188:191], v[76:79], v[52:55], v[188:191]
    v_mfma_f32_16x16x32_bf16 v[192:195], v[80:83], v[40:43], v[192:195]
    ds_read_b64_tr_b16 v[76:77], v14 offset:160
    v_mfma_f32_16x16x32_bf16 v[196:199], v[80:83], v[44:47], v[196:199]
    ds_read_b64_tr_b16 v[78:79], v14 offset:9376
    v_mfma_f32_16x16x32_bf16 v[200:203], v[80:83], v[48:51], v[200:203]
    v_mfma_f32_16x16x32_bf16 v[204:207], v[80:83], v[52:55], v[204:207]
    v_mfma_f32_16x16x32_bf16 v[208:211], v[84:87], v[40:43], v[208:211]
    ds_read_b64_tr_b16 v[80:81], v14 offset:192
    v_mfma_f32_16x16x32_bf16 v[212:215], v[84:87], v[44:47], v[212:215]
    ds_read_b64_tr_b16 v[82:83], v14 offset:9408
    v_mfma_f32_16x16x32_bf16 v[216:219], v[84:87], v[48:51], v[216:219]
    v_mfma_f32_16x16x32_bf16 v[220:223], v[84:87], v[52:55], v[220:223]
    s_waitcnt lgkmcnt(6)
    v_mfma_f32_16x16x32_bf16 v[96:99], v[56:59], v[24:27], v[96:99]
    ds_read_b64_tr_b16 v[84:85], v14 offset:224
    v_mfma_f32_16x16x32_bf16 v[100:103], v[56:59], v[28:31], v[100:103]
    ds_read_b64_tr_b16 v[86:87], v14 offset:9440
    v_mfma_f32_16x16x32_bf16 v[104:107], v[56:59], v[32:35], v[104:107]
    v_mfma_f32_16x16x32_bf16 v[108:111], v[56:59], v[36:39], v[108:111]
    v_mfma_f32_16x16x32_bf16 v[112:115], v[60:63], v[24:27], v[112:115]
    ds_read_b64_tr_b16 v[56:57], v14 offset:18432
    v_mfma_f32_16x16x32_bf16 v[116:119], v[60:63], v[28:31], v[116:119]
    ds_read_b64_tr_b16 v[58:59], v14 offset:27648
    v_mfma_f32_16x16x32_bf16 v[120:123], v[60:63], v[32:35], v[120:123]
    v_mfma_f32_16x16x32_bf16 v[124:127], v[60:63], v[36:39], v[124:127]
    v_mfma_f32_16x16x32_bf16 v[128:131], v[64:67], v[24:27], v[128:131]
    ds_read_b64_tr_b16 v[60:61], v14 offset:18464
    v_mfma_f32_16x16x32_bf16 v[132:135], v[64:67], v[28:31], v[132:135]
    ds_read_b64_tr_b16 v[62:63], v14 offset:27680
    v_mfma_f32_16x16x32_bf16 v[136:139], v[64:67], v[32:35], v[136:139]
    v_mfma_f32_16x16x32_bf16 v[140:143], v[64:67], v[36:39], v[140:143]
    v_mfma_f32_16x16x32_bf16 v[144:147], v[68:71], v[24:27], v[144:147]
    ds_read_b64_tr_b16 v[64:65], v14 offset:18496
    v_mfma_f32_16x16x32_bf16 v[148:151], v[68:71], v[28:31], v[148:151]
    ds_read_b64_tr_b16 v[66:67], v14 offset:27712
    v_mfma_f32_16x16x32_bf16 v[152:155], v[68:71], v[32:35], v[152:155]
    ds_read_b128 v[40:43], v13 offset:0
    v_mfma_f32_16x16x32_bf16 v[156:159], v[68:71], v[36:39], v[156:159]
    ds_read_b128 v[44:47], v13 offset:2048
    s_waitcnt lgkmcnt(12)
    v_mfma_f32_16x16x32_bf16 v[160:163], v[72:75], v[24:27], v[160:163]
    ds_read_b64_tr_b16 v[68:69], v14 offset:18528
    v_mfma_f32_16x16x32_bf16 v[164:167], v[72:75], v[28:31], v[164:167]
    ds_read_b64_tr_b16 v[70:71], v14 offset:27744
    v_mfma_f32_16x16x32_bf16 v[168:171], v[72:75], v[32:35], v[168:171]
    ds_read_b128 v[48:51], v13 offset:4096
    v_mfma_f32_16x16x32_bf16 v[172:175], v[72:75], v[36:39], v[172:175]
    ds_read_b128 v[52:55], v13 offset:6144
    v_mfma_f32_16x16x32_bf16 v[176:179], v[76:79], v[24:27], v[176:179]
    ds_read_b64_tr_b16 v[72:73], v14 offset:18560
    v_mfma_f32_16x16x32_bf16 v[180:183], v[76:79], v[28:31], v[180:183]
    ds_read_b64_tr_b16 v[74:75], v14 offset:27776
    v_mfma_f32_16x16x32_bf16 v[184:187], v[76:79], v[32:35], v[184:187]
    v_mfma_f32_16x16x32_bf16 v[188:191], v[76:79], v[36:39], v[188:191]
    s_waitcnt lgkmcnt(12)
    v_mfma_f32_16x16x32_bf16 v[192:195], v[80:83], v[24:27], v[192:195]
    ds_read_b64_tr_b16 v[76:77], v14 offset:18592
    v_mfma_f32_16x16x32_bf16 v[196:199], v[80:83], v[28:31], v[196:199]
    ds_read_b64_tr_b16 v[78:79], v14 offset:27808
    v_mfma_f32_16x16x32_bf16 v[200:203], v[80:83], v[32:35], v[200:203]
    v_mfma_f32_16x16x32_bf16 v[204:207], v[80:83], v[36:39], v[204:207]
    v_mfma_f32_16x16x32_bf16 v[208:211], v[84:87], v[24:27], v[208:211]
    ds_read_b64_tr_b16 v[80:81], v14 offset:18624
    v_mfma_f32_16x16x32_bf16 v[212:215], v[84:87], v[28:31], v[212:215]
    ds_read_b64_tr_b16 v[82:83], v14 offset:27840
    v_mfma_f32_16x16x32_bf16 v[216:219], v[84:87], v[32:35], v[216:219]
    v_mfma_f32_16x16x32_bf16 v[220:223], v[84:87], v[36:39], v[220:223]
    s_waitcnt lgkmcnt(6)
    v_mfma_f32_16x16x32_bf16 v[96:99], v[56:59], v[40:43], v[96:99]
    ds_read_b64_tr_b16 v[84:85], v14 offset:18656
    v_mfma_f32_16x16x32_bf16 v[100:103], v[56:59], v[44:47], v[100:103]
    ds_read_b64_tr_b16 v[86:87], v14 offset:27872
    v_mfma_f32_16x16x32_bf16 v[104:107], v[56:59], v[48:51], v[104:107]
    v_mfma_f32_16x16x32_bf16 v[108:111], v[56:59], v[52:55], v[108:111]
    v_mfma_f32_16x16x32_bf16 v[112:115], v[60:63], v[40:43], v[112:115]
    v_mfma_f32_16x16x32_bf16 v[116:119], v[60:63], v[44:47], v[116:119]
    v_mfma_f32_16x16x32_bf16 v[120:123], v[60:63], v[48:51], v[120:123]
    v_mfma_f32_16x16x32_bf16 v[124:127], v[60:63], v[52:55], v[124:127]
    s_waitcnt lgkmcnt(0)
    s_barrier
    v_mfma_f32_16x16x32_bf16 v[128:131], v[64:67], v[40:43], v[128:131]
    ds_read_b128 v[56:59], v4 offset:1024
    v_mfma_f32_16x16x32_bf16 v[132:135], v[64:67], v[44:47], v[132:135]
    ds_read_b128 v[60:63], v4 offset:1088
    v_mfma_f32_16x16x32_bf16 v[136:139], v[64:67], v[48:51], v[136:139]
    ds_read_b32 v24, v3 offset:0
    v_mfma_f32_16x16x32_bf16 v[140:143], v[64:67], v[52:55], v[140:143]
    ds_read_b32 v25, v3 offset:512
    v_mfma_f32_16x16x32_bf16 v[144:147], v[68:71], v[40:43], v[144:147]
    ds_read_b128 v[64:67], v4 offset:1152
    v_mfma_f32_16x16x32_bf16 v[148:151], v[68:71], v[44:47], v[148:151]
    ds_read_b32 v26, v3 offset:64
    v_mfma_f32_16x16x32_bf16 v[152:155], v[68:71], v[48:51], v[152:155]
    ds_read_b32 v27, v3 offset:576
    v_mfma_f32_16x16x32_bf16 v[156:159], v[68:71], v[52:55], v[156:159]
    v_mfma_f32_16x16x32_bf16 v[160:163], v[72:75], v[40:43], v[160:163]
    ds_read_b128 v[68:71], v4 offset:1216
    v_mfma_f32_16x16x32_bf16 v[164:167], v[72:75], v[44:47], v[164:167]
    ds_read_b32 v28, v3 offset:128
    v_mfma_f32_16x16x32_bf16 v[168:171], v[72:75], v[48:51], v[168:171]
    ds_read_b32 v29, v3 offset:640
    v_mfma_f32_16x16x32_bf16 v[172:175], v[72:75], v[52:55], v[172:175]
    v_mfma_f32_16x16x32_bf16 v[176:179], v[76:79], v[40:43], v[176:179]
    ds_read_b128 v[72:75], v4 offset:1280
    v_mfma_f32_16x16x32_bf16 v[180:183], v[76:79], v[44:47], v[180:183]
    ds_read_b32 v30, v3 offset:192
    v_mfma_f32_16x16x32_bf16 v[184:187], v[76:79], v[48:51], v[184:187]
    ds_read_b32 v31, v3 offset:704
    v_mfma_f32_16x16x32_bf16 v[188:191], v[76:79], v[52:55], v[188:191]
    v_mfma_f32_16x16x32_bf16 v[192:195], v[80:83], v[40:43], v[192:195]
    ds_read_b128 v[76:79], v4 offset:1344
    v_mfma_f32_16x16x32_bf16 v[196:199], v[80:83], v[44:47], v[196:199]
    v_mfma_f32_16x16x32_bf16 v[200:203], v[80:83], v[48:51], v[200:203]
    v_mfma_f32_16x16x32_bf16 v[204:207], v[80:83], v[52:55], v[204:207]
    v_mfma_f32_16x16x32_bf16 v[208:211], v[84:87], v[40:43], v[208:211]
    ds_read_b128 v[80:83], v4 offset:1408
    v_mfma_f32_16x16x32_bf16 v[212:215], v[84:87], v[44:47], v[212:215]
    v_mfma_f32_16x16x32_bf16 v[216:219], v[84:87], v[48:51], v[216:219]
    v_mfma_f32_16x16x32_bf16 v[220:223], v[84:87], v[52:55], v[220:223]
    ds_read_b128 v[84:87], v4 offset:1472
    s_waitcnt lgkmcnt(3)
    v_mul_f32 v25, s66, v25
    v_mul_f32 v27, s66, v27
    v_mul_f32 v29, s66, v29
    v_mul_f32 v31, s66, v31
    v_pk_fma_f32 v[96:97], v[56:57], v[24:25], v[96:97] op_sel_hi:[1,0,1]
    v_pk_fma_f32 v[98:99], v[58:59], v[24:25], v[98:99] op_sel_hi:[1,0,1]
    v_pk_mul_f32 v[96:97], v[96:97], v[24:25] op_sel:[0,1] op_sel_hi:[1,1]
    v_pk_mul_f32 v[98:99], v[98:99], v[24:25] op_sel:[0,1] op_sel_hi:[1,1]
    v_pk_fma_f32 v[100:101], v[56:57], v[26:27], v[100:101] op_sel_hi:[1,0,1]
    v_pk_fma_f32 v[102:103], v[58:59], v[26:27], v[102:103] op_sel_hi:[1,0,1]
    v_pk_mul_f32 v[100:101], v[100:101], v[26:27] op_sel:[0,1] op_sel_hi:[1,1]
    v_pk_mul_f32 v[102:103], v[102:103], v[26:27] op_sel:[0,1] op_sel_hi:[1,1]
    v_cvt_pk_bf16_f32 v96, v96, v97
    v_cvt_pk_bf16_f32 v97, v98, v99
    v_cvt_pk_bf16_f32 v98, v100, v101
    v_cvt_pk_bf16_f32 v99, v102, v103
    s_nop 0
    v_permlane16_swap_b32 v96, v98
    v_permlane16_swap_b32 v97, v99
    buffer_store_dwordx4 v[96:99], v7, s[48:51], s60 offen offset:0 sc1
    v_pk_fma_f32 v[104:105], v[56:57], v[28:29], v[104:105] op_sel_hi:[1,0,1]
    v_pk_fma_f32 v[106:107], v[58:59], v[28:29], v[106:107] op_sel_hi:[1,0,1]
    v_pk_mul_f32 v[104:105], v[104:105], v[28:29] op_sel:[0,1] op_sel_hi:[1,1]
    v_pk_mul_f32 v[106:107], v[106:107], v[28:29] op_sel:[0,1] op_sel_hi:[1,1]
    v_pk_fma_f32 v[108:109], v[56:57], v[30:31], v[108:109] op_sel_hi:[1,0,1]
    v_pk_fma_f32 v[110:111], v[58:59], v[30:31], v[110:111] op_sel_hi:[1,0,1]
    v_pk_mul_f32 v[108:109], v[108:109], v[30:31] op_sel:[0,1] op_sel_hi:[1,1]
    v_pk_mul_f32 v[110:111], v[110:111], v[30:31] op_sel:[0,1] op_sel_hi:[1,1]
    v_cvt_pk_bf16_f32 v104, v104, v105
    v_cvt_pk_bf16_f32 v105, v106, v107
    v_cvt_pk_bf16_f32 v106, v108, v109
    v_cvt_pk_bf16_f32 v107, v110, v111
    s_nop 0
    v_permlane16_swap_b32 v104, v106
    v_permlane16_swap_b32 v105, v107
    buffer_store_dwordx4 v[104:107], v7, s[48:51], s60 offen offset:1024 sc1
    s_add_u32 s60, s60, 65536
    v_pk_fma_f32 v[112:113], v[60:61], v[24:25], v[112:113] op_sel_hi:[1,0,1]
    v_pk_fma_f32 v[114:115], v[62:63], v[24:25], v[114:115] op_sel_hi:[1,0,1]
    v_pk_mul_f32 v[112:113], v[112:113], v[24:25] op_sel:[0,1] op_sel_hi:[1,1]
    v_pk_mul_f32 v[114:115], v[114:115], v[24:25] op_sel:[0,1] op_sel_hi:[1,1]
    v_pk_fma_f32 v[116:117], v[60:61], v[26:27], v[116:117] op_sel_hi:[1,0,1]
    v_pk_fma_f32 v[118:119], v[62:63], v[26:27], v[118:119] op_sel_hi:[1,0,1]
    v_pk_mul_f32 v[116:117], v[116:117], v[26:27] op_sel:[0,1] op_sel_hi:[1,1]
    v_pk_mul_f32 v[118:119], v[118:119], v[26:27] op_sel:[0,1] op_sel_hi:[1,1]
    v_cvt_pk_bf16_f32 v112, v112, v113
    v_cvt_pk_bf16_f32 v113, v114, v115
    v_cvt_pk_bf16_f32 v114, v116, v117
    v_cvt_pk_bf16_f32 v115, v118, v119
    s_nop 0
    v_permlane16_swap_b32 v112, v114
    v_permlane16_swap_b32 v113, v115
    buffer_store_dwordx4 v[112:115], v7, s[48:51], s60 offen offset:0 sc1
    v_pk_fma_f32 v[120:121], v[60:61], v[28:29], v[120:121] op_sel_hi:[1,0,1]
    v_pk_fma_f32 v[122:123], v[62:63], v[28:29], v[122:123] op_sel_hi:[1,0,1]
    v_pk_mul_f32 v[120:121], v[120:121], v[28:29] op_sel:[0,1] op_sel_hi:[1,1]
    v_pk_mul_f32 v[122:123], v[122:123], v[28:29] op_sel:[0,1] op_sel_hi:[1,1]
    v_pk_fma_f32 v[124:125], v[60:61], v[30:31], v[124:125] op_sel_hi:[1,0,1]
    v_pk_fma_f32 v[126:127], v[62:63], v[30:31], v[126:127] op_sel_hi:[1,0,1]
    v_pk_mul_f32 v[124:125], v[124:125], v[30:31] op_sel:[0,1] op_sel_hi:[1,1]
    v_pk_mul_f32 v[126:127], v[126:127], v[30:31] op_sel:[0,1] op_sel_hi:[1,1]
    v_cvt_pk_bf16_f32 v120, v120, v121
    v_cvt_pk_bf16_f32 v121, v122, v123
    v_cvt_pk_bf16_f32 v122, v124, v125
    v_cvt_pk_bf16_f32 v123, v126, v127
    s_nop 0
    v_permlane16_swap_b32 v120, v122
    v_permlane16_swap_b32 v121, v123
    buffer_store_dwordx4 v[120:123], v7, s[48:51], s60 offen offset:1024 sc1
    s_add_u32 s60, s60, 65536
    v_pk_fma_f32 v[128:129], v[64:65], v[24:25], v[128:129] op_sel_hi:[1,0,1]
    v_pk_fma_f32 v[130:131], v[66:67], v[24:25], v[130:131] op_sel_hi:[1,0,1]
    v_pk_mul_f32 v[128:129], v[128:129], v[24:25] op_sel:[0,1] op_sel_hi:[1,1]
    v_pk_mul_f32 v[130:131], v[130:131], v[24:25] op_sel:[0,1] op_sel_hi:[1,1]
    v_pk_fma_f32 v[132:133], v[64:65], v[26:27], v[132:133] op_sel_hi:[1,0,1]
    v_pk_fma_f32 v[134:135], v[66:67], v[26:27], v[134:135] op_sel_hi:[1,0,1]
    v_pk_mul_f32 v[132:133], v[132:133], v[26:27] op_sel:[0,1] op_sel_hi:[1,1]
    v_pk_mul_f32 v[134:135], v[134:135], v[26:27] op_sel:[0,1] op_sel_hi:[1,1]
    v_cvt_pk_bf16_f32 v128, v128, v129
    v_cvt_pk_bf16_f32 v129, v130, v131
    v_cvt_pk_bf16_f32 v130, v132, v133
    v_cvt_pk_bf16_f32 v131, v134, v135
    s_nop 0
    v_permlane16_swap_b32 v128, v130
    v_permlane16_swap_b32 v129, v131
    buffer_store_dwordx4 v[128:131], v7, s[48:51], s60 offen offset:0 sc1
    v_pk_fma_f32 v[136:137], v[64:65], v[28:29], v[136:137] op_sel_hi:[1,0,1]
    v_pk_fma_f32 v[138:139], v[66:67], v[28:29], v[138:139] op_sel_hi:[1,0,1]
    v_pk_mul_f32 v[136:137], v[136:137], v[28:29] op_sel:[0,1] op_sel_hi:[1,1]
    v_pk_mul_f32 v[138:139], v[138:139], v[28:29] op_sel:[0,1] op_sel_hi:[1,1]
    v_pk_fma_f32 v[140:141], v[64:65], v[30:31], v[140:141] op_sel_hi:[1,0,1]
    v_pk_fma_f32 v[142:143], v[66:67], v[30:31], v[142:143] op_sel_hi:[1,0,1]
    v_pk_mul_f32 v[140:141], v[140:141], v[30:31] op_sel:[0,1] op_sel_hi:[1,1]
    v_pk_mul_f32 v[142:143], v[142:143], v[30:31] op_sel:[0,1] op_sel_hi:[1,1]
    v_cvt_pk_bf16_f32 v136, v136, v137
    v_cvt_pk_bf16_f32 v137, v138, v139
    v_cvt_pk_bf16_f32 v138, v140, v141
    v_cvt_pk_bf16_f32 v139, v142, v143
    s_nop 0
    v_permlane16_swap_b32 v136, v138
    v_permlane16_swap_b32 v137, v139
    buffer_store_dwordx4 v[136:139], v7, s[48:51], s60 offen offset:1024 sc1
    s_add_u32 s60, s60, 65536
    v_pk_fma_f32 v[144:145], v[68:69], v[24:25], v[144:145] op_sel_hi:[1,0,1]
    v_pk_fma_f32 v[146:147], v[70:71], v[24:25], v[146:147] op_sel_hi:[1,0,1]
    v_pk_mul_f32 v[144:145], v[144:145], v[24:25] op_sel:[0,1] op_sel_hi:[1,1]
    v_pk_mul_f32 v[146:147], v[146:147], v[24:25] op_sel:[0,1] op_sel_hi:[1,1]
    v_pk_fma_f32 v[148:149], v[68:69], v[26:27], v[148:149] op_sel_hi:[1,0,1]
    v_pk_fma_f32 v[150:151], v[70:71], v[26:27], v[150:151] op_sel_hi:[1,0,1]
    v_pk_mul_f32 v[148:149], v[148:149], v[26:27] op_sel:[0,1] op_sel_hi:[1,1]
    v_pk_mul_f32 v[150:151], v[150:151], v[26:27] op_sel:[0,1] op_sel_hi:[1,1]
    v_cvt_pk_bf16_f32 v144, v144, v145
    v_cvt_pk_bf16_f32 v145, v146, v147
    v_cvt_pk_bf16_f32 v146, v148, v149
    v_cvt_pk_bf16_f32 v147, v150, v151
    s_nop 0
    v_permlane16_swap_b32 v144, v146
    v_permlane16_swap_b32 v145, v147
    buffer_store_dwordx4 v[144:147], v7, s[48:51], s60 offen offset:0 sc1
    v_pk_fma_f32 v[152:153], v[68:69], v[28:29], v[152:153] op_sel_hi:[1,0,1]
    v_pk_fma_f32 v[154:155], v[70:71], v[28:29], v[154:155] op_sel_hi:[1,0,1]
    v_pk_mul_f32 v[152:153], v[152:153], v[28:29] op_sel:[0,1] op_sel_hi:[1,1]
    v_pk_mul_f32 v[154:155], v[154:155], v[28:29] op_sel:[0,1] op_sel_hi:[1,1]
    v_pk_fma_f32 v[156:157], v[68:69], v[30:31], v[156:157] op_sel_hi:[1,0,1]
    v_pk_fma_f32 v[158:159], v[70:71], v[30:31], v[158:159] op_sel_hi:[1,0,1]
    v_pk_mul_f32 v[156:157], v[156:157], v[30:31] op_sel:[0,1] op_sel_hi:[1,1]
    v_pk_mul_f32 v[158:159], v[158:159], v[30:31] op_sel:[0,1] op_sel_hi:[1,1]
    v_cvt_pk_bf16_f32 v152, v152, v153
    v_cvt_pk_bf16_f32 v153, v154, v155
    v_cvt_pk_bf16_f32 v154, v156, v157
    v_cvt_pk_bf16_f32 v155, v158, v159
    s_nop 0
    v_permlane16_swap_b32 v152, v154
    v_permlane16_swap_b32 v153, v155
    buffer_store_dwordx4 v[152:155], v7, s[48:51], s60 offen offset:1024 sc1
    s_add_u32 s60, s60, 65536
    v_pk_fma_f32 v[160:161], v[72:73], v[24:25], v[160:161] op_sel_hi:[1,0,1]
    v_pk_fma_f32 v[162:163], v[74:75], v[24:25], v[162:163] op_sel_hi:[1,0,1]
    v_pk_mul_f32 v[160:161], v[160:161], v[24:25] op_sel:[0,1] op_sel_hi:[1,1]
    v_pk_mul_f32 v[162:163], v[162:163], v[24:25] op_sel:[0,1] op_sel_hi:[1,1]
    v_pk_fma_f32 v[164:165], v[72:73], v[26:27], v[164:165] op_sel_hi:[1,0,1]
    v_pk_fma_f32 v[166:167], v[74:75], v[26:27], v[166:167] op_sel_hi:[1,0,1]
    v_pk_mul_f32 v[164:165], v[164:165], v[26:27] op_sel:[0,1] op_sel_hi:[1,1]
    v_pk_mul_f32 v[166:167], v[166:167], v[26:27] op_sel:[0,1] op_sel_hi:[1,1]
    v_cvt_pk_bf16_f32 v160, v160, v161
    v_cvt_pk_bf16_f32 v161, v162, v163
    v_cvt_pk_bf16_f32 v162, v164, v165
    v_cvt_pk_bf16_f32 v163, v166, v167
    s_nop 0
    v_permlane16_swap_b32 v160, v162
    v_permlane16_swap_b32 v161, v163
    buffer_store_dwordx4 v[160:163], v7, s[48:51], s60 offen offset:0 sc1
    v_pk_fma_f32 v[168:169], v[72:73], v[28:29], v[168:169] op_sel_hi:[1,0,1]
    v_pk_fma_f32 v[170:171], v[74:75], v[28:29], v[170:171] op_sel_hi:[1,0,1]
    v_pk_mul_f32 v[168:169], v[168:169], v[28:29] op_sel:[0,1] op_sel_hi:[1,1]
    v_pk_mul_f32 v[170:171], v[170:171], v[28:29] op_sel:[0,1] op_sel_hi:[1,1]
    v_pk_fma_f32 v[172:173], v[72:73], v[30:31], v[172:173] op_sel_hi:[1,0,1]
    v_pk_fma_f32 v[174:175], v[74:75], v[30:31], v[174:175] op_sel_hi:[1,0,1]
    v_pk_mul_f32 v[172:173], v[172:173], v[30:31] op_sel:[0,1] op_sel_hi:[1,1]
    v_pk_mul_f32 v[174:175], v[174:175], v[30:31] op_sel:[0,1] op_sel_hi:[1,1]
    v_cvt_pk_bf16_f32 v168, v168, v169
    v_cvt_pk_bf16_f32 v169, v170, v171
    v_cvt_pk_bf16_f32 v170, v172, v173
    v_cvt_pk_bf16_f32 v171, v174, v175
    s_nop 0
    v_permlane16_swap_b32 v168, v170
    v_permlane16_swap_b32 v169, v171
    buffer_store_dwordx4 v[168:171], v7, s[48:51], s60 offen offset:1024 sc1
    s_add_u32 s60, s60, 65536
    s_waitcnt lgkmcnt(2)
    v_pk_fma_f32 v[176:177], v[76:77], v[24:25], v[176:177] op_sel_hi:[1,0,1]
    v_pk_fma_f32 v[178:179], v[78:79], v[24:25], v[178:179] op_sel_hi:[1,0,1]
    v_pk_mul_f32 v[176:177], v[176:177], v[24:25] op_sel:[0,1] op_sel_hi:[1,1]
    v_pk_mul_f32 v[178:179], v[178:179], v[24:25] op_sel:[0,1] op_sel_hi:[1,1]
    v_pk_fma_f32 v[180:181], v[76:77], v[26:27], v[180:181] op_sel_hi:[1,0,1]
    v_pk_fma_f32 v[182:183], v[78:79], v[26:27], v[182:183] op_sel_hi:[1,0,1]
    v_pk_mul_f32 v[180:181], v[180:181], v[26:27] op_sel:[0,1] op_sel_hi:[1,1]
    v_pk_mul_f32 v[182:183], v[182:183], v[26:27] op_sel:[0,1] op_sel_hi:[1,1]
    v_cvt_pk_bf16_f32 v176, v176, v177
    v_cvt_pk_bf16_f32 v177, v178, v179
    v_cvt_pk_bf16_f32 v178, v180, v181
    v_cvt_pk_bf16_f32 v179, v182, v183
    s_nop 0
    v_permlane16_swap_b32 v176, v178
    v_permlane16_swap_b32 v177, v179
    buffer_store_dwordx4 v[176:179], v7, s[48:51], s60 offen offset:0 sc1
    v_pk_fma_f32 v[184:185], v[76:77], v[28:29], v[184:185] op_sel_hi:[1,0,1]
    v_pk_fma_f32 v[186:187], v[78:79], v[28:29], v[186:187] op_sel_hi:[1,0,1]
    v_pk_mul_f32 v[184:185], v[184:185], v[28:29] op_sel:[0,1] op_sel_hi:[1,1]
    v_pk_mul_f32 v[186:187], v[186:187], v[28:29] op_sel:[0,1] op_sel_hi:[1,1]
    v_pk_fma_f32 v[188:189], v[76:77], v[30:31], v[188:189] op_sel_hi:[1,0,1]
    v_pk_fma_f32 v[190:191], v[78:79], v[30:31], v[190:191] op_sel_hi:[1,0,1]
    v_pk_mul_f32 v[188:189], v[188:189], v[30:31] op_sel:[0,1] op_sel_hi:[1,1]
    v_pk_mul_f32 v[190:191], v[190:191], v[30:31] op_sel:[0,1] op_sel_hi:[1,1]
    v_cvt_pk_bf16_f32 v184, v184, v185
    v_cvt_pk_bf16_f32 v185, v186, v187
    v_cvt_pk_bf16_f32 v186, v188, v189
    v_cvt_pk_bf16_f32 v187, v190, v191
    s_nop 0
    v_permlane16_swap_b32 v184, v186
    v_permlane16_swap_b32 v185, v187
    buffer_store_dwordx4 v[184:187], v7, s[48:51], s60 offen offset:1024 sc1
    s_add_u32 s60, s60, 65536
    s_waitcnt lgkmcnt(1)
    v_pk_fma_f32 v[192:193], v[80:81], v[24:25], v[192:193] op_sel_hi:[1,0,1]
    v_pk_fma_f32 v[194:195], v[82:83], v[24:25], v[194:195] op_sel_hi:[1,0,1]
    v_pk_mul_f32 v[192:193], v[192:193], v[24:25] op_sel:[0,1] op_sel_hi:[1,1]
    v_pk_mul_f32 v[194:195], v[194:195], v[24:25] op_sel:[0,1] op_sel_hi:[1,1]
    v_pk_fma_f32 v[196:197], v[80:81], v[26:27], v[196:197] op_sel_hi:[1,0,1]
    v_pk_fma_f32 v[198:199], v[82:83], v[26:27], v[198:199] op_sel_hi:[1,0,1]
    v_pk_mul_f32 v[196:197], v[196:197], v[26:27] op_sel:[0,1] op_sel_hi:[1,1]
    v_pk_mul_f32 v[198:199], v[198:199], v[26:27] op_sel:[0,1] op_sel_hi:[1,1]
    v_cvt_pk_bf16_f32 v192, v192, v193
    v_cvt_pk_bf16_f32 v193, v194, v195
    v_cvt_pk_bf16_f32 v194, v196, v197
    v_cvt_pk_bf16_f32 v195, v198, v199
    s_nop 0
    v_permlane16_swap_b32 v192, v194
    v_permlane16_swap_b32 v193, v195
    buffer_store_dwordx4 v[192:195], v7, s[48:51], s60 offen offset:0 sc1
    v_pk_fma_f32 v[200:201], v[80:81], v[28:29], v[200:201] op_sel_hi:[1,0,1]
    v_pk_fma_f32 v[202:203], v[82:83], v[28:29], v[202:203] op_sel_hi:[1,0,1]
    v_pk_mul_f32 v[200:201], v[200:201], v[28:29] op_sel:[0,1] op_sel_hi:[1,1]
    v_pk_mul_f32 v[202:203], v[202:203], v[28:29] op_sel:[0,1] op_sel_hi:[1,1]
    v_pk_fma_f32 v[204:205], v[80:81], v[30:31], v[204:205] op_sel_hi:[1,0,1]
    v_pk_fma_f32 v[206:207], v[82:83], v[30:31], v[206:207] op_sel_hi:[1,0,1]
    v_pk_mul_f32 v[204:205], v[204:205], v[30:31] op_sel:[0,1] op_sel_hi:[1,1]
    v_pk_mul_f32 v[206:207], v[206:207], v[30:31] op_sel:[0,1] op_sel_hi:[1,1]
    v_cvt_pk_bf16_f32 v200, v200, v201
    v_cvt_pk_bf16_f32 v201, v202, v203
    v_cvt_pk_bf16_f32 v202, v204, v205
    v_cvt_pk_bf16_f32 v203, v206, v207
    s_nop 0
    v_permlane16_swap_b32 v200, v202
    v_permlane16_swap_b32 v201, v203
    buffer_store_dwordx4 v[200:203], v7, s[48:51], s60 offen offset:1024 sc1
    s_add_u32 s60, s60, 65536
    s_waitcnt lgkmcnt(0)
    v_pk_fma_f32 v[208:209], v[84:85], v[24:25], v[208:209] op_sel_hi:[1,0,1]
    v_pk_fma_f32 v[210:211], v[86:87], v[24:25], v[210:211] op_sel_hi:[1,0,1]
    v_pk_mul_f32 v[208:209], v[208:209], v[24:25] op_sel:[0,1] op_sel_hi:[1,1]
    v_pk_mul_f32 v[210:211], v[210:211], v[24:25] op_sel:[0,1] op_sel_hi:[1,1]
    v_pk_fma_f32 v[212:213], v[84:85], v[26:27], v[212:213] op_sel_hi:[1,0,1]
    v_pk_fma_f32 v[214:215], v[86:87], v[26:27], v[214:215] op_sel_hi:[1,0,1]
    v_pk_mul_f32 v[212:213], v[212:213], v[26:27] op_sel:[0,1] op_sel_hi:[1,1]
    v_pk_mul_f32 v[214:215], v[214:215], v[26:27] op_sel:[0,1] op_sel_hi:[1,1]
    v_cvt_pk_bf16_f32 v208, v208, v209
    v_cvt_pk_bf16_f32 v209, v210, v211
    v_cvt_pk_bf16_f32 v210, v212, v213
    v_cvt_pk_bf16_f32 v211, v214, v215
    s_nop 0
    v_permlane16_swap_b32 v208, v210
    v_permlane16_swap_b32 v209, v211
    buffer_store_dwordx4 v[208:211], v7, s[48:51], s60 offen offset:0 sc1
    v_pk_fma_f32 v[216:217], v[84:85], v[28:29], v[216:217] op_sel_hi:[1,0,1]
    v_pk_fma_f32 v[218:219], v[86:87], v[28:29], v[218:219] op_sel_hi:[1,0,1]
    v_pk_mul_f32 v[216:217], v[216:217], v[28:29] op_sel:[0,1] op_sel_hi:[1,1]
    v_pk_mul_f32 v[218:219], v[218:219], v[28:29] op_sel:[0,1] op_sel_hi:[1,1]
    v_pk_fma_f32 v[220:221], v[84:85], v[30:31], v[220:221] op_sel_hi:[1,0,1]
    v_pk_fma_f32 v[222:223], v[86:87], v[30:31], v[222:223] op_sel_hi:[1,0,1]
    v_pk_mul_f32 v[220:221], v[220:221], v[30:31] op_sel:[0,1] op_sel_hi:[1,1]
    v_pk_mul_f32 v[222:223], v[222:223], v[30:31] op_sel:[0,1] op_sel_hi:[1,1]
    v_cvt_pk_bf16_f32 v216, v216, v217
    v_cvt_pk_bf16_f32 v217, v218, v219
    v_cvt_pk_bf16_f32 v218, v220, v221
    v_cvt_pk_bf16_f32 v219, v222, v223
    s_nop 0
    v_permlane16_swap_b32 v216, v218
    v_permlane16_swap_b32 v217, v219
    buffer_store_dwordx4 v[216:219], v7, s[48:51], s60 offen offset:1024 sc1
    s_add_u32 s60, s60, 65536
    s_branch fz_mdone
fz_mF:
    s_cmp_eq_u32 s43, 1
    s_cbranch_scc1 fz_mF1
    ds_read_b128 v[24:27], v9 offset:0
    ds_read_b128 v[28:31], v9 offset:2048
    ds_read_b128 v[32:35], v9 offset:4096
    ds_read_b128 v[36:39], v9 offset:6144
    ds_read_b64_tr_b16 v[56:57], v11 offset:0
    ds_read_b64_tr_b16 v[58:59], v11 offset:4608
    ds_read_b64_tr_b16 v[60:61], v11 offset:32
    ds_read_b64_tr_b16 v[62:63], v11 offset:4640
    ds_read_b64_tr_b16 v[64:65], v11 offset:64
    ds_read_b64_tr_b16 v[66:67], v11 offset:4672
    ds_read_b64_tr_b16 v[68:69], v11 offset:96
    ds_read_b64_tr_b16 v[70:71], v11 offset:4704
    s_waitcnt lgkmcnt(6)
    ds_read_b64_tr_b16 v[72:73], v11 offset:128
    ds_read_b64_tr_b16 v[74:75], v11 offset:4736
    ds_read_b64_tr_b16 v[76:77], v11 offset:18432
    ds_read_b64_tr_b16 v[78:79], v11 offset:23040
    ds_read_b64_tr_b16 v[80:81], v11 offset:18464
    ds_read_b64_tr_b16 v[82:83], v11 offset:23072
    ds_read_b64_tr_b16 v[84:85], v11 offset:18496
    ds_read_b64_tr_b16 v[86:87], v11 offset:23104
    s_waitcnt lgkmcnt(6)
    ds_read_b64_tr_b16 v[88:89], v11 offset:18528
    ds_read_b64_tr_b16 v[90:91], v11 offset:23136
    ds_read_b64_tr_b16 v[92:93], v11 offset:18560
    ds_read_b64_tr_b16 v[94:95], v11 offset:23168
    v_mfma_f32_16x16x32_bf16 v[96:99], v[56:59], v[24:27], 0
    v_mfma_f32_16x16x32_bf16 v[100:103], v[56:59], v[28:31], 0
    v_mfma_f32_16x16x32_bf16 v[104:107], v[56:59], v[32:35], 0
    v_mfma_f32_16x16x32_bf16 v[108:111], v[56:59], v[36:39], 0
    s_waitcnt lgkmcnt(8)
    v_mfma_f32_16x16x32_bf16 v[176:179], v[76:79], v[24:27], 0
    ds_read_b64_tr_b16 v[56:57], v11 offset:9216
    v_mfma_f32_16x16x32_bf16 v[180:183], v[76:79], v[28:31], 0
    ds_read_b64_tr_b16 v[58:59], v11 offset:13824
    v_mfma_f32_16x16x32_bf16 v[184:187], v[76:79], v[32:35], 0
    v_mfma_f32_16x16x32_bf16 v[188:191], v[76:79], v[36:39], 0
    v_mfma_f32_16x16x32_bf16 v[112:115], v[60:63], v[24:27], 0
    ds_read_b64_tr_b16 v[76:77], v11 offset:27648
    v_mfma_f32_16x16x32_bf16 v[116:119], v[60:63], v[28:31], 0
    ds_read_b64_tr_b16 v[78:79], v11 offset:32256
    v_mfma_f32_16x16x32_bf16 v[120:123], v[60:63], v[32:35], 0
    v_mfma_f32_16x16x32_bf16 v[124:127], v[60:63], v[36:39], 0
    s_waitcnt lgkmcnt(10)
    v_mfma_f32_16x16x32_bf16 v[192:195], v[80:83], v[24:27], 0
    ds_read_b64_tr_b16 v[60:61], v11 offset:9248
    v_mfma_f32_16x16x32_bf16 v[196:199], v[80:83], v[28:31], 0
    ds_read_b64_tr_b16 v[62:63], v11 offset:13856
    v_mfma_f32_16x16x32_bf16 v[200:203], v[80:83], v[32:35], 0
    ds_read_b128 v[40:43], v10 offset:0
    v_mfma_f32_16x16x32_bf16 v[204:207], v[80:83], v[36:39], 0
    ds_read_b128 v[44:47], v10 offset:2048
    v_mfma_f32_16x16x32_bf16 v[160:163], v[72:75], v[24:27], 0
    ds_read_b64_tr_b16 v[80:81], v11 offset:27680
    v_mfma_f32_16x16x32_bf16 v[164:167], v[72:75], v[28:31], 0
    ds_read_b64_tr_b16 v[82:83], v11 offset:32288
    s_waitcnt lgkmcnt(10)
    v_mfma_f32_16x16x32_bf16 v[240:243], v[92:95], v[24:27], 0
    ds_read_b128 v[48:51], v10 offset:4096
    v_mfma_f32_16x16x32_bf16 v[244:247], v[92:95], v[28:31], 0
    ds_read_b128 v[52:55], v10 offset:6144
    v_mfma_f32_16x16x32_bf16 v[128:131], v[64:67], v[24:27], 0
    ds_read_b64_tr_b16 v[72:73], v11 offset:9344
    v_mfma_f32_16x16x32_bf16 v[132:135], v[64:67], v[28:31], 0
    ds_read_b64_tr_b16 v[74:75], v11 offset:13952
    v_mfma_f32_16x16x32_bf16 v[136:139], v[64:67], v[32:35], 0
    ds_read_b64_tr_b16 v[92:93], v11 offset:27776
    v_mfma_f32_16x16x32_bf16 v[140:143], v[64:67], v[36:39], 0
    ds_read_b64_tr_b16 v[94:95], v11 offset:32384
    v_mfma_f32_16x16x32_bf16 v[208:211], v[84:87], v[24:27], 0
    ds_read_b64_tr_b16 v[64:65], v11 offset:9280
    v_mfma_f32_16x16x32_bf16 v[212:215], v[84:87], v[28:31], 0
    ds_read_b64_tr_b16 v[66:67], v11 offset:13888
    v_mfma_f32_16x16x32_bf16 v[216:219], v[84:87], v[32:35], 0
    v_mfma_f32_16x16x32_bf16 v[220:223], v[84:87], v[36:39], 0
    v_mfma_f32_16x16x32_bf16 v[144:147], v[68:71], v[24:27], 0
    ds_read_b64_tr_b16 v[84:85], v11 offset:27712
    v_mfma_f32_16x16x32_bf16 v[148:151], v[68:71], v[28:31], 0
    ds_read_b64_tr_b16 v[86:87], v11 offset:32320
    v_mfma_f32_16x16x32_bf16 v[152:155], v[68:71], v[32:35], 0
    v_mfma_f32_16x16x32_bf16 v[156:159], v[68:71], v[36:39], 0
    v_mfma_f32_16x16x32_bf16 v[224:227], v[88:91], v[24:27], 0
    ds_read_b64_tr_b16 v[68:69], v11 offset:9312
    v_mfma_f32_16x16x32_bf16 v[228:231], v[88:91], v[28:31], 0
    ds_read_b64_tr_b16 v[70:71], v11 offset:13920
    v_mfma_f32_16x16x32_bf16 v[232:235], v[88:91], v[32:35], 0
    v_mfma_f32_16x16x32_bf16 v[236:239], v[88:91], v[36:39], 0
    s_waitcnt lgkmcnt(10)
    v_mfma_f32_16x16x32_bf16 v[96:99], v[56:59], v[40:43], v[96:99]
    ds_read_b64_tr_b16 v[88:89], v11 offset:27744
    v_mfma_f32_16x16x32_bf16 v[100:103], v[56:59], v[44:47], v[100:103]
    ds_read_b64_tr_b16 v[90:91], v11 offset:32352
    v_mfma_f32_16x16x32_bf16 v[104:107], v[56:59], v[48:51], v[104:107]
    v_mfma_f32_16x16x32_bf16 v[108:111], v[56:59], v[52:55], v[108:111]
    v_mfma_f32_16x16x32_bf16 v[176:179], v[76:79], v[40:43], v[176:179]
    v_mfma_f32_16x16x32_bf16 v[180:183], v[76:79], v[44:47], v[180:183]
    v_mfma_f32_16x16x32_bf16 v[184:187], v[76:79], v[48:51], v[184:187]
    v_mfma_f32_16x16x32_bf16 v[188:191], v[76:79], v[52:55], v[188:191]
    s_waitcnt lgkmcnt(0)
    s_barrier
    v_mfma_f32_16x16x32_bf16 v[112:115], v[60:63], v[40:43], v[112:115]
    ds_read_b64_tr_b16 v[56:57], v14 offset:0
    v_mfma_f32_16x16x32_bf16 v[116:119], v[60:63], v[44:47], v[116:119]
    ds_read_b64_tr_b16 v[58:59], v14 offset:4608
    v_mfma_f32_16x16x32_bf16 v[120:123], v[60:63], v[48:51], v[120:123]
    ds_read_b64_tr_b16 v[76:77], v14 offset:18432
    v_mfma_f32_16x16x32_bf16 v[124:127], v[60:63], v[52:55], v[124:127]
    ds_read_b64_tr_b16 v[78:79], v14 offset:23040
    v_mfma_f32_16x16x32_bf16 v[192:195], v[80:83], v[40:43], v[192:195]
    ds_read_b64_tr_b16 v[60:61], v14 offset:32
    v_mfma_f32_16x16x32_bf16 v[196:199], v[80:83], v[44:47], v[196:199]
    ds_read_b64_tr_b16 v[62:63], v14 offset:4640
    v_mfma_f32_16x16x32_bf16 v[200:203], v[80:83], v[48:51], v[200:203]
    ds_read_b128 v[24:27], v12 offset:0
    v_mfma_f32_16x16x32_bf16 v[204:207], v[80:83], v[52:55], v[204:207]
    ds_read_b128 v[28:31], v12 offset:2048
    v_mfma_f32_16x16x32_bf16 v[160:163], v[72:75], v[40:43], v[160:163]
    ds_read_b64_tr_b16 v[80:81], v14 offset:18464
    v_mfma_f32_16x16x32_bf16 v[164:167], v[72:75], v[44:47], v[164:167]
    ds_read_b64_tr_b16 v[82:83], v14 offset:23072
    v_mfma_f32_16x16x32_bf16 v[240:243], v[92:95], v[40:43], v[240:243]
    ds_read_b128 v[32:35], v12 offset:4096
    v_mfma_f32_16x16x32_bf16 v[244:247], v[92:95], v[44:47], v[244:247]
    ds_read_b128 v[36:39], v12 offset:6144
    v_mfma_f32_16x16x32_bf16 v[128:131], v[64:67], v[40:43], v[128:131]
    ds_read_b64_tr_b16 v[72:73], v14 offset:128
    v_mfma_f32_16x16x32_bf16 v[132:135], v[64:67], v[44:47], v[132:135]
    ds_read_b64_tr_b16 v[74:75], v14 offset:4736
    v_mfma_f32_16x16x32_bf16 v[136:139], v[64:67], v[48:51], v[136:139]
    ds_read_b64_tr_b16 v[92:93], v14 offset:18560
    v_mfma_f32_16x16x32_bf16 v[140:143], v[64:67], v[52:55], v[140:143]
    ds_read_b64_tr_b16 v[94:95], v14 offset:23168
    v_mfma_f32_16x16x32_bf16 v[208:211], v[84:87], v[40:43], v[208:211]
    ds_read_b64_tr_b16 v[64:65], v14 offset:64
    v_mfma_f32_16x16x32_bf16 v[212:215], v[84:87], v[44:47], v[212:215]
    ds_read_b64_tr_b16 v[66:67], v14 offset:4672
    v_mfma_f32_16x16x32_bf16 v[216:219], v[84:87], v[48:51], v[216:219]
    v_mfma_f32_16x16x32_bf16 v[220:223], v[84:87], v[52:55], v[220:223]
    v_mfma_f32_16x16x32_bf16 v[144:147], v[68:71], v[40:43], v[144:147]
    ds_read_b64_tr_b16 v[84:85], v14 offset:18496
    v_mfma_f32_16x16x32_bf16 v[148:151], v[68:71], v[44:47], v[148:151]
    ds_read_b64_tr_b16 v[86:87], v14 offset:23104
    v_mfma_f32_16x16x32_bf16 v[152:155], v[68:71], v[48:51], v[152:155]
    v_mfma_f32_16x16x32_bf16 v[156:159], v[68:71], v[52:55], v[156:159]
    v_mfma_f32_16x16x32_bf16 v[224:227], v[88:91], v[40:43], v[224:227]
    ds_read_b64_tr_b16 v[68:69], v14 offset:96
    v_mfma_f32_16x16x32_bf16 v[228:231], v[88:91], v[44:47], v[228:231]
    ds_read_b64_tr_b16 v[70:71], v14 offset:4704
    v_mfma_f32_16x16x32_bf16 v[232:235], v[88:91], v[48:51], v[232:235]
    v_mfma_f32_16x16x32_bf16 v[236:239], v[88:91], v[52:55], v[236:239]
    s_waitcnt lgkmcnt(10)
    v_mfma_f32_16x16x32_bf16 v[96:99], v[56:59], v[24:27], v[96:99]
    ds_read_b64_tr_b16 v[88:89], v14 offset:18528
    v_mfma_f32_16x16x32_bf16 v[100:103], v[56:59], v[28:31], v[100:103]
    ds_read_b64_tr_b16 v[90:91], v14 offset:23136
    v_mfma_f32_16x16x32_bf16 v[104:107], v[56:59], v[32:35], v[104:107]
    v_mfma_f32_16x16x32_bf16 v[108:111], v[56:59], v[36:39], v[108:111]
    v_mfma_f32_16x16x32_bf16 v[176:179], v[76:79], v[24:27], v[176:179]
    ds_read_b64_tr_b16 v[56:57], v14 offset:9216
    v_mfma_f32_16x16x32_bf16 v[180:183], v[76:79], v[28:31], v[180:183]
    ds_read_b64_tr_b16 v[58:59], v14 offset:13824
    v_mfma_f32_16x16x32_bf16 v[184:187], v[76:79], v[32:35], v[184:187]
    v_mfma_f32_16x16x32_bf16 v[188:191], v[76:79], v[36:39], v[188:191]
    v_mfma_f32_16x16x32_bf16 v[112:115], v[60:63], v[24:27], v[112:115]
    ds_read_b64_tr_b16 v[76:77], v14 offset:27648
    v_mfma_f32_16x16x32_bf16 v[116:119], v[60:63], v[28:31], v[116:119]
    ds_read_b64_tr_b16 v[78:79], v14 offset:32256
    v_mfma_f32_16x16x32_bf16 v[120:123], v[60:63], v[32:35], v[120:123]
    v_mfma_f32_16x16x32_bf16 v[124:127], v[60:63], v[36:39], v[124:127]
    v_mfma_f32_16x16x32_bf16 v[192:195], v[80:83], v[24:27], v[192:195]
    ds_read_b64_tr_b16 v[60:61], v14 offset:9248
    v_mfma_f32_16x16x32_bf16 v[196:199], v[80:83], v[28:31], v[196:199]
    ds_read_b64_tr_b16 v[62:63], v14 offset:13856
    v_mfma_f32_16x16x32_bf16 v[200:203], v[80:83], v[32:35], v[200:203]
    ds_read_b128 v[40:43], v13 offset:0
    v_mfma_f32_16x16x32_bf16 v[204:207], v[80:83], v[36:39], v[204:207]
    ds_read_b128 v[44:47], v13 offset:2048
    s_waitcnt lgkmcnt(12)
    v_mfma_f32_16x16x32_bf16 v[160:163], v[72:75], v[24:27], v[160:163]
    ds_read_b64_tr_b16 v[80:81], v14 offset:27680
    v_mfma_f32_16x16x32_bf16 v[164:167], v[72:75], v[28:31], v[164:167]
    ds_read_b64_tr_b16 v[82:83], v14 offset:32288
    v_mfma_f32_16x16x32_bf16 v[240:243], v[92:95], v[24:27], v[240:243]
    ds_read_b128 v[48:51], v13 offset:4096
    v_mfma_f32_16x16x32_bf16 v[244:247], v[92:95], v[28:31], v[244:247]
    ds_read_b128 v[52:55], v13 offset:6144
    v_mfma_f32_16x16x32_bf16 v[128:131], v[64:67], v[24:27], v[128:131]
    ds_read_b64_tr_b16 v[72:73], v14 offset:9344
    v_mfma_f32_16x16x32_bf16 v[132:135], v[64:67], v[28:31], v[132:135]
    ds_read_b64_tr_b16 v[74:75], v14 offset:13952
    v_mfma_f32_16x16x32_bf16 v[136:139], v[64:67], v[32:35], v[136:139]
    ds_read_b64_tr_b16 v[92:93], v14 offset:27776
    v_mfma_f32_16x16x32_bf16 v[140:143], v[64:67], v[36:39], v[140:143]
    ds_read_b64_tr_b16 v[94:95], v14 offset:32384
    v_mfma_f32_16x16x32_bf16 v[208:211], v[84:87], v[24:27], v[208:211]
    ds_read_b64_tr_b16 v[64:65], v14 offset:9280
    v_mfma_f32_16x16x32_bf16 v[212:215], v[84:87], v[28:31], v[212:215]
    ds_read_b64_tr_b16 v[66:67], v14 offset:13888
    v_mfma_f32_16x16x32_bf16 v[216:219], v[84:87], v[32:35], v[216:219]
    v_mfma_f32_16x16x32_bf16 v[220:223], v[84:87], v[36:39], v[220:223]
    s_waitcnt lgkmcnt(12)
    v_mfma_f32_16x16x32_bf16 v[144:147], v[68:71], v[24:27], v[144:147]
    ds_read_b64_tr_b16 v[84:85], v14 offset:27712
    v_mfma_f32_16x16x32_bf16 v[148:151], v[68:71], v[28:31], v[148:151]
    ds_read_b64_tr_b16 v[86:87], v14 offset:32320
    v_mfma_f32_16x16x32_bf16 v[152:155], v[68:71], v[32:35], v[152:155]
    v_mfma_f32_16x16x32_bf16 v[156:159], v[68:71], v[36:39], v[156:159]
    v_mfma_f32_16x16x32_bf16 v[224:227], v[88:91], v[24:27], v[224:227]
    ds_read_b64_tr_b16 v[68:69], v14 offset:9312
    v_mfma_f32_16x16x32_bf16 v[228:231], v[88:91], v[28:31], v[228:231]
    ds_read_b64_tr_b16 v[70:71], v14 offset:13920
    v_mfma_f32_16x16x32_bf16 v[232:235], v[88:91], v[32:35], v[232:235]
    v_mfma_f32_16x16x32_bf16 v[236:239], v[88:91], v[36:39], v[236:239]
    s_waitcnt lgkmcnt(10)
    v_mfma_f32_16x16x32_bf16 v[96:99], v[56:59], v[40:43], v[96:99]
    ds_read_b64_tr_b16 v[88:89], v14 offset:27744
    v_mfma_f32_16x16x32_bf16 v[100:103], v[56:59], v[44:47], v[100:103]
    ds_read_b64_tr_b16 v[90:91], v14 offset:32352
    v_mfma_f32_16x16x32_bf16 v[104:107], v[56:59], v[48:51], v[104:107]
    v_mfma_f32_16x16x32_bf16 v[108:111], v[56:59], v[52:55], v[108:111]
    v_mfma_f32_16x16x32_bf16 v[176:179], v[76:79], v[40:43], v[176:179]
    v_mfma_f32_16x16x32_bf16 v[180:183], v[76:79], v[44:47], v[180:183]
    v_mfma_f32_16x16x32_bf16 v[184:187], v[76:79], v[48:51], v[184:187]
    v_mfma_f32_16x16x32_bf16 v[188:191], v[76:79], v[52:55], v[188:191]
    s_waitcnt lgkmcnt(0)
    s_barrier
    v_mfma_f32_16x16x32_bf16 v[112:115], v[60:63], v[40:43], v[112:115]
    ds_read_b64_tr_b16 v[56:57], v17 offset:0
    v_mfma_f32_16x16x32_bf16 v[116:119], v[60:63], v[44:47], v[116:119]
    ds_read_b64_tr_b16 v[58:59], v17 offset:4608
    v_mfma_f32_16x16x32_bf16 v[120:123], v[60:63], v[48:51], v[120:123]
    ds_read_b64_tr_b16 v[76:77], v17 offset:18432
    v_mfma_f32_16x16x32_bf16 v[124:127], v[60:63], v[52:55], v[124:127]
    ds_read_b64_tr_b16 v[78:79], v17 offset:23040
    v_mfma_f32_16x16x32_bf16 v[192:195], v[80:83], v[40:43], v[192:195]
    ds_read_b64_tr_b16 v[60:61], v17 offset:32
    v_mfma_f32_16x16x32_bf16 v[196:199], v[80:83], v[44:47], v[196:199]
    ds_read_b64_tr_b16 v[62:63], v17 offset:4640
    v_mfma_f32_16x16x32_bf16 v[200:203], v[80:83], v[48:51], v[200:203]
    ds_read_b128 v[24:27], v15 offset:0
    v_mfma_f32_16x16x32_bf16 v[204:207], v[80:83], v[52:55], v[204:207]
    ds_read_b128 v[28:31], v15 offset:2048
    v_mfma_f32_16x16x32_bf16 v[160:163], v[72:75], v[40:43], v[160:163]
    ds_read_b64_tr_b16 v[80:81], v17 offset:18464
    v_mfma_f32_16x16x32_bf16 v[164:167], v[72:75], v[44:47], v[164:167]
    ds_read_b64_tr_b16 v[82:83], v17 offset:23072
    v_mfma_f32_16x16x32_bf16 v[240:243], v[92:95], v[40:43], v[240:243]
    ds_read_b128 v[32:35], v15 offset:4096
    v_mfma_f32_16x16x32_bf16 v[244:247], v[92:95], v[44:47], v[244:247]
    ds_read_b128 v[36:39], v15 offset:6144
    v_mfma_f32_16x16x32_bf16 v[128:131], v[64:67], v[40:43], v[128:131]
    ds_read_b64_tr_b16 v[72:73], v17 offset:128
    v_mfma_f32_16x16x32_bf16 v[132:135], v[64:67], v[44:47], v[132:135]
    ds_read_b64_tr_b16 v[74:75], v17 offset:4736
    v_mfma_f32_16x16x32_bf16 v[136:139], v[64:67], v[48:51], v[136:139]
    ds_read_b64_tr_b16 v[92:93], v17 offset:18560
    v_mfma_f32_16x16x32_bf16 v[140:143], v[64:67], v[52:55], v[140:143]
    ds_read_b64_tr_b16 v[94:95], v17 offset:23168
    v_mfma_f32_16x16x32_bf16 v[208:211], v[84:87], v[40:43], v[208:211]
    ds_read_b64_tr_b16 v[64:65], v17 offset:64
    v_mfma_f32_16x16x32_bf16 v[212:215], v[84:87], v[44:47], v[212:215]
    ds_read_b64_tr_b16 v[66:67], v17 offset:4672
    v_mfma_f32_16x16x32_bf16 v[216:219], v[84:87], v[48:51], v[216:219]
    v_mfma_f32_16x16x32_bf16 v[220:223], v[84:87], v[52:55], v[220:223]
    v_mfma_f32_16x16x32_bf16 v[144:147], v[68:71], v[40:43], v[144:147]
    ds_read_b64_tr_b16 v[84:85], v17 offset:18496
    v_mfma_f32_16x16x32_bf16 v[148:151], v[68:71], v[44:47], v[148:151]
    ds_read_b64_tr_b16 v[86:87], v17 offset:23104
    v_mfma_f32_16x16x32_bf16 v[152:155], v[68:71], v[48:51], v[152:155]
    v_mfma_f32_16x16x32_bf16 v[156:159], v[68:71], v[52:55], v[156:159]
    v_mfma_f32_16x16x32_bf16 v[224:227], v[88:91], v[40:43], v[224:227]
    ds_read_b64_tr_b16 v[68:69], v17 offset:96
    v_mfma_f32_16x16x32_bf16 v[228:231], v[88:91], v[44:47], v[228:231]
    ds_read_b64_tr_b16 v[70:71], v17 offset:4704
    v_mfma_f32_16x16x32_bf16 v[232:235], v[88:91], v[48:51], v[232:235]
    v_mfma_f32_16x16x32_bf16 v[236:239], v[88:91], v[52:55], v[236:239]
    s_cmp_lg_u32 s26, 0
    s_cbranch_scc1 fz_npd8
    s_mov_b32 s52, s16
    s_mov_b32 s53, s17
    s_mov_b32 s54, 0x158000
    s_mov_b32 s55, 0x00020000
    s_mul_i32 s67, s2, 5504
    v_lshlrev_b32 v22, 7, v0
    v_min_u32 v22, 5376, v22
    buffer_load_dword v21, v22, s[52:55], s67 offen
fz_npd8:
    s_cmp_lg_u32 s26, 1
    s_cbranch_scc1 fz_npd9
    s_mov_b32 s52, s8
    s_mov_b32 s53, s9
    s_mov_b32 s54, 0x80000
    s_mov_b32 s55, 0x00020000
    s_mul_i32 s67, s2, 2048
    v_lshlrev_b32 v22, 7, v0
    v_min_u32 v22, 1920, v22
    buffer_load_dword v21, v22, s[52:55], s67 offen
fz_npd9:
    s_waitcnt lgkmcnt(10)
    v_mfma_f32_16x16x32_bf16 v[96:99], v[56:59], v[24:27], v[96:99]
    ds_read_b64_tr_b16 v[88:89], v17 offset:18528
    v_mfma_f32_16x16x32_bf16 v[100:103], v[56:59], v[28:31], v[100:103]
    ds_read_b64_tr_b16 v[90:91], v17 offset:23136
    v_mfma_f32_16x16x32_bf16 v[104:107], v[56:59], v[32:35], v[104:107]
    v_mfma_f32_16x16x32_bf16 v[108:111], v[56:59], v[36:39], v[108:111]
    v_mfma_f32_16x16x32_bf16 v[176:179], v[76:79], v[24:27], v[176:179]
    ds_read_b64_tr_b16 v[56:57], v17 offset:9216
    v_mfma_f32_16x16x32_bf16 v[180:183], v[76:79], v[28:31], v[180:183]
    ds_read_b64_tr_b16 v[58:59], v17 offset:13824
    v_mfma_f32_16x16x32_bf16 v[184:187], v[76:79], v[32:35], v[184:187]
    v_mfma_f32_16x16x32_bf16 v[188:191], v[76:79], v[36:39], v[188:191]
    v_mfma_f32_16x16x32_bf16 v[112:115], v[60:63], v[24:27], v[112:115]
    ds_read_b64_tr_b16 v[76:77], v17 offset:27648
    v_mfma_f32_16x16x32_bf16 v[116:119], v[60:63], v[28:31], v[116:119]
    ds_read_b64_tr_b16 v[78:79], v17 offset:32256
    v_mfma_f32_16x16x32_bf16 v[120:123], v[60:63], v[32:35], v[120:123]
    v_mfma_f32_16x16x32_bf16 v[124:127], v[60:63], v[36:39], v[124:127]
    v_mfma_f32_16x16x32_bf16 v[192:195], v[80:83], v[24:27], v[192:195]
    ds_read_b64_tr_b16 v[60:61], v17 offset:9248
    v_mfma_f32_16x16x32_bf16 v[196:199], v[80:83], v[28:31], v[196:199]
    ds_read_b64_tr_b16 v[62:63], v17 offset:13856
    v_mfma_f32_16x16x32_bf16 v[200:203], v[80:83], v[32:35], v[200:203]
    ds_read_b128 v[40:43], v16 offset:0
    v_mfma_f32_16x16x32_bf16 v[204:207], v[80:83], v[36:39], v[204:207]
    ds_read_b128 v[44:47], v16 offset:2048
    s_waitcnt lgkmcnt(12)
    v_mfma_f32_16x16x32_bf16 v[160:163], v[72:75], v[24:27], v[160:163]
    ds_read_b64_tr_b16 v[80:81], v17 offset:27680
    v_mfma_f32_16x16x32_bf16 v[164:167], v[72:75], v[28:31], v[164:167]
    ds_read_b64_tr_b16 v[82:83], v17 offset:32288
    v_mfma_f32_16x16x32_bf16 v[240:243], v[92:95], v[24:27], v[240:243]
    ds_read_b128 v[48:51], v16 offset:4096
    v_mfma_f32_16x16x32_bf16 v[244:247], v[92:95], v[28:31], v[244:247]
    ds_read_b128 v[52:55], v16 offset:6144
    v_mfma_f32_16x16x32_bf16 v[128:131], v[64:67], v[24:27], v[128:131]
    ds_read_b64_tr_b16 v[72:73], v17 offset:9344
    v_mfma_f32_16x16x32_bf16 v[132:135], v[64:67], v[28:31], v[132:135]
    ds_read_b64_tr_b16 v[74:75], v17 offset:13952
    v_mfma_f32_16x16x32_bf16 v[136:139], v[64:67], v[32:35], v[136:139]
    ds_read_b64_tr_b16 v[92:93], v17 offset:27776
    v_mfma_f32_16x16x32_bf16 v[140:143], v[64:67], v[36:39], v[140:143]
    ds_read_b64_tr_b16 v[94:95], v17 offset:32384
    v_mfma_f32_16x16x32_bf16 v[208:211], v[84:87], v[24:27], v[208:211]
    ds_read_b64_tr_b16 v[64:65], v17 offset:9280
    v_mfma_f32_16x16x32_bf16 v[212:215], v[84:87], v[28:31], v[212:215]
    ds_read_b64_tr_b16 v[66:67], v17 offset:13888
    v_mfma_f32_16x16x32_bf16 v[216:219], v[84:87], v[32:35], v[216:219]
    v_mfma_f32_16x16x32_bf16 v[220:223], v[84:87], v[36:39], v[220:223]
    s_waitcnt lgkmcnt(12)
    v_mfma_f32_16x16x32_bf16 v[144:147], v[68:71], v[24:27], v[144:147]
    ds_read_b64_tr_b16 v[84:85], v17 offset:27712
    v_mfma_f32_16x16x32_bf16 v[148:151], v[68:71], v[28:31], v[148:151]
    ds_read_b64_tr_b16 v[86:87], v17 offset:32320
    v_mfma_f32_16x16x32_bf16 v[152:155], v[68:71], v[32:35], v[152:155]
    v_mfma_f32_16x16x32_bf16 v[156:159], v[68:71], v[36:39], v[156:159]
    v_mfma_f32_16x16x32_bf16 v[224:227], v[88:91], v[24:27], v[224:227]
    ds_read_b64_tr_b16 v[68:69], v17 offset:9312
    v_mfma_f32_16x16x32_bf16 v[228:231], v[88:91], v[28:31], v[228:231]
    ds_read_b64_tr_b16 v[70:71], v17 offset:13920
    v_mfma_f32_16x16x32_bf16 v[232:235], v[88:91], v[32:35], v[232:235]
    v_mfma_f32_16x16x32_bf16 v[236:239], v[88:91], v[36:39], v[236:239]
    s_waitcnt lgkmcnt(10)
    v_mfma_f32_16x16x32_bf16 v[96:99], v[56:59], v[40:43], v[96:99]
    ds_read_b64_tr_b16 v[88:89], v17 offset:27744
    v_mfma_f32_16x16x32_bf16 v[100:103], v[56:59], v[44:47], v[100:103]
    ds_read_b64_tr_b16 v[90:91], v17 offset:32352
    v_mfma_f32_16x16x32_bf16 v[104:107], v[56:59], v[48:51], v[104:107]
    v_mfma_f32_16x16x32_bf16 v[108:111], v[56:59], v[52:55], v[108:111]
    v_mfma_f32_16x16x32_bf16 v[176:179], v[76:79], v[40:43], v[176:179]
    v_mfma_f32_16x16x32_bf16 v[180:183], v[76:79], v[44:47], v[180:183]
    v_mfma_f32_16x16x32_bf16 v[184:187], v[76:79], v[48:51], v[184:187]
    v_mfma_f32_16x16x32_bf16 v[188:191], v[76:79], v[52:55], v[188:191]
    s_waitcnt lgkmcnt(0)
    s_barrier
    v_mfma_f32_16x16x32_bf16 v[112:115], v[60:63], v[40:43], v[112:115]
    ds_read_b64_tr_b16 v[56:57], v11 offset:0
    v_mfma_f32_16x16x32_bf16 v[116:119], v[60:63], v[44:47], v[116:119]
    ds_read_b64_tr_b16 v[58:59], v11 offset:4608
    v_mfma_f32_16x16x32_bf16 v[120:123], v[60:63], v[48:51], v[120:123]
    ds_read_b64_tr_b16 v[76:77], v11 offset:18432
    v_mfma_f32_16x16x32_bf16 v[124:127], v[60:63], v[52:55], v[124:127]
    ds_read_b64_tr_b16 v[78:79], v11 offset:23040
    v_mfma_f32_16x16x32_bf16 v[192:195], v[80:83], v[40:43], v[192:195]
    ds_read_b64_tr_b16 v[60:61], v11 offset:32
    v_mfma_f32_16x16x32_bf16 v[196:199], v[80:83], v[44:47], v[196:199]
    ds_read_b64_tr_b16 v[62:63], v11 offset:4640
    v_mfma_f32_16x16x32_bf16 v[200:203], v[80:83], v[48:51], v[200:203]
    ds_read_b128 v[24:27], v9 offset:0
    v_mfma_f32_16x16x32_bf16 v[204:207], v[80:83], v[52:55], v[204:207]
    ds_read_b128 v[28:31], v9 offset:2048
    v_mfma_f32_16x16x32_bf16 v[160:163], v[72:75], v[40:43], v[160:163]
    ds_read_b64_tr_b16 v[80:81], v11 offset:18464
    v_mfma_f32_16x16x32_bf16 v[164:167], v[72:75], v[44:47], v[164:167]
    ds_read_b64_tr_b16 v[82:83], v11 offset:23072
    v_mfma_f32_16x16x32_bf16 v[240:243], v[92:95], v[40:43], v[240:243]
    ds_read_b128 v[32:35], v9 offset:4096
    v_mfma_f32_16x16x32_bf16 v[244:247], v[92:95], v[44:47], v[244:247]
    ds_read_b128 v[36:39], v9 offset:6144
    v_mfma_f32_16x16x32_bf16 v[128:131], v[64:67], v[40:43], v[128:131]
    ds_read_b64_tr_b16 v[72:73], v11 offset:128
    v_mfma_f32_16x16x32_bf16 v[132:135], v[64:67], v[44:47], v[132:135]
    ds_read_b64_tr_b16 v[74:75], v11 offset:4736
    v_mfma_f32_16x16x32_bf16 v[136:139], v[64:67], v[48:51], v[136:139]
    ds_read_b64_tr_b16 v[92:93], v11 offset:18560
    v_mfma_f32_16x16x32_bf16 v[140:143], v[64:67], v[52:55], v[140:143]
    ds_read_b64_tr_b16 v[94:95], v11 offset:23168
    v_mfma_f32_16x16x32_bf16 v[208:211], v[84:87], v[40:43], v[208:211]
    ds_read_b64_tr_b16 v[64:65], v11 offset:64
    v_mfma_f32_16x16x32_bf16 v[212:215], v[84:87], v[44:47], v[212:215]
    ds_read_b64_tr_b16 v[66:67], v11 offset:4672
    v_mfma_f32_16x16x32_bf16 v[216:219], v[84:87], v[48:51], v[216:219]
    v_mfma_f32_16x16x32_bf16 v[220:223], v[84:87], v[52:55], v[220:223]
    v_mfma_f32_16x16x32_bf16 v[144:147], v[68:71], v[40:43], v[144:147]
    ds_read_b64_tr_b16 v[84:85], v11 offset:18496
    v_mfma_f32_16x16x32_bf16 v[148:151], v[68:71], v[44:47], v[148:151]
    ds_read_b64_tr_b16 v[86:87], v11 offset:23104
    v_mfma_f32_16x16x32_bf16 v[152:155], v[68:71], v[48:51], v[152:155]
    v_mfma_f32_16x16x32_bf16 v[156:159], v[68:71], v[52:55], v[156:159]
    v_mfma_f32_16x16x32_bf16 v[224:227], v[88:91], v[40:43], v[224:227]
    ds_read_b64_tr_b16 v[68:69], v11 offset:96
    v_mfma_f32_16x16x32_bf16 v[228:231], v[88:91], v[44:47], v[228:231]
    ds_read_b64_tr_b16 v[70:71], v11 offset:4704
    v_mfma_f32_16x16x32_bf16 v[232:235], v[88:91], v[48:51], v[232:235]
    v_mfma_f32_16x16x32_bf16 v[236:239], v[88:91], v[52:55], v[236:239]
    s_waitcnt lgkmcnt(10)
    v_mfma_f32_16x16x32_bf16 v[96:99], v[56:59], v[24:27], v[96:99]
    ds_read_b64_tr_b16 v[88:89], v11 offset:18528
    v_mfma_f32_16x16x32_bf16 v[100:103], v[56:59], v[28:31], v[100:103]
    ds_read_b64_tr_b16 v[90:91], v11 offset:23136
    v_mfma_f32_16x16x32_bf16 v[104:107], v[56:59], v[32:35], v[104:107]
    v_mfma_f32_16x16x32_bf16 v[108:111], v[56:59], v[36:39], v[108:111]
    v_mfma_f32_16x16x32_bf16 v[176:179], v[76:79], v[24:27], v[176:179]
    ds_read_b64_tr_b16 v[56:57], v11 offset:9216
    v_mfma_f32_16x16x32_bf16 v[180:183], v[76:79], v[28:31], v[180:183]
    ds_read_b64_tr_b16 v[58:59], v11 offset:13824
    v_mfma_f32_16x16x32_bf16 v[184:187], v[76:79], v[32:35], v[184:187]
    v_mfma_f32_16x16x32_bf16 v[188:191], v[76:79], v[36:39], v[188:191]
    v_mfma_f32_16x16x32_bf16 v[112:115], v[60:63], v[24:27], v[112:115]
    ds_read_b64_tr_b16 v[76:77], v11 offset:27648
    v_mfma_f32_16x16x32_bf16 v[116:119], v[60:63], v[28:31], v[116:119]
    ds_read_b64_tr_b16 v[78:79], v11 offset:32256
    v_mfma_f32_16x16x32_bf16 v[120:123], v[60:63], v[32:35], v[120:123]
    v_mfma_f32_16x16x32_bf16 v[124:127], v[60:63], v[36:39], v[124:127]
    v_mfma_f32_16x16x32_bf16 v[192:195], v[80:83], v[24:27], v[192:195]
    ds_read_b64_tr_b16 v[60:61], v11 offset:9248
    v_mfma_f32_16x16x32_bf16 v[196:199], v[80:83], v[28:31], v[196:199]
    ds_read_b64_tr_b16 v[62:63], v11 offset:13856
    v_mfma_f32_16x16x32_bf16 v[200:203], v[80:83], v[32:35], v[200:203]
    ds_read_b128 v[40:43], v10 offset:0
    v_mfma_f32_16x16x32_bf16 v[204:207], v[80:83], v[36:39], v[204:207]
    ds_read_b128 v[44:47], v10 offset:2048
    s_waitcnt lgkmcnt(12)
    v_mfma_f32_16x16x32_bf16 v[160:163], v[72:75], v[24:27], v[160:163]
    ds_read_b64_tr_b16 v[80:81], v11 offset:27680
    v_mfma_f32_16x16x32_bf16 v[164:167], v[72:75], v[28:31], v[164:167]
    ds_read_b64_tr_b16 v[82:83], v11 offset:32288
    v_mfma_f32_16x16x32_bf16 v[240:243], v[92:95], v[24:27], v[240:243]
    ds_read_b128 v[48:51], v10 offset:4096
    v_mfma_f32_16x16x32_bf16 v[244:247], v[92:95], v[28:31], v[244:247]
    ds_read_b128 v[52:55], v10 offset:6144
    v_mfma_f32_16x16x32_bf16 v[128:131], v[64:67], v[24:27], v[128:131]
    ds_read_b64_tr_b16 v[72:73], v11 offset:9344
    v_mfma_f32_16x16x32_bf16 v[132:135], v[64:67], v[28:31], v[132:135]
    ds_read_b64_tr_b16 v[74:75], v11 offset:13952
    v_mfma_f32_16x16x32_bf16 v[136:139], v[64:67], v[32:35], v[136:139]
    ds_read_b64_tr_b16 v[92:93], v11 offset:27776
    v_mfma_f32_16x16x32_bf16 v[140:143], v[64:67], v[36:39], v[140:143]
    ds_read_b64_tr_b16 v[94:95], v11 offset:32384
    v_mfma_f32_16x16x32_bf16 v[208:211], v[84:87], v[24:27], v[208:211]
    ds_read_b64_tr_b16 v[64:65], v11 offset:9280
    v_mfma_f32_16x16x32_bf16 v[212:215], v[84:87], v[28:31], v[212:215]
    ds_read_b64_tr_b16 v[66:67], v11 offset:13888
    v_mfma_f32_16x16x32_bf16 v[216:219], v[84:87], v[32:35], v[216:219]
    v_mfma_f32_16x16x32_bf16 v[220:223], v[84:87], v[36:39], v[220:223]
    s_waitcnt lgkmcnt(12)
    v_mfma_f32_16x16x32_bf16 v[144:147], v[68:71], v[24:27], v[144:147]
    ds_read_b64_tr_b16 v[84:85], v11 offset:27712
    v_mfma_f32_16x16x32_bf16 v[148:151], v[68:71], v[28:31], v[148:151]
    ds_read_b64_tr_b16 v[86:87], v11 offset:32320
    v_mfma_f32_16x16x32_bf16 v[152:155], v[68:71], v[32:35], v[152:155]
    v_mfma_f32_16x16x32_bf16 v[156:159], v[68:71], v[36:39], v[156:159]
    v_mfma_f32_16x16x32_bf16 v[224:227], v[88:91], v[24:27], v[224:227]
    ds_read_b64_tr_b16 v[68:69], v11 offset:9312
    v_mfma_f32_16x16x32_bf16 v[228:231], v[88:91], v[28:31], v[228:231]
    ds_read_b64_tr_b16 v[70:71], v11 offset:13920
    v_mfma_f32_16x16x32_bf16 v[232:235], v[88:91], v[32:35], v[232:235]
    v_mfma_f32_16x16x32_bf16 v[236:239], v[88:91], v[36:39], v[236:239]
    s_waitcnt lgkmcnt(10)
    v_mfma_f32_16x16x32_bf16 v[96:99], v[56:59], v[40:43], v[96:99]
    ds_read_b64_tr_b16 v[88:89], v11 offset:27744
    v_mfma_f32_16x16x32_bf16 v[100:103], v[56:59], v[44:47], v[100:103]
    ds_read_b64_tr_b16 v[90:91], v11 offset:32352
    v_mfma_f32_16x16x32_bf16 v[104:107], v[56:59], v[48:51], v[104:107]
    v_mfma_f32_16x16x32_bf16 v[108:111], v[56:59], v[52:55], v[108:111]
    v_mfma_f32_16x16x32_bf16 v[176:179], v[76:79], v[40:43], v[176:179]
    v_mfma_f32_16x16x32_bf16 v[180:183], v[76:79], v[44:47], v[180:183]
    v_mfma_f32_16x16x32_bf16 v[184:187], v[76:79], v[48:51], v[184:187]
    v_mfma_f32_16x16x32_bf16 v[188:191], v[76:79], v[52:55], v[188:191]
    s_waitcnt lgkmcnt(0)
    s_barrier
    v_mfma_f32_16x16x32_bf16 v[112:115], v[60:63], v[40:43], v[112:115]
    ds_read_b64_tr_b16 v[56:57], v14 offset:0
    v_mfma_f32_16x16x32_bf16 v[116:119], v[60:63], v[44:47], v[116:119]
    ds_read_b64_tr_b16 v[58:59], v14 offset:4608
    v_mfma_f32_16x16x32_bf16 v[120:123], v[60:63], v[48:51], v[120:123]
    ds_read_b64_tr_b16 v[76:77], v14 offset:18432
    v_mfma_f32_16x16x32_bf16 v[124:127], v[60:63], v[52:55], v[124:127]
    ds_read_b64_tr_b16 v[78:79], v14 offset:23040
    v_mfma_f32_16x16x32_bf16 v[192:195], v[80:83], v[40:43], v[192:195]
    ds_read_b64_tr_b16 v[60:61], v14 offset:32
    v_mfma_f32_16x16x32_bf16 v[196:199], v[80:83], v[44:47], v[196:199]
    ds_read_b64_tr_b16 v[62:63], v14 offset:4640
    v_mfma_f32_16x16x32_bf16 v[200:203], v[80:83], v[48:51], v[200:203]
    ds_read_b128 v[24:27], v12 offset:0
    v_mfma_f32_16x16x32_bf16 v[204:207], v[80:83], v[52:55], v[204:207]
    ds_read_b128 v[28:31], v12 offset:2048
    v_mfma_f32_16x16x32_bf16 v[160:163], v[72:75], v[40:43], v[160:163]
    ds_read_b64_tr_b16 v[80:81], v14 offset:18464
    v_mfma_f32_16x16x32_bf16 v[164:167], v[72:75], v[44:47], v[164:167]
    ds_read_b64_tr_b16 v[82:83], v14 offset:23072
    v_mfma_f32_16x16x32_bf16 v[240:243], v[92:95], v[40:43], v[240:243]
    ds_read_b128 v[32:35], v12 offset:4096
    v_mfma_f32_16x16x32_bf16 v[244:247], v[92:95], v[44:47], v[244:247]
    ds_read_b128 v[36:39], v12 offset:6144
    v_mfma_f32_16x16x32_bf16 v[128:131], v[64:67], v[40:43], v[128:131]
    ds_read_b64_tr_b16 v[72:73], v14 offset:128
    v_mfma_f32_16x16x32_bf16 v[132:135], v[64:67], v[44:47], v[132:135]
    ds_read_b64_tr_b16 v[74:75], v14 offset:4736
    v_mfma_f32_16x16x32_bf16 v[136:139], v[64:67], v[48:51], v[136:139]
    ds_read_b64_tr_b16 v[92:93], v14 offset:18560
    v_mfma_f32_16x16x32_bf16 v[140:143], v[64:67], v[52:55], v[140:143]
    ds_read_b64_tr_b16 v[94:95], v14 offset:23168
    v_mfma_f32_16x16x32_bf16 v[208:211], v[84:87], v[40:43], v[208:211]
    ds_read_b64_tr_b16 v[64:65], v14 offset:64
    v_mfma_f32_16x16x32_bf16 v[212:215], v[84:87], v[44:47], v[212:215]
    ds_read_b64_tr_b16 v[66:67], v14 offset:4672
    v_mfma_f32_16x16x32_bf16 v[216:219], v[84:87], v[48:51], v[216:219]
    v_mfma_f32_16x16x32_bf16 v[220:223], v[84:87], v[52:55], v[220:223]
    v_mfma_f32_16x16x32_bf16 v[144:147], v[68:71], v[40:43], v[144:147]
    ds_read_b64_tr_b16 v[84:85], v14 offset:18496
    v_mfma_f32_16x16x32_bf16 v[148:151], v[68:71], v[44:47], v[148:151]
    ds_read_b64_tr_b16 v[86:87], v14 offset:23104
    v_mfma_f32_16x16x32_bf16 v[152:155], v[68:71], v[48:51], v[152:155]
    v_mfma_f32_16x16x32_bf16 v[156:159], v[68:71], v[52:55], v[156:159]
    v_mfma_f32_16x16x32_bf16 v[224:227], v[88:91], v[40:43], v[224:227]
    ds_read_b64_tr_b16 v[68:69], v14 offset:96
    v_mfma_f32_16x16x32_bf16 v[228:231], v[88:91], v[44:47], v[228:231]
    ds_read_b64_tr_b16 v[70:71], v14 offset:4704
    v_mfma_f32_16x16x32_bf16 v[232:235], v[88:91], v[48:51], v[232:235]
    v_mfma_f32_16x16x32_bf16 v[236:239], v[88:91], v[52:55], v[236:239]
    s_waitcnt lgkmcnt(10)
    v_mfma_f32_16x16x32_bf16 v[96:99], v[56:59], v[24:27], v[96:99]
    ds_read_b64_tr_b16 v[88:89], v14 offset:18528
    v_mfma_f32_16x16x32_bf16 v[100:103], v[56:59], v[28:31], v[100:103]
    ds_read_b64_tr_b16 v[90:91], v14 offset:23136
    v_mfma_f32_16x16x32_bf16 v[104:107], v[56:59], v[32:35], v[104:107]
    v_mfma_f32_16x16x32_bf16 v[108:111], v[56:59], v[36:39], v[108:111]
    v_mfma_f32_16x16x32_bf16 v[176:179], v[76:79], v[24:27], v[176:179]
    ds_read_b64_tr_b16 v[56:57], v14 offset:9216
    v_mfma_f32_16x16x32_bf16 v[180:183], v[76:79], v[28:31], v[180:183]
    ds_read_b64_tr_b16 v[58:59], v14 offset:13824
    v_mfma_f32_16x16x32_bf16 v[184:187], v[76:79], v[32:35], v[184:187]
    v_mfma_f32_16x16x32_bf16 v[188:191], v[76:79], v[36:39], v[188:191]
    v_mfma_f32_16x16x32_bf16 v[112:115], v[60:63], v[24:27], v[112:115]
    ds_read_b64_tr_b16 v[76:77], v14 offset:27648
    v_mfma_f32_16x16x32_bf16 v[116:119], v[60:63], v[28:31], v[116:119]
    ds_read_b64_tr_b16 v[78:79], v14 offset:32256
    v_mfma_f32_16x16x32_bf16 v[120:123], v[60:63], v[32:35], v[120:123]
    v_mfma_f32_16x16x32_bf16 v[124:127], v[60:63], v[36:39], v[124:127]
    v_mfma_f32_16x16x32_bf16 v[192:195], v[80:83], v[24:27], v[192:195]
    ds_read_b64_tr_b16 v[60:61], v14 offset:9248
    v_mfma_f32_16x16x32_bf16 v[196:199], v[80:83], v[28:31], v[196:199]
    ds_read_b64_tr_b16 v[62:63], v14 offset:13856
    v_mfma_f32_16x16x32_bf16 v[200:203], v[80:83], v[32:35], v[200:203]
    ds_read_b128 v[40:43], v13 offset:0
    v_mfma_f32_16x16x32_bf16 v[204:207], v[80:83], v[36:39], v[204:207]
    ds_read_b128 v[44:47], v13 offset:2048
    s_waitcnt lgkmcnt(12)
    v_mfma_f32_16x16x32_bf16 v[160:163], v[72:75], v[24:27], v[160:163]
    ds_read_b64_tr_b16 v[80:81], v14 offset:27680
    v_mfma_f32_16x16x32_bf16 v[164:167], v[72:75], v[28:31], v[164:167]
    ds_read_b64_tr_b16 v[82:83], v14 offset:32288
    v_mfma_f32_16x16x32_bf16 v[240:243], v[92:95], v[24:27], v[240:243]
    ds_read_b128 v[48:51], v13 offset:4096
    v_mfma_f32_16x16x32_bf16 v[244:247], v[92:95], v[28:31], v[244:247]
    ds_read_b128 v[52:55], v13 offset:6144
    v_mfma_f32_16x16x32_bf16 v[128:131], v[64:67], v[24:27], v[128:131]
    ds_read_b64_tr_b16 v[72:73], v14 offset:9344
    v_mfma_f32_16x16x32_bf16 v[132:135], v[64:67], v[28:31], v[132:135]
    ds_read_b64_tr_b16 v[74:75], v14 offset:13952
    v_mfma_f32_16x16x32_bf16 v[136:139], v[64:67], v[32:35], v[136:139]
    ds_read_b64_tr_b16 v[92:93], v14 offset:27776
    v_mfma_f32_16x16x32_bf16 v[140:143], v[64:67], v[36:39], v[140:143]
    ds_read_b64_tr_b16 v[94:95], v14 offset:32384
    v_mfma_f32_16x16x32_bf16 v[208:211], v[84:87], v[24:27], v[208:211]
    ds_read_b64_tr_b16 v[64:65], v14 offset:9280
    v_mfma_f32_16x16x32_bf16 v[212:215], v[84:87], v[28:31], v[212:215]
    ds_read_b64_tr_b16 v[66:67], v14 offset:13888
    v_mfma_f32_16x16x32_bf16 v[216:219], v[84:87], v[32:35], v[216:219]
    v_mfma_f32_16x16x32_bf16 v[220:223], v[84:87], v[36:39], v[220:223]
    s_waitcnt lgkmcnt(12)
    v_mfma_f32_16x16x32_bf16 v[144:147], v[68:71], v[24:27], v[144:147]
    ds_read_b64_tr_b16 v[84:85], v14 offset:27712
    v_mfma_f32_16x16x32_bf16 v[148:151], v[68:71], v[28:31], v[148:151]
    ds_read_b64_tr_b16 v[86:87], v14 offset:32320
    v_mfma_f32_16x16x32_bf16 v[152:155], v[68:71], v[32:35], v[152:155]
    v_mfma_f32_16x16x32_bf16 v[156:159], v[68:71], v[36:39], v[156:159]
    v_mfma_f32_16x16x32_bf16 v[224:227], v[88:91], v[24:27], v[224:227]
    ds_read_b64_tr_b16 v[68:69], v14 offset:9312
    v_mfma_f32_16x16x32_bf16 v[228:231], v[88:91], v[28:31], v[228:231]
    ds_read_b64_tr_b16 v[70:71], v14 offset:13920
    v_mfma_f32_16x16x32_bf16 v[232:235], v[88:91], v[32:35], v[232:235]
    v_mfma_f32_16x16x32_bf16 v[236:239], v[88:91], v[36:39], v[236:239]
    s_waitcnt lgkmcnt(10)
    v_mfma_f32_16x16x32_bf16 v[96:99], v[56:59], v[40:43], v[96:99]
    ds_read_b64_tr_b16 v[88:89], v14 offset:27744
    v_mfma_f32_16x16x32_bf16 v[100:103], v[56:59], v[44:47], v[100:103]
    ds_read_b64_tr_b16 v[90:91], v14 offset:32352
    v_mfma_f32_16x16x32_bf16 v[104:107], v[56:59], v[48:51], v[104:107]
    v_mfma_f32_16x16x32_bf16 v[108:111], v[56:59], v[52:55], v[108:111]
    v_mfma_f32_16x16x32_bf16 v[176:179], v[76:79], v[40:43], v[176:179]
    v_mfma_f32_16x16x32_bf16 v[180:183], v[76:79], v[44:47], v[180:183]
    v_mfma_f32_16x16x32_bf16 v[184:187], v[76:79], v[48:51], v[184:187]
    v_mfma_f32_16x16x32_bf16 v[188:191], v[76:79], v[52:55], v[188:191]
    s_waitcnt lgkmcnt(0)
    s_barrier
    v_mfma_f32_16x16x32_bf16 v[112:115], v[60:63], v[40:43], v[112:115]
    ds_read_b64_tr_b16 v[56:57], v17 offset:0
    v_mfma_f32_16x16x32_bf16 v[116:119], v[60:63], v[44:47], v[116:119]
    ds_read_b64_tr_b16 v[58:59], v17 offset:4608
    v_mfma_f32_16x16x32_bf16 v[120:123], v[60:63], v[48:51], v[120:123]
    ds_read_b64_tr_b16 v[76:77], v17 offset:18432
    v_mfma_f32_16x16x32_bf16 v[124:127], v[60:63], v[52:55], v[124:127]
    ds_read_b64_tr_b16 v[78:79], v17 offset:23040
    v_mfma_f32_16x16x32_bf16 v[192:195], v[80:83], v[40:43], v[192:195]
    ds_read_b64_tr_b16 v[60:61], v17 offset:32
    v_mfma_f32_16x16x32_bf16 v[196:199], v[80:83], v[44:47], v[196:199]
    ds_read_b64_tr_b16 v[62:63], v17 offset:4640
    v_mfma_f32_16x16x32_bf16 v[200:203], v[80:83], v[48:51], v[200:203]
    ds_read_b128 v[24:27], v15 offset:0
    v_mfma_f32_16x16x32_bf16 v[204:207], v[80:83], v[52:55], v[204:207]
    ds_read_b128 v[28:31], v15 offset:2048
    v_mfma_f32_16x16x32_bf16 v[160:163], v[72:75], v[40:43], v[160:163]
    ds_read_b64_tr_b16 v[80:81], v17 offset:18464
    v_mfma_f32_16x16x32_bf16 v[164:167], v[72:75], v[44:47], v[164:167]
    ds_read_b64_tr_b16 v[82:83], v17 offset:23072
    v_mfma_f32_16x16x32_bf16 v[240:243], v[92:95], v[40:43], v[240:243]
    ds_read_b128 v[32:35], v15 offset:4096
    v_mfma_f32_16x16x32_bf16 v[244:247], v[92:95], v[44:47], v[244:247]
    ds_read_b128 v[36:39], v15 offset:6144
    v_mfma_f32_16x16x32_bf16 v[128:131], v[64:67], v[40:43], v[128:131]
    ds_read_b64_tr_b16 v[72:73], v17 offset:128
    v_mfma_f32_16x16x32_bf16 v[132:135], v[64:67], v[44:47], v[132:135]
    ds_read_b64_tr_b16 v[74:75], v17 offset:4736
    v_mfma_f32_16x16x32_bf16 v[136:139], v[64:67], v[48:51], v[136:139]
    ds_read_b64_tr_b16 v[92:93], v17 offset:18560
    v_mfma_f32_16x16x32_bf16 v[140:143], v[64:67], v[52:55], v[140:143]
    ds_read_b64_tr_b16 v[94:95], v17 offset:23168
    v_mfma_f32_16x16x32_bf16 v[208:211], v[84:87], v[40:43], v[208:211]
    ds_read_b64_tr_b16 v[64:65], v17 offset:64
    v_mfma_f32_16x16x32_bf16 v[212:215], v[84:87], v[44:47], v[212:215]
    ds_read_b64_tr_b16 v[66:67], v17 offset:4672
    v_mfma_f32_16x16x32_bf16 v[216:219], v[84:87], v[48:51], v[216:219]
    v_mfma_f32_16x16x32_bf16 v[220:223], v[84:87], v[52:55], v[220:223]
    v_mfma_f32_16x16x32_bf16 v[144:147], v[68:71], v[40:43], v[144:147]
    ds_read_b64_tr_b16 v[84:85], v17 offset:18496
    v_mfma_f32_16x16x32_bf16 v[148:151], v[68:71], v[44:47], v[148:151]
    ds_read_b64_tr_b16 v[86:87], v17 offset:23104
    v_mfma_f32_16x16x32_bf16 v[152:155], v[68:71], v[48:51], v[152:155]
    v_mfma_f32_16x16x32_bf16 v[156:159], v[68:71], v[52:55], v[156:159]
    v_mfma_f32_16x16x32_bf16 v[224:227], v[88:91], v[40:43], v[224:227]
    ds_read_b64_tr_b16 v[68:69], v17 offset:96
    v_mfma_f32_16x16x32_bf16 v[228:231], v[88:91], v[44:47], v[228:231]
    ds_read_b64_tr_b16 v[70:71], v17 offset:4704
    v_mfma_f32_16x16x32_bf16 v[232:235], v[88:91], v[48:51], v[232:235]
    v_mfma_f32_16x16x32_bf16 v[236:239], v[88:91], v[52:55], v[236:239]
    s_waitcnt lgkmcnt(10)
    v_mfma_f32_16x16x32_bf16 v[96:99], v[56:59], v[24:27], v[96:99]
    ds_read_b64_tr_b16 v[88:89], v17 offset:18528
    v_mfma_f32_16x16x32_bf16 v[100:103], v[56:59], v[28:31], v[100:103]
    ds_read_b64_tr_b16 v[90:91], v17 offset:23136
    v_mfma_f32_16x16x32_bf16 v[104:107], v[56:59], v[32:35], v[104:107]
    v_mfma_f32_16x16x32_bf16 v[108:111], v[56:59], v[36:39], v[108:111]
    v_mfma_f32_16x16x32_bf16 v[176:179], v[76:79], v[24:27], v[176:179]
    ds_read_b64_tr_b16 v[56:57], v17 offset:9216
    v_mfma_f32_16x16x32_bf16 v[180:183], v[76:79], v[28:31], v[180:183]
    ds_read_b64_tr_b16 v[58:59], v17 offset:13824
    v_mfma_f32_16x16x32_bf16 v[184:187], v[76:79], v[32:35], v[184:187]
    v_mfma_f32_16x16x32_bf16 v[188:191], v[76:79], v[36:39], v[188:191]
    v_mfma_f32_16x16x32_bf16 v[112:115], v[60:63], v[24:27], v[112:115]
    ds_read_b64_tr_b16 v[76:77], v17 offset:27648
    v_mfma_f32_16x16x32_bf16 v[116:119], v[60:63], v[28:31], v[116:119]
    ds_read_b64_tr_b16 v[78:79], v17 offset:32256
    v_mfma_f32_16x16x32_bf16 v[120:123], v[60:63], v[32:35], v[120:123]
    v_mfma_f32_16x16x32_bf16 v[124:127], v[60:63], v[36:39], v[124:127]
    v_mfma_f32_16x16x32_bf16 v[192:195], v[80:83], v[24:27], v[192:195]
    ds_read_b64_tr_b16 v[60:61], v17 offset:9248
    v_mfma_f32_16x16x32_bf16 v[196:199], v[80:83], v[28:31], v[196:199]
    ds_read_b64_tr_b16 v[62:63], v17 offset:13856
    v_mfma_f32_16x16x32_bf16 v[200:203], v[80:83], v[32:35], v[200:203]
    ds_read_b128 v[40:43], v16 offset:0
    v_mfma_f32_16x16x32_bf16 v[204:207], v[80:83], v[36:39], v[204:207]
    ds_read_b128 v[44:47], v16 offset:2048
    s_waitcnt lgkmcnt(12)
    v_mfma_f32_16x16x32_bf16 v[160:163], v[72:75], v[24:27], v[160:163]
    ds_read_b64_tr_b16 v[80:81], v17 offset:27680
    v_mfma_f32_16x16x32_bf16 v[164:167], v[72:75], v[28:31], v[164:167]
    ds_read_b64_tr_b16 v[82:83], v17 offset:32288
    v_mfma_f32_16x16x32_bf16 v[240:243], v[92:95], v[24:27], v[240:243]
    ds_read_b128 v[48:51], v16 offset:4096
    v_mfma_f32_16x16x32_bf16 v[244:247], v[92:95], v[28:31], v[244:247]
    ds_read_b128 v[52:55], v16 offset:6144
    v_mfma_f32_16x16x32_bf16 v[128:131], v[64:67], v[24:27], v[128:131]
    ds_read_b64_tr_b16 v[72:73], v17 offset:9344
    v_mfma_f32_16x16x32_bf16 v[132:135], v[64:67], v[28:31], v[132:135]
    ds_read_b64_tr_b16 v[74:75], v17 offset:13952
    v_mfma_f32_16x16x32_bf16 v[136:139], v[64:67], v[32:35], v[136:139]
    ds_read_b64_tr_b16 v[92:93], v17 offset:27776
    v_mfma_f32_16x16x32_bf16 v[140:143], v[64:67], v[36:39], v[140:143]
    ds_read_b64_tr_b16 v[94:95], v17 offset:32384
    v_mfma_f32_16x16x32_bf16 v[208:211], v[84:87], v[24:27], v[208:211]
    ds_read_b64_tr_b16 v[64:65], v17 offset:9280
    v_mfma_f32_16x16x32_bf16 v[212:215], v[84:87], v[28:31], v[212:215]
    ds_read_b64_tr_b16 v[66:67], v17 offset:13888
    v_mfma_f32_16x16x32_bf16 v[216:219], v[84:87], v[32:35], v[216:219]
    v_mfma_f32_16x16x32_bf16 v[220:223], v[84:87], v[36:39], v[220:223]
    s_waitcnt lgkmcnt(12)
    v_mfma_f32_16x16x32_bf16 v[144:147], v[68:71], v[24:27], v[144:147]
    ds_read_b64_tr_b16 v[84:85], v17 offset:27712
    v_mfma_f32_16x16x32_bf16 v[148:151], v[68:71], v[28:31], v[148:151]
    ds_read_b64_tr_b16 v[86:87], v17 offset:32320
    v_mfma_f32_16x16x32_bf16 v[152:155], v[68:71], v[32:35], v[152:155]
    v_mfma_f32_16x16x32_bf16 v[156:159], v[68:71], v[36:39], v[156:159]
    v_mfma_f32_16x16x32_bf16 v[224:227], v[88:91], v[24:27], v[224:227]
    ds_read_b64_tr_b16 v[68:69], v17 offset:9312
    v_mfma_f32_16x16x32_bf16 v[228:231], v[88:91], v[28:31], v[228:231]
    ds_read_b64_tr_b16 v[70:71], v17 offset:13920
    v_mfma_f32_16x16x32_bf16 v[232:235], v[88:91], v[32:35], v[232:235]
    v_mfma_f32_16x16x32_bf16 v[236:239], v[88:91], v[36:39], v[236:239]
    s_waitcnt lgkmcnt(10)
    v_mfma_f32_16x16x32_bf16 v[96:99], v[56:59], v[40:43], v[96:99]
    ds_read_b64_tr_b16 v[88:89], v17 offset:27744
    v_mfma_f32_16x16x32_bf16 v[100:103], v[56:59], v[44:47], v[100:103]
    ds_read_b64_tr_b16 v[90:91], v17 offset:32352
    v_mfma_f32_16x16x32_bf16 v[104:107], v[56:59], v[48:51], v[104:107]
    v_mfma_f32_16x16x32_bf16 v[108:111], v[56:59], v[52:55], v[108:111]
    v_mfma_f32_16x16x32_bf16 v[176:179], v[76:79], v[40:43], v[176:179]
    v_mfma_f32_16x16x32_bf16 v[180:183], v[76:79], v[44:47], v[180:183]
    v_mfma_f32_16x16x32_bf16 v[184:187], v[76:79], v[48:51], v[184:187]
    v_mfma_f32_16x16x32_bf16 v[188:191], v[76:79], v[52:55], v[188:191]
    s_waitcnt lgkmcnt(0)
    s_barrier
    v_mfma_f32_16x16x32_bf16 v[112:115], v[60:63], v[40:43], v[112:115]
    ds_read_b64_tr_b16 v[56:57], v11 offset:0
    v_mfma_f32_16x16x32_bf16 v[116:119], v[60:63], v[44:47], v[116:119]
    ds_read_b64_tr_b16 v[58:59], v11 offset:4608
    v_mfma_f32_16x16x32_bf16 v[120:123], v[60:63], v[48:51], v[120:123]
    ds_read_b64_tr_b16 v[76:77], v11 offset:18432
    v_mfma_f32_16x16x32_bf16 v[124:127], v[60:63], v[52:55], v[124:127]
    ds_read_b64_tr_b16 v[78:79], v11 offset:23040
    v_mfma_f32_16x16x32_bf16 v[192:195], v[80:83], v[40:43], v[192:195]
    ds_read_b64_tr_b16 v[60:61], v11 offset:32
    v_mfma_f32_16x16x32_bf16 v[196:199], v[80:83], v[44:47], v[196:199]
    ds_read_b64_tr_b16 v[62:63], v11 offset:4640
    v_mfma_f32_16x16x32_bf16 v[200:203], v[80:83], v[48:51], v[200:203]
    ds_read_b128 v[24:27], v9 offset:0
    v_mfma_f32_16x16x32_bf16 v[204:207], v[80:83], v[52:55], v[204:207]
    ds_read_b128 v[28:31], v9 offset:2048
    v_mfma_f32_16x16x32_bf16 v[160:163], v[72:75], v[40:43], v[160:163]
    ds_read_b64_tr_b16 v[80:81], v11 offset:18464
    v_mfma_f32_16x16x32_bf16 v[164:167], v[72:75], v[44:47], v[164:167]
    ds_read_b64_tr_b16 v[82:83], v11 offset:23072
    v_mfma_f32_16x16x32_bf16 v[240:243], v[92:95], v[40:43], v[240:243]
    ds_read_b128 v[32:35], v9 offset:4096
    v_mfma_f32_16x16x32_bf16 v[244:247], v[92:95], v[44:47], v[244:247]
    ds_read_b128 v[36:39], v9 offset:6144
    v_mfma_f32_16x16x32_bf16 v[128:131], v[64:67], v[40:43], v[128:131]
    ds_read_b64_tr_b16 v[72:73], v11 offset:128
    v_mfma_f32_16x16x32_bf16 v[132:135], v[64:67], v[44:47], v[132:135]
    ds_read_b64_tr_b16 v[74:75], v11 offset:4736
    v_mfma_f32_16x16x32_bf16 v[136:139], v[64:67], v[48:51], v[136:139]
    ds_read_b64_tr_b16 v[92:93], v11 offset:18560
    v_mfma_f32_16x16x32_bf16 v[140:143], v[64:67], v[52:55], v[140:143]
    ds_read_b64_tr_b16 v[94:95], v11 offset:23168
    v_mfma_f32_16x16x32_bf16 v[208:211], v[84:87], v[40:43], v[208:211]
    ds_read_b64_tr_b16 v[64:65], v11 offset:64
    v_mfma_f32_16x16x32_bf16 v[212:215], v[84:87], v[44:47], v[212:215]
    ds_read_b64_tr_b16 v[66:67], v11 offset:4672
    v_mfma_f32_16x16x32_bf16 v[216:219], v[84:87], v[48:51], v[216:219]
    v_mfma_f32_16x16x32_bf16 v[220:223], v[84:87], v[52:55], v[220:223]
    v_mfma_f32_16x16x32_bf16 v[144:147], v[68:71], v[40:43], v[144:147]
    ds_read_b64_tr_b16 v[84:85], v11 offset:18496
    v_mfma_f32_16x16x32_bf16 v[148:151], v[68:71], v[44:47], v[148:151]
    ds_read_b64_tr_b16 v[86:87], v11 offset:23104
    v_mfma_f32_16x16x32_bf16 v[152:155], v[68:71], v[48:51], v[152:155]
    v_mfma_f32_16x16x32_bf16 v[156:159], v[68:71], v[52:55], v[156:159]
    v_mfma_f32_16x16x32_bf16 v[224:227], v[88:91], v[40:43], v[224:227]
    ds_read_b64_tr_b16 v[68:69], v11 offset:96
    v_mfma_f32_16x16x32_bf16 v[228:231], v[88:91], v[44:47], v[228:231]
    ds_read_b64_tr_b16 v[70:71], v11 offset:4704
    v_mfma_f32_16x16x32_bf16 v[232:235], v[88:91], v[48:51], v[232:235]
    v_mfma_f32_16x16x32_bf16 v[236:239], v[88:91], v[52:55], v[236:239]
    s_waitcnt lgkmcnt(10)
    v_mfma_f32_16x16x32_bf16 v[96:99], v[56:59], v[24:27], v[96:99]
    ds_read_b64_tr_b16 v[88:89], v11 offset:18528
    v_mfma_f32_16x16x32_bf16 v[100:103], v[56:59], v[28:31], v[100:103]
    ds_read_b64_tr_b16 v[90:91], v11 offset:23136
    v_mfma_f32_16x16x32_bf16 v[104:107], v[56:59], v[32:35], v[104:107]
    v_mfma_f32_16x16x32_bf16 v[108:111], v[56:59], v[36:39], v[108:111]
    v_mfma_f32_16x16x32_bf16 v[176:179], v[76:79], v[24:27], v[176:179]
    ds_read_b64_tr_b16 v[56:57], v11 offset:9216
    v_mfma_f32_16x16x32_bf16 v[180:183], v[76:79], v[28:31], v[180:183]
    ds_read_b64_tr_b16 v[58:59], v11 offset:13824
    v_mfma_f32_16x16x32_bf16 v[184:187], v[76:79], v[32:35], v[184:187]
    v_mfma_f32_16x16x32_bf16 v[188:191], v[76:79], v[36:39], v[188:191]
    v_mfma_f32_16x16x32_bf16 v[112:115], v[60:63], v[24:27], v[112:115]
    ds_read_b64_tr_b16 v[76:77], v11 offset:27648
    v_mfma_f32_16x16x32_bf16 v[116:119], v[60:63], v[28:31], v[116:119]
    ds_read_b64_tr_b16 v[78:79], v11 offset:32256
    v_mfma_f32_16x16x32_bf16 v[120:123], v[60:63], v[32:35], v[120:123]
    v_mfma_f32_16x16x32_bf16 v[124:127], v[60:63], v[36:39], v[124:127]
    v_mfma_f32_16x16x32_bf16 v[192:195], v[80:83], v[24:27], v[192:195]
    ds_read_b64_tr_b16 v[60:61], v11 offset:9248
    v_mfma_f32_16x16x32_bf16 v[196:199], v[80:83], v[28:31], v[196:199]
    ds_read_b64_tr_b16 v[62:63], v11 offset:13856
    v_mfma_f32_16x16x32_bf16 v[200:203], v[80:83], v[32:35], v[200:203]
    ds_read_b128 v[40:43], v10 offset:0
    v_mfma_f32_16x16x32_bf16 v[204:207], v[80:83], v[36:39], v[204:207]
    ds_read_b128 v[44:47], v10 offset:2048
    s_waitcnt lgkmcnt(12)
    v_mfma_f32_16x16x32_bf16 v[160:163], v[72:75], v[24:27], v[160:163]
    ds_read_b64_tr_b16 v[80:81], v11 offset:27680
    v_mfma_f32_16x16x32_bf16 v[164:167], v[72:75], v[28:31], v[164:167]
    ds_read_b64_tr_b16 v[82:83], v11 offset:32288
    v_mfma_f32_16x16x32_bf16 v[240:243], v[92:95], v[24:27], v[240:243]
    ds_read_b128 v[48:51], v10 offset:4096
    v_mfma_f32_16x16x32_bf16 v[244:247], v[92:95], v[28:31], v[244:247]
    ds_read_b128 v[52:55], v10 offset:6144
    v_mfma_f32_16x16x32_bf16 v[128:131], v[64:67], v[24:27], v[128:131]
    ds_read_b64_tr_b16 v[72:73], v11 offset:9344
    v_mfma_f32_16x16x32_bf16 v[132:135], v[64:67], v[28:31], v[132:135]
    ds_read_b64_tr_b16 v[74:75], v11 offset:13952
    v_mfma_f32_16x16x32_bf16 v[136:139], v[64:67], v[32:35], v[136:139]
    ds_read_b64_tr_b16 v[92:93], v11 offset:27776
    v_mfma_f32_16x16x32_bf16 v[140:143], v[64:67], v[36:39], v[140:143]
    ds_read_b64_tr_b16 v[94:95], v11 offset:32384
    v_mfma_f32_16x16x32_bf16 v[208:211], v[84:87], v[24:27], v[208:211]
    ds_read_b64_tr_b16 v[64:65], v11 offset:9280
    v_mfma_f32_16x16x32_bf16 v[212:215], v[84:87], v[28:31], v[212:215]
    ds_read_b64_tr_b16 v[66:67], v11 offset:13888
    v_mfma_f32_16x16x32_bf16 v[216:219], v[84:87], v[32:35], v[216:219]
    v_mfma_f32_16x16x32_bf16 v[220:223], v[84:87], v[36:39], v[220:223]
    s_waitcnt lgkmcnt(12)
    v_mfma_f32_16x16x32_bf16 v[144:147], v[68:71], v[24:27], v[144:147]
    ds_read_b64_tr_b16 v[84:85], v11 offset:27712
    v_mfma_f32_16x16x32_bf16 v[148:151], v[68:71], v[28:31], v[148:151]
    ds_read_b64_tr_b16 v[86:87], v11 offset:32320
    v_mfma_f32_16x16x32_bf16 v[152:155], v[68:71], v[32:35], v[152:155]
    v_mfma_f32_16x16x32_bf16 v[156:159], v[68:71], v[36:39], v[156:159]
    v_mfma_f32_16x16x32_bf16 v[224:227], v[88:91], v[24:27], v[224:227]
    ds_read_b64_tr_b16 v[68:69], v11 offset:9312
    v_mfma_f32_16x16x32_bf16 v[228:231], v[88:91], v[28:31], v[228:231]
    ds_read_b64_tr_b16 v[70:71], v11 offset:13920
    v_mfma_f32_16x16x32_bf16 v[232:235], v[88:91], v[32:35], v[232:235]
    v_mfma_f32_16x16x32_bf16 v[236:239], v[88:91], v[36:39], v[236:239]
    s_waitcnt lgkmcnt(10)
    v_mfma_f32_16x16x32_bf16 v[96:99], v[56:59], v[40:43], v[96:99]
    ds_read_b64_tr_b16 v[88:89], v11 offset:27744
    v_mfma_f32_16x16x32_bf16 v[100:103], v[56:59], v[44:47], v[100:103]
    ds_read_b64_tr_b16 v[90:91], v11 offset:32352
    v_mfma_f32_16x16x32_bf16 v[104:107], v[56:59], v[48:51], v[104:107]
    v_mfma_f32_16x16x32_bf16 v[108:111], v[56:59], v[52:55], v[108:111]
    v_mfma_f32_16x16x32_bf16 v[176:179], v[76:79], v[40:43], v[176:179]
    v_mfma_f32_16x16x32_bf16 v[180:183], v[76:79], v[44:47], v[180:183]
    v_mfma_f32_16x16x32_bf16 v[184:187], v[76:79], v[48:51], v[184:187]
    v_mfma_f32_16x16x32_bf16 v[188:191], v[76:79], v[52:55], v[188:191]
    s_waitcnt lgkmcnt(0)
    s_barrier
    v_mfma_f32_16x16x32_bf16 v[112:115], v[60:63], v[40:43], v[112:115]
    ds_read_b64_tr_b16 v[56:57], v14 offset:0
    v_mfma_f32_16x16x32_bf16 v[116:119], v[60:63], v[44:47], v[116:119]
    ds_read_b64_tr_b16 v[58:59], v14 offset:4608
    v_mfma_f32_16x16x32_bf16 v[120:123], v[60:63], v[48:51], v[120:123]
    ds_read_b64_tr_b16 v[76:77], v14 offset:18432
    v_mfma_f32_16x16x32_bf16 v[124:127], v[60:63], v[52:55], v[124:127]
    ds_read_b64_tr_b16 v[78:79], v14 offset:23040
    v_mfma_f32_16x16x32_bf16 v[192:195], v[80:83], v[40:43], v[192:195]
    ds_read_b64_tr_b16 v[60:61], v14 offset:32
    v_mfma_f32_16x16x32_bf16 v[196:199], v[80:83], v[44:47], v[196:199]
    ds_read_b64_tr_b16 v[62:63], v14 offset:4640
    v_mfma_f32_16x16x32_bf16 v[200:203], v[80:83], v[48:51], v[200:203]
    ds_read_b128 v[24:27], v12 offset:0
    v_mfma_f32_16x16x32_bf16 v[204:207], v[80:83], v[52:55], v[204:207]
    ds_read_b128 v[28:31], v12 offset:2048
    v_mfma_f32_16x16x32_bf16 v[160:163], v[72:75], v[40:43], v[160:163]
    ds_read_b64_tr_b16 v[80:81], v14 offset:18464
    v_mfma_f32_16x16x32_bf16 v[164:167], v[72:75], v[44:47], v[164:167]
    ds_read_b64_tr_b16 v[82:83], v14 offset:23072
    v_mfma_f32_16x16x32_bf16 v[240:243], v[92:95], v[40:43], v[240:243]
    ds_read_b128 v[32:35], v12 offset:4096
    v_mfma_f32_16x16x32_bf16 v[244:247], v[92:95], v[44:47], v[244:247]
    ds_read_b128 v[36:39], v12 offset:6144
    v_mfma_f32_16x16x32_bf16 v[128:131], v[64:67], v[40:43], v[128:131]
    ds_read_b64_tr_b16 v[72:73], v14 offset:128
    v_mfma_f32_16x16x32_bf16 v[132:135], v[64:67], v[44:47], v[132:135]
    ds_read_b64_tr_b16 v[74:75], v14 offset:4736
    v_mfma_f32_16x16x32_bf16 v[136:139], v[64:67], v[48:51], v[136:139]
    ds_read_b64_tr_b16 v[92:93], v14 offset:18560
    v_mfma_f32_16x16x32_bf16 v[140:143], v[64:67], v[52:55], v[140:143]
    ds_read_b64_tr_b16 v[94:95], v14 offset:23168
    v_mfma_f32_16x16x32_bf16 v[208:211], v[84:87], v[40:43], v[208:211]
    ds_read_b64_tr_b16 v[64:65], v14 offset:64
    v_mfma_f32_16x16x32_bf16 v[212:215], v[84:87], v[44:47], v[212:215]
    ds_read_b64_tr_b16 v[66:67], v14 offset:4672
    v_mfma_f32_16x16x32_bf16 v[216:219], v[84:87], v[48:51], v[216:219]
    v_mfma_f32_16x16x32_bf16 v[220:223], v[84:87], v[52:55], v[220:223]
    v_mfma_f32_16x16x32_bf16 v[144:147], v[68:71], v[40:43], v[144:147]
    ds_read_b64_tr_b16 v[84:85], v14 offset:18496
    v_mfma_f32_16x16x32_bf16 v[148:151], v[68:71], v[44:47], v[148:151]
    ds_read_b64_tr_b16 v[86:87], v14 offset:23104
    v_mfma_f32_16x16x32_bf16 v[152:155], v[68:71], v[48:51], v[152:155]
    v_mfma_f32_16x16x32_bf16 v[156:159], v[68:71], v[52:55], v[156:159]
    v_mfma_f32_16x16x32_bf16 v[224:227], v[88:91], v[40:43], v[224:227]
    ds_read_b64_tr_b16 v[68:69], v14 offset:96
    v_mfma_f32_16x16x32_bf16 v[228:231], v[88:91], v[44:47], v[228:231]
    ds_read_b64_tr_b16 v[70:71], v14 offset:4704
    v_mfma_f32_16x16x32_bf16 v[232:235], v[88:91], v[48:51], v[232:235]
    v_mfma_f32_16x16x32_bf16 v[236:239], v[88:91], v[52:55], v[236:239]
    s_waitcnt lgkmcnt(10)
    v_mfma_f32_16x16x32_bf16 v[96:99], v[56:59], v[24:27], v[96:99]
    ds_read_b64_tr_b16 v[88:89], v14 offset:18528
    v_mfma_f32_16x16x32_bf16 v[100:103], v[56:59], v[28:31], v[100:103]
    ds_read_b64_tr_b16 v[90:91], v14 offset:23136
    v_mfma_f32_16x16x32_bf16 v[104:107], v[56:59], v[32:35], v[104:107]
    v_mfma_f32_16x16x32_bf16 v[108:111], v[56:59], v[36:39], v[108:111]
    v_mfma_f32_16x16x32_bf16 v[176:179], v[76:79], v[24:27], v[176:179]
    ds_read_b64_tr_b16 v[56:57], v14 offset:9216
    v_mfma_f32_16x16x32_bf16 v[180:183], v[76:79], v[28:31], v[180:183]
    ds_read_b64_tr_b16 v[58:59], v14 offset:13824
    v_mfma_f32_16x16x32_bf16 v[184:187], v[76:79], v[32:35], v[184:187]
    v_mfma_f32_16x16x32_bf16 v[188:191], v[76:79], v[36:39], v[188:191]
    v_mfma_f32_16x16x32_bf16 v[112:115], v[60:63], v[24:27], v[112:115]
    ds_read_b64_tr_b16 v[76:77], v14 offset:27648
    v_mfma_f32_16x16x32_bf16 v[116:119], v[60:63], v[28:31], v[116:119]
    ds_read_b64_tr_b16 v[78:79], v14 offset:32256
    v_mfma_f32_16x16x32_bf16 v[120:123], v[60:63], v[32:35], v[120:123]
    v_mfma_f32_16x16x32_bf16 v[124:127], v[60:63], v[36:39], v[124:127]
    v_mfma_f32_16x16x32_bf16 v[192:195], v[80:83], v[24:27], v[192:195]
    ds_read_b64_tr_b16 v[60:61], v14 offset:9248
    v_mfma_f32_16x16x32_bf16 v[196:199], v[80:83], v[28:31], v[196:199]
    ds_read_b64_tr_b16 v[62:63], v14 offset:13856
    v_mfma_f32_16x16x32_bf16 v[200:203], v[80:83], v[32:35], v[200:203]
    ds_read_b128 v[40:43], v13 offset:0
    v_mfma_f32_16x16x32_bf16 v[204:207], v[80:83], v[36:39], v[204:207]
    ds_read_b128 v[44:47], v13 offset:2048
    s_waitcnt lgkmcnt(12)
    v_mfma_f32_16x16x32_bf16 v[160:163], v[72:75], v[24:27], v[160:163]
    ds_read_b64_tr_b16 v[80:81], v14 offset:27680
    v_mfma_f32_16x16x32_bf16 v[164:167], v[72:75], v[28:31], v[164:167]
    ds_read_b64_tr_b16 v[82:83], v14 offset:32288
    v_mfma_f32_16x16x32_bf16 v[240:243], v[92:95], v[24:27], v[240:243]
    ds_read_b128 v[48:51], v13 offset:4096
    v_mfma_f32_16x16x32_bf16 v[244:247], v[92:95], v[28:31], v[244:247]
    ds_read_b128 v[52:55], v13 offset:6144
    v_mfma_f32_16x16x32_bf16 v[128:131], v[64:67], v[24:27], v[128:131]
    ds_read_b64_tr_b16 v[72:73], v14 offset:9344
    v_mfma_f32_16x16x32_bf16 v[132:135], v[64:67], v[28:31], v[132:135]
    ds_read_b64_tr_b16 v[74:75], v14 offset:13952
    v_mfma_f32_16x16x32_bf16 v[136:139], v[64:67], v[32:35], v[136:139]
    ds_read_b64_tr_b16 v[92:93], v14 offset:27776
    v_mfma_f32_16x16x32_bf16 v[140:143], v[64:67], v[36:39], v[140:143]
    ds_read_b64_tr_b16 v[94:95], v14 offset:32384
    v_mfma_f32_16x16x32_bf16 v[208:211], v[84:87], v[24:27], v[208:211]
    ds_read_b64_tr_b16 v[64:65], v14 offset:9280
    v_mfma_f32_16x16x32_bf16 v[212:215], v[84:87], v[28:31], v[212:215]
    ds_read_b64_tr_b16 v[66:67], v14 offset:13888
    v_mfma_f32_16x16x32_bf16 v[216:219], v[84:87], v[32:35], v[216:219]
    v_mfma_f32_16x16x32_bf16 v[220:223], v[84:87], v[36:39], v[220:223]
    s_waitcnt lgkmcnt(12)
    v_mfma_f32_16x16x32_bf16 v[144:147], v[68:71], v[24:27], v[144:147]
    ds_read_b64_tr_b16 v[84:85], v14 offset:27712
    v_mfma_f32_16x16x32_bf16 v[148:151], v[68:71], v[28:31], v[148:151]
    ds_read_b64_tr_b16 v[86:87], v14 offset:32320
    v_mfma_f32_16x16x32_bf16 v[152:155], v[68:71], v[32:35], v[152:155]
    v_mfma_f32_16x16x32_bf16 v[156:159], v[68:71], v[36:39], v[156:159]
    v_mfma_f32_16x16x32_bf16 v[224:227], v[88:91], v[24:27], v[224:227]
    ds_read_b64_tr_b16 v[68:69], v14 offset:9312
    v_mfma_f32_16x16x32_bf16 v[228:231], v[88:91], v[28:31], v[228:231]
    ds_read_b64_tr_b16 v[70:71], v14 offset:13920
    v_mfma_f32_16x16x32_bf16 v[232:235], v[88:91], v[32:35], v[232:235]
    v_mfma_f32_16x16x32_bf16 v[236:239], v[88:91], v[36:39], v[236:239]
    s_waitcnt lgkmcnt(10)
    v_mfma_f32_16x16x32_bf16 v[96:99], v[56:59], v[40:43], v[96:99]
    ds_read_b64_tr_b16 v[88:89], v14 offset:27744
    v_mfma_f32_16x16x32_bf16 v[100:103], v[56:59], v[44:47], v[100:103]
    ds_read_b64_tr_b16 v[90:91], v14 offset:32352
    v_mfma_f32_16x16x32_bf16 v[104:107], v[56:59], v[48:51], v[104:107]
    v_mfma_f32_16x16x32_bf16 v[108:111], v[56:59], v[52:55], v[108:111]
    v_mfma_f32_16x16x32_bf16 v[176:179], v[76:79], v[40:43], v[176:179]
    v_mfma_f32_16x16x32_bf16 v[180:183], v[76:79], v[44:47], v[180:183]
    v_mfma_f32_16x16x32_bf16 v[184:187], v[76:79], v[48:51], v[184:187]
    v_mfma_f32_16x16x32_bf16 v[188:191], v[76:79], v[52:55], v[188:191]
    s_waitcnt lgkmcnt(0)
    s_barrier
    v_mfma_f32_16x16x32_bf16 v[112:115], v[60:63], v[40:43], v[112:115]
    ds_read_b128 v[56:59], v4 offset:1024
    v_mfma_f32_16x16x32_bf16 v[116:119], v[60:63], v[44:47], v[116:119]
    ds_read_b128 v[76:79], v4 offset:1600
    v_mfma_f32_16x16x32_bf16 v[120:123], v[60:63], v[48:51], v[120:123]
    ds_read_b32 v24, v3 offset:0
    v_mfma_f32_16x16x32_bf16 v[124:127], v[60:63], v[52:55], v[124:127]
    ds_read_b32 v25, v3 offset:512
    v_mfma_f32_16x16x32_bf16 v[192:195], v[80:83], v[40:43], v[192:195]
    ds_read_b128 v[60:63], v4 offset:1088
    v_mfma_f32_16x16x32_bf16 v[196:199], v[80:83], v[44:47], v[196:199]
    ds_read_b32 v26, v3 offset:64
    v_mfma_f32_16x16x32_bf16 v[200:203], v[80:83], v[48:51], v[200:203]
    ds_read_b32 v27, v3 offset:576
    v_mfma_f32_16x16x32_bf16 v[204:207], v[80:83], v[52:55], v[204:207]
    v_mfma_f32_16x16x32_bf16 v[160:163], v[72:75], v[40:43], v[160:163]
    ds_read_b128 v[80:83], v4 offset:1664
    v_mfma_f32_16x16x32_bf16 v[164:167], v[72:75], v[44:47], v[164:167]
    ds_read_b32 v28, v3 offset:128
    v_mfma_f32_16x16x32_bf16 v[240:243], v[92:95], v[40:43], v[240:243]
    ds_read_b32 v29, v3 offset:640
    v_mfma_f32_16x16x32_bf16 v[244:247], v[92:95], v[44:47], v[244:247]
    ds_read_b128 v[72:75], v4 offset:1280
    v_mfma_f32_16x16x32_bf16 v[128:131], v[64:67], v[40:43], v[128:131]
    ds_read_b32 v30, v3 offset:192
    v_mfma_f32_16x16x32_bf16 v[132:135], v[64:67], v[44:47], v[132:135]
    ds_read_b32 v31, v3 offset:704
    v_mfma_f32_16x16x32_bf16 v[136:139], v[64:67], v[48:51], v[136:139]
    ds_read_b128 v[92:95], v4 offset:1856
    v_mfma_f32_16x16x32_bf16 v[140:143], v[64:67], v[52:55], v[140:143]
    v_mfma_f32_16x16x32_bf16 v[208:211], v[84:87], v[40:43], v[208:211]
    ds_read_b128 v[64:67], v4 offset:1152
    v_mfma_f32_16x16x32_bf16 v[212:215], v[84:87], v[44:47], v[212:215]
    v_mfma_f32_16x16x32_bf16 v[216:219], v[84:87], v[48:51], v[216:219]
    v_mfma_f32_16x16x32_bf16 v[220:223], v[84:87], v[52:55], v[220:223]
    v_mfma_f32_16x16x32_bf16 v[144:147], v[68:71], v[40:43], v[144:147]
    ds_read_b128 v[84:87], v4 offset:1728
    v_mfma_f32_16x16x32_bf16 v[148:151], v[68:71], v[44:47], v[148:151]
    v_mfma_f32_16x16x32_bf16 v[152:155], v[68:71], v[48:51], v[152:155]
    v_mfma_f32_16x16x32_bf16 v[156:159], v[68:71], v[52:55], v[156:159]
    v_mfma_f32_16x16x32_bf16 v[224:227], v[88:91], v[40:43], v[224:227]
    ds_read_b128 v[68:71], v4 offset:1216
    v_mfma_f32_16x16x32_bf16 v[228:231], v[88:91], v[44:47], v[228:231]
    v_mfma_f32_16x16x32_bf16 v[232:235], v[88:91], v[48:51], v[232:235]
    v_mfma_f32_16x16x32_bf16 v[236:239], v[88:91], v[52:55], v[236:239]
    ds_read_b128 v[88:91], v4 offset:1792
    s_waitcnt lgkmcnt(5)
    v_mul_f32 v25, v25, v25
    v_mul_f32 v27, v27, v27
    v_mul_f32 v29, v29, v29
    v_mul_f32 v31, v31, v31
    v_pk_fma_f32 v[96:97], v[56:57], v[24:25], v[96:97] op_sel_hi:[1,0,1]
    v_pk_fma_f32 v[98:99], v[58:59], v[24:25], v[98:99] op_sel_hi:[1,0,1]
    v_pk_fma_f32 v[176:177], v[76:77], v[24:25], v[176:177] op_sel_hi:[1,0,1]
    v_pk_fma_f32 v[178:179], v[78:79], v[24:25], v[178:179] op_sel_hi:[1,0,1]
    v_max_f32 v96, 0, v96
    v_max_f32 v97, 0, v97
    v_max_f32 v98, 0, v98
    v_max_f32 v99, 0, v99
    v_pk_mul_f32 v[176:177], v[176:177], v[24:25] op_sel:[0,1] op_sel_hi:[1,1]
    v_pk_mul_f32 v[178:179], v[178:179], v[24:25] op_sel:[0,1] op_sel_hi:[1,1]
    v_pk_mul_f32 v[96:97], v[96:97], v[176:177]
    v_pk_mul_f32 v[98:99], v[98:99], v[178:179]
    v_pk_fma_f32 v[100:101], v[56:57], v[26:27], v[100:101] op_sel_hi:[1,0,1]
    v_pk_fma_f32 v[102:103], v[58:59], v[26:27], v[102:103] op_sel_hi:[1,0,1]
    v_pk_fma_f32 v[180:181], v[76:77], v[26:27], v[180:181] op_sel_hi:[1,0,1]
    v_pk_fma_f32 v[182:183], v[78:79], v[26:27], v[182:183] op_sel_hi:[1,0,1]
    v_max_f32 v100, 0, v100
    v_max_f32 v101, 0, v101
    v_max_f32 v102, 0, v102
    v_max_f32 v103, 0, v103
    v_pk_mul_f32 v[180:181], v[180:181], v[26:27] op_sel:[0,1] op_sel_hi:[1,1]
    v_pk_mul_f32 v[182:183], v[182:183], v[26:27] op_sel:[0,1] op_sel_hi:[1,1]
    v_pk_mul_f32 v[100:101], v[100:101], v[180:181]
    v_pk_mul_f32 v[102:103], v[102:103], v[182:183]
    v_cvt_pk_bf16_f32 v96, v96, v97
    v_cvt_pk_bf16_f32 v97, v98, v99
    v_cvt_pk_bf16_f32 v98, v100, v101
    v_cvt_pk_bf16_f32 v99, v102, v103
    s_nop 0
    v_permlane16_swap_b32 v96, v98
    v_permlane16_swap_b32 v97, v99
    buffer_store_dwordx4 v[96:99], v7, s[48:51], s60 offen offset:0 sc1
    v_pk_fma_f32 v[104:105], v[56:57], v[28:29], v[104:105] op_sel_hi:[1,0,1]
    v_pk_fma_f32 v[106:107], v[58:59], v[28:29], v[106:107] op_sel_hi:[1,0,1]
    v_pk_fma_f32 v[184:185], v[76:77], v[28:29], v[184:185] op_sel_hi:[1,0,1]
    v_pk_fma_f32 v[186:187], v[78:79], v[28:29], v[186:187] op_sel_hi:[1,0,1]
    v_max_f32 v104, 0, v104
    v_max_f32 v105, 0, v105
    v_max_f32 v106, 0, v106
    v_max_f32 v107, 0, v107
    v_pk_mul_f32 v[184:185], v[184:185], v[28:29] op_sel:[0,1] op_sel_hi:[1,1]
    v_pk_mul_f32 v[186:187], v[186:187], v[28:29] op_sel:[0,1] op_sel_hi:[1,1]
    v_pk_mul_f32 v[104:105], v[104:105], v[184:185]
    v_pk_mul_f32 v[106:107], v[106:107], v[186:187]
    v_pk_fma_f32 v[108:109], v[56:57], v[30:31], v[108:109] op_sel_hi:[1,0,1]
    v_pk_fma_f32 v[110:111], v[58:59], v[30:31], v[110:111] op_sel_hi:[1,0,1]
    v_pk_fma_f32 v[188:189], v[76:77], v[30:31], v[188:189] op_sel_hi:[1,0,1]
    v_pk_fma_f32 v[190:191], v[78:79], v[30:31], v[190:191] op_sel_hi:[1,0,1]
    v_max_f32 v108, 0, v108
    v_max_f32 v109, 0, v109
    v_max_f32 v110, 0, v110
    v_max_f32 v111, 0, v111
    v_pk_mul_f32 v[188:189], v[188:189], v[30:31] op_sel:[0,1] op_sel_hi:[1,1]
    v_pk_mul_f32 v[190:191], v[190:191], v[30:31] op_sel:[0,1] op_sel_hi:[1,1]
    v_pk_mul_f32 v[108:109], v[108:109], v[188:189]
    v_pk_mul_f32 v[110:111], v[110:111], v[190:191]
    v_cvt_pk_bf16_f32 v104, v104, v105
    v_cvt_pk_bf16_f32 v105, v106, v107
    v_cvt_pk_bf16_f32 v106, v108, v109
    v_cvt_pk_bf16_f32 v107, v110, v111
    s_nop 0
    v_permlane16_swap_b32 v104, v106
    v_permlane16_swap_b32 v105, v107
    buffer_store_dwordx4 v[104:107], v7, s[48:51], s60 offen offset:2048 sc1
    v_pk_fma_f32 v[112:113], v[60:61], v[24:25], v[112:113] op_sel_hi:[1,0,1]
    v_pk_fma_f32 v[114:115], v[62:63], v[24:25], v[114:115] op_sel_hi:[1,0,1]
    v_pk_fma_f32 v[192:193], v[80:81], v[24:25], v[192:193] op_sel_hi:[1,0,1]
    v_pk_fma_f32 v[194:195], v[82:83], v[24:25], v[194:195] op_sel_hi:[1,0,1]
    v_max_f32 v112, 0, v112
    v_max_f32 v113, 0, v113
    v_max_f32 v114, 0, v114
    v_max_f32 v115, 0, v115
    v_pk_mul_f32 v[192:193], v[192:193], v[24:25] op_sel:[0,1] op_sel_hi:[1,1]
    v_pk_mul_f32 v[194:195], v[194:195], v[24:25] op_sel:[0,1] op_sel_hi:[1,1]
    v_pk_mul_f32 v[112:113], v[112:113], v[192:193]
    v_pk_mul_f32 v[114:115], v[114:115], v[194:195]
    v_pk_fma_f32 v[116:117], v[60:61], v[26:27], v[116:117] op_sel_hi:[1,0,1]
    v_pk_fma_f32 v[118:119], v[62:63], v[26:27], v[118:119] op_sel_hi:[1,0,1]
    v_pk_fma_f32 v[196:197], v[80:81], v[26:27], v[196:197] op_sel_hi:[1,0,1]
    v_pk_fma_f32 v[198:199], v[82:83], v[26:27], v[198:199] op_sel_hi:[1,0,1]
    v_max_f32 v116, 0, v116
    v_max_f32 v117, 0, v117
    v_max_f32 v118, 0, v118
    v_max_f32 v119, 0, v119
    v_pk_mul_f32 v[196:197], v[196:197], v[26:27] op_sel:[0,1] op_sel_hi:[1,1]
    v_pk_mul_f32 v[198:199], v[198:199], v[26:27] op_sel:[0,1] op_sel_hi:[1,1]
    v_pk_mul_f32 v[116:117], v[116:117], v[196:197]
    v_pk_mul_f32 v[118:119], v[118:119], v[198:199]
    v_cvt_pk_bf16_f32 v112, v112, v113
    v_cvt_pk_bf16_f32 v113, v114, v115
    v_cvt_pk_bf16_f32 v114, v116, v117
    v_cvt_pk_bf16_f32 v115, v118, v119
    s_nop 0
    v_permlane16_swap_b32 v112, v114
    v_permlane16_swap_b32 v113, v115
    buffer_store_dwordx4 v[112:115], v7, s[48:51], s61 offen offset:0 sc1
    v_pk_fma_f32 v[120:121], v[60:61], v[28:29], v[120:121] op_sel_hi:[1,0,1]
    v_pk_fma_f32 v[122:123], v[62:63], v[28:29], v[122:123] op_sel_hi:[1,0,1]
    v_pk_fma_f32 v[200:201], v[80:81], v[28:29], v[200:201] op_sel_hi:[1,0,1]
    v_pk_fma_f32 v[202:203], v[82:83], v[28:29], v[202:203] op_sel_hi:[1,0,1]
    v_max_f32 v120, 0, v120
    v_max_f32 v121, 0, v121
    v_max_f32 v122, 0, v122
    v_max_f32 v123, 0, v123
    v_pk_mul_f32 v[200:201], v[200:201], v[28:29] op_sel:[0,1] op_sel_hi:[1,1]
    v_pk_mul_f32 v[202:203], v[202:203], v[28:29] op_sel:[0,1] op_sel_hi:[1,1]
    v_pk_mul_f32 v[120:121], v[120:121], v[200:201]
    v_pk_mul_f32 v[122:123], v[122:123], v[202:203]
    v_pk_fma_f32 v[124:125], v[60:61], v[30:31], v[124:125] op_sel_hi:[1,0,1]
    v_pk_fma_f32 v[126:127], v[62:63], v[30:31], v[126:127] op_sel_hi:[1,0,1]
    v_pk_fma_f32 v[204:205], v[80:81], v[30:31], v[204:205] op_sel_hi:[1,0,1]
    v_pk_fma_f32 v[206:207], v[82:83], v[30:31], v[206:207] op_sel_hi:[1,0,1]
    v_max_f32 v124, 0, v124
    v_max_f32 v125, 0, v125
    v_max_f32 v126, 0, v126
    v_max_f32 v127, 0, v127
    v_pk_mul_f32 v[204:205], v[204:205], v[30:31] op_sel:[0,1] op_sel_hi:[1,1]
    v_pk_mul_f32 v[206:207], v[206:207], v[30:31] op_sel:[0,1] op_sel_hi:[1,1]
    v_pk_mul_f32 v[124:125], v[124:125], v[204:205]
    v_pk_mul_f32 v[126:127], v[126:127], v[206:207]
    v_cvt_pk_bf16_f32 v120, v120, v121
    v_cvt_pk_bf16_f32 v121, v122, v123
    v_cvt_pk_bf16_f32 v122, v124, v125
    v_cvt_pk_bf16_f32 v123, v126, v127
    s_nop 0
    v_permlane16_swap_b32 v120, v122
    v_permlane16_swap_b32 v121, v123
    buffer_store_dwordx4 v[120:123], v7, s[48:51], s61 offen offset:2048 sc1
    s_waitcnt lgkmcnt(4)
    v_pk_fma_f32 v[160:161], v[72:73], v[24:25], v[160:161] op_sel_hi:[1,0,1]
    v_pk_fma_f32 v[162:163], v[74:75], v[24:25], v[162:163] op_sel_hi:[1,0,1]
    v_pk_fma_f32 v[240:241], v[92:93], v[24:25], v[240:241] op_sel_hi:[1,0,1]
    v_pk_fma_f32 v[242:243], v[94:95], v[24:25], v[242:243] op_sel_hi:[1,0,1]
    v_max_f32 v160, 0, v160
    v_max_f32 v161, 0, v161
    v_max_f32 v162, 0, v162
    v_max_f32 v163, 0, v163
    v_pk_mul_f32 v[240:241], v[240:241], v[24:25] op_sel:[0,1] op_sel_hi:[1,1]
    v_pk_mul_f32 v[242:243], v[242:243], v[24:25] op_sel:[0,1] op_sel_hi:[1,1]
    v_pk_mul_f32 v[160:161], v[160:161], v[240:241]
    v_pk_mul_f32 v[162:163], v[162:163], v[242:243]
    v_pk_fma_f32 v[164:165], v[72:73], v[26:27], v[164:165] op_sel_hi:[1,0,1]
    v_pk_fma_f32 v[166:167], v[74:75], v[26:27], v[166:167] op_sel_hi:[1,0,1]
    v_pk_fma_f32 v[244:245], v[92:93], v[26:27], v[244:245] op_sel_hi:[1,0,1]
    v_pk_fma_f32 v[246:247], v[94:95], v[26:27], v[246:247] op_sel_hi:[1,0,1]
    v_max_f32 v164, 0, v164
    v_max_f32 v165, 0, v165
    v_max_f32 v166, 0, v166
    v_max_f32 v167, 0, v167
    v_pk_mul_f32 v[244:245], v[244:245], v[26:27] op_sel:[0,1] op_sel_hi:[1,1]
    v_pk_mul_f32 v[246:247], v[246:247], v[26:27] op_sel:[0,1] op_sel_hi:[1,1]
    v_pk_mul_f32 v[164:165], v[164:165], v[244:245]
    v_pk_mul_f32 v[166:167], v[166:167], v[246:247]
    v_cvt_pk_bf16_f32 v160, v160, v161
    v_cvt_pk_bf16_f32 v161, v162, v163
    v_cvt_pk_bf16_f32 v162, v164, v165
    v_cvt_pk_bf16_f32 v163, v166, v167
    s_nop 0
    v_permlane16_swap_b32 v160, v162
    v_permlane16_swap_b32 v161, v163
    buffer_store_dwordx4 v[160:163], v7, s[48:51], s64 offen offset:0 sc1
    s_waitcnt lgkmcnt(2)
    v_pk_fma_f32 v[128:129], v[64:65], v[24:25], v[128:129] op_sel_hi:[1,0,1]
    v_pk_fma_f32 v[130:131], v[66:67], v[24:25], v[130:131] op_sel_hi:[1,0,1]
    v_pk_fma_f32 v[208:209], v[84:85], v[24:25], v[208:209] op_sel_hi:[1,0,1]
    v_pk_fma_f32 v[210:211], v[86:87], v[24:25], v[210:211] op_sel_hi:[1,0,1]
    v_max_f32 v128, 0, v128
    v_max_f32 v129, 0, v129
    v_max_f32 v130, 0, v130
    v_max_f32 v131, 0, v131
    v_pk_mul_f32 v[208:209], v[208:209], v[24:25] op_sel:[0,1] op_sel_hi:[1,1]
    v_pk_mul_f32 v[210:211], v[210:211], v[24:25] op_sel:[0,1] op_sel_hi:[1,1]
    v_pk_mul_f32 v[128:129], v[128:129], v[208:209]
    v_pk_mul_f32 v[130:131], v[130:131], v[210:211]
    v_pk_fma_f32 v[132:133], v[64:65], v[26:27], v[132:133] op_sel_hi:[1,0,1]
    v_pk_fma_f32 v[134:135], v[66:67], v[26:27], v[134:135] op_sel_hi:[1,0,1]
    v_pk_fma_f32 v[212:213], v[84:85], v[26:27], v[212:213] op_sel_hi:[1,0,1]
    v_pk_fma_f32 v[214:215], v[86:87], v[26:27], v[214:215] op_sel_hi:[1,0,1]
    v_max_f32 v132, 0, v132
    v_max_f32 v133, 0, v133
    v_max_f32 v134, 0, v134
    v_max_f32 v135, 0, v135
    v_pk_mul_f32 v[212:213], v[212:213], v[26:27] op_sel:[0,1] op_sel_hi:[1,1]
    v_pk_mul_f32 v[214:215], v[214:215], v[26:27] op_sel:[0,1] op_sel_hi:[1,1]
    v_pk_mul_f32 v[132:133], v[132:133], v[212:213]
    v_pk_mul_f32 v[134:135], v[134:135], v[214:215]
    v_cvt_pk_bf16_f32 v128, v128, v129
    v_cvt_pk_bf16_f32 v129, v130, v131
    v_cvt_pk_bf16_f32 v130, v132, v133
    v_cvt_pk_bf16_f32 v131, v134, v135
    s_nop 0
    v_permlane16_swap_b32 v128, v130
    v_permlane16_swap_b32 v129, v131
    buffer_store_dwordx4 v[128:131], v7, s[48:51], s62 offen offset:0 sc1
    v_pk_fma_f32 v[136:137], v[64:65], v[28:29], v[136:137] op_sel_hi:[1,0,1]
    v_pk_fma_f32 v[138:139], v[66:67], v[28:29], v[138:139] op_sel_hi:[1,0,1]
    v_pk_fma_f32 v[216:217], v[84:85], v[28:29], v[216:217] op_sel_hi:[1,0,1]
    v_pk_fma_f32 v[218:219], v[86:87], v[28:29], v[218:219] op_sel_hi:[1,0,1]
    v_max_f32 v136, 0, v136
    v_max_f32 v137, 0, v137
    v_max_f32 v138, 0, v138
    v_max_f32 v139, 0, v139
    v_pk_mul_f32 v[216:217], v[216:217], v[28:29] op_sel:[0,1] op_sel_hi:[1,1]
    v_pk_mul_f32 v[218:219], v[218:219], v[28:29] op_sel:[0,1] op_sel_hi:[1,1]
    v_pk_mul_f32 v[136:137], v[136:137], v[216:217]
    v_pk_mul_f32 v[138:139], v[138:139], v[218:219]
    v_pk_fma_f32 v[140:141], v[64:65], v[30:31], v[140:141] op_sel_hi:[1,0,1]
    v_pk_fma_f32 v[142:143], v[66:67], v[30:31], v[142:143] op_sel_hi:[1,0,1]
    v_pk_fma_f32 v[220:221], v[84:85], v[30:31], v[220:221] op_sel_hi:[1,0,1]
    v_pk_fma_f32 v[222:223], v[86:87], v[30:31], v[222:223] op_sel_hi:[1,0,1]
    v_max_f32 v140, 0, v140
    v_max_f32 v141, 0, v141
    v_max_f32 v142, 0, v142
    v_max_f32 v143, 0, v143
    v_pk_mul_f32 v[220:221], v[220:221], v[30:31] op_sel:[0,1] op_sel_hi:[1,1]
    v_pk_mul_f32 v[222:223], v[222:223], v[30:31] op_sel:[0,1] op_sel_hi:[1,1]
    v_pk_mul_f32 v[140:141], v[140:141], v[220:221]
    v_pk_mul_f32 v[142:143], v[142:143], v[222:223]
    v_cvt_pk_bf16_f32 v136, v136, v137
    v_cvt_pk_bf16_f32 v137, v138, v139
    v_cvt_pk_bf16_f32 v138, v140, v141
    v_cvt_pk_bf16_f32 v139, v142, v143
    s_nop 0
    v_permlane16_swap_b32 v136, v138
    v_permlane16_swap_b32 v137, v139
    buffer_store_dwordx4 v[136:139], v7, s[48:51], s62 offen offset:2048 sc1
    s_waitcnt lgkmcnt(0)
    v_pk_fma_f32 v[144:145], v[68:69], v[24:25], v[144:145] op_sel_hi:[1,0,1]
    v_pk_fma_f32 v[146:147], v[70:71], v[24:25], v[146:147] op_sel_hi:[1,0,1]
    v_pk_fma_f32 v[224:225], v[88:89], v[24:25], v[224:225] op_sel_hi:[1,0,1]
    v_pk_fma_f32 v[226:227], v[90:91], v[24:25], v[226:227] op_sel_hi:[1,0,1]
    v_max_f32 v144, 0, v144
    v_max_f32 v145, 0, v145
    v_max_f32 v146, 0, v146
    v_max_f32 v147, 0, v147
    v_pk_mul_f32 v[224:225], v[224:225], v[24:25] op_sel:[0,1] op_sel_hi:[1,1]
    v_pk_mul_f32 v[226:227], v[226:227], v[24:25] op_sel:[0,1] op_sel_hi:[1,1]
    v_pk_mul_f32 v[144:145], v[144:145], v[224:225]
    v_pk_mul_f32 v[146:147], v[146:147], v[226:227]
    v_pk_fma_f32 v[148:149], v[68:69], v[26:27], v[148:149] op_sel_hi:[1,0,1]
    v_pk_fma_f32 v[150:151], v[70:71], v[26:27], v[150:151] op_sel_hi:[1,0,1]
    v_pk_fma_f32 v[228:229], v[88:89], v[26:27], v[228:229] op_sel_hi:[1,0,1]
    v_pk_fma_f32 v[230:231], v[90:91], v[26:27], v[230:231] op_sel_hi:[1,0,1]
    v_max_f32 v148, 0, v148
    v_max_f32 v149, 0, v149
    v_max_f32 v150, 0, v150
    v_max_f32 v151, 0, v151
    v_pk_mul_f32 v[228:229], v[228:229], v[26:27] op_sel:[0,1] op_sel_hi:[1,1]
    v_pk_mul_f32 v[230:231], v[230:231], v[26:27] op_sel:[0,1] op_sel_hi:[1,1]
    v_pk_mul_f32 v[148:149], v[148:149], v[228:229]
    v_pk_mul_f32 v[150:151], v[150:151], v[230:231]
    v_cvt_pk_bf16_f32 v144, v144, v145
    v_cvt_pk_bf16_f32 v145, v146, v147
    v_cvt_pk_bf16_f32 v146, v148, v149
    v_cvt_pk_bf16_f32 v147, v150, v151
    s_nop 0
    v_permlane16_swap_b32 v144, v146
    v_permlane16_swap_b32 v145, v147
    buffer_store_dwordx4 v[144:147], v7, s[48:51], s63 offen offset:0 sc1
    v_pk_fma_f32 v[152:153], v[68:69], v[28:29], v[152:153] op_sel_hi:[1,0,1]
    v_pk_fma_f32 v[154:155], v[70:71], v[28:29], v[154:155] op_sel_hi:[1,0,1]
    v_pk_fma_f32 v[232:233], v[88:89], v[28:29], v[232:233] op_sel_hi:[1,0,1]
    v_pk_fma_f32 v[234:235], v[90:91], v[28:29], v[234:235] op_sel_hi:[1,0,1]
    v_max_f32 v152, 0, v152
    v_max_f32 v153, 0, v153
    v_max_f32 v154, 0, v154
    v_max_f32 v155, 0, v155
    v_pk_mul_f32 v[232:233], v[232:233], v[28:29] op_sel:[0,1] op_sel_hi:[1,1]
    v_pk_mul_f32 v[234:235], v[234:235], v[28:29] op_sel:[0,1] op_sel_hi:[1,1]
    v_pk_mul_f32 v[152:153], v[152:153], v[232:233]
    v_pk_mul_f32 v[154:155], v[154:155], v[234:235]
    v_pk_fma_f32 v[156:157], v[68:69], v[30:31], v[156:157] op_sel_hi:[1,0,1]
    v_pk_fma_f32 v[158:159], v[70:71], v[30:31], v[158:159] op_sel_hi:[1,0,1]
    v_pk_fma_f32 v[236:237], v[88:89], v[30:31], v[236:237] op_sel_hi:[1,0,1]
    v_pk_fma_f32 v[238:239], v[90:91], v[30:31], v[238:239] op_sel_hi:[1,0,1]
    v_max_f32 v156, 0, v156
    v_max_f32 v157, 0, v157
    v_max_f32 v158, 0, v158
    v_max_f32 v159, 0, v159
    v_pk_mul_f32 v[236:237], v[236:237], v[30:31] op_sel:[0,1] op_sel_hi:[1,1]
    v_pk_mul_f32 v[238:239], v[238:239], v[30:31] op_sel:[0,1] op_sel_hi:[1,1]
    v_pk_mul_f32 v[156:157], v[156:157], v[236:237]
    v_pk_mul_f32 v[158:159], v[158:159], v[238:239]
    v_cvt_pk_bf16_f32 v152, v152, v153
    v_cvt_pk_bf16_f32 v153, v154, v155
    v_cvt_pk_bf16_f32 v154, v156, v157
    v_cvt_pk_bf16_f32 v155, v158, v159
    s_nop 0
    v_permlane16_swap_b32 v152, v154
    v_permlane16_swap_b32 v153, v155
    buffer_store_dwordx4 v[152:155], v7, s[48:51], s63 offen offset:2048 sc1
    s_branch fz_mdone
fz_mF1:
    ds_read_b128 v[24:27], v9 offset:0
    ds_read_b128 v[28:31], v9 offset:2048
    ds_read_b128 v[32:35], v9 offset:4096
    ds_read_b128 v[36:39], v9 offset:6144
    ds_read_b64_tr_b16 v[56:57], v11 offset:0
    ds_read_b64_tr_b16 v[58:59], v11 offset:4608
    ds_read_b64_tr_b16 v[60:61], v11 offset:32
    ds_read_b64_tr_b16 v[62:63], v11 offset:4640
    ds_read_b64_tr_b16 v[64:65], v11 offset:64
    ds_read_b64_tr_b16 v[66:67], v11 offset:4672
    ds_read_b64_tr_b16 v[68:69], v11 offset:96
    ds_read_b64_tr_b16 v[70:71], v11 offset:4704
    s_waitcnt lgkmcnt(6)
    ds_read_b64_tr_b16 v[72:73], v11 offset:128
    ds_read_b64_tr_b16 v[74:75], v11 offset:4736
    ds_read_b64_tr_b16 v[76:77], v11 offset:18432
    ds_read_b64_tr_b16 v[78:79], v11 offset:23040
    ds_read_b64_tr_b16 v[80:81], v11 offset:18464
    ds_read_b64_tr_b16 v[82:83], v11 offset:23072
    ds_read_b64_tr_b16 v[84:85], v11 offset:18496
    ds_read_b64_tr_b16 v[86:87], v11 offset:23104
    s_waitcnt lgkmcnt(6)
    ds_read_b64_tr_b16 v[88:89], v11 offset:18528
    ds_read_b64_tr_b16 v[90:91], v11 offset:23136
    ds_read_b64_tr_b16 v[92:93], v11 offset:18560
    ds_read_b64_tr_b16 v[94:95], v11 offset:23168
    v_mfma_f32_16x16x32_bf16 v[112:115], v[60:63], v[24:27], 0
    v_mfma_f32_16x16x32_bf16 v[116:119], v[60:63], v[28:31], 0
    v_mfma_f32_16x16x32_bf16 v[120:123], v[60:63], v[32:35], 0
    v_mfma_f32_16x16x32_bf16 v[124:127], v[60:63], v[36:39], 0
    s_waitcnt lgkmcnt(6)
    v_mfma_f32_16x16x32_bf16 v[192:195], v[80:83], v[24:27], 0
    ds_read_b64_tr_b16 v[60:61], v11 offset:9248
    v_mfma_f32_16x16x32_bf16 v[196:199], v[80:83], v[28:31], 0
    ds_read_b64_tr_b16 v[62:63], v11 offset:13856
    v_mfma_f32_16x16x32_bf16 v[200:203], v[80:83], v[32:35], 0
    v_mfma_f32_16x16x32_bf16 v[204:207], v[80:83], v[36:39], 0
    v_mfma_f32_16x16x32_bf16 v[128:131], v[64:67], v[24:27], 0
    ds_read_b64_tr_b16 v[80:81], v11 offset:27680
    v_mfma_f32_16x16x32_bf16 v[132:135], v[64:67], v[28:31], 0
    ds_read_b64_tr_b16 v[82:83], v11 offset:32288
    v_mfma_f32_16x16x32_bf16 v[136:139], v[64:67], v[32:35], 0
    v_mfma_f32_16x16x32_bf16 v[140:143], v[64:67], v[36:39], 0
    s_waitcnt lgkmcnt(8)
    v_mfma_f32_16x16x32_bf16 v[208:211], v[84:87], v[24:27], 0
    ds_read_b64_tr_b16 v[64:65], v11 offset:9280
    v_mfma_f32_16x16x32_bf16 v[212:215], v[84:87], v[28:31], 0
    ds_read_b64_tr_b16 v[66:67], v11 offset:13888
    v_mfma_f32_16x16x32_bf16 v[216:219], v[84:87], v[32:35], 0
    ds_read_b128 v[40:43], v10 offset:0
    v_mfma_f32_16x16x32_bf16 v[220:223], v[84:87], v[36:39], 0
    ds_read_b128 v[44:47], v10 offset:2048
    v_mfma_f32_16x16x32_bf16 v[104:107], v[56:59], v[32:35], 0
    ds_read_b64_tr_b16 v[84:85], v11 offset:27712
    v_mfma_f32_16x16x32_bf16 v[108:111], v[56:59], v[36:39], 0
    ds_read_b64_tr_b16 v[86:87], v11 offset:32320
    v_mfma_f32_16x16x32_bf16 v[184:187], v[76:79], v[32:35], 0
    ds_read_b128 v[48:51], v10 offset:4096
    v_mfma_f32_16x16x32_bf16 v[188:191], v[76:79], v[36:39], 0
    ds_read_b128 v[52:55], v10 offset:6144
    v_mfma_f32_16x16x32_bf16 v[144:147], v[68:71], v[24:27], 0
    ds_read_b64_tr_b16 v[56:57], v11 offset:9216
    v_mfma_f32_16x16x32_bf16 v[148:151], v[68:71], v[28:31], 0
    ds_read_b64_tr_b16 v[58:59], v11 offset:13824
    v_mfma_f32_16x16x32_bf16 v[152:155], v[68:71], v[32:35], 0
    ds_read_b64_tr_b16 v[76:77], v11 offset:27648
    v_mfma_f32_16x16x32_bf16 v[156:159], v[68:71], v[36:39], 0
    ds_read_b64_tr_b16 v[78:79], v11 offset:32256
    s_waitcnt lgkmcnt(12)
    v_mfma_f32_16x16x32_bf16 v[224:227], v[88:91], v[24:27], 0
    ds_read_b64_tr_b16 v[68:69], v11 offset:9312
    v_mfma_f32_16x16x32_bf16 v[228:231], v[88:91], v[28:31], 0
    ds_read_b64_tr_b16 v[70:71], v11 offset:13920
    v_mfma_f32_16x16x32_bf16 v[232:235], v[88:91], v[32:35], 0
    v_mfma_f32_16x16x32_bf16 v[236:239], v[88:91], v[36:39], 0
    v_mfma_f32_16x16x32_bf16 v[160:163], v[72:75], v[24:27], 0
    ds_read_b64_tr_b16 v[88:89], v11 offset:27744
    v_mfma_f32_16x16x32_bf16 v[164:167], v[72:75], v[28:31], 0
    ds_read_b64_tr_b16 v[90:91], v11 offset:32352
    v_mfma_f32_16x16x32_bf16 v[168:171], v[72:75], v[32:35], 0
    v_mfma_f32_16x16x32_bf16 v[172:175], v[72:75], v[36:39], 0
    v_mfma_f32_16x16x32_bf16 v[240:243], v[92:95], v[24:27], 0
    ds_read_b64_tr_b16 v[72:73], v11 offset:9344
    v_mfma_f32_16x16x32_bf16 v[244:247], v[92:95], v[28:31], 0
    ds_read_b64_tr_b16 v[74:75], v11 offset:13952
    v_mfma_f32_16x16x32_bf16 v[248:251], v[92:95], v[32:35], 0
    v_mfma_f32_16x16x32_bf16 v[252:255], v[92:95], v[36:39], 0
    s_waitcnt lgkmcnt(10)
    v_mfma_f32_16x16x32_bf16 v[112:115], v[60:63], v[40:43], v[112:115]
    ds_read_b64_tr_b16 v[92:93], v11 offset:27776
    v_mfma_f32_16x16x32_bf16 v[116:119], v[60:63], v[44:47], v[116:119]
    ds_read_b64_tr_b16 v[94:95], v11 offset:32384
    v_mfma_f32_16x16x32_bf16 v[120:123], v[60:63], v[48:51], v[120:123]
    v_mfma_f32_16x16x32_bf16 v[124:127], v[60:63], v[52:55], v[124:127]
    v_mfma_f32_16x16x32_bf16 v[192:195], v[80:83], v[40:43], v[192:195]
    v_mfma_f32_16x16x32_bf16 v[196:199], v[80:83], v[44:47], v[196:199]
    v_mfma_f32_16x16x32_bf16 v[200:203], v[80:83], v[48:51], v[200:203]
    v_mfma_f32_16x16x32_bf16 v[204:207], v[80:83], v[52:55], v[204:207]
    s_waitcnt lgkmcnt(0)
    s_barrier
    v_mfma_f32_16x16x32_bf16 v[128:131], v[64:67], v[40:43], v[128:131]
    ds_read_b64_tr_b16 v[60:61], v14 offset:32
    v_mfma_f32_16x16x32_bf16 v[132:135], v[64:67], v[44:47], v[132:135]
    ds_read_b64_tr_b16 v[62:63], v14 offset:4640
    v_mfma_f32_16x16x32_bf16 v[136:139], v[64:67], v[48:51], v[136:139]
    ds_read_b64_tr_b16 v[80:81], v14 offset:18464
    v_mfma_f32_16x16x32_bf16 v[140:143], v[64:67], v[52:55], v[140:143]
    ds_read_b64_tr_b16 v[82:83], v14 offset:23072
    v_mfma_f32_16x16x32_bf16 v[208:211], v[84:87], v[40:43], v[208:211]
    ds_read_b64_tr_b16 v[64:65], v14 offset:64
    v_mfma_f32_16x16x32_bf16 v[212:215], v[84:87], v[44:47], v[212:215]
    ds_read_b64_tr_b16 v[66:67], v14 offset:4672
    v_mfma_f32_16x16x32_bf16 v[216:219], v[84:87], v[48:51], v[216:219]
    ds_read_b128 v[24:27], v12 offset:0
    v_mfma_f32_16x16x32_bf16 v[220:223], v[84:87], v[52:55], v[220:223]
    ds_read_b128 v[28:31], v12 offset:2048
    v_mfma_f32_16x16x32_bf16 v[104:107], v[56:59], v[48:51], v[104:107]
    ds_read_b64_tr_b16 v[84:85], v14 offset:18496
    v_mfma_f32_16x16x32_bf16 v[108:111], v[56:59], v[52:55], v[108:111]
    ds_read_b64_tr_b16 v[86:87], v14 offset:23104
    v_mfma_f32_16x16x32_bf16 v[184:187], v[76:79], v[48:51], v[184:187]
    ds_read_b128 v[32:35], v12 offset:4096
    v_mfma_f32_16x16x32_bf16 v[188:191], v[76:79], v[52:55], v[188:191]
    ds_read_b128 v[36:39], v12 offset:6144
    v_mfma_f32_16x16x32_bf16 v[144:147], v[68:71], v[40:43], v[144:147]
    ds_read_b64_tr_b16 v[56:57], v14 offset:0
    v_mfma_f32_16x16x32_bf16 v[148:151], v[68:71], v[44:47], v[148:151]
    ds_read_b64_tr_b16 v[58:59], v14 offset:4608
    v_mfma_f32_16x16x32_bf16 v[152:155], v[68:71], v[48:51], v[152:155]
    ds_read_b64_tr_b16 v[76:77], v14 offset:18432
    v_mfma_f32_16x16x32_bf16 v[156:159], v[68:71], v[52:55], v[156:159]
    ds_read_b64_tr_b16 v[78:79], v14 offset:23040
    v_mfma_f32_16x16x32_bf16 v[224:227], v[88:91], v[40:43], v[224:227]
    ds_read_b64_tr_b16 v[68:69], v14 offset:96
    v_mfma_f32_16x16x32_bf16 v[228:231], v[88:91], v[44:47], v[228:231]
    ds_read_b64_tr_b16 v[70:71], v14 offset:4704
    v_mfma_f32_16x16x32_bf16 v[232:235], v[88:91], v[48:51], v[232:235]
    v_mfma_f32_16x16x32_bf16 v[236:239], v[88:91], v[52:55], v[236:239]
    v_mfma_f32_16x16x32_bf16 v[160:163], v[72:75], v[40:43], v[160:163]
    ds_read_b64_tr_b16 v[88:89], v14 offset:18528
    v_mfma_f32_16x16x32_bf16 v[164:167], v[72:75], v[44:47], v[164:167]
    ds_read_b64_tr_b16 v[90:91], v14 offset:23136
    v_mfma_f32_16x16x32_bf16 v[168:171], v[72:75], v[48:51], v[168:171]
    v_mfma_f32_16x16x32_bf16 v[172:175], v[72:75], v[52:55], v[172:175]
    v_mfma_f32_16x16x32_bf16 v[240:243], v[92:95], v[40:43], v[240:243]
    ds_read_b64_tr_b16 v[72:73], v14 offset:128
    v_mfma_f32_16x16x32_bf16 v[244:247], v[92:95], v[44:47], v[244:247]
    ds_read_b64_tr_b16 v[74:75], v14 offset:4736
    v_mfma_f32_16x16x32_bf16 v[248:251], v[92:95], v[48:51], v[248:251]
    v_mfma_f32_16x16x32_bf16 v[252:255], v[92:95], v[52:55], v[252:255]
    s_waitcnt lgkmcnt(10)
    v_mfma_f32_16x16x32_bf16 v[112:115], v[60:63], v[24:27], v[112:115]
    ds_read_b64_tr_b16 v[92:93], v14 offset:18560
    v_mfma_f32_16x16x32_bf16 v[116:119], v[60:63], v[28:31], v[116:119]
    ds_read_b64_tr_b16 v[94:95], v14 offset:23168
    v_mfma_f32_16x16x32_bf16 v[120:123], v[60:63], v[32:35], v[120:123]
    v_mfma_f32_16x16x32_bf16 v[124:127], v[60:63], v[36:39], v[124:127]
    v_mfma_f32_16x16x32_bf16 v[192:195], v[80:83], v[24:27], v[192:195]
    ds_read_b64_tr_b16 v[60:61], v14 offset:9248
    v_mfma_f32_16x16x32_bf16 v[196:199], v[80:83], v[28:31], v[196:199]
    ds_read_b64_tr_b16 v[62:63], v14 offset:13856
    v_mfma_f32_16x16x32_bf16 v[200:203], v[80:83], v[32:35], v[200:203]
    v_mfma_f32_16x16x32_bf16 v[204:207], v[80:83], v[36:39], v[204:207]
    v_mfma_f32_16x16x32_bf16 v[128:131], v[64:67], v[24:27], v[128:131]
    ds_read_b64_tr_b16 v[80:81], v14 offset:27680
    v_mfma_f32_16x16x32_bf16 v[132:135], v[64:67], v[28:31], v[132:135]
    ds_read_b64_tr_b16 v[82:83], v14 offset:32288
    v_mfma_f32_16x16x32_bf16 v[136:139], v[64:67], v[32:35], v[136:139]
    v_mfma_f32_16x16x32_bf16 v[140:143], v[64:67], v[36:39], v[140:143]
    v_mfma_f32_16x16x32_bf16 v[208:211], v[84:87], v[24:27], v[208:211]
    ds_read_b64_tr_b16 v[64:65], v14 offset:9280
    v_mfma_f32_16x16x32_bf16 v[212:215], v[84:87], v[28:31], v[212:215]
    ds_read_b64_tr_b16 v[66:67], v14 offset:13888
    v_mfma_f32_16x16x32_bf16 v[216:219], v[84:87], v[32:35], v[216:219]
    ds_read_b128 v[40:43], v13 offset:0
    v_mfma_f32_16x16x32_bf16 v[220:223], v[84:87], v[36:39], v[220:223]
    ds_read_b128 v[44:47], v13 offset:2048
    s_waitcnt lgkmcnt(12)
    v_mfma_f32_16x16x32_bf16 v[104:107], v[56:59], v[32:35], v[104:107]
    ds_read_b64_tr_b16 v[84:85], v14 offset:27712
    v_mfma_f32_16x16x32_bf16 v[108:111], v[56:59], v[36:39], v[108:111]
    ds_read_b64_tr_b16 v[86:87], v14 offset:32320
    v_mfma_f32_16x16x32_bf16 v[184:187], v[76:79], v[32:35], v[184:187]
    ds_read_b128 v[48:51], v13 offset:4096
    v_mfma_f32_16x16x32_bf16 v[188:191], v[76:79], v[36:39], v[188:191]
    ds_read_b128 v[52:55], v13 offset:6144
    v_mfma_f32_16x16x32_bf16 v[144:147], v[68:71], v[24:27], v[144:147]
    ds_read_b64_tr_b16 v[56:57], v14 offset:9216
    v_mfma_f32_16x16x32_bf16 v[148:151], v[68:71], v[28:31], v[148:151]
    ds_read_b64_tr_b16 v[58:59], v14 offset:13824
    v_mfma_f32_16x16x32_bf16 v[152:155], v[68:71], v[32:35], v[152:155]
    ds_read_b64_tr_b16 v[76:77], v14 offset:27648
    v_mfma_f32_16x16x32_bf16 v[156:159], v[68:71], v[36:39], v[156:159]
    ds_read_b64_tr_b16 v[78:79], v14 offset:32256
    v_mfma_f32_16x16x32_bf16 v[224:227], v[88:91], v[24:27], v[224:227]
    ds_read_b64_tr_b16 v[68:69], v14 offset:9312
    v_mfma_f32_16x16x32_bf16 v[228:231], v[88:91], v[28:31], v[228:231]
    ds_read_b64_tr_b16 v[70:71], v14 offset:13920
    v_mfma_f32_16x16x32_bf16 v[232:235], v[88:91], v[32:35], v[232:235]
    v_mfma_f32_16x16x32_bf16 v[236:239], v[88:91], v[36:39], v[236:239]
    s_waitcnt lgkmcnt(12)
    v_mfma_f32_16x16x32_bf16 v[160:163], v[72:75], v[24:27], v[160:163]
    ds_read_b64_tr_b16 v[88:89], v14 offset:27744
    v_mfma_f32_16x16x32_bf16 v[164:167], v[72:75], v[28:31], v[164:167]
    ds_read_b64_tr_b16 v[90:91], v14 offset:32352
    v_mfma_f32_16x16x32_bf16 v[168:171], v[72:75], v[32:35], v[168:171]
    v_mfma_f32_16x16x32_bf16 v[172:175], v[72:75], v[36:39], v[172:175]
    v_mfma_f32_16x16x32_bf16 v[240:243], v[92:95], v[24:27], v[240:243]
    ds_read_b64_tr_b16 v[72:73], v14 offset:9344
    v_mfma_f32_16x16x32_bf16 v[244:247], v[92:95], v[28:31], v[244:247]
    ds_read_b64_tr_b16 v[74:75], v14 offset:13952
    v_mfma_f32_16x16x32_bf16 v[248:251], v[92:95], v[32:35], v[248:251]
    v_mfma_f32_16x16x32_bf16 v[252:255], v[92:95], v[36:39], v[252:255]
    s_waitcnt lgkmcnt(10)
    v_mfma_f32_16x16x32_bf16 v[112:115], v[60:63], v[40:43], v[112:115]
    ds_read_b64_tr_b16 v[92:93], v14 offset:27776
    v_mfma_f32_16x16x32_bf16 v[116:119], v[60:63], v[44:47], v[116:119]
    ds_read_b64_tr_b16 v[94:95], v14 offset:32384
    v_mfma_f32_16x16x32_bf16 v[120:123], v[60:63], v[48:51], v[120:123]
    v_mfma_f32_16x16x32_bf16 v[124:127], v[60:63], v[52:55], v[124:127]
    v_mfma_f32_16x16x32_bf16 v[192:195], v[80:83], v[40:43], v[192:195]
    v_mfma_f32_16x16x32_bf16 v[196:199], v[80:83], v[44:47], v[196:199]
    v_mfma_f32_16x16x32_bf16 v[200:203], v[80:83], v[48:51], v[200:203]
    v_mfma_f32_16x16x32_bf16 v[204:207], v[80:83], v[52:55], v[204:207]
    s_waitcnt lgkmcnt(0)
    s_barrier
    v_mfma_f32_16x16x32_bf16 v[128:131], v[64:67], v[40:43], v[128:131]
    ds_read_b64_tr_b16 v[60:61], v17 offset:32
    v_mfma_f32_16x16x32_bf16 v[132:135], v[64:67], v[44:47], v[132:135]
    ds_read_b64_tr_b16 v[62:63], v17 offset:4640
    v_mfma_f32_16x16x32_bf16 v[136:139], v[64:67], v[48:51], v[136:139]
    ds_read_b64_tr_b16 v[80:81], v17 offset:18464
    v_mfma_f32_16x16x32_bf16 v[140:143], v[64:67], v[52:55], v[140:143]
    ds_read_b64_tr_b16 v[82:83], v17 offset:23072
    v_mfma_f32_16x16x32_bf16 v[208:211], v[84:87], v[40:43], v[208:211]
    ds_read_b64_tr_b16 v[64:65], v17 offset:64
    v_mfma_f32_16x16x32_bf16 v[212:215], v[84:87], v[44:47], v[212:215]
    ds_read_b64_tr_b16 v[66:67], v17 offset:4672
    v_mfma_f32_16x16x32_bf16 v[216:219], v[84:87], v[48:51], v[216:219]
    ds_read_b128 v[24:27], v15 offset:0
    v_mfma_f32_16x16x32_bf16 v[220:223], v[84:87], v[52:55], v[220:223]
    ds_read_b128 v[28:31], v15 offset:2048
    v_mfma_f32_16x16x32_bf16 v[104:107], v[56:59], v[48:51], v[104:107]
    ds_read_b64_tr_b16 v[84:85], v17 offset:18496
    v_mfma_f32_16x16x32_bf16 v[108:111], v[56:59], v[52:55], v[108:111]
    ds_read_b64_tr_b16 v[86:87], v17 offset:23104
    v_mfma_f32_16x16x32_bf16 v[184:187], v[76:79], v[48:51], v[184:187]
    ds_read_b128 v[32:35], v15 offset:4096
    v_mfma_f32_16x16x32_bf16 v[188:191], v[76:79], v[52:55], v[188:191]
    ds_read_b128 v[36:39], v15 offset:6144
    v_mfma_f32_16x16x32_bf16 v[144:147], v[68:71], v[40:43], v[144:147]
    ds_read_b64_tr_b16 v[56:57], v17 offset:0
    v_mfma_f32_16x16x32_bf16 v[148:151], v[68:71], v[44:47], v[148:151]
    ds_read_b64_tr_b16 v[58:59], v17 offset:4608
    v_mfma_f32_16x16x32_bf16 v[152:155], v[68:71], v[48:51], v[152:155]
    ds_read_b64_tr_b16 v[76:77], v17 offset:18432
    v_mfma_f32_16x16x32_bf16 v[156:159], v[68:71], v[52:55], v[156:159]
    ds_read_b64_tr_b16 v[78:79], v17 offset:23040
    v_mfma_f32_16x16x32_bf16 v[224:227], v[88:91], v[40:43], v[224:227]
    ds_read_b64_tr_b16 v[68:69], v17 offset:96
    v_mfma_f32_16x16x32_bf16 v[228:231], v[88:91], v[44:47], v[228:231]
    ds_read_b64_tr_b16 v[70:71], v17 offset:4704
    v_mfma_f32_16x16x32_bf16 v[232:235], v[88:91], v[48:51], v[232:235]
    v_mfma_f32_16x16x32_bf16 v[236:239], v[88:91], v[52:55], v[236:239]
    v_mfma_f32_16x16x32_bf16 v[160:163], v[72:75], v[40:43], v[160:163]
    ds_read_b64_tr_b16 v[88:89], v17 offset:18528
    v_mfma_f32_16x16x32_bf16 v[164:167], v[72:75], v[44:47], v[164:167]
    ds_read_b64_tr_b16 v[90:91], v17 offset:23136
    v_mfma_f32_16x16x32_bf16 v[168:171], v[72:75], v[48:51], v[168:171]
    v_mfma_f32_16x16x32_bf16 v[172:175], v[72:75], v[52:55], v[172:175]
    v_mfma_f32_16x16x32_bf16 v[240:243], v[92:95], v[40:43], v[240:243]
    ds_read_b64_tr_b16 v[72:73], v17 offset:128
    v_mfma_f32_16x16x32_bf16 v[244:247], v[92:95], v[44:47], v[244:247]
    ds_read_b64_tr_b16 v[74:75], v17 offset:4736
    v_mfma_f32_16x16x32_bf16 v[248:251], v[92:95], v[48:51], v[248:251]
    v_mfma_f32_16x16x32_bf16 v[252:255], v[92:95], v[52:55], v[252:255]
    s_cmp_lg_u32 s26, 0
    s_cbranch_scc1 fz_npd10
    s_mov_b32 s52, s16
    s_mov_b32 s53, s17
    s_mov_b32 s54, 0x158000
    s_mov_b32 s55, 0x00020000
    s_mul_i32 s67, s2, 5504
    v_lshlrev_b32 v22, 7, v0
    v_min_u32 v22, 5376, v22
    buffer_load_dword v21, v22, s[52:55], s67 offen
fz_npd10:
    s_cmp_lg_u32 s26, 1
    s_cbranch_scc1 fz_npd11
    s_mov_b32 s52, s8
    s_mov_b32 s53, s9
    s_mov_b32 s54, 0x80000
    s_mov_b32 s55, 0x00020000
    s_mul_i32 s67, s2, 2048
    v_lshlrev_b32 v22, 7, v0
    v_min_u32 v22, 1920, v22
    buffer_load_dword v21, v22, s[52:55], s67 offen
fz_npd11:
    s_waitcnt lgkmcnt(10)
    v_mfma_f32_16x16x32_bf16 v[112:115], v[60:63], v[24:27], v[112:115]
    ds_read_b64_tr_b16 v[92:93], v17 offset:18560
    v_mfma_f32_16x16x32_bf16 v[116:119], v[60:63], v[28:31], v[116:119]
    ds_read_b64_tr_b16 v[94:95], v17 offset:23168
    v_mfma_f32_16x16x32_bf16 v[120:123], v[60:63], v[32:35], v[120:123]
    v_mfma_f32_16x16x32_bf16 v[124:127], v[60:63], v[36:39], v[124:127]
    v_mfma_f32_16x16x32_bf16 v[192:195], v[80:83], v[24:27], v[192:195]
    ds_read_b64_tr_b16 v[60:61], v17 offset:9248
    v_mfma_f32_16x16x32_bf16 v[196:199], v[80:83], v[28:31], v[196:199]
    ds_read_b64_tr_b16 v[62:63], v17 offset:13856
    v_mfma_f32_16x16x32_bf16 v[200:203], v[80:83], v[32:35], v[200:203]
    v_mfma_f32_16x16x32_bf16 v[204:207], v[80:83], v[36:39], v[204:207]
    v_mfma_f32_16x16x32_bf16 v[128:131], v[64:67], v[24:27], v[128:131]
    ds_read_b64_tr_b16 v[80:81], v17 offset:27680
    v_mfma_f32_16x16x32_bf16 v[132:135], v[64:67], v[28:31], v[132:135]
    ds_read_b64_tr_b16 v[82:83], v17 offset:32288
    v_mfma_f32_16x16x32_bf16 v[136:139], v[64:67], v[32:35], v[136:139]
    v_mfma_f32_16x16x32_bf16 v[140:143], v[64:67], v[36:39], v[140:143]
    v_mfma_f32_16x16x32_bf16 v[208:211], v[84:87], v[24:27], v[208:211]
    ds_read_b64_tr_b16 v[64:65], v17 offset:9280
    v_mfma_f32_16x16x32_bf16 v[212:215], v[84:87], v[28:31], v[212:215]
    ds_read_b64_tr_b16 v[66:67], v17 offset:13888
    v_mfma_f32_16x16x32_bf16 v[216:219], v[84:87], v[32:35], v[216:219]
    ds_read_b128 v[40:43], v16 offset:0
    v_mfma_f32_16x16x32_bf16 v[220:223], v[84:87], v[36:39], v[220:223]
    ds_read_b128 v[44:47], v16 offset:2048
    s_waitcnt lgkmcnt(12)
    v_mfma_f32_16x16x32_bf16 v[104:107], v[56:59], v[32:35], v[104:107]
    ds_read_b64_tr_b16 v[84:85], v17 offset:27712
    v_mfma_f32_16x16x32_bf16 v[108:111], v[56:59], v[36:39], v[108:111]
    ds_read_b64_tr_b16 v[86:87], v17 offset:32320
    v_mfma_f32_16x16x32_bf16 v[184:187], v[76:79], v[32:35], v[184:187]
    ds_read_b128 v[48:51], v16 offset:4096
    v_mfma_f32_16x16x32_bf16 v[188:191], v[76:79], v[36:39], v[188:191]
    ds_read_b128 v[52:55], v16 offset:6144
    v_mfma_f32_16x16x32_bf16 v[144:147], v[68:71], v[24:27], v[144:147]
    ds_read_b64_tr_b16 v[56:57], v17 offset:9216
    v_mfma_f32_16x16x32_bf16 v[148:151], v[68:71], v[28:31], v[148:151]
    ds_read_b64_tr_b16 v[58:59], v17 offset:13824
    v_mfma_f32_16x16x32_bf16 v[152:155], v[68:71], v[32:35], v[152:155]
    ds_read_b64_tr_b16 v[76:77], v17 offset:27648
    v_mfma_f32_16x16x32_bf16 v[156:159], v[68:71], v[36:39], v[156:159]
    ds_read_b64_tr_b16 v[78:79], v17 offset:32256
    v_mfma_f32_16x16x32_bf16 v[224:227], v[88:91], v[24:27], v[224:227]
    ds_read_b64_tr_b16 v[68:69], v17 offset:9312
    v_mfma_f32_16x16x32_bf16 v[228:231], v[88:91], v[28:31], v[228:231]
    ds_read_b64_tr_b16 v[70:71], v17 offset:13920
    v_mfma_f32_16x16x32_bf16 v[232:235], v[88:91], v[32:35], v[232:235]
    v_mfma_f32_16x16x32_bf16 v[236:239], v[88:91], v[36:39], v[236:239]
    s_waitcnt lgkmcnt(12)
    v_mfma_f32_16x16x32_bf16 v[160:163], v[72:75], v[24:27], v[160:163]
    ds_read_b64_tr_b16 v[88:89], v17 offset:27744
    v_mfma_f32_16x16x32_bf16 v[164:167], v[72:75], v[28:31], v[164:167]
    ds_read_b64_tr_b16 v[90:91], v17 offset:32352
    v_mfma_f32_16x16x32_bf16 v[168:171], v[72:75], v[32:35], v[168:171]
    v_mfma_f32_16x16x32_bf16 v[172:175], v[72:75], v[36:39], v[172:175]
    v_mfma_f32_16x16x32_bf16 v[240:243], v[92:95], v[24:27], v[240:243]
    ds_read_b64_tr_b16 v[72:73], v17 offset:9344
    v_mfma_f32_16x16x32_bf16 v[244:247], v[92:95], v[28:31], v[244:247]
    ds_read_b64_tr_b16 v[74:75], v17 offset:13952
    v_mfma_f32_16x16x32_bf16 v[248:251], v[92:95], v[32:35], v[248:251]
    v_mfma_f32_16x16x32_bf16 v[252:255], v[92:95], v[36:39], v[252:255]
    s_waitcnt lgkmcnt(10)
    v_mfma_f32_16x16x32_bf16 v[112:115], v[60:63], v[40:43], v[112:115]
    ds_read_b64_tr_b16 v[92:93], v17 offset:27776
    v_mfma_f32_16x16x32_bf16 v[116:119], v[60:63], v[44:47], v[116:119]
    ds_read_b64_tr_b16 v[94:95], v17 offset:32384
    v_mfma_f32_16x16x32_bf16 v[120:123], v[60:63], v[48:51], v[120:123]
    v_mfma_f32_16x16x32_bf16 v[124:127], v[60:63], v[52:55], v[124:127]
    v_mfma_f32_16x16x32_bf16 v[192:195], v[80:83], v[40:43], v[192:195]
    v_mfma_f32_16x16x32_bf16 v[196:199], v[80:83], v[44:47], v[196:199]
    v_mfma_f32_16x16x32_bf16 v[200:203], v[80:83], v[48:51], v[200:203]
    v_mfma_f32_16x16x32_bf16 v[204:207], v[80:83], v[52:55], v[204:207]
    s_waitcnt lgkmcnt(0)
    s_barrier
    v_mfma_f32_16x16x32_bf16 v[128:131], v[64:67], v[40:43], v[128:131]
    ds_read_b64_tr_b16 v[60:61], v11 offset:32
    v_mfma_f32_16x16x32_bf16 v[132:135], v[64:67], v[44:47], v[132:135]
    ds_read_b64_tr_b16 v[62:63], v11 offset:4640
    v_mfma_f32_16x16x32_bf16 v[136:139], v[64:67], v[48:51], v[136:139]
    ds_read_b64_tr_b16 v[80:81], v11 offset:18464
    v_mfma_f32_16x16x32_bf16 v[140:143], v[64:67], v[52:55], v[140:143]
    ds_read_b64_tr_b16 v[82:83], v11 offset:23072
    v_mfma_f32_16x16x32_bf16 v[208:211], v[84:87], v[40:43], v[208:211]
    ds_read_b64_tr_b16 v[64:65], v11 offset:64
    v_mfma_f32_16x16x32_bf16 v[212:215], v[84:87], v[44:47], v[212:215]
    ds_read_b64_tr_b16 v[66:67], v11 offset:4672
    v_mfma_f32_16x16x32_bf16 v[216:219], v[84:87], v[48:51], v[216:219]
    ds_read_b128 v[24:27], v9 offset:0
    v_mfma_f32_16x16x32_bf16 v[220:223], v[84:87], v[52:55], v[220:223]
    ds_read_b128 v[28:31], v9 offset:2048
    v_mfma_f32_16x16x32_bf16 v[104:107], v[56:59], v[48:51], v[104:107]
    ds_read_b64_tr_b16 v[84:85], v11 offset:18496
    v_mfma_f32_16x16x32_bf16 v[108:111], v[56:59], v[52:55], v[108:111]
    ds_read_b64_tr_b16 v[86:87], v11 offset:23104
    v_mfma_f32_16x16x32_bf16 v[184:187], v[76:79], v[48:51], v[184:187]
    ds_read_b128 v[32:35], v9 offset:4096
    v_mfma_f32_16x16x32_bf16 v[188:191], v[76:79], v[52:55], v[188:191]
    ds_read_b128 v[36:39], v9 offset:6144
    v_mfma_f32_16x16x32_bf16 v[144:147], v[68:71], v[40:43], v[144:147]
    ds_read_b64_tr_b16 v[56:57], v11 offset:0
    v_mfma_f32_16x16x32_bf16 v[148:151], v[68:71], v[44:47], v[148:151]
    ds_read_b64_tr_b16 v[58:59], v11 offset:4608
    v_mfma_f32_16x16x32_bf16 v[152:155], v[68:71], v[48:51], v[152:155]
    ds_read_b64_tr_b16 v[76:77], v11 offset:18432
    v_mfma_f32_16x16x32_bf16 v[156:159], v[68:71], v[52:55], v[156:159]
    ds_read_b64_tr_b16 v[78:79], v11 offset:23040
    v_mfma_f32_16x16x32_bf16 v[224:227], v[88:91], v[40:43], v[224:227]
    ds_read_b64_tr_b16 v[68:69], v11 offset:96
    v_mfma_f32_16x16x32_bf16 v[228:231], v[88:91], v[44:47], v[228:231]
    ds_read_b64_tr_b16 v[70:71], v11 offset:4704
    v_mfma_f32_16x16x32_bf16 v[232:235], v[88:91], v[48:51], v[232:235]
    v_mfma_f32_16x16x32_bf16 v[236:239], v[88:91], v[52:55], v[236:239]
    v_mfma_f32_16x16x32_bf16 v[160:163], v[72:75], v[40:43], v[160:163]
    ds_read_b64_tr_b16 v[88:89], v11 offset:18528
    v_mfma_f32_16x16x32_bf16 v[164:167], v[72:75], v[44:47], v[164:167]
    ds_read_b64_tr_b16 v[90:91], v11 offset:23136
    v_mfma_f32_16x16x32_bf16 v[168:171], v[72:75], v[48:51], v[168:171]
    v_mfma_f32_16x16x32_bf16 v[172:175], v[72:75], v[52:55], v[172:175]
    v_mfma_f32_16x16x32_bf16 v[240:243], v[92:95], v[40:43], v[240:243]
    ds_read_b64_tr_b16 v[72:73], v11 offset:128
    v_mfma_f32_16x16x32_bf16 v[244:247], v[92:95], v[44:47], v[244:247]
    ds_read_b64_tr_b16 v[74:75], v11 offset:4736
    v_mfma_f32_16x16x32_bf16 v[248:251], v[92:95], v[48:51], v[248:251]
    v_mfma_f32_16x16x32_bf16 v[252:255], v[92:95], v[52:55], v[252:255]
    s_waitcnt lgkmcnt(10)
    v_mfma_f32_16x16x32_bf16 v[112:115], v[60:63], v[24:27], v[112:115]
    ds_read_b64_tr_b16 v[92:93], v11 offset:18560
    v_mfma_f32_16x16x32_bf16 v[116:119], v[60:63], v[28:31], v[116:119]
    ds_read_b64_tr_b16 v[94:95], v11 offset:23168
    v_mfma_f32_16x16x32_bf16 v[120:123], v[60:63], v[32:35], v[120:123]
    v_mfma_f32_16x16x32_bf16 v[124:127], v[60:63], v[36:39], v[124:127]
    v_mfma_f32_16x16x32_bf16 v[192:195], v[80:83], v[24:27], v[192:195]
    ds_read_b64_tr_b16 v[60:61], v11 offset:9248
    v_mfma_f32_16x16x32_bf16 v[196:199], v[80:83], v[28:31], v[196:199]
    ds_read_b64_tr_b16 v[62:63], v11 offset:13856
    v_mfma_f32_16x16x32_bf16 v[200:203], v[80:83], v[32:35], v[200:203]
    v_mfma_f32_16x16x32_bf16 v[204:207], v[80:83], v[36:39], v[204:207]
    v_mfma_f32_16x16x32_bf16 v[128:131], v[64:67], v[24:27], v[128:131]
    ds_read_b64_tr_b16 v[80:81], v11 offset:27680
    v_mfma_f32_16x16x32_bf16 v[132:135], v[64:67], v[28:31], v[132:135]
    ds_read_b64_tr_b16 v[82:83], v11 offset:32288
    v_mfma_f32_16x16x32_bf16 v[136:139], v[64:67], v[32:35], v[136:139]
    v_mfma_f32_16x16x32_bf16 v[140:143], v[64:67], v[36:39], v[140:143]
    v_mfma_f32_16x16x32_bf16 v[208:211], v[84:87], v[24:27], v[208:211]
    ds_read_b64_tr_b16 v[64:65], v11 offset:9280
    v_mfma_f32_16x16x32_bf16 v[212:215], v[84:87], v[28:31], v[212:215]
    ds_read_b64_tr_b16 v[66:67], v11 offset:13888
    v_mfma_f32_16x16x32_bf16 v[216:219], v[84:87], v[32:35], v[216:219]
    ds_read_b128 v[40:43], v10 offset:0
    v_mfma_f32_16x16x32_bf16 v[220:223], v[84:87], v[36:39], v[220:223]
    ds_read_b128 v[44:47], v10 offset:2048
    s_waitcnt lgkmcnt(12)
    v_mfma_f32_16x16x32_bf16 v[104:107], v[56:59], v[32:35], v[104:107]
    ds_read_b64_tr_b16 v[84:85], v11 offset:27712
    v_mfma_f32_16x16x32_bf16 v[108:111], v[56:59], v[36:39], v[108:111]
    ds_read_b64_tr_b16 v[86:87], v11 offset:32320
    v_mfma_f32_16x16x32_bf16 v[184:187], v[76:79], v[32:35], v[184:187]
    ds_read_b128 v[48:51], v10 offset:4096
    v_mfma_f32_16x16x32_bf16 v[188:191], v[76:79], v[36:39], v[188:191]
    ds_read_b128 v[52:55], v10 offset:6144
    v_mfma_f32_16x16x32_bf16 v[144:147], v[68:71], v[24:27], v[144:147]
    ds_read_b64_tr_b16 v[56:57], v11 offset:9216
    v_mfma_f32_16x16x32_bf16 v[148:151], v[68:71], v[28:31], v[148:151]
    ds_read_b64_tr_b16 v[58:59], v11 offset:13824
    v_mfma_f32_16x16x32_bf16 v[152:155], v[68:71], v[32:35], v[152:155]
    ds_read_b64_tr_b16 v[76:77], v11 offset:27648
    v_mfma_f32_16x16x32_bf16 v[156:159], v[68:71], v[36:39], v[156:159]
    ds_read_b64_tr_b16 v[78:79], v11 offset:32256
    v_mfma_f32_16x16x32_bf16 v[224:227], v[88:91], v[24:27], v[224:227]
    ds_read_b64_tr_b16 v[68:69], v11 offset:9312
    v_mfma_f32_16x16x32_bf16 v[228:231], v[88:91], v[28:31], v[228:231]
    ds_read_b64_tr_b16 v[70:71], v11 offset:13920
    v_mfma_f32_16x16x32_bf16 v[232:235], v[88:91], v[32:35], v[232:235]
    v_mfma_f32_16x16x32_bf16 v[236:239], v[88:91], v[36:39], v[236:239]
    s_waitcnt lgkmcnt(12)
    v_mfma_f32_16x16x32_bf16 v[160:163], v[72:75], v[24:27], v[160:163]
    ds_read_b64_tr_b16 v[88:89], v11 offset:27744
    v_mfma_f32_16x16x32_bf16 v[164:167], v[72:75], v[28:31], v[164:167]
    ds_read_b64_tr_b16 v[90:91], v11 offset:32352
    v_mfma_f32_16x16x32_bf16 v[168:171], v[72:75], v[32:35], v[168:171]
    v_mfma_f32_16x16x32_bf16 v[172:175], v[72:75], v[36:39], v[172:175]
    v_mfma_f32_16x16x32_bf16 v[240:243], v[92:95], v[24:27], v[240:243]
    ds_read_b64_tr_b16 v[72:73], v11 offset:9344
    v_mfma_f32_16x16x32_bf16 v[244:247], v[92:95], v[28:31], v[244:247]
    ds_read_b64_tr_b16 v[74:75], v11 offset:13952
    v_mfma_f32_16x16x32_bf16 v[248:251], v[92:95], v[32:35], v[248:251]
    v_mfma_f32_16x16x32_bf16 v[252:255], v[92:95], v[36:39], v[252:255]
    s_waitcnt lgkmcnt(10)
    v_mfma_f32_16x16x32_bf16 v[112:115], v[60:63], v[40:43], v[112:115]
    ds_read_b64_tr_b16 v[92:93], v11 offset:27776
    v_mfma_f32_16x16x32_bf16 v[116:119], v[60:63], v[44:47], v[116:119]
    ds_read_b64_tr_b16 v[94:95], v11 offset:32384
    v_mfma_f32_16x16x32_bf16 v[120:123], v[60:63], v[48:51], v[120:123]
    v_mfma_f32_16x16x32_bf16 v[124:127], v[60:63], v[52:55], v[124:127]
    v_mfma_f32_16x16x32_bf16 v[192:195], v[80:83], v[40:43], v[192:195]
    v_mfma_f32_16x16x32_bf16 v[196:199], v[80:83], v[44:47], v[196:199]
    v_mfma_f32_16x16x32_bf16 v[200:203], v[80:83], v[48:51], v[200:203]
    v_mfma_f32_16x16x32_bf16 v[204:207], v[80:83], v[52:55], v[204:207]
    s_waitcnt lgkmcnt(0)
    s_barrier
    v_mfma_f32_16x16x32_bf16 v[128:131], v[64:67], v[40:43], v[128:131]
    ds_read_b64_tr_b16 v[60:61], v14 offset:32
    v_mfma_f32_16x16x32_bf16 v[132:135], v[64:67], v[44:47], v[132:135]
    ds_read_b64_tr_b16 v[62:63], v14 offset:4640
    v_mfma_f32_16x16x32_bf16 v[136:139], v[64:67], v[48:51], v[136:139]
    ds_read_b64_tr_b16 v[80:81], v14 offset:18464
    v_mfma_f32_16x16x32_bf16 v[140:143], v[64:67], v[52:55], v[140:143]
    ds_read_b64_tr_b16 v[82:83], v14 offset:23072
    v_mfma_f32_16x16x32_bf16 v[208:211], v[84:87], v[40:43], v[208:211]
    ds_read_b64_tr_b16 v[64:65], v14 offset:64
    v_mfma_f32_16x16x32_bf16 v[212:215], v[84:87], v[44:47], v[212:215]
    ds_read_b64_tr_b16 v[66:67], v14 offset:4672
    v_mfma_f32_16x16x32_bf16 v[216:219], v[84:87], v[48:51], v[216:219]
    ds_read_b128 v[24:27], v12 offset:0
    v_mfma_f32_16x16x32_bf16 v[220:223], v[84:87], v[52:55], v[220:223]
    ds_read_b128 v[28:31], v12 offset:2048
    v_mfma_f32_16x16x32_bf16 v[104:107], v[56:59], v[48:51], v[104:107]
    ds_read_b64_tr_b16 v[84:85], v14 offset:18496
    v_mfma_f32_16x16x32_bf16 v[108:111], v[56:59], v[52:55], v[108:111]
    ds_read_b64_tr_b16 v[86:87], v14 offset:23104
    v_mfma_f32_16x16x32_bf16 v[184:187], v[76:79], v[48:51], v[184:187]
    ds_read_b128 v[32:35], v12 offset:4096
    v_mfma_f32_16x16x32_bf16 v[188:191], v[76:79], v[52:55], v[188:191]
    ds_read_b128 v[36:39], v12 offset:6144
    v_mfma_f32_16x16x32_bf16 v[144:147], v[68:71], v[40:43], v[144:147]
    ds_read_b64_tr_b16 v[56:57], v14 offset:0
    v_mfma_f32_16x16x32_bf16 v[148:151], v[68:71], v[44:47], v[148:151]
    ds_read_b64_tr_b16 v[58:59], v14 offset:4608
    v_mfma_f32_16x16x32_bf16 v[152:155], v[68:71], v[48:51], v[152:155]
    ds_read_b64_tr_b16 v[76:77], v14 offset:18432
    v_mfma_f32_16x16x32_bf16 v[156:159], v[68:71], v[52:55], v[156:159]
    ds_read_b64_tr_b16 v[78:79], v14 offset:23040
    v_mfma_f32_16x16x32_bf16 v[224:227], v[88:91], v[40:43], v[224:227]
    ds_read_b64_tr_b16 v[68:69], v14 offset:96
    v_mfma_f32_16x16x32_bf16 v[228:231], v[88:91], v[44:47], v[228:231]
    ds_read_b64_tr_b16 v[70:71], v14 offset:4704
    v_mfma_f32_16x16x32_bf16 v[232:235], v[88:91], v[48:51], v[232:235]
    v_mfma_f32_16x16x32_bf16 v[236:239], v[88:91], v[52:55], v[236:239]
    v_mfma_f32_16x16x32_bf16 v[160:163], v[72:75], v[40:43], v[160:163]
    ds_read_b64_tr_b16 v[88:89], v14 offset:18528
    v_mfma_f32_16x16x32_bf16 v[164:167], v[72:75], v[44:47], v[164:167]
    ds_read_b64_tr_b16 v[90:91], v14 offset:23136
    v_mfma_f32_16x16x32_bf16 v[168:171], v[72:75], v[48:51], v[168:171]
    v_mfma_f32_16x16x32_bf16 v[172:175], v[72:75], v[52:55], v[172:175]
    v_mfma_f32_16x16x32_bf16 v[240:243], v[92:95], v[40:43], v[240:243]
    ds_read_b64_tr_b16 v[72:73], v14 offset:128
    v_mfma_f32_16x16x32_bf16 v[244:247], v[92:95], v[44:47], v[244:247]
    ds_read_b64_tr_b16 v[74:75], v14 offset:4736
    v_mfma_f32_16x16x32_bf16 v[248:251], v[92:95], v[48:51], v[248:251]
    v_mfma_f32_16x16x32_bf16 v[252:255], v[92:95], v[52:55], v[252:255]
    s_waitcnt lgkmcnt(10)
    v_mfma_f32_16x16x32_bf16 v[112:115], v[60:63], v[24:27], v[112:115]
    ds_read_b64_tr_b16 v[92:93], v14 offset:18560
    v_mfma_f32_16x16x32_bf16 v[116:119], v[60:63], v[28:31], v[116:119]
    ds_read_b64_tr_b16 v[94:95], v14 offset:23168
    v_mfma_f32_16x16x32_bf16 v[120:123], v[60:63], v[32:35], v[120:123]
    v_mfma_f32_16x16x32_bf16 v[124:127], v[60:63], v[36:39], v[124:127]
    v_mfma_f32_16x16x32_bf16 v[192:195], v[80:83], v[24:27], v[192:195]
    ds_read_b64_tr_b16 v[60:61], v14 offset:9248
    v_mfma_f32_16x16x32_bf16 v[196:199], v[80:83], v[28:31], v[196:199]
    ds_read_b64_tr_b16 v[62:63], v14 offset:13856
    v_mfma_f32_16x16x32_bf16 v[200:203], v[80:83], v[32:35], v[200:203]
    v_mfma_f32_16x16x32_bf16 v[204:207], v[80:83], v[36:39], v[204:207]
    v_mfma_f32_16x16x32_bf16 v[128:131], v[64:67], v[24:27], v[128:131]
    ds_read_b64_tr_b16 v[80:81], v14 offset:27680
    v_mfma_f32_16x16x32_bf16 v[132:135], v[64:67], v[28:31], v[132:135]
    ds_read_b64_tr_b16 v[82:83], v14 offset:32288
    v_mfma_f32_16x16x32_bf16 v[136:139], v[64:67], v[32:35], v[136:139]
    v_mfma_f32_16x16x32_bf16 v[140:143], v[64:67], v[36:39], v[140:143]
    v_mfma_f32_16x16x32_bf16 v[208:211], v[84:87], v[24:27], v[208:211]
    ds_read_b64_tr_b16 v[64:65], v14 offset:9280
    v_mfma_f32_16x16x32_bf16 v[212:215], v[84:87], v[28:31], v[212:215]
    ds_read_b64_tr_b16 v[66:67], v14 offset:13888
    v_mfma_f32_16x16x32_bf16 v[216:219], v[84:87], v[32:35], v[216:219]
    ds_read_b128 v[40:43], v13 offset:0
    v_mfma_f32_16x16x32_bf16 v[220:223], v[84:87], v[36:39], v[220:223]
    ds_read_b128 v[44:47], v13 offset:2048
    s_waitcnt lgkmcnt(12)
    v_mfma_f32_16x16x32_bf16 v[104:107], v[56:59], v[32:35], v[104:107]
    ds_read_b64_tr_b16 v[84:85], v14 offset:27712
    v_mfma_f32_16x16x32_bf16 v[108:111], v[56:59], v[36:39], v[108:111]
    ds_read_b64_tr_b16 v[86:87], v14 offset:32320
    v_mfma_f32_16x16x32_bf16 v[184:187], v[76:79], v[32:35], v[184:187]
    ds_read_b128 v[48:51], v13 offset:4096
    v_mfma_f32_16x16x32_bf16 v[188:191], v[76:79], v[36:39], v[188:191]
    ds_read_b128 v[52:55], v13 offset:6144
    v_mfma_f32_16x16x32_bf16 v[144:147], v[68:71], v[24:27], v[144:147]
    ds_read_b64_tr_b16 v[56:57], v14 offset:9216
    v_mfma_f32_16x16x32_bf16 v[148:151], v[68:71], v[28:31], v[148:151]
    ds_read_b64_tr_b16 v[58:59], v14 offset:13824
    v_mfma_f32_16x16x32_bf16 v[152:155], v[68:71], v[32:35], v[152:155]
    ds_read_b64_tr_b16 v[76:77], v14 offset:27648
    v_mfma_f32_16x16x32_bf16 v[156:159], v[68:71], v[36:39], v[156:159]
    ds_read_b64_tr_b16 v[78:79], v14 offset:32256
    v_mfma_f32_16x16x32_bf16 v[224:227], v[88:91], v[24:27], v[224:227]
    ds_read_b64_tr_b16 v[68:69], v14 offset:9312
    v_mfma_f32_16x16x32_bf16 v[228:231], v[88:91], v[28:31], v[228:231]
    ds_read_b64_tr_b16 v[70:71], v14 offset:13920
    v_mfma_f32_16x16x32_bf16 v[232:235], v[88:91], v[32:35], v[232:235]
    v_mfma_f32_16x16x32_bf16 v[236:239], v[88:91], v[36:39], v[236:239]
    s_waitcnt lgkmcnt(12)
    v_mfma_f32_16x16x32_bf16 v[160:163], v[72:75], v[24:27], v[160:163]
    ds_read_b64_tr_b16 v[88:89], v14 offset:27744
    v_mfma_f32_16x16x32_bf16 v[164:167], v[72:75], v[28:31], v[164:167]
    ds_read_b64_tr_b16 v[90:91], v14 offset:32352
    v_mfma_f32_16x16x32_bf16 v[168:171], v[72:75], v[32:35], v[168:171]
    v_mfma_f32_16x16x32_bf16 v[172:175], v[72:75], v[36:39], v[172:175]
    v_mfma_f32_16x16x32_bf16 v[240:243], v[92:95], v[24:27], v[240:243]
    ds_read_b64_tr_b16 v[72:73], v14 offset:9344
    v_mfma_f32_16x16x32_bf16 v[244:247], v[92:95], v[28:31], v[244:247]
    ds_read_b64_tr_b16 v[74:75], v14 offset:13952
    v_mfma_f32_16x16x32_bf16 v[248:251], v[92:95], v[32:35], v[248:251]
    v_mfma_f32_16x16x32_bf16 v[252:255], v[92:95], v[36:39], v[252:255]
    s_waitcnt lgkmcnt(10)
    v_mfma_f32_16x16x32_bf16 v[112:115], v[60:63], v[40:43], v[112:115]
    ds_read_b64_tr_b16 v[92:93], v14 offset:27776
    v_mfma_f32_16x16x32_bf16 v[116:119], v[60:63], v[44:47], v[116:119]
    ds_read_b64_tr_b16 v[94:95], v14 offset:32384
    v_mfma_f32_16x16x32_bf16 v[120:123], v[60:63], v[48:51], v[120:123]
    v_mfma_f32_16x16x32_bf16 v[124:127], v[60:63], v[52:55], v[124:127]
    v_mfma_f32_16x16x32_bf16 v[192:195], v[80:83], v[40:43], v[192:195]
    v_mfma_f32_16x16x32_bf16 v[196:199], v[80:83], v[44:47], v[196:199]
    v_mfma_f32_16x16x32_bf16 v[200:203], v[80:83], v[48:51], v[200:203]
    v_mfma_f32_16x16x32_bf16 v[204:207], v[80:83], v[52:55], v[204:207]
    s_waitcnt lgkmcnt(0)
    s_barrier
    v_mfma_f32_16x16x32_bf16 v[128:131], v[64:67], v[40:43], v[128:131]
    ds_read_b64_tr_b16 v[60:61], v17 offset:32
    v_mfma_f32_16x16x32_bf16 v[132:135], v[64:67], v[44:47], v[132:135]
    ds_read_b64_tr_b16 v[62:63], v17 offset:4640
    v_mfma_f32_16x16x32_bf16 v[136:139], v[64:67], v[48:51], v[136:139]
    ds_read_b64_tr_b16 v[80:81], v17 offset:18464
    v_mfma_f32_16x16x32_bf16 v[140:143], v[64:67], v[52:55], v[140:143]
    ds_read_b64_tr_b16 v[82:83], v17 offset:23072
    v_mfma_f32_16x16x32_bf16 v[208:211], v[84:87], v[40:43], v[208:211]
    ds_read_b64_tr_b16 v[64:65], v17 offset:64
    v_mfma_f32_16x16x32_bf16 v[212:215], v[84:87], v[44:47], v[212:215]
    ds_read_b64_tr_b16 v[66:67], v17 offset:4672
    v_mfma_f32_16x16x32_bf16 v[216:219], v[84:87], v[48:51], v[216:219]
    ds_read_b128 v[24:27], v15 offset:0
    v_mfma_f32_16x16x32_bf16 v[220:223], v[84:87], v[52:55], v[220:223]
    ds_read_b128 v[28:31], v15 offset:2048
    v_mfma_f32_16x16x32_bf16 v[104:107], v[56:59], v[48:51], v[104:107]
    ds_read_b64_tr_b16 v[84:85], v17 offset:18496
    v_mfma_f32_16x16x32_bf16 v[108:111], v[56:59], v[52:55], v[108:111]
    ds_read_b64_tr_b16 v[86:87], v17 offset:23104
    v_mfma_f32_16x16x32_bf16 v[184:187], v[76:79], v[48:51], v[184:187]
    ds_read_b128 v[32:35], v15 offset:4096
    v_mfma_f32_16x16x32_bf16 v[188:191], v[76:79], v[52:55], v[188:191]
    ds_read_b128 v[36:39], v15 offset:6144
    v_mfma_f32_16x16x32_bf16 v[144:147], v[68:71], v[40:43], v[144:147]
    ds_read_b64_tr_b16 v[56:57], v17 offset:0
    v_mfma_f32_16x16x32_bf16 v[148:151], v[68:71], v[44:47], v[148:151]
    ds_read_b64_tr_b16 v[58:59], v17 offset:4608
    v_mfma_f32_16x16x32_bf16 v[152:155], v[68:71], v[48:51], v[152:155]
    ds_read_b64_tr_b16 v[76:77], v17 offset:18432
    v_mfma_f32_16x16x32_bf16 v[156:159], v[68:71], v[52:55], v[156:159]
    ds_read_b64_tr_b16 v[78:79], v17 offset:23040
    v_mfma_f32_16x16x32_bf16 v[224:227], v[88:91], v[40:43], v[224:227]
    ds_read_b64_tr_b16 v[68:69], v17 offset:96
    v_mfma_f32_16x16x32_bf16 v[228:231], v[88:91], v[44:47], v[228:231]
    ds_read_b64_tr_b16 v[70:71], v17 offset:4704
    v_mfma_f32_16x16x32_bf16 v[232:235], v[88:91], v[48:51], v[232:235]
    v_mfma_f32_16x16x32_bf16 v[236:239], v[88:91], v[52:55], v[236:239]
    v_mfma_f32_16x16x32_bf16 v[160:163], v[72:75], v[40:43], v[160:163]
    ds_read_b64_tr_b16 v[88:89], v17 offset:18528
    v_mfma_f32_16x16x32_bf16 v[164:167], v[72:75], v[44:47], v[164:167]
    ds_read_b64_tr_b16 v[90:91], v17 offset:23136
    v_mfma_f32_16x16x32_bf16 v[168:171], v[72:75], v[48:51], v[168:171]
    v_mfma_f32_16x16x32_bf16 v[172:175], v[72:75], v[52:55], v[172:175]
    v_mfma_f32_16x16x32_bf16 v[240:243], v[92:95], v[40:43], v[240:243]
    ds_read_b64_tr_b16 v[72:73], v17 offset:128
    v_mfma_f32_16x16x32_bf16 v[244:247], v[92:95], v[44:47], v[244:247]
    ds_read_b64_tr_b16 v[74:75], v17 offset:4736
    v_mfma_f32_16x16x32_bf16 v[248:251], v[92:95], v[48:51], v[248:251]
    v_mfma_f32_16x16x32_bf16 v[252:255], v[92:95], v[52:55], v[252:255]
    s_waitcnt lgkmcnt(10)
    v_mfma_f32_16x16x32_bf16 v[112:115], v[60:63], v[24:27], v[112:115]
    ds_read_b64_tr_b16 v[92:93], v17 offset:18560
    v_mfma_f32_16x16x32_bf16 v[116:119], v[60:63], v[28:31], v[116:119]
    ds_read_b64_tr_b16 v[94:95], v17 offset:23168
    v_mfma_f32_16x16x32_bf16 v[120:123], v[60:63], v[32:35], v[120:123]
    v_mfma_f32_16x16x32_bf16 v[124:127], v[60:63], v[36:39], v[124:127]
    v_mfma_f32_16x16x32_bf16 v[192:195], v[80:83], v[24:27], v[192:195]
    ds_read_b64_tr_b16 v[60:61], v17 offset:9248
    v_mfma_f32_16x16x32_bf16 v[196:199], v[80:83], v[28:31], v[196:199]
    ds_read_b64_tr_b16 v[62:63], v17 offset:13856
    v_mfma_f32_16x16x32_bf16 v[200:203], v[80:83], v[32:35], v[200:203]
    v_mfma_f32_16x16x32_bf16 v[204:207], v[80:83], v[36:39], v[204:207]
    v_mfma_f32_16x16x32_bf16 v[128:131], v[64:67], v[24:27], v[128:131]
    ds_read_b64_tr_b16 v[80:81], v17 offset:27680
    v_mfma_f32_16x16x32_bf16 v[132:135], v[64:67], v[28:31], v[132:135]
    ds_read_b64_tr_b16 v[82:83], v17 offset:32288
    v_mfma_f32_16x16x32_bf16 v[136:139], v[64:67], v[32:35], v[136:139]
    v_mfma_f32_16x16x32_bf16 v[140:143], v[64:67], v[36:39], v[140:143]
    v_mfma_f32_16x16x32_bf16 v[208:211], v[84:87], v[24:27], v[208:211]
    ds_read_b64_tr_b16 v[64:65], v17 offset:9280
    v_mfma_f32_16x16x32_bf16 v[212:215], v[84:87], v[28:31], v[212:215]
    ds_read_b64_tr_b16 v[66:67], v17 offset:13888
    v_mfma_f32_16x16x32_bf16 v[216:219], v[84:87], v[32:35], v[216:219]
    ds_read_b128 v[40:43], v16 offset:0
    v_mfma_f32_16x16x32_bf16 v[220:223], v[84:87], v[36:39], v[220:223]
    ds_read_b128 v[44:47], v16 offset:2048
    s_waitcnt lgkmcnt(12)
    v_mfma_f32_16x16x32_bf16 v[104:107], v[56:59], v[32:35], v[104:107]
    ds_read_b64_tr_b16 v[84:85], v17 offset:27712
    v_mfma_f32_16x16x32_bf16 v[108:111], v[56:59], v[36:39], v[108:111]
    ds_read_b64_tr_b16 v[86:87], v17 offset:32320
    v_mfma_f32_16x16x32_bf16 v[184:187], v[76:79], v[32:35], v[184:187]
    ds_read_b128 v[48:51], v16 offset:4096
    v_mfma_f32_16x16x32_bf16 v[188:191], v[76:79], v[36:39], v[188:191]
    ds_read_b128 v[52:55], v16 offset:6144
    v_mfma_f32_16x16x32_bf16 v[144:147], v[68:71], v[24:27], v[144:147]
    ds_read_b64_tr_b16 v[56:57], v17 offset:9216
    v_mfma_f32_16x16x32_bf16 v[148:151], v[68:71], v[28:31], v[148:151]
    ds_read_b64_tr_b16 v[58:59], v17 offset:13824
    v_mfma_f32_16x16x32_bf16 v[152:155], v[68:71], v[32:35], v[152:155]
    ds_read_b64_tr_b16 v[76:77], v17 offset:27648
    v_mfma_f32_16x16x32_bf16 v[156:159], v[68:71], v[36:39], v[156:159]
    ds_read_b64_tr_b16 v[78:79], v17 offset:32256
    v_mfma_f32_16x16x32_bf16 v[224:227], v[88:91], v[24:27], v[224:227]
    ds_read_b64_tr_b16 v[68:69], v17 offset:9312
    v_mfma_f32_16x16x32_bf16 v[228:231], v[88:91], v[28:31], v[228:231]
    ds_read_b64_tr_b16 v[70:71], v17 offset:13920
    v_mfma_f32_16x16x32_bf16 v[232:235], v[88:91], v[32:35], v[232:235]
    v_mfma_f32_16x16x32_bf16 v[236:239], v[88:91], v[36:39], v[236:239]
    s_waitcnt lgkmcnt(12)
    v_mfma_f32_16x16x32_bf16 v[160:163], v[72:75], v[24:27], v[160:163]
    ds_read_b64_tr_b16 v[88:89], v17 offset:27744
    v_mfma_f32_16x16x32_bf16 v[164:167], v[72:75], v[28:31], v[164:167]
    ds_read_b64_tr_b16 v[90:91], v17 offset:32352
    v_mfma_f32_16x16x32_bf16 v[168:171], v[72:75], v[32:35], v[168:171]
    v_mfma_f32_16x16x32_bf16 v[172:175], v[72:75], v[36:39], v[172:175]
    v_mfma_f32_16x16x32_bf16 v[240:243], v[92:95], v[24:27], v[240:243]
    ds_read_b64_tr_b16 v[72:73], v17 offset:9344
    v_mfma_f32_16x16x32_bf16 v[244:247], v[92:95], v[28:31], v[244:247]
    ds_read_b64_tr_b16 v[74:75], v17 offset:13952
    v_mfma_f32_16x16x32_bf16 v[248:251], v[92:95], v[32:35], v[248:251]
    v_mfma_f32_16x16x32_bf16 v[252:255], v[92:95], v[36:39], v[252:255]
    s_waitcnt lgkmcnt(10)
    v_mfma_f32_16x16x32_bf16 v[112:115], v[60:63], v[40:43], v[112:115]
    ds_read_b64_tr_b16 v[92:93], v17 offset:27776
    v_mfma_f32_16x16x32_bf16 v[116:119], v[60:63], v[44:47], v[116:119]
    ds_read_b64_tr_b16 v[94:95], v17 offset:32384
    v_mfma_f32_16x16x32_bf16 v[120:123], v[60:63], v[48:51], v[120:123]
    v_mfma_f32_16x16x32_bf16 v[124:127], v[60:63], v[52:55], v[124:127]
    v_mfma_f32_16x16x32_bf16 v[192:195], v[80:83], v[40:43], v[192:195]
    v_mfma_f32_16x16x32_bf16 v[196:199], v[80:83], v[44:47], v[196:199]
    v_mfma_f32_16x16x32_bf16 v[200:203], v[80:83], v[48:51], v[200:203]
    v_mfma_f32_16x16x32_bf16 v[204:207], v[80:83], v[52:55], v[204:207]
    s_waitcnt lgkmcnt(0)
    s_barrier
    v_mfma_f32_16x16x32_bf16 v[128:131], v[64:67], v[40:43], v[128:131]
    ds_read_b64_tr_b16 v[60:61], v11 offset:32
    v_mfma_f32_16x16x32_bf16 v[132:135], v[64:67], v[44:47], v[132:135]
    ds_read_b64_tr_b16 v[62:63], v11 offset:4640
    v_mfma_f32_16x16x32_bf16 v[136:139], v[64:67], v[48:51], v[136:139]
    ds_read_b64_tr_b16 v[80:81], v11 offset:18464
    v_mfma_f32_16x16x32_bf16 v[140:143], v[64:67], v[52:55], v[140:143]
    ds_read_b64_tr_b16 v[82:83], v11 offset:23072
    v_mfma_f32_16x16x32_bf16 v[208:211], v[84:87], v[40:43], v[208:211]
    ds_read_b64_tr_b16 v[64:65], v11 offset:64
    v_mfma_f32_16x16x32_bf16 v[212:215], v[84:87], v[44:47], v[212:215]
    ds_read_b64_tr_b16 v[66:67], v11 offset:4672
    v_mfma_f32_16x16x32_bf16 v[216:219], v[84:87], v[48:51], v[216:219]
    ds_read_b128 v[24:27], v9 offset:0
    v_mfma_f32_16x16x32_bf16 v[220:223], v[84:87], v[52:55], v[220:223]
    ds_read_b128 v[28:31], v9 offset:2048
    v_mfma_f32_16x16x32_bf16 v[104:107], v[56:59], v[48:51], v[104:107]
    ds_read_b64_tr_b16 v[84:85], v11 offset:18496
    v_mfma_f32_16x16x32_bf16 v[108:111], v[56:59], v[52:55], v[108:111]
    ds_read_b64_tr_b16 v[86:87], v11 offset:23104
    v_mfma_f32_16x16x32_bf16 v[184:187], v[76:79], v[48:51], v[184:187]
    ds_read_b128 v[32:35], v9 offset:4096
    v_mfma_f32_16x16x32_bf16 v[188:191], v[76:79], v[52:55], v[188:191]
    ds_read_b128 v[36:39], v9 offset:6144
    v_mfma_f32_16x16x32_bf16 v[144:147], v[68:71], v[40:43], v[144:147]
    ds_read_b64_tr_b16 v[56:57], v11 offset:0
    v_mfma_f32_16x16x32_bf16 v[148:151], v[68:71], v[44:47], v[148:151]
    ds_read_b64_tr_b16 v[58:59], v11 offset:4608
    v_mfma_f32_16x16x32_bf16 v[152:155], v[68:71], v[48:51], v[152:155]
    ds_read_b64_tr_b16 v[76:77], v11 offset:18432
    v_mfma_f32_16x16x32_bf16 v[156:159], v[68:71], v[52:55], v[156:159]
    ds_read_b64_tr_b16 v[78:79], v11 offset:23040
    v_mfma_f32_16x16x32_bf16 v[224:227], v[88:91], v[40:43], v[224:227]
    ds_read_b64_tr_b16 v[68:69], v11 offset:96
    v_mfma_f32_16x16x32_bf16 v[228:231], v[88:91], v[44:47], v[228:231]
    ds_read_b64_tr_b16 v[70:71], v11 offset:4704
    v_mfma_f32_16x16x32_bf16 v[232:235], v[88:91], v[48:51], v[232:235]
    v_mfma_f32_16x16x32_bf16 v[236:239], v[88:91], v[52:55], v[236:239]
    v_mfma_f32_16x16x32_bf16 v[160:163], v[72:75], v[40:43], v[160:163]
    ds_read_b64_tr_b16 v[88:89], v11 offset:18528
    v_mfma_f32_16x16x32_bf16 v[164:167], v[72:75], v[44:47], v[164:167]
    ds_read_b64_tr_b16 v[90:91], v11 offset:23136
    v_mfma_f32_16x16x32_bf16 v[168:171], v[72:75], v[48:51], v[168:171]
    v_mfma_f32_16x16x32_bf16 v[172:175], v[72:75], v[52:55], v[172:175]
    v_mfma_f32_16x16x32_bf16 v[240:243], v[92:95], v[40:43], v[240:243]
    ds_read_b64_tr_b16 v[72:73], v11 offset:128
    v_mfma_f32_16x16x32_bf16 v[244:247], v[92:95], v[44:47], v[244:247]
    ds_read_b64_tr_b16 v[74:75], v11 offset:4736
    v_mfma_f32_16x16x32_bf16 v[248:251], v[92:95], v[48:51], v[248:251]
    v_mfma_f32_16x16x32_bf16 v[252:255], v[92:95], v[52:55], v[252:255]
    s_waitcnt lgkmcnt(10)
    v_mfma_f32_16x16x32_bf16 v[112:115], v[60:63], v[24:27], v[112:115]
    ds_read_b64_tr_b16 v[92:93], v11 offset:18560
    v_mfma_f32_16x16x32_bf16 v[116:119], v[60:63], v[28:31], v[116:119]
    ds_read_b64_tr_b16 v[94:95], v11 offset:23168
    v_mfma_f32_16x16x32_bf16 v[120:123], v[60:63], v[32:35], v[120:123]
    v_mfma_f32_16x16x32_bf16 v[124:127], v[60:63], v[36:39], v[124:127]
    v_mfma_f32_16x16x32_bf16 v[192:195], v[80:83], v[24:27], v[192:195]
    ds_read_b64_tr_b16 v[60:61], v11 offset:9248
    v_mfma_f32_16x16x32_bf16 v[196:199], v[80:83], v[28:31], v[196:199]
    ds_read_b64_tr_b16 v[62:63], v11 offset:13856
    v_mfma_f32_16x16x32_bf16 v[200:203], v[80:83], v[32:35], v[200:203]
    v_mfma_f32_16x16x32_bf16 v[204:207], v[80:83], v[36:39], v[204:207]
    v_mfma_f32_16x16x32_bf16 v[128:131], v[64:67], v[24:27], v[128:131]
    ds_read_b64_tr_b16 v[80:81], v11 offset:27680
    v_mfma_f32_16x16x32_bf16 v[132:135], v[64:67], v[28:31], v[132:135]
    ds_read_b64_tr_b16 v[82:83], v11 offset:32288
    v_mfma_f32_16x16x32_bf16 v[136:139], v[64:67], v[32:35], v[136:139]
    v_mfma_f32_16x16x32_bf16 v[140:143], v[64:67], v[36:39], v[140:143]
    v_mfma_f32_16x16x32_bf16 v[208:211], v[84:87], v[24:27], v[208:211]
    ds_read_b64_tr_b16 v[64:65], v11 offset:9280
    v_mfma_f32_16x16x32_bf16 v[212:215], v[84:87], v[28:31], v[212:215]
    ds_read_b64_tr_b16 v[66:67], v11 offset:13888
    v_mfma_f32_16x16x32_bf16 v[216:219], v[84:87], v[32:35], v[216:219]
    ds_read_b128 v[40:43], v10 offset:0
    v_mfma_f32_16x16x32_bf16 v[220:223], v[84:87], v[36:39], v[220:223]
    ds_read_b128 v[44:47], v10 offset:2048
    s_waitcnt lgkmcnt(12)
    v_mfma_f32_16x16x32_bf16 v[104:107], v[56:59], v[32:35], v[104:107]
    ds_read_b64_tr_b16 v[84:85], v11 offset:27712
    v_mfma_f32_16x16x32_bf16 v[108:111], v[56:59], v[36:39], v[108:111]
    ds_read_b64_tr_b16 v[86:87], v11 offset:32320
    v_mfma_f32_16x16x32_bf16 v[184:187], v[76:79], v[32:35], v[184:187]
    ds_read_b128 v[48:51], v10 offset:4096
    v_mfma_f32_16x16x32_bf16 v[188:191], v[76:79], v[36:39], v[188:191]
    ds_read_b128 v[52:55], v10 offset:6144
    v_mfma_f32_16x16x32_bf16 v[144:147], v[68:71], v[24:27], v[144:147]
    ds_read_b64_tr_b16 v[56:57], v11 offset:9216
    v_mfma_f32_16x16x32_bf16 v[148:151], v[68:71], v[28:31], v[148:151]
    ds_read_b64_tr_b16 v[58:59], v11 offset:13824
    v_mfma_f32_16x16x32_bf16 v[152:155], v[68:71], v[32:35], v[152:155]
    ds_read_b64_tr_b16 v[76:77], v11 offset:27648
    v_mfma_f32_16x16x32_bf16 v[156:159], v[68:71], v[36:39], v[156:159]
    ds_read_b64_tr_b16 v[78:79], v11 offset:32256
    v_mfma_f32_16x16x32_bf16 v[224:227], v[88:91], v[24:27], v[224:227]
    ds_read_b64_tr_b16 v[68:69], v11 offset:9312
    v_mfma_f32_16x16x32_bf16 v[228:231], v[88:91], v[28:31], v[228:231]
    ds_read_b64_tr_b16 v[70:71], v11 offset:13920
    v_mfma_f32_16x16x32_bf16 v[232:235], v[88:91], v[32:35], v[232:235]
    v_mfma_f32_16x16x32_bf16 v[236:239], v[88:91], v[36:39], v[236:239]
    s_waitcnt lgkmcnt(12)
    v_mfma_f32_16x16x32_bf16 v[160:163], v[72:75], v[24:27], v[160:163]
    ds_read_b64_tr_b16 v[88:89], v11 offset:27744
    v_mfma_f32_16x16x32_bf16 v[164:167], v[72:75], v[28:31], v[164:167]
    ds_read_b64_tr_b16 v[90:91], v11 offset:32352
    v_mfma_f32_16x16x32_bf16 v[168:171], v[72:75], v[32:35], v[168:171]
    v_mfma_f32_16x16x32_bf16 v[172:175], v[72:75], v[36:39], v[172:175]
    v_mfma_f32_16x16x32_bf16 v[240:243], v[92:95], v[24:27], v[240:243]
    ds_read_b64_tr_b16 v[72:73], v11 offset:9344
    v_mfma_f32_16x16x32_bf16 v[244:247], v[92:95], v[28:31], v[244:247]
    ds_read_b64_tr_b16 v[74:75], v11 offset:13952
    v_mfma_f32_16x16x32_bf16 v[248:251], v[92:95], v[32:35], v[248:251]
    v_mfma_f32_16x16x32_bf16 v[252:255], v[92:95], v[36:39], v[252:255]
    s_waitcnt lgkmcnt(10)
    v_mfma_f32_16x16x32_bf16 v[112:115], v[60:63], v[40:43], v[112:115]
    ds_read_b64_tr_b16 v[92:93], v11 offset:27776
    v_mfma_f32_16x16x32_bf16 v[116:119], v[60:63], v[44:47], v[116:119]
    ds_read_b64_tr_b16 v[94:95], v11 offset:32384
    v_mfma_f32_16x16x32_bf16 v[120:123], v[60:63], v[48:51], v[120:123]
    v_mfma_f32_16x16x32_bf16 v[124:127], v[60:63], v[52:55], v[124:127]
    v_mfma_f32_16x16x32_bf16 v[192:195], v[80:83], v[40:43], v[192:195]
    v_mfma_f32_16x16x32_bf16 v[196:199], v[80:83], v[44:47], v[196:199]
    v_mfma_f32_16x16x32_bf16 v[200:203], v[80:83], v[48:51], v[200:203]
    v_mfma_f32_16x16x32_bf16 v[204:207], v[80:83], v[52:55], v[204:207]
    s_waitcnt lgkmcnt(0)
    s_barrier
    v_mfma_f32_16x16x32_bf16 v[128:131], v[64:67], v[40:43], v[128:131]
    ds_read_b64_tr_b16 v[60:61], v14 offset:32
    v_mfma_f32_16x16x32_bf16 v[132:135], v[64:67], v[44:47], v[132:135]
    ds_read_b64_tr_b16 v[62:63], v14 offset:4640
    v_mfma_f32_16x16x32_bf16 v[136:139], v[64:67], v[48:51], v[136:139]
    ds_read_b64_tr_b16 v[80:81], v14 offset:18464
    v_mfma_f32_16x16x32_bf16 v[140:143], v[64:67], v[52:55], v[140:143]
    ds_read_b64_tr_b16 v[82:83], v14 offset:23072
    v_mfma_f32_16x16x32_bf16 v[208:211], v[84:87], v[40:43], v[208:211]
    ds_read_b64_tr_b16 v[64:65], v14 offset:64
    v_mfma_f32_16x16x32_bf16 v[212:215], v[84:87], v[44:47], v[212:215]
    ds_read_b64_tr_b16 v[66:67], v14 offset:4672
    v_mfma_f32_16x16x32_bf16 v[216:219], v[84:87], v[48:51], v[216:219]
    ds_read_b128 v[24:27], v12 offset:0
    v_mfma_f32_16x16x32_bf16 v[220:223], v[84:87], v[52:55], v[220:223]
    ds_read_b128 v[28:31], v12 offset:2048
    v_mfma_f32_16x16x32_bf16 v[104:107], v[56:59], v[48:51], v[104:107]
    ds_read_b64_tr_b16 v[84:85], v14 offset:18496
    v_mfma_f32_16x16x32_bf16 v[108:111], v[56:59], v[52:55], v[108:111]
    ds_read_b64_tr_b16 v[86:87], v14 offset:23104
    v_mfma_f32_16x16x32_bf16 v[184:187], v[76:79], v[48:51], v[184:187]
    ds_read_b128 v[32:35], v12 offset:4096
    v_mfma_f32_16x16x32_bf16 v[188:191], v[76:79], v[52:55], v[188:191]
    ds_read_b128 v[36:39], v12 offset:6144
    v_mfma_f32_16x16x32_bf16 v[144:147], v[68:71], v[40:43], v[144:147]
    ds_read_b64_tr_b16 v[56:57], v14 offset:0
    v_mfma_f32_16x16x32_bf16 v[148:151], v[68:71], v[44:47], v[148:151]
    ds_read_b64_tr_b16 v[58:59], v14 offset:4608
    v_mfma_f32_16x16x32_bf16 v[152:155], v[68:71], v[48:51], v[152:155]
    ds_read_b64_tr_b16 v[76:77], v14 offset:18432
    v_mfma_f32_16x16x32_bf16 v[156:159], v[68:71], v[52:55], v[156:159]
    ds_read_b64_tr_b16 v[78:79], v14 offset:23040
    v_mfma_f32_16x16x32_bf16 v[224:227], v[88:91], v[40:43], v[224:227]
    ds_read_b64_tr_b16 v[68:69], v14 offset:96
    v_mfma_f32_16x16x32_bf16 v[228:231], v[88:91], v[44:47], v[228:231]
    ds_read_b64_tr_b16 v[70:71], v14 offset:4704
    v_mfma_f32_16x16x32_bf16 v[232:235], v[88:91], v[48:51], v[232:235]
    v_mfma_f32_16x16x32_bf16 v[236:239], v[88:91], v[52:55], v[236:239]
    v_mfma_f32_16x16x32_bf16 v[160:163], v[72:75], v[40:43], v[160:163]
    ds_read_b64_tr_b16 v[88:89], v14 offset:18528
    v_mfma_f32_16x16x32_bf16 v[164:167], v[72:75], v[44:47], v[164:167]
    ds_read_b64_tr_b16 v[90:91], v14 offset:23136
    v_mfma_f32_16x16x32_bf16 v[168:171], v[72:75], v[48:51], v[168:171]
    v_mfma_f32_16x16x32_bf16 v[172:175], v[72:75], v[52:55], v[172:175]
    v_mfma_f32_16x16x32_bf16 v[240:243], v[92:95], v[40:43], v[240:243]
    ds_read_b64_tr_b16 v[72:73], v14 offset:128
    v_mfma_f32_16x16x32_bf16 v[244:247], v[92:95], v[44:47], v[244:247]
    ds_read_b64_tr_b16 v[74:75], v14 offset:4736
    v_mfma_f32_16x16x32_bf16 v[248:251], v[92:95], v[48:51], v[248:251]
    v_mfma_f32_16x16x32_bf16 v[252:255], v[92:95], v[52:55], v[252:255]
    s_waitcnt lgkmcnt(10)
    v_mfma_f32_16x16x32_bf16 v[112:115], v[60:63], v[24:27], v[112:115]
    ds_read_b64_tr_b16 v[92:93], v14 offset:18560
    v_mfma_f32_16x16x32_bf16 v[116:119], v[60:63], v[28:31], v[116:119]
    ds_read_b64_tr_b16 v[94:95], v14 offset:23168
    v_mfma_f32_16x16x32_bf16 v[120:123], v[60:63], v[32:35], v[120:123]
    v_mfma_f32_16x16x32_bf16 v[124:127], v[60:63], v[36:39], v[124:127]
    v_mfma_f32_16x16x32_bf16 v[192:195], v[80:83], v[24:27], v[192:195]
    ds_read_b64_tr_b16 v[60:61], v14 offset:9248
    v_mfma_f32_16x16x32_bf16 v[196:199], v[80:83], v[28:31], v[196:199]
    ds_read_b64_tr_b16 v[62:63], v14 offset:13856
    v_mfma_f32_16x16x32_bf16 v[200:203], v[80:83], v[32:35], v[200:203]
    v_mfma_f32_16x16x32_bf16 v[204:207], v[80:83], v[36:39], v[204:207]
    v_mfma_f32_16x16x32_bf16 v[128:131], v[64:67], v[24:27], v[128:131]
    ds_read_b64_tr_b16 v[80:81], v14 offset:27680
    v_mfma_f32_16x16x32_bf16 v[132:135], v[64:67], v[28:31], v[132:135]
    ds_read_b64_tr_b16 v[82:83], v14 offset:32288
    v_mfma_f32_16x16x32_bf16 v[136:139], v[64:67], v[32:35], v[136:139]
    v_mfma_f32_16x16x32_bf16 v[140:143], v[64:67], v[36:39], v[140:143]
    v_mfma_f32_16x16x32_bf16 v[208:211], v[84:87], v[24:27], v[208:211]
    ds_read_b64_tr_b16 v[64:65], v14 offset:9280
    v_mfma_f32_16x16x32_bf16 v[212:215], v[84:87], v[28:31], v[212:215]
    ds_read_b64_tr_b16 v[66:67], v14 offset:13888
    v_mfma_f32_16x16x32_bf16 v[216:219], v[84:87], v[32:35], v[216:219]
    ds_read_b128 v[40:43], v13 offset:0
    v_mfma_f32_16x16x32_bf16 v[220:223], v[84:87], v[36:39], v[220:223]
    ds_read_b128 v[44:47], v13 offset:2048
    s_waitcnt lgkmcnt(12)
    v_mfma_f32_16x16x32_bf16 v[104:107], v[56:59], v[32:35], v[104:107]
    ds_read_b64_tr_b16 v[84:85], v14 offset:27712
    v_mfma_f32_16x16x32_bf16 v[108:111], v[56:59], v[36:39], v[108:111]
    ds_read_b64_tr_b16 v[86:87], v14 offset:32320
    v_mfma_f32_16x16x32_bf16 v[184:187], v[76:79], v[32:35], v[184:187]
    ds_read_b128 v[48:51], v13 offset:4096
    v_mfma_f32_16x16x32_bf16 v[188:191], v[76:79], v[36:39], v[188:191]
    ds_read_b128 v[52:55], v13 offset:6144
    v_mfma_f32_16x16x32_bf16 v[144:147], v[68:71], v[24:27], v[144:147]
    ds_read_b64_tr_b16 v[56:57], v14 offset:9216
    v_mfma_f32_16x16x32_bf16 v[148:151], v[68:71], v[28:31], v[148:151]
    ds_read_b64_tr_b16 v[58:59], v14 offset:13824
    v_mfma_f32_16x16x32_bf16 v[152:155], v[68:71], v[32:35], v[152:155]
    ds_read_b64_tr_b16 v[76:77], v14 offset:27648
    v_mfma_f32_16x16x32_bf16 v[156:159], v[68:71], v[36:39], v[156:159]
    ds_read_b64_tr_b16 v[78:79], v14 offset:32256
    v_mfma_f32_16x16x32_bf16 v[224:227], v[88:91], v[24:27], v[224:227]
    ds_read_b64_tr_b16 v[68:69], v14 offset:9312
    v_mfma_f32_16x16x32_bf16 v[228:231], v[88:91], v[28:31], v[228:231]
    ds_read_b64_tr_b16 v[70:71], v14 offset:13920
    v_mfma_f32_16x16x32_bf16 v[232:235], v[88:91], v[32:35], v[232:235]
    v_mfma_f32_16x16x32_bf16 v[236:239], v[88:91], v[36:39], v[236:239]
    s_waitcnt lgkmcnt(12)
    v_mfma_f32_16x16x32_bf16 v[160:163], v[72:75], v[24:27], v[160:163]
    ds_read_b64_tr_b16 v[88:89], v14 offset:27744
    v_mfma_f32_16x16x32_bf16 v[164:167], v[72:75], v[28:31], v[164:167]
    ds_read_b64_tr_b16 v[90:91], v14 offset:32352
    v_mfma_f32_16x16x32_bf16 v[168:171], v[72:75], v[32:35], v[168:171]
    v_mfma_f32_16x16x32_bf16 v[172:175], v[72:75], v[36:39], v[172:175]
    v_mfma_f32_16x16x32_bf16 v[240:243], v[92:95], v[24:27], v[240:243]
    ds_read_b64_tr_b16 v[72:73], v14 offset:9344
    v_mfma_f32_16x16x32_bf16 v[244:247], v[92:95], v[28:31], v[244:247]
    ds_read_b64_tr_b16 v[74:75], v14 offset:13952
    v_mfma_f32_16x16x32_bf16 v[248:251], v[92:95], v[32:35], v[248:251]
    v_mfma_f32_16x16x32_bf16 v[252:255], v[92:95], v[36:39], v[252:255]
    s_waitcnt lgkmcnt(10)
    v_mfma_f32_16x16x32_bf16 v[112:115], v[60:63], v[40:43], v[112:115]
    ds_read_b64_tr_b16 v[92:93], v14 offset:27776
    v_mfma_f32_16x16x32_bf16 v[116:119], v[60:63], v[44:47], v[116:119]
    ds_read_b64_tr_b16 v[94:95], v14 offset:32384
    v_mfma_f32_16x16x32_bf16 v[120:123], v[60:63], v[48:51], v[120:123]
    v_mfma_f32_16x16x32_bf16 v[124:127], v[60:63], v[52:55], v[124:127]
    v_mfma_f32_16x16x32_bf16 v[192:195], v[80:83], v[40:43], v[192:195]
    v_mfma_f32_16x16x32_bf16 v[196:199], v[80:83], v[44:47], v[196:199]
    v_mfma_f32_16x16x32_bf16 v[200:203], v[80:83], v[48:51], v[200:203]
    v_mfma_f32_16x16x32_bf16 v[204:207], v[80:83], v[52:55], v[204:207]
    s_waitcnt lgkmcnt(0)
    s_barrier
    v_mfma_f32_16x16x32_bf16 v[128:131], v[64:67], v[40:43], v[128:131]
    ds_read_b128 v[60:63], v4 offset:1088
    v_mfma_f32_16x16x32_bf16 v[132:135], v[64:67], v[44:47], v[132:135]
    ds_read_b128 v[80:83], v4 offset:1664
    v_mfma_f32_16x16x32_bf16 v[136:139], v[64:67], v[48:51], v[136:139]
    ds_read_b32 v24, v3 offset:0
    v_mfma_f32_16x16x32_bf16 v[140:143], v[64:67], v[52:55], v[140:143]
    ds_read_b32 v25, v3 offset:512
    v_mfma_f32_16x16x32_bf16 v[208:211], v[84:87], v[40:43], v[208:211]
    ds_read_b128 v[64:67], v4 offset:1152
    v_mfma_f32_16x16x32_bf16 v[212:215], v[84:87], v[44:47], v[212:215]
    ds_read_b32 v26, v3 offset:64
    v_mfma_f32_16x16x32_bf16 v[216:219], v[84:87], v[48:51], v[216:219]
    ds_read_b32 v27, v3 offset:576
    v_mfma_f32_16x16x32_bf16 v[220:223], v[84:87], v[52:55], v[220:223]
    v_mfma_f32_16x16x32_bf16 v[104:107], v[56:59], v[48:51], v[104:107]
    ds_read_b128 v[84:87], v4 offset:1728
    v_mfma_f32_16x16x32_bf16 v[108:111], v[56:59], v[52:55], v[108:111]
    ds_read_b32 v28, v3 offset:128
    v_mfma_f32_16x16x32_bf16 v[184:187], v[76:79], v[48:51], v[184:187]
    ds_read_b32 v29, v3 offset:640
    v_mfma_f32_16x16x32_bf16 v[188:191], v[76:79], v[52:55], v[188:191]
    ds_read_b128 v[56:59], v4 offset:1024
    v_mfma_f32_16x16x32_bf16 v[144:147], v[68:71], v[40:43], v[144:147]
    ds_read_b32 v30, v3 offset:192
    v_mfma_f32_16x16x32_bf16 v[148:151], v[68:71], v[44:47], v[148:151]
    ds_read_b32 v31, v3 offset:704
    v_mfma_f32_16x16x32_bf16 v[152:155], v[68:71], v[48:51], v[152:155]
    ds_read_b128 v[76:79], v4 offset:1600
    v_mfma_f32_16x16x32_bf16 v[156:159], v[68:71], v[52:55], v[156:159]
    v_mfma_f32_16x16x32_bf16 v[224:227], v[88:91], v[40:43], v[224:227]
    ds_read_b128 v[68:71], v4 offset:1216
    v_mfma_f32_16x16x32_bf16 v[228:231], v[88:91], v[44:47], v[228:231]
    v_mfma_f32_16x16x32_bf16 v[232:235], v[88:91], v[48:51], v[232:235]
    v_mfma_f32_16x16x32_bf16 v[236:239], v[88:91], v[52:55], v[236:239]
    v_mfma_f32_16x16x32_bf16 v[160:163], v[72:75], v[40:43], v[160:163]
    ds_read_b128 v[88:91], v4 offset:1792
    v_mfma_f32_16x16x32_bf16 v[164:167], v[72:75], v[44:47], v[164:167]
    v_mfma_f32_16x16x32_bf16 v[168:171], v[72:75], v[48:51], v[168:171]
    v_mfma_f32_16x16x32_bf16 v[172:175], v[72:75], v[52:55], v[172:175]
    v_mfma_f32_16x16x32_bf16 v[240:243], v[92:95], v[40:43], v[240:243]
    ds_read_b128 v[72:75], v4 offset:1280
    v_mfma_f32_16x16x32_bf16 v[244:247], v[92:95], v[44:47], v[244:247]
    v_mfma_f32_16x16x32_bf16 v[248:251], v[92:95], v[48:51], v[248:251]
    v_mfma_f32_16x16x32_bf16 v[252:255], v[92:95], v[52:55], v[252:255]
    ds_read_b128 v[92:95], v4 offset:1856
    s_waitcnt lgkmcnt(5)
    v_mul_f32 v25, v25, v25
    v_mul_f32 v27, v27, v27
    v_mul_f32 v29, v29, v29
    v_mul_f32 v31, v31, v31
    v_pk_fma_f32 v[112:113], v[60:61], v[24:25], v[112:113] op_sel_hi:[1,0,1]
    v_pk_fma_f32 v[114:115], v[62:63], v[24:25], v[114:115] op_sel_hi:[1,0,1]
    v_pk_fma_f32 v[192:193], v[80:81], v[24:25], v[192:193] op_sel_hi:[1,0,1]
    v_pk_fma_f32 v[194:195], v[82:83], v[24:25], v[194:195] op_sel_hi:[1,0,1]
    v_max_f32 v112, 0, v112
    v_max_f32 v113, 0, v113
    v_max_f32 v114, 0, v114
    v_max_f32 v115, 0, v115
    v_pk_mul_f32 v[192:193], v[192:193], v[24:25] op_sel:[0,1] op_sel_hi:[1,1]
    v_pk_mul_f32 v[194:195], v[194:195], v[24:25] op_sel:[0,1] op_sel_hi:[1,1]
    v_pk_mul_f32 v[112:113], v[112:113], v[192:193]
    v_pk_mul_f32 v[114:115], v[114:115], v[194:195]
    v_pk_fma_f32 v[116:117], v[60:61], v[26:27], v[116:117] op_sel_hi:[1,0,1]
    v_pk_fma_f32 v[118:119], v[62:63], v[26:27], v[118:119] op_sel_hi:[1,0,1]
    v_pk_fma_f32 v[196:197], v[80:81], v[26:27], v[196:197] op_sel_hi:[1,0,1]
    v_pk_fma_f32 v[198:199], v[82:83], v[26:27], v[198:199] op_sel_hi:[1,0,1]
    v_max_f32 v116, 0, v116
    v_max_f32 v117, 0, v117
    v_max_f32 v118, 0, v118
    v_max_f32 v119, 0, v119
    v_pk_mul_f32 v[196:197], v[196:197], v[26:27] op_sel:[0,1] op_sel_hi:[1,1]
    v_pk_mul_f32 v[198:199], v[198:199], v[26:27] op_sel:[0,1] op_sel_hi:[1,1]
    v_pk_mul_f32 v[116:117], v[116:117], v[196:197]
    v_pk_mul_f32 v[118:119], v[118:119], v[198:199]
    v_cvt_pk_bf16_f32 v112, v112, v113
    v_cvt_pk_bf16_f32 v113, v114, v115
    v_cvt_pk_bf16_f32 v114, v116, v117
    v_cvt_pk_bf16_f32 v115, v118, v119
    s_nop 0
    v_permlane16_swap_b32 v112, v114
    v_permlane16_swap_b32 v113, v115
    buffer_store_dwordx4 v[112:115], v7, s[48:51], s61 offen offset:0 sc1
    v_pk_fma_f32 v[120:121], v[60:61], v[28:29], v[120:121] op_sel_hi:[1,0,1]
    v_pk_fma_f32 v[122:123], v[62:63], v[28:29], v[122:123] op_sel_hi:[1,0,1]
    v_pk_fma_f32 v[200:201], v[80:81], v[28:29], v[200:201] op_sel_hi:[1,0,1]
    v_pk_fma_f32 v[202:203], v[82:83], v[28:29], v[202:203] op_sel_hi:[1,0,1]
    v_max_f32 v120, 0, v120
    v_max_f32 v121, 0, v121
    v_max_f32 v122, 0, v122
    v_max_f32 v123, 0, v123
    v_pk_mul_f32 v[200:201], v[200:201], v[28:29] op_sel:[0,1] op_sel_hi:[1,1]
    v_pk_mul_f32 v[202:203], v[202:203], v[28:29] op_sel:[0,1] op_sel_hi:[1,1]
    v_pk_mul_f32 v[120:121], v[120:121], v[200:201]
    v_pk_mul_f32 v[122:123], v[122:123], v[202:203]
    v_pk_fma_f32 v[124:125], v[60:61], v[30:31], v[124:125] op_sel_hi:[1,0,1]
    v_pk_fma_f32 v[126:127], v[62:63], v[30:31], v[126:127] op_sel_hi:[1,0,1]
    v_pk_fma_f32 v[204:205], v[80:81], v[30:31], v[204:205] op_sel_hi:[1,0,1]
    v_pk_fma_f32 v[206:207], v[82:83], v[30:31], v[206:207] op_sel_hi:[1,0,1]
    v_max_f32 v124, 0, v124
    v_max_f32 v125, 0, v125
    v_max_f32 v126, 0, v126
    v_max_f32 v127, 0, v127
    v_pk_mul_f32 v[204:205], v[204:205], v[30:31] op_sel:[0,1] op_sel_hi:[1,1]
    v_pk_mul_f32 v[206:207], v[206:207], v[30:31] op_sel:[0,1] op_sel_hi:[1,1]
    v_pk_mul_f32 v[124:125], v[124:125], v[204:205]
    v_pk_mul_f32 v[126:127], v[126:127], v[206:207]
    v_cvt_pk_bf16_f32 v120, v120, v121
    v_cvt_pk_bf16_f32 v121, v122, v123
    v_cvt_pk_bf16_f32 v122, v124, v125
    v_cvt_pk_bf16_f32 v123, v126, v127
    s_nop 0
    v_permlane16_swap_b32 v120, v122
    v_permlane16_swap_b32 v121, v123
    buffer_store_dwordx4 v[120:123], v7, s[48:51], s61 offen offset:2048 sc1
    v_pk_fma_f32 v[128:129], v[64:65], v[24:25], v[128:129] op_sel_hi:[1,0,1]
    v_pk_fma_f32 v[130:131], v[66:67], v[24:25], v[130:131] op_sel_hi:[1,0,1]
    v_pk_fma_f32 v[208:209], v[84:85], v[24:25], v[208:209] op_sel_hi:[1,0,1]
    v_pk_fma_f32 v[210:211], v[86:87], v[24:25], v[210:211] op_sel_hi:[1,0,1]
    v_max_f32 v128, 0, v128
    v_max_f32 v129, 0, v129
    v_max_f32 v130, 0, v130
    v_max_f32 v131, 0, v131
    v_pk_mul_f32 v[208:209], v[208:209], v[24:25] op_sel:[0,1] op_sel_hi:[1,1]
    v_pk_mul_f32 v[210:211], v[210:211], v[24:25] op_sel:[0,1] op_sel_hi:[1,1]
    v_pk_mul_f32 v[128:129], v[128:129], v[208:209]
    v_pk_mul_f32 v[130:131], v[130:131], v[210:211]
    v_pk_fma_f32 v[132:133], v[64:65], v[26:27], v[132:133] op_sel_hi:[1,0,1]
    v_pk_fma_f32 v[134:135], v[66:67], v[26:27], v[134:135] op_sel_hi:[1,0,1]
    v_pk_fma_f32 v[212:213], v[84:85], v[26:27], v[212:213] op_sel_hi:[1,0,1]
    v_pk_fma_f32 v[214:215], v[86:87], v[26:27], v[214:215] op_sel_hi:[1,0,1]
    v_max_f32 v132, 0, v132
    v_max_f32 v133, 0, v133
    v_max_f32 v134, 0, v134
    v_max_f32 v135, 0, v135
    v_pk_mul_f32 v[212:213], v[212:213], v[26:27] op_sel:[0,1] op_sel_hi:[1,1]
    v_pk_mul_f32 v[214:215], v[214:215], v[26:27] op_sel:[0,1] op_sel_hi:[1,1]
    v_pk_mul_f32 v[132:133], v[132:133], v[212:213]
    v_pk_mul_f32 v[134:135], v[134:135], v[214:215]
    v_cvt_pk_bf16_f32 v128, v128, v129
    v_cvt_pk_bf16_f32 v129, v130, v131
    v_cvt_pk_bf16_f32 v130, v132, v133
    v_cvt_pk_bf16_f32 v131, v134, v135
    s_nop 0
    v_permlane16_swap_b32 v128, v130
    v_permlane16_swap_b32 v129, v131
    buffer_store_dwordx4 v[128:131], v7, s[48:51], s62 offen offset:0 sc1
    v_pk_fma_f32 v[136:137], v[64:65], v[28:29], v[136:137] op_sel_hi:[1,0,1]
    v_pk_fma_f32 v[138:139], v[66:67], v[28:29], v[138:139] op_sel_hi:[1,0,1]
    v_pk_fma_f32 v[216:217], v[84:85], v[28:29], v[216:217] op_sel_hi:[1,0,1]
    v_pk_fma_f32 v[218:219], v[86:87], v[28:29], v[218:219] op_sel_hi:[1,0,1]
    v_max_f32 v136, 0, v136
    v_max_f32 v137, 0, v137
    v_max_f32 v138, 0, v138
    v_max_f32 v139, 0, v139
    v_pk_mul_f32 v[216:217], v[216:217], v[28:29] op_sel:[0,1] op_sel_hi:[1,1]
    v_pk_mul_f32 v[218:219], v[218:219], v[28:29] op_sel:[0,1] op_sel_hi:[1,1]
    v_pk_mul_f32 v[136:137], v[136:137], v[216:217]
    v_pk_mul_f32 v[138:139], v[138:139], v[218:219]
    v_pk_fma_f32 v[140:141], v[64:65], v[30:31], v[140:141] op_sel_hi:[1,0,1]
    v_pk_fma_f32 v[142:143], v[66:67], v[30:31], v[142:143] op_sel_hi:[1,0,1]
    v_pk_fma_f32 v[220:221], v[84:85], v[30:31], v[220:221] op_sel_hi:[1,0,1]
    v_pk_fma_f32 v[222:223], v[86:87], v[30:31], v[222:223] op_sel_hi:[1,0,1]
    v_max_f32 v140, 0, v140
    v_max_f32 v141, 0, v141
    v_max_f32 v142, 0, v142
    v_max_f32 v143, 0, v143
    v_pk_mul_f32 v[220:221], v[220:221], v[30:31] op_sel:[0,1] op_sel_hi:[1,1]
    v_pk_mul_f32 v[222:223], v[222:223], v[30:31] op_sel:[0,1] op_sel_hi:[1,1]
    v_pk_mul_f32 v[140:141], v[140:141], v[220:221]
    v_pk_mul_f32 v[142:143], v[142:143], v[222:223]
    v_cvt_pk_bf16_f32 v136, v136, v137
    v_cvt_pk_bf16_f32 v137, v138, v139
    v_cvt_pk_bf16_f32 v138, v140, v141
    v_cvt_pk_bf16_f32 v139, v142, v143
    s_nop 0
    v_permlane16_swap_b32 v136, v138
    v_permlane16_swap_b32 v137, v139
    buffer_store_dwordx4 v[136:139], v7, s[48:51], s62 offen offset:2048 sc1
    s_waitcnt lgkmcnt(4)
    v_pk_fma_f32 v[104:105], v[56:57], v[28:29], v[104:105] op_sel_hi:[1,0,1]
    v_pk_fma_f32 v[106:107], v[58:59], v[28:29], v[106:107] op_sel_hi:[1,0,1]
    v_pk_fma_f32 v[184:185], v[76:77], v[28:29], v[184:185] op_sel_hi:[1,0,1]
    v_pk_fma_f32 v[186:187], v[78:79], v[28:29], v[186:187] op_sel_hi:[1,0,1]
    v_max_f32 v104, 0, v104
    v_max_f32 v105, 0, v105
    v_max_f32 v106, 0, v106
    v_max_f32 v107, 0, v107
    v_pk_mul_f32 v[184:185], v[184:185], v[28:29] op_sel:[0,1] op_sel_hi:[1,1]
    v_pk_mul_f32 v[186:187], v[186:187], v[28:29] op_sel:[0,1] op_sel_hi:[1,1]
    v_pk_mul_f32 v[104:105], v[104:105], v[184:185]
    v_pk_mul_f32 v[106:107], v[106:107], v[186:187]
    v_pk_fma_f32 v[108:109], v[56:57], v[30:31], v[108:109] op_sel_hi:[1,0,1]
    v_pk_fma_f32 v[110:111], v[58:59], v[30:31], v[110:111] op_sel_hi:[1,0,1]
    v_pk_fma_f32 v[188:189], v[76:77], v[30:31], v[188:189] op_sel_hi:[1,0,1]
    v_pk_fma_f32 v[190:191], v[78:79], v[30:31], v[190:191] op_sel_hi:[1,0,1]
    v_max_f32 v108, 0, v108
    v_max_f32 v109, 0, v109
    v_max_f32 v110, 0, v110
    v_max_f32 v111, 0, v111
    v_pk_mul_f32 v[188:189], v[188:189], v[30:31] op_sel:[0,1] op_sel_hi:[1,1]
    v_pk_mul_f32 v[190:191], v[190:191], v[30:31] op_sel:[0,1] op_sel_hi:[1,1]
    v_pk_mul_f32 v[108:109], v[108:109], v[188:189]
    v_pk_mul_f32 v[110:111], v[110:111], v[190:191]
    v_cvt_pk_bf16_f32 v104, v104, v105
    v_cvt_pk_bf16_f32 v105, v106, v107
    v_cvt_pk_bf16_f32 v106, v108, v109
    v_cvt_pk_bf16_f32 v107, v110, v111
    s_nop 0
    v_permlane16_swap_b32 v104, v106
    v_permlane16_swap_b32 v105, v107
    buffer_store_dwordx4 v[104:107], v7, s[48:51], s60 offen offset:2048 sc1
    s_waitcnt lgkmcnt(2)
    v_pk_fma_f32 v[144:145], v[68:69], v[24:25], v[144:145] op_sel_hi:[1,0,1]
    v_pk_fma_f32 v[146:147], v[70:71], v[24:25], v[146:147] op_sel_hi:[1,0,1]
    v_pk_fma_f32 v[224:225], v[88:89], v[24:25], v[224:225] op_sel_hi:[1,0,1]
    v_pk_fma_f32 v[226:227], v[90:91], v[24:25], v[226:227] op_sel_hi:[1,0,1]
    v_max_f32 v144, 0, v144
    v_max_f32 v145, 0, v145
    v_max_f32 v146, 0, v146
    v_max_f32 v147, 0, v147
    v_pk_mul_f32 v[224:225], v[224:225], v[24:25] op_sel:[0,1] op_sel_hi:[1,1]
    v_pk_mul_f32 v[226:227], v[226:227], v[24:25] op_sel:[0,1] op_sel_hi:[1,1]
    v_pk_mul_f32 v[144:145], v[144:145], v[224:225]
    v_pk_mul_f32 v[146:147], v[146:147], v[226:227]
    v_pk_fma_f32 v[148:149], v[68:69], v[26:27], v[148:149] op_sel_hi:[1,0,1]
    v_pk_fma_f32 v[150:151], v[70:71], v[26:27], v[150:151] op_sel_hi:[1,0,1]
    v_pk_fma_f32 v[228:229], v[88:89], v[26:27], v[228:229] op_sel_hi:[1,0,1]
    v_pk_fma_f32 v[230:231], v[90:91], v[26:27], v[230:231] op_sel_hi:[1,0,1]
    v_max_f32 v148, 0, v148
    v_max_f32 v149, 0, v149
    v_max_f32 v150, 0, v150
    v_max_f32 v151, 0, v151
    v_pk_mul_f32 v[228:229], v[228:229], v[26:27] op_sel:[0,1] op_sel_hi:[1,1]
    v_pk_mul_f32 v[230:231], v[230:231], v[26:27] op_sel:[0,1] op_sel_hi:[1,1]
    v_pk_mul_f32 v[148:149], v[148:149], v[228:229]
    v_pk_mul_f32 v[150:151], v[150:151], v[230:231]
    v_cvt_pk_bf16_f32 v144, v144, v145
    v_cvt_pk_bf16_f32 v145, v146, v147
    v_cvt_pk_bf16_f32 v146, v148, v149
    v_cvt_pk_bf16_f32 v147, v150, v151
    s_nop 0
    v_permlane16_swap_b32 v144, v146
    v_permlane16_swap_b32 v145, v147
    buffer_store_dwordx4 v[144:147], v7, s[48:51], s63 offen offset:0 sc1
    v_pk_fma_f32 v[152:153], v[68:69], v[28:29], v[152:153] op_sel_hi:[1,0,1]
    v_pk_fma_f32 v[154:155], v[70:71], v[28:29], v[154:155] op_sel_hi:[1,0,1]
    v_pk_fma_f32 v[232:233], v[88:89], v[28:29], v[232:233] op_sel_hi:[1,0,1]
    v_pk_fma_f32 v[234:235], v[90:91], v[28:29], v[234:235] op_sel_hi:[1,0,1]
    v_max_f32 v152, 0, v152
    v_max_f32 v153, 0, v153
    v_max_f32 v154, 0, v154
    v_max_f32 v155, 0, v155
    v_pk_mul_f32 v[232:233], v[232:233], v[28:29] op_sel:[0,1] op_sel_hi:[1,1]
    v_pk_mul_f32 v[234:235], v[234:235], v[28:29] op_sel:[0,1] op_sel_hi:[1,1]
    v_pk_mul_f32 v[152:153], v[152:153], v[232:233]
    v_pk_mul_f32 v[154:155], v[154:155], v[234:235]
    v_pk_fma_f32 v[156:157], v[68:69], v[30:31], v[156:157] op_sel_hi:[1,0,1]
    v_pk_fma_f32 v[158:159], v[70:71], v[30:31], v[158:159] op_sel_hi:[1,0,1]
    v_pk_fma_f32 v[236:237], v[88:89], v[30:31], v[236:237] op_sel_hi:[1,0,1]
    v_pk_fma_f32 v[238:239], v[90:91], v[30:31], v[238:239] op_sel_hi:[1,0,1]
    v_max_f32 v156, 0, v156
    v_max_f32 v157, 0, v157
    v_max_f32 v158, 0, v158
    v_max_f32 v159, 0, v159
    v_pk_mul_f32 v[236:237], v[236:237], v[30:31] op_sel:[0,1] op_sel_hi:[1,1]
    v_pk_mul_f32 v[238:239], v[238:239], v[30:31] op_sel:[0,1] op_sel_hi:[1,1]
    v_pk_mul_f32 v[156:157], v[156:157], v[236:237]
    v_pk_mul_f32 v[158:159], v[158:159], v[238:239]
    v_cvt_pk_bf16_f32 v152, v152, v153
    v_cvt_pk_bf16_f32 v153, v154, v155
    v_cvt_pk_bf16_f32 v154, v156, v157
    v_cvt_pk_bf16_f32 v155, v158, v159
    s_nop 0
    v_permlane16_swap_b32 v152, v154
    v_permlane16_swap_b32 v153, v155
    buffer_store_dwordx4 v[152:155], v7, s[48:51], s63 offen offset:2048 sc1
    s_waitcnt lgkmcnt(0)
    v_pk_fma_f32 v[160:161], v[72:73], v[24:25], v[160:161] op_sel_hi:[1,0,1]
    v_pk_fma_f32 v[162:163], v[74:75], v[24:25], v[162:163] op_sel_hi:[1,0,1]
    v_pk_fma_f32 v[240:241], v[92:93], v[24:25], v[240:241] op_sel_hi:[1,0,1]
    v_pk_fma_f32 v[242:243], v[94:95], v[24:25], v[242:243] op_sel_hi:[1,0,1]
    v_max_f32 v160, 0, v160
    v_max_f32 v161, 0, v161
    v_max_f32 v162, 0, v162
    v_max_f32 v163, 0, v163
    v_pk_mul_f32 v[240:241], v[240:241], v[24:25] op_sel:[0,1] op_sel_hi:[1,1]
    v_pk_mul_f32 v[242:243], v[242:243], v[24:25] op_sel:[0,1] op_sel_hi:[1,1]
    v_pk_mul_f32 v[160:161], v[160:161], v[240:241]
    v_pk_mul_f32 v[162:163], v[162:163], v[242:243]
    v_pk_fma_f32 v[164:165], v[72:73], v[26:27], v[164:165] op_sel_hi:[1,0,1]
    v_pk_fma_f32 v[166:167], v[74:75], v[26:27], v[166:167] op_sel_hi:[1,0,1]
    v_pk_fma_f32 v[244:245], v[92:93], v[26:27], v[244:245] op_sel_hi:[1,0,1]
    v_pk_fma_f32 v[246:247], v[94:95], v[26:27], v[246:247] op_sel_hi:[1,0,1]
    v_max_f32 v164, 0, v164
    v_max_f32 v165, 0, v165
    v_max_f32 v166, 0, v166
    v_max_f32 v167, 0, v167
    v_pk_mul_f32 v[244:245], v[244:245], v[26:27] op_sel:[0,1] op_sel_hi:[1,1]
    v_pk_mul_f32 v[246:247], v[246:247], v[26:27] op_sel:[0,1] op_sel_hi:[1,1]
    v_pk_mul_f32 v[164:165], v[164:165], v[244:245]
    v_pk_mul_f32 v[166:167], v[166:167], v[246:247]
    v_cvt_pk_bf16_f32 v160, v160, v161
    v_cvt_pk_bf16_f32 v161, v162, v163
    v_cvt_pk_bf16_f32 v162, v164, v165
    v_cvt_pk_bf16_f32 v163, v166, v167
    s_nop 0
    v_permlane16_swap_b32 v160, v162
    v_permlane16_swap_b32 v161, v163
    buffer_store_dwordx4 v[160:163], v7, s[48:51], s64 offen offset:0 sc1
    v_pk_fma_f32 v[168:169], v[72:73], v[28:29], v[168:169] op_sel_hi:[1,0,1]
    v_pk_fma_f32 v[170:171], v[74:75], v[28:29], v[170:171] op_sel_hi:[1,0,1]
    v_pk_fma_f32 v[248:249], v[92:93], v[28:29], v[248:249] op_sel_hi:[1,0,1]
    v_pk_fma_f32 v[250:251], v[94:95], v[28:29], v[250:251] op_sel_hi:[1,0,1]
    v_max_f32 v168, 0, v168
    v_max_f32 v169, 0, v169
    v_max_f32 v170, 0, v170
    v_max_f32 v171, 0, v171
    v_pk_mul_f32 v[248:249], v[248:249], v[28:29] op_sel:[0,1] op_sel_hi:[1,1]
    v_pk_mul_f32 v[250:251], v[250:251], v[28:29] op_sel:[0,1] op_sel_hi:[1,1]
    v_pk_mul_f32 v[168:169], v[168:169], v[248:249]
    v_pk_mul_f32 v[170:171], v[170:171], v[250:251]
    v_pk_fma_f32 v[172:173], v[72:73], v[30:31], v[172:173] op_sel_hi:[1,0,1]
    v_pk_fma_f32 v[174:175], v[74:75], v[30:31], v[174:175] op_sel_hi:[1,0,1]
    v_pk_fma_f32 v[252:253], v[92:93], v[30:31], v[252:253] op_sel_hi:[1,0,1]
    v_pk_fma_f32 v[254:255], v[94:95], v[30:31], v[254:255] op_sel_hi:[1,0,1]
    v_max_f32 v172, 0, v172
    v_max_f32 v173, 0, v173
    v_max_f32 v174, 0, v174
    v_max_f32 v175, 0, v175
    v_pk_mul_f32 v[252:253], v[252:253], v[30:31] op_sel:[0,1] op_sel_hi:[1,1]
    v_pk_mul_f32 v[254:255], v[254:255], v[30:31] op_sel:[0,1] op_sel_hi:[1,1]
    v_pk_mul_f32 v[172:173], v[172:173], v[252:253]
    v_pk_mul_f32 v[174:175], v[174:175], v[254:255]
    v_cvt_pk_bf16_f32 v168, v168, v169
    v_cvt_pk_bf16_f32 v169, v170, v171
    v_cvt_pk_bf16_f32 v170, v172, v173
    v_cvt_pk_bf16_f32 v171, v174, v175
    s_nop 0
    v_permlane16_swap_b32 v168, v170
    v_permlane16_swap_b32 v169, v171
    buffer_store_dwordx4 v[168:171], v7, s[48:51], s64 offen offset:2048 sc1
fz_mdone:
    v_mov_b32 v252, s29
    v_mov_b32 v253, s29
    v_mov_b32 v254, s29
    v_mov_b32 v255, s29
    v_mov_b32 v15, v8
    s_setprio 2
    s_add_u32 s56, s22, 0x1a00000
    s_addc_u32 s57, s23, 0
    s_mov_b32 s58, 0x200000
    s_mov_b32 s59, 0x00020000
    s_mov_b32 s42, s11
    s_lshl_b32 s43, s10, 2
    s_add_u32 s43, s43, s26
    s_lshl_b32 s45, s43, 6
    v_and_b32 v1, 31, v0
    v_lshrrev_b32 v2, 5, v0
    v_lshlrev_b32 v3, 4, v2
    v_lshlrev_b32 v8, 3, v2
    v_sub_u32 v8, v1, v8
    s_sub_u32 s37, s45, 256
    s_mov_b32 exec_lo, 0xffff0000
    s_mov_b32 exec_hi, 0xffff0000
    s_cmp_ge_i32 s37, 0
    s_cselect_b32 s40, 0x3f803f80, 0
    s_mov_b32 s41, s40
    v_pk_mov_b32 v[56:57], s[40:41], s[40:41]
    v_pk_mov_b32 v[58:59], s[40:41], s[40:41]
    v_pk_mov_b32 v[60:61], s[40:41], s[40:41]
    v_pk_mov_b32 v[62:63], s[40:41], s[40:41]
    s_cmp_ge_i32 s37, -32
    s_cselect_b32 s40, 0x3f803f80, 0
    s_mov_b32 s41, s40
    v_pk_mov_b32 v[64:65], s[40:41], s[40:41]
    v_pk_mov_b32 v[66:67], s[40:41], s[40:41]
    v_pk_mov_b32 v[68:69], s[40:41], s[40:41]
    v_pk_mov_b32 v[70:71], s[40:41], s[40:41]
    s_cmp_ge_i32 s37, -64
    s_cselect_b32 s40, 0x3f803f80, 0
    s_mov_b32 s41, s40
    v_pk_mov_b32 v[72:73], s[40:41], s[40:41]
    v_pk_mov_b32 v[74:75], s[40:41], s[40:41]
    v_pk_mov_b32 v[76:77], s[40:41], s[40:41]
    v_pk_mov_b32 v[78:79], s[40:41], s[40:41]
    s_cmp_ge_i32 s37, -96
    s_cselect_b32 s40, 0x3f803f80, 0
    s_mov_b32 s41, s40
    v_pk_mov_b32 v[80:81], s[40:41], s[40:41]
    v_pk_mov_b32 v[82:83], s[40:41], s[40:41]
    v_pk_mov_b32 v[84:85], s[40:41], s[40:41]
    v_pk_mov_b32 v[86:87], s[40:41], s[40:41]
    s_cmp_ge_i32 s37, -128
    s_cselect_b32 s40, 0x3f803f80, 0
    s_mov_b32 s41, s40
    v_pk_mov_b32 v[88:89], s[40:41], s[40:41]
    v_pk_mov_b32 v[90:91], s[40:41], s[40:41]
    v_pk_mov_b32 v[92:93], s[40:41], s[40:41]
    v_pk_mov_b32 v[94:95], s[40:41], s[40:41]
    s_cmp_ge_i32 s37, -160
    s_cselect_b32 s40, 0x3f803f80, 0
    s_mov_b32 s41, s40
    v_pk_mov_b32 v[96:97], s[40:41], s[40:41]
    v_pk_mov_b32 v[98:99], s[40:41], s[40:41]
    v_pk_mov_b32 v[100:101], s[40:41], s[40:41]
    v_pk_mov_b32 v[102:103], s[40:41], s[40:41]
    s_cmp_ge_i32 s37, -192
    s_cselect_b32 s40, 0x3f803f80, 0
    s_mov_b32 s41, s40
    v_pk_mov_b32 v[104:105], s[40:41], s[40:41]
    v_pk_mov_b32 v[106:107], s[40:41], s[40:41]
    v_pk_mov_b32 v[108:109], s[40:41], s[40:41]
    v_pk_mov_b32 v[110:111], s[40:41], s[40:41]
    s_cmp_ge_i32 s37, -224
    s_cselect_b32 s40, 0x3f803f80, 0
    s_mov_b32 s41, s40
    v_pk_mov_b32 v[112:113], s[40:41], s[40:41]
    v_pk_mov_b32 v[114:115], s[40:41], s[40:41]
    v_pk_mov_b32 v[116:117], s[40:41], s[40:41]
    v_pk_mov_b32 v[118:119], s[40:41], s[40:41]
    s_cmp_ge_i32 s37, -256
    s_cselect_b32 s40, 0x3f803f80, 0
    s_mov_b32 s41, s40
    v_pk_mov_b32 v[120:121], s[40:41], s[40:41]
    v_pk_mov_b32 v[122:123], s[40:41], s[40:41]
    v_pk_mov_b32 v[124:125], s[40:41], s[40:41]
    v_pk_mov_b32 v[126:127], s[40:41], s[40:41]
    s_cmp_ge_i32 s37, -288
    s_cselect_b32 s40, 0x3f803f80, 0
    s_mov_b32 s41, s40
    v_pk_mov_b32 v[128:129], s[40:41], s[40:41]
    v_pk_mov_b32 v[130:131], s[40:41], s[40:41]
    v_pk_mov_b32 v[132:133], s[40:41], s[40:41]
    v_pk_mov_b32 v[134:135], s[40:41], s[40:41]
    s_mov_b64 exec, -1
    s_lshl_b32 s40, s26, 11
    s_add_u32 s40, s40, 57344
    v_add_u32 v4, s40, v15
    v_and_b32 v5, 0x13, v1
    v_bfe_u32 v7, v1, 2, 1
    v_lshl_or_b32 v5, v7, 3, v5
    v_bfe_u32 v7, v1, 3, 1
    v_lshl_or_b32 v5, v7, 2, v5
    v_lshl_add_u32 v7, v5, 5, v3
    v_add_u32 v7, s40, v7
    v_and_b32 v12, 15, v1
    v_lshl_add_u32 v12, v2, 4, v12
    v_lshlrev_b32 v12, 4, v12
    v_lshrrev_b32 v13, 4, v1
    v_lshl_add_u32 v12, v13, 10, v12
    s_and_b32 s40, s42, 1
    s_lshl_b32 s40, s40, 9
    v_add_u32 v12, s40, v12
    s_lshr_b32 s46, s42, 1
    s_mul_i32 s46, s46, 131072
    s_lshl_b32 s40, s43, 12
    s_add_u32 s46, s46, s40
    v_cmp_le_i32 s[60:61], 0, v8
    v_cmp_le_i32 s[62:63], 1, v8
    v_cmp_le_i32 s[64:65], 2, v8
    v_cmp_le_i32 s[66:67], 3, v8
    v_cmp_le_i32 s[68:69], 4, v8
    v_cmp_le_i32 s[70:71], 5, v8
    v_cmp_le_i32 s[72:73], 6, v8
    v_cmp_le_i32 s[74:75], 7, v8
    v_cmp_le_i32 s[76:77], 16, v8
    v_cmp_le_i32 s[78:79], 17, v8
    v_cmp_le_i32 s[80:81], 18, v8
    v_cmp_le_i32 s[82:83], 19, v8
    v_cmp_le_i32 s[84:85], 20, v8
    v_cmp_le_i32 s[86:87], 21, v8
    v_cmp_le_i32 s[88:89], 22, v8
    v_cmp_le_i32 s[90:91], 23, v8
    v_mov_b32 v9, 0xffff
    v_mov_b32 v10, 0xffff0000
    v_cndmask_b32 v240, 0, v9, s[60:61]
    v_cndmask_b32 v11, 0, v10, s[62:63]
    v_or_b32 v240, v240, v11
    v_cndmask_b32 v241, 0, v9, s[64:65]
    v_cndmask_b32 v11, 0, v10, s[66:67]
    v_or_b32 v241, v241, v11
    v_cndmask_b32 v242, 0, v9, s[68:69]
    v_cndmask_b32 v11, 0, v10, s[70:71]
    v_or_b32 v242, v242, v11
    v_cndmask_b32 v243, 0, v9, s[72:73]
    v_cndmask_b32 v11, 0, v10, s[74:75]
    v_or_b32 v243, v243, v11
    v_cndmask_b32 v244, 0, v9, s[76:77]
    v_cndmask_b32 v11, 0, v10, s[78:79]
    v_or_b32 v244, v244, v11
    v_cndmask_b32 v245, 0, v9, s[80:81]
    v_cndmask_b32 v11, 0, v10, s[82:83]
    v_or_b32 v245, v245, v11
    v_cndmask_b32 v246, 0, v9, s[84:85]
    v_cndmask_b32 v11, 0, v10, s[86:87]
    v_or_b32 v246, v246, v11
    v_cndmask_b32 v247, 0, v9, s[88:89]
    v_cndmask_b32 v11, 0, v10, s[90:91]
    v_or_b32 v247, v247, v11
    s_waitcnt vmcnt(0)
    s_mov_b64 exec, 0xff
    buffer_store_dwordx4 v[252:255], v15, s[32:35], s31 offen sc1
    s_mov_b64 exec, -1
    s_lshl_b32 s3, s26, 2
    v_mov_b32 v14, s3
    ds_write_b32 v14, v252 offset:2320
    v_and_b32 v14, 3, v0
    v_lshlrev_b32 v14, 2, v14
    s_mov_b32 s3, 6000000
fz_msync:
    ds_read_b32 v13, v14 offset:2304
    s_waitcnt lgkmcnt(0)
    v_cmp_eq_u32 vcc, s29, v13
    s_sub_u32 s3, s3, 1
    s_cmp_eq_u32 s3, 0
    s_cbranch_scc1 fz_msync_ok
    s_cmp_eq_u64 vcc, -1
    s_cbranch_scc1 fz_msync_ok
    s_sleep 1
    s_branch fz_msync
fz_msync_ok:
    ds_read_b128 v[136:139], v4 offset:32768
    ds_read_b128 v[140:143], v4 offset:33792
    ds_read_b128 v[16:19], v4 offset:0
    ds_read_b128 v[20:23], v4 offset:1024
    ds_read_b128 v[24:27], v4 offset:2048
    ds_read_b128 v[28:31], v4 offset:3072
    ds_read_b128 v[32:35], v4 offset:4096
    ds_read_b128 v[36:39], v4 offset:5120
    ds_read_b128 v[40:43], v4 offset:6144
    ds_read_b128 v[44:47], v4 offset:7168
    ds_read_b128 v[48:51], v4 offset:8192
    ds_read_b128 v[52:55], v4 offset:9216
    s_mov_b32 exec_lo, 0xffff
    s_mov_b32 exec_hi, 0xffff
    s_waitcnt lgkmcnt(9)
    ds_read_b128 v[56:59], v7 offset:16384
    ds_read_b128 v[60:63], v7 offset:16896
    s_waitcnt lgkmcnt(10)
    ds_read_b128 v[64:67], v7 offset:17408
    ds_read_b128 v[68:71], v7 offset:17920
    s_waitcnt lgkmcnt(11)
    ds_read_b128 v[72:75], v7 offset:18432
    ds_read_b128 v[76:79], v7 offset:18944
    s_waitcnt lgkmcnt(12)
    ds_read_b128 v[80:83], v7 offset:19456
    ds_read_b128 v[84:87], v7 offset:19968
    s_waitcnt lgkmcnt(12)
    ds_read_b128 v[88:91], v7 offset:20480
    ds_read_b128 v[92:95], v7 offset:20992
    ds_read_b128 v[96:99], v7 offset:21504
    ds_read_b128 v[100:103], v7 offset:22016
    s_waitcnt lgkmcnt(12)
    ds_read_b128 v[104:107], v7 offset:22528
    ds_read_b128 v[108:111], v7 offset:23040
    ds_read_b128 v[112:115], v7 offset:23552
    ds_read_b128 v[116:119], v7 offset:24064
    ds_read_b128 v[120:123], v7 offset:24576
    ds_read_b128 v[124:127], v7 offset:25088
    ds_read_b128 v[128:131], v7 offset:25600
    ds_read_b128 v[132:135], v7 offset:26112
    s_mov_b64 exec, -1
    v_mfma_f32_32x32x16_bf16 v[144:159], v[20:23], v[136:139], 0
    v_mfma_f32_32x32x16_bf16 v[160:175], v[24:27], v[140:143], 0
    v_mfma_f32_32x32x16_bf16 v[208:223], v[16:19], v[136:139], 0
    v_mfma_f32_32x32x16_bf16 v[224:239], v[20:23], v[140:143], 0
    v_mfma_f32_32x32x16_bf16 v[176:191], v[24:27], v[136:139], 0
    s_nop 6
    v_mfma_f32_32x32x16_bf16 v[192:207], v[28:31], v[140:143], 0
    v_max_f32 v8, v144, v145
    v_max_f32 v9, v146, v147
    v_max3_f32 v8, v148, v149, v8
    v_max3_f32 v9, v150, v151, v9
    v_max3_f32 v8, v152, v153, v8
    v_max3_f32 v9, v154, v155, v9
    v_max3_f32 v8, v156, v157, v8
    v_max3_f32 v9, v158, v159, v9
    v_mfma_f32_32x32x16_bf16 v[144:159], v[28:31], v[136:139], 0
    v_max_f32 v10, v160, v161
    v_max_f32 v11, v162, v163
    v_max3_f32 v10, v164, v165, v10
    v_max3_f32 v11, v166, v167, v11
    v_max3_f32 v10, v168, v169, v10
    v_max3_f32 v11, v170, v171, v11
    v_max3_f32 v10, v172, v173, v10
    v_max3_f32 v11, v174, v175, v11
    v_mfma_f32_32x32x16_bf16 v[160:175], v[32:35], v[140:143], 0
    v_max3_f32 v8, v176, v177, v8
    v_max3_f32 v9, v178, v179, v9
    v_max3_f32 v8, v180, v181, v8
    v_max3_f32 v9, v182, v183, v9
    v_max3_f32 v8, v184, v185, v8
    v_max3_f32 v9, v186, v187, v9
    v_max3_f32 v8, v188, v189, v8
    v_max3_f32 v9, v190, v191, v9
    v_mfma_f32_32x32x16_bf16 v[176:191], v[48:51], v[136:139], 0
    v_max3_f32 v10, v192, v193, v10
    v_max3_f32 v11, v194, v195, v11
    v_max3_f32 v10, v196, v197, v10
    v_max3_f32 v11, v198, v199, v11
    v_max3_f32 v10, v200, v201, v10
    v_max3_f32 v11, v202, v203, v11
    v_max3_f32 v10, v204, v205, v10
    v_max3_f32 v11, v206, v207, v11
    v_mfma_f32_32x32x16_bf16 v[192:207], v[52:55], v[140:143], 0
    v_max3_f32 v8, v144, v145, v8
    v_max3_f32 v9, v146, v147, v9
    v_max3_f32 v8, v148, v149, v8
    v_max3_f32 v9, v150, v151, v9
    v_max3_f32 v8, v152, v153, v8
    v_max3_f32 v9, v154, v155, v9
    v_max3_f32 v8, v156, v157, v8
    v_max3_f32 v9, v158, v159, v9
    v_mfma_f32_32x32x16_bf16 v[144:159], v[32:35], v[136:139], 0
    v_max3_f32 v10, v160, v161, v10
    v_max3_f32 v11, v162, v163, v11
    v_max3_f32 v10, v164, v165, v10
    v_max3_f32 v11, v166, v167, v11
    v_max3_f32 v10, v168, v169, v10
    v_max3_f32 v11, v170, v171, v11
    v_max3_f32 v10, v172, v173, v10
    v_max3_f32 v11, v174, v175, v11
    v_mfma_f32_32x32x16_bf16 v[160:175], v[36:39], v[140:143], 0
    v_cndmask_b32 v176, v208, v176, s[60:61]
    v_cndmask_b32 v177, v209, v177, s[62:63]
    v_cndmask_b32 v178, v210, v178, s[64:65]
    v_cndmask_b32 v179, v211, v179, s[66:67]
    v_cndmask_b32 v180, v212, v180, s[68:69]
    v_cndmask_b32 v181, v213, v181, s[70:71]
    v_cndmask_b32 v182, v214, v182, s[72:73]
    v_cndmask_b32 v183, v215, v183, s[74:75]
    v_cndmask_b32 v184, v216, v184, s[76:77]
    v_cndmask_b32 v185, v217, v185, s[78:79]
    v_cndmask_b32 v186, v218, v186, s[80:81]
    v_cndmask_b32 v187, v219, v187, s[82:83]
    v_cndmask_b32 v188, v220, v188, s[84:85]
    v_cndmask_b32 v189, v221, v189, s[86:87]
    v_cndmask_b32 v190, v222, v190, s[88:89]
    v_cndmask_b32 v191, v223, v191, s[90:91]
    v_max3_f32 v8, v176, v177, v8
    v_max3_f32 v9, v178, v179, v9
    v_max3_f32 v8, v180, v181, v8
    v_max3_f32 v9, v182, v183, v9
    v_max3_f32 v8, v184, v185, v8
    v_max3_f32 v9, v186, v187, v9
    v_max3_f32 v8, v188, v189, v8
    v_max3_f32 v9, v190, v191, v9
    v_mfma_f32_32x32x16_bf16 v[176:191], v[36:39], v[136:139], 0
    v_cndmask_b32 v192, v224, v192, s[60:61]
    v_cndmask_b32 v193, v225, v193, s[62:63]
    v_cndmask_b32 v194, v226, v194, s[64:65]
    v_cndmask_b32 v195, v227, v195, s[66:67]
    v_cndmask_b32 v196, v228, v196, s[68:69]
    v_cndmask_b32 v197, v229, v197, s[70:71]
    v_cndmask_b32 v198, v230, v198, s[72:73]
    v_cndmask_b32 v199, v231, v199, s[74:75]
    v_cndmask_b32 v200, v232, v200, s[76:77]
    v_cndmask_b32 v201, v233, v201, s[78:79]
    v_cndmask_b32 v202, v234, v202, s[80:81]
    v_cndmask_b32 v203, v235, v203, s[82:83]
    v_cndmask_b32 v204, v236, v204, s[84:85]
    v_cndmask_b32 v205, v237, v205, s[86:87]
    v_cndmask_b32 v206, v238, v206, s[88:89]
    v_cndmask_b32 v207, v239, v207, s[90:91]
    v_max3_f32 v10, v192, v193, v10
    v_max3_f32 v11, v194, v195, v11
    v_max3_f32 v10, v196, v197, v10
    v_max3_f32 v11, v198, v199, v11
    v_max3_f32 v10, v200, v201, v10
    v_max3_f32 v11, v202, v203, v11
    v_max3_f32 v10, v204, v205, v10
    v_max3_f32 v11, v206, v207, v11
    v_mfma_f32_32x32x16_bf16 v[192:207], v[40:43], v[140:143], 0
    v_max3_f32 v8, v144, v145, v8
    v_max3_f32 v9, v146, v147, v9
    v_max3_f32 v8, v148, v149, v8
    v_max3_f32 v9, v150, v151, v9
    v_max3_f32 v8, v152, v153, v8
    v_max3_f32 v9, v154, v155, v9
    v_max3_f32 v8, v156, v157, v8
    v_max3_f32 v9, v158, v159, v9
    v_mfma_f32_32x32x16_bf16 v[144:159], v[40:43], v[136:139], 0
    v_max3_f32 v10, v160, v161, v10
    v_max3_f32 v11, v162, v163, v11
    v_max3_f32 v10, v164, v165, v10
    v_max3_f32 v11, v166, v167, v11
    v_max3_f32 v10, v168, v169, v10
    v_max3_f32 v11, v170, v171, v11
    v_max3_f32 v10, v172, v173, v10
    v_max3_f32 v11, v174, v175, v11
    v_mfma_f32_32x32x16_bf16 v[160:175], v[44:47], v[140:143], 0
    v_max3_f32 v8, v176, v177, v8
    v_max3_f32 v9, v178, v179, v9
    v_max3_f32 v8, v180, v181, v8
    v_max3_f32 v9, v182, v183, v9
    v_max3_f32 v8, v184, v185, v8
    v_max3_f32 v9, v186, v187, v9
    v_max3_f32 v8, v188, v189, v8
    v_max3_f32 v9, v190, v191, v9
    v_mfma_f32_32x32x16_bf16 v[176:191], v[44:47], v[136:139], 0
    v_max3_f32 v10, v192, v193, v10
    v_max3_f32 v11, v194, v195, v11
    v_max3_f32 v10, v196, v197, v10
    v_max3_f32 v11, v198, v199, v11
    v_max3_f32 v10, v200, v201, v10
    v_max3_f32 v11, v202, v203, v11
    v_max3_f32 v10, v204, v205, v10
    v_max3_f32 v11, v206, v207, v11
    v_mfma_f32_32x32x16_bf16 v[192:207], v[48:51], v[140:143], 0
    v_max3_f32 v8, v144, v145, v8
    v_max3_f32 v9, v146, v147, v9
    v_max3_f32 v8, v148, v149, v8
    v_max3_f32 v9, v150, v151, v9
    v_max3_f32 v8, v152, v153, v8
    v_max3_f32 v9, v154, v155, v9
    v_max3_f32 v8, v156, v157, v8
    v_max3_f32 v9, v158, v159, v9
    v_max3_f32 v10, v160, v161, v10
    v_max3_f32 v11, v162, v163, v11
    v_max3_f32 v10, v164, v165, v10
    v_max3_f32 v11, v166, v167, v11
    v_max3_f32 v10, v168, v169, v10
    v_max3_f32 v11, v170, v171, v11
    v_max3_f32 v10, v172, v173, v10
    v_max3_f32 v11, v174, v175, v11
    v_max3_f32 v8, v176, v177, v8
    v_max3_f32 v9, v178, v179, v9
    v_max3_f32 v8, v180, v181, v8
    v_max3_f32 v9, v182, v183, v9
    v_max3_f32 v8, v184, v185, v8
    v_max3_f32 v9, v186, v187, v9
    v_max3_f32 v8, v188, v189, v8
    v_max3_f32 v9, v190, v191, v9
    v_max3_f32 v10, v192, v193, v10
    v_max3_f32 v11, v194, v195, v11
    v_max3_f32 v10, v196, v197, v10
    v_max3_f32 v11, v198, v199, v11
    v_max3_f32 v10, v200, v201, v10
    v_max3_f32 v11, v202, v203, v11
    v_max3_f32 v10, v204, v205, v10
    v_max3_f32 v11, v206, v207, v11
    v_max_f32 v8, v8, v9
    v_max_f32 v10, v10, v11
    v_mov_b32 v9, v8
    v_mov_b32 v11, v10
    s_nop 0
    v_permlane32_swap_b32 v8, v9
    v_permlane32_swap_b32 v10, v11
    s_nop 0
    v_max_f32 v8, v8, v9
    v_max_f32 v10, v10, v11
    v_sub_f32 v8, 0, v8
    v_sub_f32 v10, 0, v10
    v_pk_mov_b32 v[192:193], v[8:9], v[8:9] op_sel:[0,0]
    v_pk_mov_b32 v[194:195], v[8:9], v[8:9] op_sel:[0,0]
    v_pk_mov_b32 v[196:197], v[8:9], v[8:9] op_sel:[0,0]
    v_pk_mov_b32 v[198:199], v[8:9], v[8:9] op_sel:[0,0]
    v_pk_mov_b32 v[200:201], v[8:9], v[8:9] op_sel:[0,0]
    v_pk_mov_b32 v[202:203], v[8:9], v[8:9] op_sel:[0,0]
    v_pk_mov_b32 v[204:205], v[8:9], v[8:9] op_sel:[0,0]
    v_pk_mov_b32 v[206:207], v[8:9], v[8:9] op_sel:[0,0]
    s_waitcnt lgkmcnt(0)
    s_lshl_b32 s3, s26, 2
    v_mov_b32 v13, s3
    ds_write_b32 v13, v252 offset:2336
    v_mfma_f32_32x32x16_bf16 v[144:159], v[48:51], v[136:139], v[192:207]
    v_mfma_f32_32x32x16_bf16 v[176:191], v[16:19], v[136:139], v[192:207]
    s_nop 9
    v_mfma_f32_32x32x16_bf16 v[160:175], v[20:23], v[136:139], v[192:207]
    s_nop 0
    v_cndmask_b32 v144, v176, v144, s[60:61]
    v_cndmask_b32 v145, v177, v145, s[62:63]
    v_cndmask_b32 v146, v178, v146, s[64:65]
    v_cndmask_b32 v147, v179, v147, s[66:67]
    v_cndmask_b32 v148, v180, v148, s[68:69]
    v_cndmask_b32 v149, v181, v149, s[70:71]
    v_cndmask_b32 v150, v182, v150, s[72:73]
    v_cndmask_b32 v151, v183, v151, s[74:75]
    v_cndmask_b32 v152, v184, v152, s[76:77]
    v_cndmask_b32 v153, v185, v153, s[78:79]
    v_cndmask_b32 v154, v186, v154, s[80:81]
    v_cndmask_b32 v155, v187, v155, s[82:83]
    v_cndmask_b32 v156, v188, v156, s[84:85]
    v_cndmask_b32 v157, v189, v157, s[86:87]
    v_cndmask_b32 v158, v190, v158, s[88:89]
    v_cndmask_b32 v159, v191, v159, s[90:91]
    v_exp_f32 v144, v144
    v_exp_f32 v145, v145
    v_exp_f32 v146, v146
    v_exp_f32 v147, v147
    v_exp_f32 v148, v148
    v_exp_f32 v149, v149
    v_exp_f32 v150, v150
    v_exp_f32 v151, v151
    v_exp_f32 v152, v152
    v_exp_f32 v153, v153
    v_exp_f32 v154, v154
    v_exp_f32 v155, v155
    v_exp_f32 v156, v156
    v_exp_f32 v157, v157
    v_exp_f32 v158, v158
    v_exp_f32 v159, v159
    v_cvt_pk_bf16_f32 v224, v144, v145
    v_cvt_pk_bf16_f32 v225, v146, v147
    v_cvt_pk_bf16_f32 v226, v148, v149
    v_cvt_pk_bf16_f32 v227, v150, v151
    v_cvt_pk_bf16_f32 v228, v152, v153
    v_cvt_pk_bf16_f32 v229, v154, v155
    v_cvt_pk_bf16_f32 v230, v156, v157
    v_cvt_pk_bf16_f32 v231, v158, v159
    v_bfi_b32 v232, v240, 0, v224
    v_and_b32 v224, v240, v224
    v_bfi_b32 v233, v241, 0, v225
    v_and_b32 v225, v241, v225
    v_bfi_b32 v234, v242, 0, v226
    v_and_b32 v226, v242, v226
    v_bfi_b32 v235, v243, 0, v227
    v_and_b32 v227, v243, v227
    v_bfi_b32 v236, v244, 0, v228
    v_and_b32 v228, v244, v228
    v_bfi_b32 v237, v245, 0, v229
    v_and_b32 v229, v245, v229
    v_bfi_b32 v238, v246, 0, v230
    v_and_b32 v230, v246, v230
    v_bfi_b32 v239, v247, 0, v231
    v_and_b32 v231, v247, v231
    v_mfma_f32_32x32x16_bf16 v[144:159], v[24:27], v[136:139], v[192:207]
    v_exp_f32 v160, v160
    v_exp_f32 v161, v161
    v_exp_f32 v162, v162
    v_mfma_f32_32x32x16_bf16 v[208:223], v[120:123], v[224:227], 0
    v_exp_f32 v163, v163
    v_exp_f32 v164, v164
    v_exp_f32 v165, v165
    v_exp_f32 v166, v166
    v_mfma_f32_32x32x16_bf16 v[208:223], v[124:127], v[228:231], v[208:223]
    v_exp_f32 v167, v167
    v_exp_f32 v168, v168
    v_exp_f32 v169, v169
    v_exp_f32 v170, v170
    v_mfma_f32_32x32x16_bf16 v[208:223], v[56:59], v[232:235], v[208:223]
    v_exp_f32 v171, v171
    v_exp_f32 v172, v172
    v_exp_f32 v173, v173
    v_exp_f32 v174, v174
    v_mfma_f32_32x32x16_bf16 v[208:223], v[60:63], v[236:239], v[208:223]
    v_exp_f32 v175, v175
    v_cvt_pk_bf16_f32 v224, v160, v161
    v_cvt_pk_bf16_f32 v225, v162, v163
    v_cvt_pk_bf16_f32 v226, v164, v165
    v_cvt_pk_bf16_f32 v227, v166, v167
    v_cvt_pk_bf16_f32 v228, v168, v169
    v_cvt_pk_bf16_f32 v229, v170, v171
    v_cvt_pk_bf16_f32 v230, v172, v173
    v_cvt_pk_bf16_f32 v231, v174, v175
    v_mfma_f32_32x32x16_bf16 v[160:175], v[28:31], v[136:139], v[192:207]
    v_exp_f32 v144, v144
    v_exp_f32 v145, v145
    v_exp_f32 v146, v146
    v_exp_f32 v147, v147
    v_exp_f32 v148, v148
    v_exp_f32 v149, v149
    v_mfma_f32_32x32x16_bf16 v[208:223], v[64:67], v[224:227], v[208:223]
    v_exp_f32 v150, v150
    v_exp_f32 v151, v151
    v_exp_f32 v152, v152
    v_exp_f32 v153, v153
    v_exp_f32 v154, v154
    v_exp_f32 v155, v155
    v_mfma_f32_32x32x16_bf16 v[208:223], v[68:71], v[228:231], v[208:223]
    v_exp_f32 v156, v156
    v_exp_f32 v157, v157
    v_exp_f32 v158, v158
    v_exp_f32 v159, v159
    v_cvt_pk_bf16_f32 v224, v144, v145
    v_cvt_pk_bf16_f32 v225, v146, v147
    v_cvt_pk_bf16_f32 v226, v148, v149
    v_cvt_pk_bf16_f32 v227, v150, v151
    v_cvt_pk_bf16_f32 v228, v152, v153
    v_cvt_pk_bf16_f32 v229, v154, v155
    v_cvt_pk_bf16_f32 v230, v156, v157
    v_cvt_pk_bf16_f32 v231, v158, v159
    v_mfma_f32_32x32x16_bf16 v[144:159], v[32:35], v[136:139], v[192:207]
    v_exp_f32 v160, v160
    v_exp_f32 v161, v161
    v_exp_f32 v162, v162
    v_exp_f32 v163, v163
    v_exp_f32 v164, v164
    v_exp_f32 v165, v165
    v_mfma_f32_32x32x16_bf16 v[208:223], v[72:75], v[224:227], v[208:223]
    v_exp_f32 v166, v166
    v_exp_f32 v167, v167
    v_exp_f32 v168, v168
    v_exp_f32 v169, v169
    v_exp_f32 v170, v170
    v_exp_f32 v171, v171
    v_mfma_f32_32x32x16_bf16 v[208:223], v[76:79], v[228:231], v[208:223]
    v_exp_f32 v172, v172
    v_exp_f32 v173, v173
    v_exp_f32 v174, v174
    v_exp_f32 v175, v175
    v_cvt_pk_bf16_f32 v224, v160, v161
    v_cvt_pk_bf16_f32 v225, v162, v163
    v_cvt_pk_bf16_f32 v226, v164, v165
    v_cvt_pk_bf16_f32 v227, v166, v167
    v_cvt_pk_bf16_f32 v228, v168, v169
    v_cvt_pk_bf16_f32 v229, v170, v171
    v_cvt_pk_bf16_f32 v230, v172, v173
    v_cvt_pk_bf16_f32 v231, v174, v175
    v_mfma_f32_32x32x16_bf16 v[160:175], v[36:39], v[136:139], v[192:207]
    v_exp_f32 v144, v144
    v_exp_f32 v145, v145
    v_exp_f32 v146, v146
    v_exp_f32 v147, v147
    v_exp_f32 v148, v148
    v_exp_f32 v149, v149
    v_mfma_f32_32x32x16_bf16 v[208:223], v[80:83], v[224:227], v[208:223]
    v_exp_f32 v150, v150
    v_exp_f32 v151, v151
    v_exp_f32 v152, v152
    v_exp_f32 v153, v153
    v_exp_f32 v154, v154
    v_exp_f32 v155, v155
    v_mfma_f32_32x32x16_bf16 v[208:223], v[84:87], v[228:231], v[208:223]
    v_exp_f32 v156, v156
    v_exp_f32 v157, v157
    v_exp_f32 v158, v158
    v_exp_f32 v159, v159
    v_cvt_pk_bf16_f32 v224, v144, v145
    v_cvt_pk_bf16_f32 v225, v146, v147
    v_cvt_pk_bf16_f32 v226, v148, v149
    v_cvt_pk_bf16_f32 v227, v150, v151
    v_cvt_pk_bf16_f32 v228, v152, v153
    v_cvt_pk_bf16_f32 v229, v154, v155
    v_cvt_pk_bf16_f32 v230, v156, v157
    v_cvt_pk_bf16_f32 v231, v158, v159
    v_mfma_f32_32x32x16_bf16 v[144:159], v[40:43], v[136:139], v[192:207]
    v_exp_f32 v160, v160
    v_exp_f32 v161, v161
    v_exp_f32 v162, v162
    v_exp_f32 v163, v163
    v_exp_f32 v164, v164
    v_exp_f32 v165, v165
    v_mfma_f32_32x32x16_bf16 v[208:223], v[88:91], v[224:227], v[208:223]
    v_exp_f32 v166, v166
    v_exp_f32 v167, v167
    v_exp_f32 v168, v168
    v_exp_f32 v169, v169
    v_exp_f32 v170, v170
    v_exp_f32 v171, v171
    v_mfma_f32_32x32x16_bf16 v[208:223], v[92:95], v[228:231], v[208:223]
    v_exp_f32 v172, v172
    v_exp_f32 v173, v173
    v_exp_f32 v174, v174
    v_exp_f32 v175, v175
    v_cvt_pk_bf16_f32 v224, v160, v161
    v_cvt_pk_bf16_f32 v225, v162, v163
    v_cvt_pk_bf16_f32 v226, v164, v165
    v_cvt_pk_bf16_f32 v227, v166, v167
    v_cvt_pk_bf16_f32 v228, v168, v169
    v_cvt_pk_bf16_f32 v229, v170, v171
    v_cvt_pk_bf16_f32 v230, v172, v173
    v_cvt_pk_bf16_f32 v231, v174, v175
    v_mfma_f32_32x32x16_bf16 v[160:175], v[44:47], v[136:139], v[192:207]
    v_exp_f32 v144, v144
    v_exp_f32 v145, v145
    v_exp_f32 v146, v146
    v_exp_f32 v147, v147
    v_exp_f32 v148, v148
    v_exp_f32 v149, v149
    v_mfma_f32_32x32x16_bf16 v[208:223], v[96:99], v[224:227], v[208:223]
    v_exp_f32 v150, v150
    v_exp_f32 v151, v151
    v_exp_f32 v152, v152
    v_exp_f32 v153, v153
    v_exp_f32 v154, v154
    v_exp_f32 v155, v155
    v_mfma_f32_32x32x16_bf16 v[208:223], v[100:103], v[228:231], v[208:223]
    v_exp_f32 v156, v156
    v_exp_f32 v157, v157
    v_exp_f32 v158, v158
    v_exp_f32 v159, v159
    v_cvt_pk_bf16_f32 v224, v144, v145
    v_cvt_pk_bf16_f32 v225, v146, v147
    v_cvt_pk_bf16_f32 v226, v148, v149
    v_cvt_pk_bf16_f32 v227, v150, v151
    v_cvt_pk_bf16_f32 v228, v152, v153
    v_cvt_pk_bf16_f32 v229, v154, v155
    v_cvt_pk_bf16_f32 v230, v156, v157
    v_cvt_pk_bf16_f32 v231, v158, v159
    v_exp_f32 v160, v160
    v_exp_f32 v161, v161
    v_exp_f32 v162, v162
    v_exp_f32 v163, v163
    v_exp_f32 v164, v164
    v_exp_f32 v165, v165
    v_mfma_f32_32x32x16_bf16 v[208:223], v[104:107], v[224:227], v[208:223]
    v_exp_f32 v166, v166
    v_exp_f32 v167, v167
    v_exp_f32 v168, v168
    v_exp_f32 v169, v169
    v_exp_f32 v170, v170
    v_exp_f32 v171, v171
    v_mfma_f32_32x32x16_bf16 v[208:223], v[108:111], v[228:231], v[208:223]
    v_exp_f32 v172, v172
    v_pk_mov_b32 v[192:193], v[10:11], v[10:11] op_sel:[0,0]
    v_pk_mov_b32 v[194:195], v[10:11], v[10:11] op_sel:[0,0]
    v_pk_mov_b32 v[196:197], v[10:11], v[10:11] op_sel:[0,0]
    v_pk_mov_b32 v[198:199], v[10:11], v[10:11] op_sel:[0,0]
    v_pk_mov_b32 v[200:201], v[10:11], v[10:11] op_sel:[0,0]
    v_pk_mov_b32 v[202:203], v[10:11], v[10:11] op_sel:[0,0]
    v_pk_mov_b32 v[204:205], v[10:11], v[10:11] op_sel:[0,0]
    v_pk_mov_b32 v[206:207], v[10:11], v[10:11] op_sel:[0,0]
    v_exp_f32 v173, v173
    v_exp_f32 v174, v174
    v_exp_f32 v175, v175
    v_mfma_f32_32x32x16_bf16 v[144:159], v[52:55], v[140:143], v[192:207]
    v_mfma_f32_32x32x16_bf16 v[176:191], v[20:23], v[140:143], v[192:207]
    v_cvt_pk_bf16_f32 v224, v160, v161
    v_cvt_pk_bf16_f32 v225, v162, v163
    v_cvt_pk_bf16_f32 v226, v164, v165
    v_cvt_pk_bf16_f32 v227, v166, v167
    v_cvt_pk_bf16_f32 v228, v168, v169
    v_cvt_pk_bf16_f32 v229, v170, v171
    v_cvt_pk_bf16_f32 v230, v172, v173
    v_cvt_pk_bf16_f32 v231, v174, v175
    s_nop 2
    v_mfma_f32_32x32x16_bf16 v[160:175], v[24:27], v[140:143], v[192:207]
    v_cndmask_b32 v144, v176, v144, s[60:61]
    v_cndmask_b32 v145, v177, v145, s[62:63]
    v_cndmask_b32 v146, v178, v146, s[64:65]
    v_cndmask_b32 v147, v179, v147, s[66:67]
    v_mfma_f32_32x32x16_bf16 v[208:223], v[112:115], v[224:227], v[208:223]
    v_cndmask_b32 v148, v180, v148, s[68:69]
    v_cndmask_b32 v149, v181, v149, s[70:71]
    v_cndmask_b32 v150, v182, v150, s[72:73]
    v_cndmask_b32 v151, v183, v151, s[74:75]
    v_cndmask_b32 v152, v184, v152, s[76:77]
    v_cndmask_b32 v153, v185, v153, s[78:79]
    v_cndmask_b32 v154, v186, v154, s[80:81]
    v_cndmask_b32 v155, v187, v155, s[82:83]
    v_mfma_f32_32x32x16_bf16 v[208:223], v[116:119], v[228:231], v[208:223]
    v_cndmask_b32 v156, v188, v156, s[84:85]
    v_cndmask_b32 v157, v189, v157, s[86:87]
    v_cndmask_b32 v158, v190, v158, s[88:89]
    v_cndmask_b32 v159, v191, v159, s[90:91]
    v_exp_f32 v144, v144
    v_exp_f32 v145, v145
    v_exp_f32 v146, v146
    v_exp_f32 v147, v147
    v_exp_f32 v148, v148
    v_exp_f32 v149, v149
    v_exp_f32 v150, v150
    v_exp_f32 v151, v151
    v_exp_f32 v152, v152
    v_exp_f32 v153, v153
    v_exp_f32 v154, v154
    v_exp_f32 v155, v155
    v_exp_f32 v156, v156
    v_rcp_f32 v14, v216
    s_nop 0
    v_mul_f32 v208, v14, v208
    v_mul_f32 v209, v14, v209
    v_mul_f32 v210, v14, v210
    v_mul_f32 v211, v14, v211
    v_mul_f32 v212, v14, v212
    v_mul_f32 v213, v14, v213
    v_mul_f32 v214, v14, v214
    v_mul_f32 v215, v14, v215
    v_cvt_pk_bf16_f32 v248, v208, v209
    v_cvt_pk_bf16_f32 v249, v210, v211
    v_cvt_pk_bf16_f32 v250, v212, v213
    v_cvt_pk_bf16_f32 v251, v214, v215
    buffer_store_dwordx4 v[248:251], v12, s[56:59], s46 offen offset:0 sc1
    v_exp_f32 v157, v157
    v_exp_f32 v158, v158
    v_exp_f32 v159, v159
    v_cvt_pk_bf16_f32 v224, v144, v145
    v_cvt_pk_bf16_f32 v225, v146, v147
    v_cvt_pk_bf16_f32 v226, v148, v149
    v_cvt_pk_bf16_f32 v227, v150, v151
    v_cvt_pk_bf16_f32 v228, v152, v153
    v_cvt_pk_bf16_f32 v229, v154, v155
    v_cvt_pk_bf16_f32 v230, v156, v157
    v_cvt_pk_bf16_f32 v231, v158, v159
    v_bfi_b32 v232, v240, 0, v224
    v_and_b32 v224, v240, v224
    v_bfi_b32 v233, v241, 0, v225
    v_and_b32 v225, v241, v225
    v_bfi_b32 v234, v242, 0, v226
    v_and_b32 v226, v242, v226
    v_bfi_b32 v235, v243, 0, v227
    v_and_b32 v227, v243, v227
    v_bfi_b32 v236, v244, 0, v228
    v_and_b32 v228, v244, v228
    v_bfi_b32 v237, v245, 0, v229
    v_and_b32 v229, v245, v229
    v_bfi_b32 v238, v246, 0, v230
    v_and_b32 v230, v246, v230
    v_bfi_b32 v239, v247, 0, v231
    v_and_b32 v231, v247, v231
    v_mfma_f32_32x32x16_bf16 v[144:159], v[28:31], v[140:143], v[192:207]
    v_exp_f32 v160, v160
    v_exp_f32 v161, v161
    v_exp_f32 v162, v162
    v_mfma_f32_32x32x16_bf16 v[208:223], v[128:131], v[224:227], 0
    v_exp_f32 v163, v163
    v_exp_f32 v164, v164
    v_exp_f32 v165, v165
    v_exp_f32 v166, v166
    v_mfma_f32_32x32x16_bf16 v[208:223], v[132:135], v[228:231], v[208:223]
    v_exp_f32 v167, v167
    v_exp_f32 v168, v168
    v_exp_f32 v169, v169
    v_exp_f32 v170, v170
    v_mfma_f32_32x32x16_bf16 v[208:223], v[64:67], v[232:235], v[208:223]
    v_exp_f32 v171, v171
    v_exp_f32 v172, v172
    v_exp_f32 v173, v173
    v_exp_f32 v174, v174
    v_mfma_f32_32x32x16_bf16 v[208:223], v[68:71], v[236:239], v[208:223]
    v_exp_f32 v175, v175
    v_cvt_pk_bf16_f32 v224, v160, v161
    v_cvt_pk_bf16_f32 v225, v162, v163
    v_cvt_pk_bf16_f32 v226, v164, v165
    v_cvt_pk_bf16_f32 v227, v166, v167
    v_cvt_pk_bf16_f32 v228, v168, v169
    v_cvt_pk_bf16_f32 v229, v170, v171
    v_cvt_pk_bf16_f32 v230, v172, v173
    v_cvt_pk_bf16_f32 v231, v174, v175
    v_mfma_f32_32x32x16_bf16 v[160:175], v[32:35], v[140:143], v[192:207]
    v_exp_f32 v144, v144
    v_exp_f32 v145, v145
    v_exp_f32 v146, v146
    v_exp_f32 v147, v147
    v_exp_f32 v148, v148
    v_exp_f32 v149, v149
    v_mfma_f32_32x32x16_bf16 v[208:223], v[72:75], v[224:227], v[208:223]
    v_exp_f32 v150, v150
    v_exp_f32 v151, v151
    v_exp_f32 v152, v152
    v_exp_f32 v153, v153
    v_exp_f32 v154, v154
    v_exp_f32 v155, v155
    v_mfma_f32_32x32x16_bf16 v[208:223], v[76:79], v[228:231], v[208:223]
    v_exp_f32 v156, v156
    v_exp_f32 v157, v157
    v_exp_f32 v158, v158
    v_exp_f32 v159, v159
    v_cvt_pk_bf16_f32 v224, v144, v145
    v_cvt_pk_bf16_f32 v225, v146, v147
    v_cvt_pk_bf16_f32 v226, v148, v149
    v_cvt_pk_bf16_f32 v227, v150, v151
    v_cvt_pk_bf16_f32 v228, v152, v153
    v_cvt_pk_bf16_f32 v229, v154, v155
    v_cvt_pk_bf16_f32 v230, v156, v157
    v_cvt_pk_bf16_f32 v231, v158, v159
    v_mfma_f32_32x32x16_bf16 v[144:159], v[36:39], v[140:143], v[192:207]
    v_exp_f32 v160, v160
    v_exp_f32 v161, v161
    v_exp_f32 v162, v162
    v_exp_f32 v163, v163
    v_exp_f32 v164, v164
    v_exp_f32 v165, v165
    v_mfma_f32_32x32x16_bf16 v[208:223], v[80:83], v[224:227], v[208:223]
    v_exp_f32 v166, v166
    v_exp_f32 v167, v167
    v_exp_f32 v168, v168
    v_exp_f32 v169, v169
    v_exp_f32 v170, v170
    v_exp_f32 v171, v171
    v_mfma_f32_32x32x16_bf16 v[208:223], v[84:87], v[228:231], v[208:223]
    v_exp_f32 v172, v172
    v_exp_f32 v173, v173
    v_exp_f32 v174, v174
    v_exp_f32 v175, v175
    v_cvt_pk_bf16_f32 v224, v160, v161
    v_cvt_pk_bf16_f32 v225, v162, v163
    v_cvt_pk_bf16_f32 v226, v164, v165
    v_cvt_pk_bf16_f32 v227, v166, v167
    v_cvt_pk_bf16_f32 v228, v168, v169
    v_cvt_pk_bf16_f32 v229, v170, v171
    v_cvt_pk_bf16_f32 v230, v172, v173
    v_cvt_pk_bf16_f32 v231, v174, v175
    v_mfma_f32_32x32x16_bf16 v[160:175], v[40:43], v[140:143], v[192:207]
    v_exp_f32 v144, v144
    v_exp_f32 v145, v145
    v_exp_f32 v146, v146
    v_exp_f32 v147, v147
    v_exp_f32 v148, v148
    v_exp_f32 v149, v149
    v_mfma_f32_32x32x16_bf16 v[208:223], v[88:91], v[224:227], v[208:223]
    v_exp_f32 v150, v150
    v_exp_f32 v151, v151
    v_exp_f32 v152, v152
    v_exp_f32 v153, v153
    v_exp_f32 v154, v154
    v_exp_f32 v155, v155
    v_mfma_f32_32x32x16_bf16 v[208:223], v[92:95], v[228:231], v[208:223]
    v_exp_f32 v156, v156
    v_exp_f32 v157, v157
    v_exp_f32 v158, v158
    v_exp_f32 v159, v159
    v_cvt_pk_bf16_f32 v224, v144, v145
    v_cvt_pk_bf16_f32 v225, v146, v147
    v_cvt_pk_bf16_f32 v226, v148, v149
    v_cvt_pk_bf16_f32 v227, v150, v151
    v_cvt_pk_bf16_f32 v228, v152, v153
    v_cvt_pk_bf16_f32 v229, v154, v155
    v_cvt_pk_bf16_f32 v230, v156, v157
    v_cvt_pk_bf16_f32 v231, v158, v159
    v_mfma_f32_32x32x16_bf16 v[144:159], v[44:47], v[140:143], v[192:207]
    v_exp_f32 v160, v160
    v_exp_f32 v161, v161
    v_exp_f32 v162, v162
    v_exp_f32 v163, v163
    v_exp_f32 v164, v164
    v_exp_f32 v165, v165
    v_mfma_f32_32x32x16_bf16 v[208:223], v[96:99], v[224:227], v[208:223]
    v_exp_f32 v166, v166
    v_exp_f32 v167, v167
    v_exp_f32 v168, v168
    v_exp_f32 v169, v169
    v_exp_f32 v170, v170
    v_exp_f32 v171, v171
    v_mfma_f32_32x32x16_bf16 v[208:223], v[100:103], v[228:231], v[208:223]
    v_exp_f32 v172, v172
    v_exp_f32 v173, v173
    v_exp_f32 v174, v174
    v_exp_f32 v175, v175
    v_cvt_pk_bf16_f32 v224, v160, v161
    v_cvt_pk_bf16_f32 v225, v162, v163
    v_cvt_pk_bf16_f32 v226, v164, v165
    v_cvt_pk_bf16_f32 v227, v166, v167
    v_cvt_pk_bf16_f32 v228, v168, v169
    v_cvt_pk_bf16_f32 v229, v170, v171
    v_cvt_pk_bf16_f32 v230, v172, v173
    v_cvt_pk_bf16_f32 v231, v174, v175
    v_mfma_f32_32x32x16_bf16 v[160:175], v[48:51], v[140:143], v[192:207]
    v_exp_f32 v144, v144
    v_exp_f32 v145, v145
    v_exp_f32 v146, v146
    v_exp_f32 v147, v147
    v_exp_f32 v148, v148
    v_exp_f32 v149, v149
    v_mfma_f32_32x32x16_bf16 v[208:223], v[104:107], v[224:227], v[208:223]
    v_exp_f32 v150, v150
    v_exp_f32 v151, v151
    v_exp_f32 v152, v152
    v_exp_f32 v153, v153
    v_exp_f32 v154, v154
    v_exp_f32 v155, v155
    v_mfma_f32_32x32x16_bf16 v[208:223], v[108:111], v[228:231], v[208:223]
    v_exp_f32 v156, v156
    v_exp_f32 v157, v157
    v_exp_f32 v158, v158
    v_exp_f32 v159, v159
    v_cvt_pk_bf16_f32 v224, v144, v145
    v_cvt_pk_bf16_f32 v225, v146, v147
    v_cvt_pk_bf16_f32 v226, v148, v149
    v_cvt_pk_bf16_f32 v227, v150, v151
    v_cvt_pk_bf16_f32 v228, v152, v153
    v_cvt_pk_bf16_f32 v229, v154, v155
    v_cvt_pk_bf16_f32 v230, v156, v157
    v_cvt_pk_bf16_f32 v231, v158, v159
    v_exp_f32 v160, v160
    v_exp_f32 v161, v161
    v_exp_f32 v162, v162
    v_exp_f32 v163, v163
    v_exp_f32 v164, v164
    v_exp_f32 v165, v165
    v_mfma_f32_32x32x16_bf16 v[208:223], v[112:115], v[224:227], v[208:223]
    v_exp_f32 v166, v166
    v_exp_f32 v167, v167
    v_exp_f32 v168, v168
    v_exp_f32 v169, v169
    v_exp_f32 v170, v170
    v_exp_f32 v171, v171
    v_mfma_f32_32x32x16_bf16 v[208:223], v[116:119], v[228:231], v[208:223]
    v_exp_f32 v172, v172
    v_exp_f32 v173, v173
    v_exp_f32 v174, v174
    v_exp_f32 v175, v175
    v_cvt_pk_bf16_f32 v224, v160, v161
    v_cvt_pk_bf16_f32 v225, v162, v163
    v_cvt_pk_bf16_f32 v226, v164, v165
    v_cvt_pk_bf16_f32 v227, v166, v167
    v_cvt_pk_bf16_f32 v228, v168, v169
    v_cvt_pk_bf16_f32 v229, v170, v171
    v_cvt_pk_bf16_f32 v230, v172, v173
    v_cvt_pk_bf16_f32 v231, v174, v175
    s_nop 1
    v_mfma_f32_32x32x16_bf16 v[208:223], v[120:123], v[224:227], v[208:223]
    v_mfma_f32_32x32x16_bf16 v[208:223], v[124:127], v[228:231], v[208:223]
    s_nop 11
    v_rcp_f32 v14, v216
    s_nop 0
    v_mul_f32 v208, v14, v208
    v_mul_f32 v209, v14, v209
    v_mul_f32 v210, v14, v210
    v_mul_f32 v211, v14, v211
    v_mul_f32 v212, v14, v212
    v_mul_f32 v213, v14, v213
    v_mul_f32 v214, v14, v214
    v_mul_f32 v215, v14, v215
    v_cvt_pk_bf16_f32 v252, v208, v209
    v_cvt_pk_bf16_f32 v253, v210, v211
    v_cvt_pk_bf16_f32 v254, v212, v213
    v_cvt_pk_bf16_f32 v255, v214, v215
    buffer_store_dwordx4 v[252:255], v12, s[56:59], s46 offen offset:2048 sc1
    s_lshl_b32 s40, s43, 5
    s_add_u32 s40, s40, s42
    s_lshl_b32 s40, s40, 7
    s_add_u32 s40, s40, 524288
    v_lshlrev_b32 v3, 4, v0
    v_mov_b32 v4, s29
    v_mov_b32 v5, s29
    v_mov_b32 v6, s29
    v_mov_b32 v7, s29
    s_mov_b64 exec, 0xff
    s_waitcnt vmcnt(0)
    buffer_store_dwordx4 v[4:7], v3, s[32:35], s40 offen sc1
    s_mov_b64 exec, -1
    s_or_b32 s3, s2, s26
    s_cmp_lg_u32 s3, 0
    s_cbranch_scc1 fz_noep
    v_lshlrev_b32 v8, 9, v0
    v_add_u32 v8, 262144, v8
    s_mov_b32 s3, 300000
fz_pe0:
    buffer_load_dword v9, v8, s[32:35], 0 offen sc1
    s_waitcnt vmcnt(0)
    v_cmp_eq_u32 vcc, s29, v9
    s_sub_u32 s3, s3, 1
    s_cmp_eq_u32 s3, 0
    s_cbranch_scc1 fz_pe0_ok
    s_cmp_eq_u64 vcc, -1
    s_cbranch_scc1 fz_pe0_ok
    s_sleep 2
    s_branch fz_pe0
fz_pe0_ok:
    v_add_u32 v8, 0x8000, v8
    s_mov_b32 s3, 300000
fz_pe1:
    buffer_load_dword v9, v8, s[32:35], 0 offen sc1
    s_waitcnt vmcnt(0)
    v_cmp_eq_u32 vcc, s29, v9
    s_sub_u32 s3, s3, 1
    s_cmp_eq_u32 s3, 0
    s_cbranch_scc1 fz_pe1_ok
    s_cmp_eq_u64 vcc, -1
    s_cbranch_scc1 fz_pe1_ok
    s_sleep 2
    s_branch fz_pe1
fz_pe1_ok:
    v_add_u32 v8, 0x8000, v8
    s_mov_b32 s3, 300000
fz_pe2:
    buffer_load_dword v9, v8, s[32:35], 0 offen sc1
    s_waitcnt vmcnt(0)
    v_cmp_eq_u32 vcc, s29, v9
    s_sub_u32 s3, s3, 1
    s_cmp_eq_u32 s3, 0
    s_cbranch_scc1 fz_pe2_ok
    s_cmp_eq_u64 vcc, -1
    s_cbranch_scc1 fz_pe2_ok
    s_sleep 2
    s_branch fz_pe2
fz_pe2_ok:
    v_add_u32 v8, 0x8000, v8
    s_mov_b32 s3, 300000
fz_pe3:
    buffer_load_dword v9, v8, s[32:35], 0 offen sc1
    s_waitcnt vmcnt(0)
    v_cmp_eq_u32 vcc, s29, v9
    s_sub_u32 s3, s3, 1
    s_cmp_eq_u32 s3, 0
    s_cbranch_scc1 fz_pe3_ok
    s_cmp_eq_u64 vcc, -1
    s_cbranch_scc1 fz_pe3_ok
    s_sleep 2
    s_branch fz_pe3
fz_pe3_ok:
    v_add_u32 v8, 0x8000, v8
    s_add_u32 s3, s30, 1
    v_mov_b32 v9, s3
    v_mov_b32 v8, 0
    s_mov_b64 exec, 1
    buffer_store_dword v9, v8, s[32:35], 0 offen sc1
fz_noep:
    s_branch fz_end
fz_loader:
    s_sub_u32 s31, s26, 4
    s_setprio 3
    v_lshrrev_b32 v1, 3, v0
    v_and_b32 v2, 7, v0
    s_lshl_b32 s54, s24, 7
    s_lshl_b32 s55, s31, 5
    s_add_u32 s54, s54, s55
    v_lshrrev_b32 v4, 4, v0
    v_xor_b32 v4, v4, v2
    v_add_u32 v3, s54, v1
    v_lshlrev_b32 v3, 10, v3
    v_lshl_add_u32 v10, v4, 4, v3
    v_xor_b32 v11, 64, v10
    v_add_u32 v11, 0x2000, v11
    v_add_u32 v12, 0x4000, v10
    v_add_u32 v13, 0x4000, v11
    s_lshl_b32 s56, s31, 12
    s_add_u32 s56, s56, 4096
    s_mul_i32 s57, s31, 9216
    s_add_u32 s57, s57, 20480
    s_cmp_lt_u32 s25, 10
    s_cbranch_scc1 fz_lF
    s_movk_i32 s63, 3072
    s_lshr_b32 s54, s31, 1
    s_lshl_b32 s54, s54, 5
    s_and_b32 s55, s31, 1
    s_lshl_b32 s55, s55, 2
    s_add_u32 s54, s54, s55
    s_sub_u32 s55, s25, 10
    s_lshl_b32 s55, s55, 9
    s_movk_i32 s64, 1928
    v_mov_b32 v9, 0x7fff0000
    s_waitcnt lgkmcnt(0)
    s_mov_b32 s36, s4
    s_mov_b32 s37, s5
    s_mov_b32 s38, 0x200000
    s_mov_b32 s39, 0x00020000
    s_mov_b32 s40, s6
    s_mov_b32 s41, s7
    s_mov_b32 s42, 0x180000
    s_mov_b32 s43, 0x00020000
    s_add_u32 m0, s56, 0
    s_movk_i32 s58, 0
    buffer_load_dwordx4 v10, s[36:39], s58 offen lds
    s_add_u32 m0, s56, 1024
    s_movk_i32 s58, 0
    buffer_load_dwordx4 v11, s[36:39], s58 offen lds
    s_add_u32 m0, s56, 2048
    s_movk_i32 s58, 0
    buffer_load_dwordx4 v12, s[36:39], s58 offen lds
    s_add_u32 m0, s56, 3072
    s_movk_i32 s58, 0
    buffer_load_dwordx4 v13, s[36:39], s58 offen lds
    v_add_u32 v3, 0, v0
    v_mul_u32_u24 v4, s64, v3
    v_lshrrev_b32 v4, 16, v4
    v_mul_u32_u24 v5, 34, v4
    v_sub_u32 v5, v3, v5
    v_and_b32 v6, 3, v4
    v_bfe_u32 v7, v4, 2, 2
    v_lshl_add_u32 v6, v7, 3, v6
    v_add_u32 v6, s54, v6
    v_mul_u32_u24 v6, s63, v6
    v_lshl_add_u32 v6, v5, 4, v6
    v_cmp_gt_u32 vcc, 32, v5
    v_add_u32 v6, s55, v6
    v_cmp_gt_u32 s[60:61], 16, v4
    v_cndmask_b32 v6, v9, v6, vcc
    s_nop 0
    v_cndmask_b32 v14, v9, v6, s[60:61]
    s_add_u32 m0, s57, 0
    s_mov_b32 s58, 0
    buffer_load_dwordx4 v14, s[40:43], s58 offen lds
    v_add_u32 v3, 64, v0
    v_mul_u32_u24 v4, s64, v3
    v_lshrrev_b32 v4, 16, v4
    v_mul_u32_u24 v5, 34, v4
    v_sub_u32 v5, v3, v5
    v_and_b32 v6, 3, v4
    v_bfe_u32 v7, v4, 2, 2
    v_lshl_add_u32 v6, v7, 3, v6
    v_add_u32 v6, s54, v6
    v_mul_u32_u24 v6, s63, v6
    v_lshl_add_u32 v6, v5, 4, v6
    v_cmp_gt_u32 vcc, 32, v5
    v_add_u32 v6, s55, v6
    v_cmp_gt_u32 s[60:61], 16, v4
    v_cndmask_b32 v6, v9, v6, vcc
    s_nop 0
    v_cndmask_b32 v15, v9, v6, s[60:61]
    s_add_u32 m0, s57, 1024
    s_mov_b32 s58, 0
    buffer_load_dwordx4 v15, s[40:43], s58 offen lds
    v_add_u32 v3, 128, v0
    v_mul_u32_u24 v4, s64, v3
    v_lshrrev_b32 v4, 16, v4
    v_mul_u32_u24 v5, 34, v4
    v_sub_u32 v5, v3, v5
    v_and_b32 v6, 3, v4
    v_bfe_u32 v7, v4, 2, 2
    v_lshl_add_u32 v6, v7, 3, v6
    v_add_u32 v6, s54, v6
    v_mul_u32_u24 v6, s63, v6
    v_lshl_add_u32 v6, v5, 4, v6
    v_cmp_gt_u32 vcc, 32, v5
    v_add_u32 v6, s55, v6
    v_cmp_gt_u32 s[60:61], 16, v4
    v_cndmask_b32 v6, v9, v6, vcc
    s_nop 0
    v_cndmask_b32 v16, v9, v6, s[60:61]
    s_add_u32 m0, s57, 2048
    s_mov_b32 s58, 0
    buffer_load_dwordx4 v16, s[40:43], s58 offen lds
    v_add_u32 v3, 192, v0
    v_mul_u32_u24 v4, s64, v3
    v_lshrrev_b32 v4, 16, v4
    v_mul_u32_u24 v5, 34, v4
    v_sub_u32 v5, v3, v5
    v_and_b32 v6, 3, v4
    v_bfe_u32 v7, v4, 2, 2
    v_lshl_add_u32 v6, v7, 3, v6
    v_add_u32 v6, s54, v6
    v_mul_u32_u24 v6, s63, v6
    v_lshl_add_u32 v6, v5, 4, v6
    v_cmp_gt_u32 vcc, 32, v5
    v_add_u32 v6, s55, v6
    v_cmp_gt_u32 s[60:61], 16, v4
    v_cndmask_b32 v6, v9, v6, vcc
    s_nop 0
    v_cndmask_b32 v17, v9, v6, s[60:61]
    s_add_u32 m0, s57, 3072
    s_mov_b32 s58, 0
    buffer_load_dwordx4 v17, s[40:43], s58 offen lds
    v_add_u32 v3, 256, v0
    v_mul_u32_u24 v4, s64, v3
    v_lshrrev_b32 v4, 16, v4
    v_mul_u32_u24 v5, 34, v4
    v_sub_u32 v5, v3, v5
    v_and_b32 v6, 3, v4
    v_bfe_u32 v7, v4, 2, 2
    v_lshl_add_u32 v6, v7, 3, v6
    v_add_u32 v6, s54, v6
    v_mul_u32_u24 v6, s63, v6
    v_lshl_add_u32 v6, v5, 4, v6
    v_cmp_gt_u32 vcc, 32, v5
    v_add_u32 v6, s55, v6
    v_cmp_gt_u32 s[60:61], 16, v4
    v_cndmask_b32 v6, v9, v6, vcc
    s_nop 0
    v_cndmask_b32 v18, v9, v6, s[60:61]
    s_add_u32 m0, s57, 4096
    s_mov_b32 s58, 0
    buffer_load_dwordx4 v18, s[40:43], s58 offen lds
    v_add_u32 v3, 320, v0
    v_mul_u32_u24 v4, s64, v3
    v_lshrrev_b32 v4, 16, v4
    v_mul_u32_u24 v5, 34, v4
    v_sub_u32 v5, v3, v5
    v_and_b32 v6, 3, v4
    v_bfe_u32 v7, v4, 2, 2
    v_lshl_add_u32 v6, v7, 3, v6
    v_add_u32 v6, s54, v6
    v_mul_u32_u24 v6, s63, v6
    v_lshl_add_u32 v6, v5, 4, v6
    v_cmp_gt_u32 vcc, 32, v5
    v_add_u32 v6, s55, v6
    v_cmp_gt_u32 s[60:61], 16, v4
    v_cndmask_b32 v6, v9, v6, vcc
    s_nop 0
    v_cndmask_b32 v19, v9, v6, s[60:61]
    s_add_u32 m0, s57, 5120
    s_mov_b32 s58, 0
    buffer_load_dwordx4 v19, s[40:43], s58 offen lds
    v_add_u32 v3, 384, v0
    v_mul_u32_u24 v4, s64, v3
    v_lshrrev_b32 v4, 16, v4
    v_mul_u32_u24 v5, 34, v4
    v_sub_u32 v5, v3, v5
    v_and_b32 v6, 3, v4
    v_bfe_u32 v7, v4, 2, 2
    v_lshl_add_u32 v6, v7, 3, v6
    v_add_u32 v6, s54, v6
    v_mul_u32_u24 v6, s63, v6
    v_lshl_add_u32 v6, v5, 4, v6
    v_cmp_gt_u32 vcc, 32, v5
    v_add_u32 v6, s55, v6
    v_cmp_gt_u32 s[60:61], 16, v4
    v_cndmask_b32 v6, v9, v6, vcc
    s_nop 0
    v_cndmask_b32 v20, v9, v6, s[60:61]
    s_add_u32 m0, s57, 6144
    s_mov_b32 s58, 0
    buffer_load_dwordx4 v20, s[40:43], s58 offen lds
    v_add_u32 v3, 448, v0
    v_mul_u32_u24 v4, s64, v3
    v_lshrrev_b32 v4, 16, v4
    v_mul_u32_u24 v5, 34, v4
    v_sub_u32 v5, v3, v5
    v_and_b32 v6, 3, v4
    v_bfe_u32 v7, v4, 2, 2
    v_lshl_add_u32 v6, v7, 3, v6
    v_add_u32 v6, s54, v6
    v_mul_u32_u24 v6, s63, v6
    v_lshl_add_u32 v6, v5, 4, v6
    v_cmp_gt_u32 vcc, 32, v5
    v_add_u32 v6, s55, v6
    v_cmp_gt_u32 s[60:61], 16, v4
    v_cndmask_b32 v6, v9, v6, vcc
    s_nop 0
    v_cndmask_b32 v21, v9, v6, s[60:61]
    s_add_u32 m0, s57, 7168
    s_mov_b32 s58, 0
    buffer_load_dwordx4 v21, s[40:43], s58 offen lds
    v_add_u32 v3, 512, v0
    v_mul_u32_u24 v4, s64, v3
    v_lshrrev_b32 v4, 16, v4
    v_mul_u32_u24 v5, 34, v4
    v_sub_u32 v5, v3, v5
    v_and_b32 v6, 3, v4
    v_bfe_u32 v7, v4, 2, 2
    v_lshl_add_u32 v6, v7, 3, v6
    v_add_u32 v6, s54, v6
    v_mul_u32_u24 v6, s63, v6
    v_lshl_add_u32 v6, v5, 4, v6
    v_cmp_gt_u32 vcc, 32, v5
    v_add_u32 v6, s55, v6
    v_cmp_gt_u32 s[60:61], 16, v4
    v_cndmask_b32 v6, v9, v6, vcc
    s_nop 0
    v_cndmask_b32 v22, v9, v6, s[60:61]
    s_add_u32 m0, s57, 8192
    s_mov_b32 s58, 0
    buffer_load_dwordx4 v22, s[40:43], s58 offen lds
    s_add_u32 m0, s56, 53248
    s_movk_i32 s58, 128
    buffer_load_dwordx4 v10, s[36:39], s58 offen lds
    s_add_u32 m0, s56, 54272
    s_movk_i32 s58, 128
    buffer_load_dwordx4 v11, s[36:39], s58 offen lds
    s_add_u32 m0, s56, 55296
    s_movk_i32 s58, 128
    buffer_load_dwordx4 v12, s[36:39], s58 offen lds
    s_add_u32 m0, s56, 56320
    s_movk_i32 s58, 128
    buffer_load_dwordx4 v13, s[36:39], s58 offen lds
    s_add_u32 m0, s57, 53248
    s_mov_b32 s58, 196608
    buffer_load_dwordx4 v14, s[40:43], s58 offen lds
    s_add_u32 m0, s57, 54272
    s_mov_b32 s58, 196608
    buffer_load_dwordx4 v15, s[40:43], s58 offen lds
    s_add_u32 s32, s22, 0xe00000
    s_addc_u32 s33, s23, 0
    s_mov_b32 s34, 0xa0000
    s_mov_b32 s35, 0x00020000
    s_load_dword s30, s[32:33], 0
    v_lshrrev_b32 v4, 2, v0
    v_mul_u32_u24 v4, 544, v4
    v_and_b32 v5, 3, v0
    v_lshl_add_u32 v4, v5, 3, v4
    v_add_u32 v4, 20480, v4
    s_add_u32 s61, s31, 0
    s_lshl_b32 s54, s61, 5
    v_add_u32 v112, s54, v4
    v_add_u32 v117, 53248, v112
    v_add_u32 v122, 106496, v112
    s_add_u32 s62, s31, 4
    s_lshl_b32 s54, s62, 5
    v_add_u32 v113, s54, v4
    v_add_u32 v118, 53248, v113
    v_add_u32 v123, 106496, v113
    s_add_u32 s63, s31, 8
    s_lshl_b32 s54, s63, 5
    v_add_u32 v114, s54, v4
    v_add_u32 v119, 53248, v114
    v_add_u32 v124, 106496, v114
    s_add_u32 s64, s31, 12
    s_lshl_b32 s54, s64, 5
    v_add_u32 v115, s54, v4
    v_add_u32 v120, 53248, v115
    v_add_u32 v125, 106496, v115
    v_mov_b32 v28, 0x3f803f80
    v_mov_b32 v29, 0x3f803f80
    v_mov_b32 v30, 0x3f803f80
    v_mov_b32 v31, 0x3f803f80
    s_lshl_b32 s54, s24, 13
    s_lshl_b32 s55, s31, 11
    s_add_u32 s54, s54, s55
    s_add_u32 s54, s54, 131072
    v_and_b32 v27, 15, v0
    v_lshlrev_b32 v26, 7, v27
    v_add_u32 v26, s54, v26
    s_lshl_b32 s3, s31, 7
    v_lshl_add_u32 v27, v27, 3, s3
    s_waitcnt lgkmcnt(0)
    s_mul_i32 s29, s30, 0x01010101
    s_add_u32 s29, s29, 0x5A3C96E1
    s_waitcnt vmcnt(6)
    s_barrier
    s_add_u32 m0, s57, 55296
    s_mov_b32 s58, 196608
    buffer_load_dwordx4 v16, s[40:43], s58 offen lds
    s_add_u32 m0, s57, 56320
    s_mov_b32 s58, 196608
    buffer_load_dwordx4 v17, s[40:43], s58 offen lds
    s_add_u32 m0, s57, 57344
    s_mov_b32 s58, 196608
    buffer_load_dwordx4 v18, s[40:43], s58 offen lds
    s_add_u32 m0, s57, 58368
    s_mov_b32 s58, 196608
    buffer_load_dwordx4 v19, s[40:43], s58 offen lds
    s_add_u32 m0, s57, 59392
    s_mov_b32 s58, 196608
    buffer_load_dwordx4 v20, s[40:43], s58 offen lds
    s_add_u32 m0, s57, 60416
    s_mov_b32 s58, 196608
    buffer_load_dwordx4 v21, s[40:43], s58 offen lds
    s_add_u32 m0, s57, 61440
    s_mov_b32 s58, 196608
    buffer_load_dwordx4 v22, s[40:43], s58 offen lds
    ds_read_b64_tr_b16 v[64:65], v112 offset:0
    ds_read_b64_tr_b16 v[66:67], v112 offset:9216
    ds_read_b64_tr_b16 v[68:69], v113 offset:0
    ds_read_b64_tr_b16 v[70:71], v113 offset:9216
    ds_read_b64_tr_b16 v[72:73], v114 offset:0
    ds_read_b64_tr_b16 v[74:75], v114 offset:9216
    ds_read_b64_tr_b16 v[76:77], v115 offset:0
    ds_read_b64_tr_b16 v[78:79], v115 offset:9216
    s_add_u32 m0, s56, 106496
    s_movk_i32 s58, 256
    buffer_load_dwordx4 v10, s[36:39], s58 offen lds
    s_add_u32 m0, s56, 107520
    s_movk_i32 s58, 256
    buffer_load_dwordx4 v11, s[36:39], s58 offen lds
    s_waitcnt lgkmcnt(6)
    v_mfma_f32_16x16x32_bf16 v[44:47], v[64:67], v[28:31], 0
    s_waitcnt lgkmcnt(4)
    v_mfma_f32_16x16x32_bf16 v[48:51], v[68:71], v[28:31], 0
    s_waitcnt lgkmcnt(2)
    v_mfma_f32_16x16x32_bf16 v[52:55], v[72:75], v[28:31], 0
    s_waitcnt lgkmcnt(0)
    v_mfma_f32_16x16x32_bf16 v[56:59], v[76:79], v[28:31], 0
    ds_read_b64_tr_b16 v[84:85], v112 offset:18432
    ds_read_b64_tr_b16 v[86:87], v112 offset:27648
    ds_read_b64_tr_b16 v[88:89], v113 offset:18432
    ds_read_b64_tr_b16 v[90:91], v113 offset:27648
    ds_read_b64_tr_b16 v[92:93], v114 offset:18432
    ds_read_b64_tr_b16 v[94:95], v114 offset:27648
    ds_read_b64_tr_b16 v[96:97], v115 offset:18432
    ds_read_b64_tr_b16 v[98:99], v115 offset:27648
    s_add_u32 m0, s56, 108544
    s_movk_i32 s58, 256
    buffer_load_dwordx4 v12, s[36:39], s58 offen lds
    s_add_u32 m0, s56, 109568
    s_movk_i32 s58, 256
    buffer_load_dwordx4 v13, s[36:39], s58 offen lds
    s_waitcnt lgkmcnt(6)
    v_mfma_f32_16x16x32_bf16 v[44:47], v[84:87], v[28:31], v[44:47]
    s_waitcnt lgkmcnt(4)
    v_mfma_f32_16x16x32_bf16 v[48:51], v[88:91], v[28:31], v[48:51]
    s_waitcnt lgkmcnt(2)
    v_mfma_f32_16x16x32_bf16 v[52:55], v[92:95], v[28:31], v[52:55]
    s_waitcnt lgkmcnt(0)
    v_mfma_f32_16x16x32_bf16 v[56:59], v[96:99], v[28:31], v[56:59]
    s_add_u32 m0, s57, 106496
    s_mov_b32 s58, 393216
    buffer_load_dwordx4 v14, s[40:43], s58 offen lds
    s_add_u32 m0, s57, 107520
    s_mov_b32 s58, 393216
    buffer_load_dwordx4 v15, s[40:43], s58 offen lds
    s_add_u32 m0, s57, 108544
    s_mov_b32 s58, 393216
    buffer_load_dwordx4 v16, s[40:43], s58 offen lds
    s_add_u32 m0, s57, 109568
    s_mov_b32 s58, 393216
    buffer_load_dwordx4 v17, s[40:43], s58 offen lds
    s_add_u32 m0, s57, 110592
    s_mov_b32 s58, 393216
    buffer_load_dwordx4 v18, s[40:43], s58 offen lds
    s_add_u32 m0, s57, 111616
    s_mov_b32 s58, 393216
    buffer_load_dwordx4 v19, s[40:43], s58 offen lds
    s_add_u32 m0, s57, 112640
    s_mov_b32 s58, 393216
    buffer_load_dwordx4 v20, s[40:43], s58 offen lds
    s_add_u32 m0, s57, 113664
    s_mov_b32 s58, 393216
    buffer_load_dwordx4 v21, s[40:43], s58 offen lds
    s_add_u32 m0, s57, 114688
    s_mov_b32 s58, 393216
    buffer_load_dwordx4 v22, s[40:43], s58 offen lds
    s_waitcnt vmcnt(13)
    s_barrier
    ds_read_b64_tr_b16 v[64:65], v117 offset:0
    ds_read_b64_tr_b16 v[66:67], v117 offset:9216
    ds_read_b64_tr_b16 v[68:69], v118 offset:0
    ds_read_b64_tr_b16 v[70:71], v118 offset:9216
    ds_read_b64_tr_b16 v[72:73], v119 offset:0
    ds_read_b64_tr_b16 v[74:75], v119 offset:9216
    ds_read_b64_tr_b16 v[76:77], v120 offset:0
    ds_read_b64_tr_b16 v[78:79], v120 offset:9216
    s_add_u32 m0, s56, 0
    s_movk_i32 s58, 384
    buffer_load_dwordx4 v10, s[36:39], s58 offen lds
    s_add_u32 m0, s56, 1024
    s_movk_i32 s58, 384
    buffer_load_dwordx4 v11, s[36:39], s58 offen lds
    s_waitcnt lgkmcnt(6)
    v_mfma_f32_16x16x32_bf16 v[44:47], v[64:67], v[28:31], v[44:47]
    s_waitcnt lgkmcnt(4)
    v_mfma_f32_16x16x32_bf16 v[48:51], v[68:71], v[28:31], v[48:51]
    s_waitcnt lgkmcnt(2)
    v_mfma_f32_16x16x32_bf16 v[52:55], v[72:75], v[28:31], v[52:55]
    s_waitcnt lgkmcnt(0)
    v_mfma_f32_16x16x32_bf16 v[56:59], v[76:79], v[28:31], v[56:59]
    ds_read_b64_tr_b16 v[84:85], v117 offset:18432
    ds_read_b64_tr_b16 v[86:87], v117 offset:27648
    ds_read_b64_tr_b16 v[88:89], v118 offset:18432
    ds_read_b64_tr_b16 v[90:91], v118 offset:27648
    ds_read_b64_tr_b16 v[92:93], v119 offset:18432
    ds_read_b64_tr_b16 v[94:95], v119 offset:27648
    ds_read_b64_tr_b16 v[96:97], v120 offset:18432
    ds_read_b64_tr_b16 v[98:99], v120 offset:27648
    s_add_u32 m0, s56, 2048
    s_movk_i32 s58, 384
    buffer_load_dwordx4 v12, s[36:39], s58 offen lds
    s_add_u32 m0, s56, 3072
    s_movk_i32 s58, 384
    buffer_load_dwordx4 v13, s[36:39], s58 offen lds
    s_waitcnt lgkmcnt(6)
    v_mfma_f32_16x16x32_bf16 v[44:47], v[84:87], v[28:31], v[44:47]
    s_waitcnt lgkmcnt(4)
    v_mfma_f32_16x16x32_bf16 v[48:51], v[88:91], v[28:31], v[48:51]
    s_waitcnt lgkmcnt(2)
    v_mfma_f32_16x16x32_bf16 v[52:55], v[92:95], v[28:31], v[52:55]
    s_waitcnt lgkmcnt(0)
    v_mfma_f32_16x16x32_bf16 v[56:59], v[96:99], v[28:31], v[56:59]
    s_add_u32 m0, s57, 0
    s_mov_b32 s58, 589824
    buffer_load_dwordx4 v14, s[40:43], s58 offen lds
    s_add_u32 m0, s57, 1024
    s_mov_b32 s58, 589824
    buffer_load_dwordx4 v15, s[40:43], s58 offen lds
    s_add_u32 m0, s57, 2048
    s_mov_b32 s58, 589824
    buffer_load_dwordx4 v16, s[40:43], s58 offen lds
    s_add_u32 m0, s57, 3072
    s_mov_b32 s58, 589824
    buffer_load_dwordx4 v17, s[40:43], s58 offen lds
    s_add_u32 m0, s57, 4096
    s_mov_b32 s58, 589824
    buffer_load_dwordx4 v18, s[40:43], s58 offen lds
    s_add_u32 m0, s57, 5120
    s_mov_b32 s58, 589824
    buffer_load_dwordx4 v19, s[40:43], s58 offen lds
    s_add_u32 m0, s57, 6144
    s_mov_b32 s58, 589824
    buffer_load_dwordx4 v20, s[40:43], s58 offen lds
    s_add_u32 m0, s57, 7168
    s_mov_b32 s58, 589824
    buffer_load_dwordx4 v21, s[40:43], s58 offen lds
    s_add_u32 m0, s57, 8192
    s_mov_b32 s58, 589824
    buffer_load_dwordx4 v22, s[40:43], s58 offen lds
    s_waitcnt vmcnt(13)
    s_barrier
    buffer_load_dwordx4 v[104:107], v26, s[32:35], 0 offen sc1
    ds_read_b64_tr_b16 v[64:65], v122 offset:0
    ds_read_b64_tr_b16 v[66:67], v122 offset:9216
    ds_read_b64_tr_b16 v[68:69], v123 offset:0
    ds_read_b64_tr_b16 v[70:71], v123 offset:9216
    ds_read_b64_tr_b16 v[72:73], v124 offset:0
    ds_read_b64_tr_b16 v[74:75], v124 offset:9216
    ds_read_b64_tr_b16 v[76:77], v125 offset:0
    ds_read_b64_tr_b16 v[78:79], v125 offset:9216
    s_add_u32 m0, s56, 53248
    s_movk_i32 s58, 512
    buffer_load_dwordx4 v10, s[36:39], s58 offen lds
    s_add_u32 m0, s56, 54272
    s_movk_i32 s58, 512
    buffer_load_dwordx4 v11, s[36:39], s58 offen lds
    s_waitcnt lgkmcnt(6)
    v_mfma_f32_16x16x32_bf16 v[44:47], v[64:67], v[28:31], v[44:47]
    s_waitcnt lgkmcnt(4)
    v_mfma_f32_16x16x32_bf16 v[48:51], v[68:71], v[28:31], v[48:51]
    s_waitcnt lgkmcnt(2)
    v_mfma_f32_16x16x32_bf16 v[52:55], v[72:75], v[28:31], v[52:55]
    s_waitcnt lgkmcnt(0)
    v_mfma_f32_16x16x32_bf16 v[56:59], v[76:79], v[28:31], v[56:59]
    ds_read_b64_tr_b16 v[84:85], v122 offset:18432
    ds_read_b64_tr_b16 v[86:87], v122 offset:27648
    ds_read_b64_tr_b16 v[88:89], v123 offset:18432
    ds_read_b64_tr_b16 v[90:91], v123 offset:27648
    ds_read_b64_tr_b16 v[92:93], v124 offset:18432
    ds_read_b64_tr_b16 v[94:95], v124 offset:27648
    ds_read_b64_tr_b16 v[96:97], v125 offset:18432
    ds_read_b64_tr_b16 v[98:99], v125 offset:27648
    s_add_u32 m0, s56, 55296
    s_movk_i32 s58, 512
    buffer_load_dwordx4 v12, s[36:39], s58 offen lds
    s_add_u32 m0, s56, 56320
    s_movk_i32 s58, 512
    buffer_load_dwordx4 v13, s[36:39], s58 offen lds
    s_waitcnt lgkmcnt(6)
    v_mfma_f32_16x16x32_bf16 v[44:47], v[84:87], v[28:31], v[44:47]
    s_waitcnt lgkmcnt(4)
    v_mfma_f32_16x16x32_bf16 v[48:51], v[88:91], v[28:31], v[48:51]
    s_waitcnt lgkmcnt(2)
    v_mfma_f32_16x16x32_bf16 v[52:55], v[92:95], v[28:31], v[52:55]
    s_waitcnt lgkmcnt(0)
    v_mfma_f32_16x16x32_bf16 v[56:59], v[96:99], v[28:31], v[56:59]
    s_add_u32 m0, s57, 53248
    s_mov_b32 s58, 786432
    buffer_load_dwordx4 v14, s[40:43], s58 offen lds
    s_add_u32 m0, s57, 54272
    s_mov_b32 s58, 786432
    buffer_load_dwordx4 v15, s[40:43], s58 offen lds
    s_add_u32 m0, s57, 55296
    s_mov_b32 s58, 786432
    buffer_load_dwordx4 v16, s[40:43], s58 offen lds
    s_add_u32 m0, s57, 56320
    s_mov_b32 s58, 786432
    buffer_load_dwordx4 v17, s[40:43], s58 offen lds
    s_add_u32 m0, s57, 57344
    s_mov_b32 s58, 786432
    buffer_load_dwordx4 v18, s[40:43], s58 offen lds
    s_add_u32 m0, s57, 58368
    s_mov_b32 s58, 786432
    buffer_load_dwordx4 v19, s[40:43], s58 offen lds
    s_add_u32 m0, s57, 59392
    s_mov_b32 s58, 786432
    buffer_load_dwordx4 v20, s[40:43], s58 offen lds
    s_add_u32 m0, s57, 60416
    s_mov_b32 s58, 786432
    buffer_load_dwordx4 v21, s[40:43], s58 offen lds
    s_add_u32 m0, s57, 61440
    s_mov_b32 s58, 786432
    buffer_load_dwordx4 v22, s[40:43], s58 offen lds
    s_waitcnt vmcnt(14)
    s_barrier
    ds_read_b64_tr_b16 v[64:65], v112 offset:0
    ds_read_b64_tr_b16 v[66:67], v112 offset:9216
    ds_read_b64_tr_b16 v[68:69], v113 offset:0
    ds_read_b64_tr_b16 v[70:71], v113 offset:9216
    ds_read_b64_tr_b16 v[72:73], v114 offset:0
    ds_read_b64_tr_b16 v[74:75], v114 offset:9216
    ds_read_b64_tr_b16 v[76:77], v115 offset:0
    ds_read_b64_tr_b16 v[78:79], v115 offset:9216
    s_add_u32 m0, s56, 106496
    s_movk_i32 s58, 640
    buffer_load_dwordx4 v10, s[36:39], s58 offen lds
    s_add_u32 m0, s56, 107520
    s_movk_i32 s58, 640
    buffer_load_dwordx4 v11, s[36:39], s58 offen lds
    s_waitcnt lgkmcnt(6)
    v_mfma_f32_16x16x32_bf16 v[44:47], v[64:67], v[28:31], v[44:47]
    s_waitcnt lgkmcnt(4)
    v_mfma_f32_16x16x32_bf16 v[48:51], v[68:71], v[28:31], v[48:51]
    s_waitcnt lgkmcnt(2)
    v_mfma_f32_16x16x32_bf16 v[52:55], v[72:75], v[28:31], v[52:55]
    s_waitcnt lgkmcnt(0)
    v_mfma_f32_16x16x32_bf16 v[56:59], v[76:79], v[28:31], v[56:59]
    ds_read_b64_tr_b16 v[84:85], v112 offset:18432
    ds_read_b64_tr_b16 v[86:87], v112 offset:27648
    ds_read_b64_tr_b16 v[88:89], v113 offset:18432
    ds_read_b64_tr_b16 v[90:91], v113 offset:27648
    ds_read_b64_tr_b16 v[92:93], v114 offset:18432
    ds_read_b64_tr_b16 v[94:95], v114 offset:27648
    ds_read_b64_tr_b16 v[96:97], v115 offset:18432
    ds_read_b64_tr_b16 v[98:99], v115 offset:27648
    s_add_u32 m0, s56, 108544
    s_movk_i32 s58, 640
    buffer_load_dwordx4 v12, s[36:39], s58 offen lds
    s_add_u32 m0, s56, 109568
    s_movk_i32 s58, 640
    buffer_load_dwordx4 v13, s[36:39], s58 offen lds
    s_waitcnt lgkmcnt(6)
    v_mfma_f32_16x16x32_bf16 v[44:47], v[84:87], v[28:31], v[44:47]
    s_waitcnt lgkmcnt(4)
    v_mfma_f32_16x16x32_bf16 v[48:51], v[88:91], v[28:31], v[48:51]
    s_waitcnt lgkmcnt(2)
    v_mfma_f32_16x16x32_bf16 v[52:55], v[92:95], v[28:31], v[52:55]
    s_waitcnt lgkmcnt(0)
    v_mfma_f32_16x16x32_bf16 v[56:59], v[96:99], v[28:31], v[56:59]
    s_add_u32 m0, s57, 106496
    s_mov_b32 s58, 983040
    buffer_load_dwordx4 v14, s[40:43], s58 offen lds
    s_add_u32 m0, s57, 107520
    s_mov_b32 s58, 983040
    buffer_load_dwordx4 v15, s[40:43], s58 offen lds
    s_add_u32 m0, s57, 108544
    s_mov_b32 s58, 983040
    buffer_load_dwordx4 v16, s[40:43], s58 offen lds
    s_add_u32 m0, s57, 109568
    s_mov_b32 s58, 983040
    buffer_load_dwordx4 v17, s[40:43], s58 offen lds
    s_add_u32 m0, s57, 110592
    s_mov_b32 s58, 983040
    buffer_load_dwordx4 v18, s[40:43], s58 offen lds
    s_add_u32 m0, s57, 111616
    s_mov_b32 s58, 983040
    buffer_load_dwordx4 v19, s[40:43], s58 offen lds
    s_add_u32 m0, s57, 112640
    s_mov_b32 s58, 983040
    buffer_load_dwordx4 v20, s[40:43], s58 offen lds
    s_add_u32 m0, s57, 113664
    s_mov_b32 s58, 983040
    buffer_load_dwordx4 v21, s[40:43], s58 offen lds
    s_add_u32 m0, s57, 114688
    s_mov_b32 s58, 983040
    buffer_load_dwordx4 v22, s[40:43], s58 offen lds
    s_waitcnt vmcnt(13)
    v_cmp_eq_u32 vcc, s29, v106
    s_nop 3
    s_cmp_eq_u64 vcc, -1
    s_cbranch_scc1 fz_valokQ
    s_mov_b32 s3, 300000
fz_prQ:
    buffer_load_dwordx4 v[104:107], v26, s[32:35], 0 offen sc1
    s_waitcnt vmcnt(0)
    v_cmp_eq_u32 vcc, s29, v106
    s_sub_u32 s3, s3, 1
    s_cmp_eq_u32 s3, 0
    s_cbranch_scc1 fz_prQ_ok
    s_cmp_eq_u64 vcc, -1
    s_cbranch_scc1 fz_prQ_ok
    s_sleep 2
    s_branch fz_prQ
fz_prQ_ok:
fz_valokQ:
    s_barrier
    ds_read_b64_tr_b16 v[64:65], v117 offset:0
    ds_read_b64_tr_b16 v[66:67], v117 offset:9216
    ds_read_b64_tr_b16 v[68:69], v118 offset:0
    ds_read_b64_tr_b16 v[70:71], v118 offset:9216
    ds_read_b64_tr_b16 v[72:73], v119 offset:0
    ds_read_b64_tr_b16 v[74:75], v119 offset:9216
    ds_read_b64_tr_b16 v[76:77], v120 offset:0
    ds_read_b64_tr_b16 v[78:79], v120 offset:9216
    s_add_u32 m0, s56, 0
    s_movk_i32 s58, 768
    buffer_load_dwordx4 v10, s[36:39], s58 offen lds
    s_add_u32 m0, s56, 1024
    s_movk_i32 s58, 768
    buffer_load_dwordx4 v11, s[36:39], s58 offen lds
    s_waitcnt lgkmcnt(6)
    v_mfma_f32_16x16x32_bf16 v[44:47], v[64:67], v[28:31], v[44:47]
    s_waitcnt lgkmcnt(4)
    v_mfma_f32_16x16x32_bf16 v[48:51], v[68:71], v[28:31], v[48:51]
    s_waitcnt lgkmcnt(2)
    v_mfma_f32_16x16x32_bf16 v[52:55], v[72:75], v[28:31], v[52:55]
    s_waitcnt lgkmcnt(0)
    v_mfma_f32_16x16x32_bf16 v[56:59], v[76:79], v[28:31], v[56:59]
    ds_read_b64_tr_b16 v[84:85], v117 offset:18432
    ds_read_b64_tr_b16 v[86:87], v117 offset:27648
    ds_read_b64_tr_b16 v[88:89], v118 offset:18432
    ds_read_b64_tr_b16 v[90:91], v118 offset:27648
    ds_read_b64_tr_b16 v[92:93], v119 offset:18432
    ds_read_b64_tr_b16 v[94:95], v119 offset:27648
    ds_read_b64_tr_b16 v[96:97], v120 offset:18432
    ds_read_b64_tr_b16 v[98:99], v120 offset:27648
    s_add_u32 m0, s56, 2048
    s_movk_i32 s58, 768
    buffer_load_dwordx4 v12, s[36:39], s58 offen lds
    s_add_u32 m0, s56, 3072
    s_movk_i32 s58, 768
    buffer_load_dwordx4 v13, s[36:39], s58 offen lds
    s_waitcnt lgkmcnt(6)
    v_mfma_f32_16x16x32_bf16 v[44:47], v[84:87], v[28:31], v[44:47]
    s_waitcnt lgkmcnt(4)
    v_mfma_f32_16x16x32_bf16 v[48:51], v[88:91], v[28:31], v[48:51]
    s_waitcnt lgkmcnt(2)
    v_mfma_f32_16x16x32_bf16 v[52:55], v[92:95], v[28:31], v[52:55]
    s_waitcnt lgkmcnt(0)
    v_mfma_f32_16x16x32_bf16 v[56:59], v[96:99], v[28:31], v[56:59]
    s_add_u32 m0, s57, 0
    s_mov_b32 s58, 1179648
    buffer_load_dwordx4 v14, s[40:43], s58 offen lds
    s_add_u32 m0, s57, 1024
    s_mov_b32 s58, 1179648
    buffer_load_dwordx4 v15, s[40:43], s58 offen lds
    s_add_u32 m0, s57, 2048
    s_mov_b32 s58, 1179648
    buffer_load_dwordx4 v16, s[40:43], s58 offen lds
    s_add_u32 m0, s57, 3072
    s_mov_b32 s58, 1179648
    buffer_load_dwordx4 v17, s[40:43], s58 offen lds
    s_add_u32 m0, s57, 4096
    s_mov_b32 s58, 1179648
    buffer_load_dwordx4 v18, s[40:43], s58 offen lds
    s_add_u32 m0, s57, 5120
    s_mov_b32 s58, 1179648
    buffer_load_dwordx4 v19, s[40:43], s58 offen lds
    s_add_u32 m0, s57, 6144
    s_mov_b32 s58, 1179648
    buffer_load_dwordx4 v20, s[40:43], s58 offen lds
    s_add_u32 m0, s57, 7168
    s_mov_b32 s58, 1179648
    buffer_load_dwordx4 v21, s[40:43], s58 offen lds
    s_add_u32 m0, s57, 8192
    s_mov_b32 s58, 1179648
    buffer_load_dwordx4 v22, s[40:43], s58 offen lds
    v_lshlrev_b32 v108, 16, v104
    v_xor_b32 v108, 0x80000000, v108
    v_and_b32 v110, 0xffff0000, v104
    v_rcp_f32 v110, v110
    v_lshlrev_b32 v109, 16, v105
    v_xor_b32 v109, 0x80000000, v109
    v_and_b32 v111, 0xffff0000, v105
    v_rcp_f32 v111, v111
    s_nop 0
    ds_write_b64 v27, v[108:109] offset:0
    ds_write_b64 v27, v[110:111] offset:512
    s_waitcnt vmcnt(13)
    s_barrier
    ds_read_b64_tr_b16 v[64:65], v122 offset:0
    ds_read_b64_tr_b16 v[66:67], v122 offset:9216
    ds_read_b64_tr_b16 v[68:69], v123 offset:0
    ds_read_b64_tr_b16 v[70:71], v123 offset:9216
    ds_read_b64_tr_b16 v[72:73], v124 offset:0
    ds_read_b64_tr_b16 v[74:75], v124 offset:9216
    ds_read_b64_tr_b16 v[76:77], v125 offset:0
    ds_read_b64_tr_b16 v[78:79], v125 offset:9216
    s_add_u32 m0, s56, 53248
    s_movk_i32 s58, 896
    buffer_load_dwordx4 v10, s[36:39], s58 offen lds
    s_add_u32 m0, s56, 54272
    s_movk_i32 s58, 896
    buffer_load_dwordx4 v11, s[36:39], s58 offen lds
    s_waitcnt lgkmcnt(6)
    v_mfma_f32_16x16x32_bf16 v[44:47], v[64:67], v[28:31], v[44:47]
    s_waitcnt lgkmcnt(4)
    v_mfma_f32_16x16x32_bf16 v[48:51], v[68:71], v[28:31], v[48:51]
    s_waitcnt lgkmcnt(2)
    v_mfma_f32_16x16x32_bf16 v[52:55], v[72:75], v[28:31], v[52:55]
    s_waitcnt lgkmcnt(0)
    v_mfma_f32_16x16x32_bf16 v[56:59], v[76:79], v[28:31], v[56:59]
    ds_read_b64_tr_b16 v[84:85], v122 offset:18432
    ds_read_b64_tr_b16 v[86:87], v122 offset:27648
    ds_read_b64_tr_b16 v[88:89], v123 offset:18432
    ds_read_b64_tr_b16 v[90:91], v123 offset:27648
    ds_read_b64_tr_b16 v[92:93], v124 offset:18432
    ds_read_b64_tr_b16 v[94:95], v124 offset:27648
    ds_read_b64_tr_b16 v[96:97], v125 offset:18432
    ds_read_b64_tr_b16 v[98:99], v125 offset:27648
    s_add_u32 m0, s56, 55296
    s_movk_i32 s58, 896
    buffer_load_dwordx4 v12, s[36:39], s58 offen lds
    s_add_u32 m0, s56, 56320
    s_movk_i32 s58, 896
    buffer_load_dwordx4 v13, s[36:39], s58 offen lds
    s_waitcnt lgkmcnt(6)
    v_mfma_f32_16x16x32_bf16 v[44:47], v[84:87], v[28:31], v[44:47]
    s_waitcnt lgkmcnt(4)
    v_mfma_f32_16x16x32_bf16 v[48:51], v[88:91], v[28:31], v[48:51]
    s_waitcnt lgkmcnt(2)
    v_mfma_f32_16x16x32_bf16 v[52:55], v[92:95], v[28:31], v[52:55]
    s_waitcnt lgkmcnt(0)
    v_mfma_f32_16x16x32_bf16 v[56:59], v[96:99], v[28:31], v[56:59]
    s_add_u32 m0, s57, 53248
    s_mov_b32 s58, 1376256
    buffer_load_dwordx4 v14, s[40:43], s58 offen lds
    s_add_u32 m0, s57, 54272
    s_mov_b32 s58, 1376256
    buffer_load_dwordx4 v15, s[40:43], s58 offen lds
    s_add_u32 m0, s57, 55296
    s_mov_b32 s58, 1376256
    buffer_load_dwordx4 v16, s[40:43], s58 offen lds
    s_add_u32 m0, s57, 56320
    s_mov_b32 s58, 1376256
    buffer_load_dwordx4 v17, s[40:43], s58 offen lds
    s_add_u32 m0, s57, 57344
    s_mov_b32 s58, 1376256
    buffer_load_dwordx4 v18, s[40:43], s58 offen lds
    s_add_u32 m0, s57, 58368
    s_mov_b32 s58, 1376256
    buffer_load_dwordx4 v19, s[40:43], s58 offen lds
    s_add_u32 m0, s57, 59392
    s_mov_b32 s58, 1376256
    buffer_load_dwordx4 v20, s[40:43], s58 offen lds
    s_add_u32 m0, s57, 60416
    s_mov_b32 s58, 1376256
    buffer_load_dwordx4 v21, s[40:43], s58 offen lds
    s_add_u32 m0, s57, 61440
    s_mov_b32 s58, 1376256
    buffer_load_dwordx4 v22, s[40:43], s58 offen lds
    s_mov_b32 s40, s16
    s_mov_b32 s41, s17
    s_mov_b32 s42, 0x158000
    s_mov_b32 s43, 0x00020000
    s_mov_b32 s44, s8
    s_mov_b32 s45, s9
    s_mov_b32 s46, 0x80000
    s_mov_b32 s47, 0x00020000
    v_lshrrev_b32 v3, 3, v0
    v_and_b32 v4, 7, v0
    v_and_b32 v5, 6, v3
    v_xor_b32 v4, v4, v5
    v_lshlrev_b32 v4, 4, v4
    v_and_b32 v5, 4, v3
    v_add_u32 v3, v3, v5
    v_lshl_add_u32 v4, v3, 10, v4
    s_lshl_b32 s3, s28, 7
    v_add_u32 v2, s3, v4
    s_mul_i32 s56, s31, 12288
    s_add_u32 s56, s56, 4096
    s_lshl_b32 s57, s31, 15
    s_mul_i32 s59, s31, 131072
    s_waitcnt lgkmcnt(0)
    s_waitcnt vmcnt(13)
    s_barrier
    ds_read_b64_tr_b16 v[64:65], v112 offset:0
    ds_read_b64_tr_b16 v[66:67], v112 offset:9216
    ds_read_b64_tr_b16 v[68:69], v113 offset:0
    ds_read_b64_tr_b16 v[70:71], v113 offset:9216
    ds_read_b64_tr_b16 v[72:73], v114 offset:0
    ds_read_b64_tr_b16 v[74:75], v114 offset:9216
    ds_read_b64_tr_b16 v[76:77], v115 offset:0
    ds_read_b64_tr_b16 v[78:79], v115 offset:9216
    s_add_u32 m0, s56, 106496
    s_add_u32 s58, s57, 0
    buffer_load_dwordx4 v2, s[40:43], s58 offen lds
    s_add_u32 m0, s56, 107520
    s_add_u32 s58, s57, 16384
    buffer_load_dwordx4 v2, s[40:43], s58 offen lds
    s_waitcnt lgkmcnt(6)
    v_mfma_f32_16x16x32_bf16 v[44:47], v[64:67], v[28:31], v[44:47]
    s_waitcnt lgkmcnt(4)
    v_mfma_f32_16x16x32_bf16 v[48:51], v[68:71], v[28:31], v[48:51]
    s_waitcnt lgkmcnt(2)
    v_mfma_f32_16x16x32_bf16 v[52:55], v[72:75], v[28:31], v[52:55]
    s_waitcnt lgkmcnt(0)
    v_mfma_f32_16x16x32_bf16 v[56:59], v[76:79], v[28:31], v[56:59]
    ds_read_b64_tr_b16 v[84:85], v112 offset:18432
    ds_read_b64_tr_b16 v[86:87], v112 offset:27648
    ds_read_b64_tr_b16 v[88:89], v113 offset:18432
    ds_read_b64_tr_b16 v[90:91], v113 offset:27648
    ds_read_b64_tr_b16 v[92:93], v114 offset:18432
    ds_read_b64_tr_b16 v[94:95], v114 offset:27648
    ds_read_b64_tr_b16 v[96:97], v115 offset:18432
    ds_read_b64_tr_b16 v[98:99], v115 offset:27648
    s_add_u32 m0, s56, 108544
    s_add_u32 s58, s57, 4096
    buffer_load_dwordx4 v2, s[40:43], s58 offen lds
    s_add_u32 m0, s56, 109568
    s_add_u32 s58, s57, 20480
    buffer_load_dwordx4 v2, s[40:43], s58 offen lds
    s_waitcnt lgkmcnt(6)
    v_mfma_f32_16x16x32_bf16 v[44:47], v[84:87], v[28:31], v[44:47]
    s_waitcnt lgkmcnt(4)
    v_mfma_f32_16x16x32_bf16 v[48:51], v[88:91], v[28:31], v[48:51]
    s_waitcnt lgkmcnt(2)
    v_mfma_f32_16x16x32_bf16 v[52:55], v[92:95], v[28:31], v[52:55]
    s_waitcnt lgkmcnt(0)
    v_mfma_f32_16x16x32_bf16 v[56:59], v[96:99], v[28:31], v[56:59]
    s_add_u32 m0, s56, 110592
    s_add_u32 s58, s57, 131072
    buffer_load_dwordx4 v2, s[40:43], s58 offen lds
    s_add_u32 m0, s56, 111616
    s_add_u32 s58, s57, 147456
    buffer_load_dwordx4 v2, s[40:43], s58 offen lds
    s_add_u32 m0, s56, 112640
    s_add_u32 s58, s57, 135168
    buffer_load_dwordx4 v2, s[40:43], s58 offen lds
    s_add_u32 m0, s56, 113664
    s_add_u32 s58, s57, 151552
    buffer_load_dwordx4 v2, s[40:43], s58 offen lds
    s_add_u32 m0, s56, 114688
    s_add_u32 s58, s57, 262144
    buffer_load_dwordx4 v2, s[40:43], s58 offen lds
    s_add_u32 m0, s56, 115712
    s_add_u32 s58, s57, 278528
    buffer_load_dwordx4 v2, s[40:43], s58 offen lds
    s_add_u32 m0, s56, 116736
    s_add_u32 s58, s57, 266240
    buffer_load_dwordx4 v2, s[40:43], s58 offen lds
    s_add_u32 m0, s56, 117760
    s_add_u32 s58, s57, 282624
    buffer_load_dwordx4 v2, s[40:43], s58 offen lds
    s_waitcnt vmcnt(12)
    s_barrier
    ds_read_b64_tr_b16 v[64:65], v117 offset:0
    ds_read_b64_tr_b16 v[66:67], v117 offset:9216
    ds_read_b64_tr_b16 v[68:69], v118 offset:0
    ds_read_b64_tr_b16 v[70:71], v118 offset:9216
    ds_read_b64_tr_b16 v[72:73], v119 offset:0
    ds_read_b64_tr_b16 v[74:75], v119 offset:9216
    ds_read_b64_tr_b16 v[76:77], v120 offset:0
    ds_read_b64_tr_b16 v[78:79], v120 offset:9216
    s_waitcnt lgkmcnt(6)
    v_mfma_f32_16x16x32_bf16 v[44:47], v[64:67], v[28:31], v[44:47]
    s_waitcnt lgkmcnt(4)
    v_mfma_f32_16x16x32_bf16 v[48:51], v[68:71], v[28:31], v[48:51]
    s_waitcnt lgkmcnt(2)
    v_mfma_f32_16x16x32_bf16 v[52:55], v[72:75], v[28:31], v[52:55]
    s_waitcnt lgkmcnt(0)
    v_mfma_f32_16x16x32_bf16 v[56:59], v[76:79], v[28:31], v[56:59]
    ds_read_b64_tr_b16 v[84:85], v117 offset:18432
    ds_read_b64_tr_b16 v[86:87], v117 offset:27648
    ds_read_b64_tr_b16 v[88:89], v118 offset:18432
    ds_read_b64_tr_b16 v[90:91], v118 offset:27648
    ds_read_b64_tr_b16 v[92:93], v119 offset:18432
    ds_read_b64_tr_b16 v[94:95], v119 offset:27648
    ds_read_b64_tr_b16 v[96:97], v120 offset:18432
    ds_read_b64_tr_b16 v[98:99], v120 offset:27648
    s_waitcnt lgkmcnt(6)
    v_mfma_f32_16x16x32_bf16 v[44:47], v[84:87], v[28:31], v[44:47]
    s_waitcnt lgkmcnt(4)
    v_mfma_f32_16x16x32_bf16 v[48:51], v[88:91], v[28:31], v[48:51]
    s_waitcnt lgkmcnt(2)
    v_mfma_f32_16x16x32_bf16 v[52:55], v[92:95], v[28:31], v[52:55]
    s_waitcnt lgkmcnt(0)
    v_mfma_f32_16x16x32_bf16 v[56:59], v[96:99], v[28:31], v[56:59]
    v_lshrrev_b32 v3, 4, v0
    v_lshlrev_b32 v6, 4, v3
    s_nop 5
    s_lshl_b32 s3, s61, 6
    v_add_u32 v7, s3, v6
    ds_write_b128 v7, v[44:47] offset:1024
    s_lshl_b32 s3, s62, 6
    v_add_u32 v7, s3, v6
    ds_write_b128 v7, v[48:51] offset:1024
    s_lshl_b32 s3, s63, 6
    v_add_u32 v7, s3, v6
    ds_write_b128 v7, v[52:55] offset:1024
    s_lshl_b32 s3, s64, 6
    v_add_u32 v7, s3, v6
    ds_write_b128 v7, v[56:59] offset:1024
    s_branch fz_ldone
fz_lF:
    s_movk_i32 s63, 2752
    s_and_b32 s54, s31, 1
    s_lshl_b32 s54, s54, 5
    s_mul_i32 s55, s25, 288
    s_movk_i32 s64, 3641
    s_waitcnt lgkmcnt(0)
    s_mov_b32 s36, s4
    s_mov_b32 s37, s5
    s_mov_b32 s38, 0x200000
    s_mov_b32 s39, 0x00020000
    s_cmp_lt_u32 s31, 2
    s_cselect_b32 s40, s12, s14
    s_cselect_b32 s41, s13, s15
    s_mov_b32 s42, 0x158000
    s_mov_b32 s43, 0x00020000
    s_add_u32 m0, s56, 0
    s_movk_i32 s58, 0
    buffer_load_dwordx4 v10, s[36:39], s58 offen lds
    s_add_u32 m0, s56, 1024
    s_movk_i32 s58, 0
    buffer_load_dwordx4 v11, s[36:39], s58 offen lds
    s_add_u32 m0, s56, 2048
    s_movk_i32 s58, 0
    buffer_load_dwordx4 v12, s[36:39], s58 offen lds
    s_add_u32 m0, s56, 3072
    s_movk_i32 s58, 0
    buffer_load_dwordx4 v13, s[36:39], s58 offen lds
    v_add_u32 v3, 0, v0
    v_mul_u32_u24 v4, s64, v3
    v_lshrrev_b32 v4, 16, v4
    v_mul_u32_u24 v5, 18, v4
    v_sub_u32 v5, v3, v5
    v_and_b32 v6, 3, v4
    v_bfe_u32 v7, v4, 2, 2
    v_lshl_add_u32 v6, v7, 3, v6
    v_lshrrev_b32 v7, 4, v4
    v_lshl_add_u32 v6, v7, 2, v6
    v_add_u32 v6, s54, v6
    v_mul_u32_u24 v6, s63, v6
    v_lshl_add_u32 v6, v5, 4, v6
    v_add_u32 v14, s55, v6
    s_add_u32 m0, s57, 0
    s_mov_b32 s58, 0
    buffer_load_dwordx4 v14, s[40:43], s58 offen lds
    v_add_u32 v3, 64, v0
    v_mul_u32_u24 v4, s64, v3
    v_lshrrev_b32 v4, 16, v4
    v_mul_u32_u24 v5, 18, v4
    v_sub_u32 v5, v3, v5
    v_and_b32 v6, 3, v4
    v_bfe_u32 v7, v4, 2, 2
    v_lshl_add_u32 v6, v7, 3, v6
    v_lshrrev_b32 v7, 4, v4
    v_lshl_add_u32 v6, v7, 2, v6
    v_add_u32 v6, s54, v6
    v_mul_u32_u24 v6, s63, v6
    v_lshl_add_u32 v6, v5, 4, v6
    v_add_u32 v15, s55, v6
    s_add_u32 m0, s57, 1024
    s_mov_b32 s58, 0
    buffer_load_dwordx4 v15, s[40:43], s58 offen lds
    v_add_u32 v3, 128, v0
    v_mul_u32_u24 v4, s64, v3
    v_lshrrev_b32 v4, 16, v4
    v_mul_u32_u24 v5, 18, v4
    v_sub_u32 v5, v3, v5
    v_and_b32 v6, 3, v4
    v_bfe_u32 v7, v4, 2, 2
    v_lshl_add_u32 v6, v7, 3, v6
    v_lshrrev_b32 v7, 4, v4
    v_lshl_add_u32 v6, v7, 2, v6
    v_add_u32 v6, s54, v6
    v_mul_u32_u24 v6, s63, v6
    v_lshl_add_u32 v6, v5, 4, v6
    v_add_u32 v16, s55, v6
    s_add_u32 m0, s57, 2048
    s_mov_b32 s58, 0
    buffer_load_dwordx4 v16, s[40:43], s58 offen lds
    v_add_u32 v3, 192, v0
    v_mul_u32_u24 v4, s64, v3
    v_lshrrev_b32 v4, 16, v4
    v_mul_u32_u24 v5, 18, v4
    v_sub_u32 v5, v3, v5
    v_and_b32 v6, 3, v4
    v_bfe_u32 v7, v4, 2, 2
    v_lshl_add_u32 v6, v7, 3, v6
    v_lshrrev_b32 v7, 4, v4
    v_lshl_add_u32 v6, v7, 2, v6
    v_add_u32 v6, s54, v6
    v_mul_u32_u24 v6, s63, v6
    v_lshl_add_u32 v6, v5, 4, v6
    v_add_u32 v17, s55, v6
    s_add_u32 m0, s57, 3072
    s_mov_b32 s58, 0
    buffer_load_dwordx4 v17, s[40:43], s58 offen lds
    v_add_u32 v3, 256, v0
    v_mul_u32_u24 v4, s64, v3
    v_lshrrev_b32 v4, 16, v4
    v_mul_u32_u24 v5, 18, v4
    v_sub_u32 v5, v3, v5
    v_and_b32 v6, 3, v4
    v_bfe_u32 v7, v4, 2, 2
    v_lshl_add_u32 v6, v7, 3, v6
    v_lshrrev_b32 v7, 4, v4
    v_lshl_add_u32 v6, v7, 2, v6
    v_add_u32 v6, s54, v6
    v_mul_u32_u24 v6, s63, v6
    v_lshl_add_u32 v6, v5, 4, v6
    v_add_u32 v18, s55, v6
    s_add_u32 m0, s57, 4096
    s_mov_b32 s58, 0
    buffer_load_dwordx4 v18, s[40:43], s58 offen lds
    v_add_u32 v3, 320, v0
    v_mul_u32_u24 v4, s64, v3
    v_lshrrev_b32 v4, 16, v4
    v_mul_u32_u24 v5, 18, v4
    v_sub_u32 v5, v3, v5
    v_and_b32 v6, 3, v4
    v_bfe_u32 v7, v4, 2, 2
    v_lshl_add_u32 v6, v7, 3, v6
    v_lshrrev_b32 v7, 4, v4
    v_lshl_add_u32 v6, v7, 2, v6
    v_add_u32 v6, s54, v6
    v_mul_u32_u24 v6, s63, v6
    v_lshl_add_u32 v6, v5, 4, v6
    v_add_u32 v19, s55, v6
    s_add_u32 m0, s57, 5120
    s_mov_b32 s58, 0
    buffer_load_dwordx4 v19, s[40:43], s58 offen lds
    v_add_u32 v3, 384, v0
    v_mul_u32_u24 v4, s64, v3
    v_lshrrev_b32 v4, 16, v4
    v_mul_u32_u24 v5, 18, v4
    v_sub_u32 v5, v3, v5
    v_and_b32 v6, 3, v4
    v_bfe_u32 v7, v4, 2, 2
    v_lshl_add_u32 v6, v7, 3, v6
    v_lshrrev_b32 v7, 4, v4
    v_lshl_add_u32 v6, v7, 2, v6
    v_add_u32 v6, s54, v6
    v_mul_u32_u24 v6, s63, v6
    v_lshl_add_u32 v6, v5, 4, v6
    v_add_u32 v20, s55, v6
    s_add_u32 m0, s57, 6144
    s_mov_b32 s58, 0
    buffer_load_dwordx4 v20, s[40:43], s58 offen lds
    v_add_u32 v3, 448, v0
    v_mul_u32_u24 v4, s64, v3
    v_lshrrev_b32 v4, 16, v4
    v_mul_u32_u24 v5, 18, v4
    v_sub_u32 v5, v3, v5
    v_and_b32 v6, 3, v4
    v_bfe_u32 v7, v4, 2, 2
    v_lshl_add_u32 v6, v7, 3, v6
    v_lshrrev_b32 v7, 4, v4
    v_lshl_add_u32 v6, v7, 2, v6
    v_add_u32 v6, s54, v6
    v_mul_u32_u24 v6, s63, v6
    v_lshl_add_u32 v6, v5, 4, v6
    v_add_u32 v21, s55, v6
    s_add_u32 m0, s57, 7168
    s_mov_b32 s58, 0
    buffer_load_dwordx4 v21, s[40:43], s58 offen lds
    v_add_u32 v3, 512, v0
    v_mul_u32_u24 v4, s64, v3
    v_lshrrev_b32 v4, 16, v4
    v_mul_u32_u24 v5, 18, v4
    v_sub_u32 v5, v3, v5
    v_and_b32 v6, 3, v4
    v_bfe_u32 v7, v4, 2, 2
    v_lshl_add_u32 v6, v7, 3, v6
    v_lshrrev_b32 v7, 4, v4
    v_lshl_add_u32 v6, v7, 2, v6
    v_add_u32 v6, s54, v6
    v_mul_u32_u24 v6, s63, v6
    v_lshl_add_u32 v6, v5, 4, v6
    v_add_u32 v22, s55, v6
    s_add_u32 m0, s57, 8192
    s_mov_b32 s58, 0
    buffer_load_dwordx4 v22, s[40:43], s58 offen lds
    s_add_u32 m0, s56, 53248
    s_movk_i32 s58, 128
    buffer_load_dwordx4 v10, s[36:39], s58 offen lds
    s_add_u32 m0, s56, 54272
    s_movk_i32 s58, 128
    buffer_load_dwordx4 v11, s[36:39], s58 offen lds
    s_add_u32 m0, s56, 55296
    s_movk_i32 s58, 128
    buffer_load_dwordx4 v12, s[36:39], s58 offen lds
    s_add_u32 m0, s56, 56320
    s_movk_i32 s58, 128
    buffer_load_dwordx4 v13, s[36:39], s58 offen lds
    s_add_u32 m0, s57, 53248
    s_mov_b32 s58, 176128
    buffer_load_dwordx4 v14, s[40:43], s58 offen lds
    s_add_u32 m0, s57, 54272
    s_mov_b32 s58, 176128
    buffer_load_dwordx4 v15, s[40:43], s58 offen lds
    s_add_u32 s32, s22, 0xe00000
    s_addc_u32 s33, s23, 0
    s_mov_b32 s34, 0xa0000
    s_mov_b32 s35, 0x00020000
    s_load_dword s30, s[32:33], 0
    v_lshrrev_b32 v4, 2, v0
    v_mul_u32_u24 v4, 288, v4
    v_and_b32 v5, 3, v0
    v_lshl_add_u32 v4, v5, 3, v4
    v_add_u32 v4, 20480, v4
    s_add_u32 s61, s31, 0
    s_lshl_b32 s54, s61, 5
    s_cmp_ge_u32 s61, 9
    s_cselect_b32 s55, 18144, 0
    s_add_u32 s54, s54, s55
    v_add_u32 v112, s54, v4
    v_add_u32 v117, 53248, v112
    v_add_u32 v122, 106496, v112
    s_add_u32 s62, s31, 4
    s_lshl_b32 s54, s62, 5
    s_cmp_ge_u32 s62, 9
    s_cselect_b32 s55, 18144, 0
    s_add_u32 s54, s54, s55
    v_add_u32 v113, s54, v4
    v_add_u32 v118, 53248, v113
    v_add_u32 v123, 106496, v113
    s_add_u32 s63, s31, 8
    s_lshl_b32 s54, s63, 5
    s_cmp_ge_u32 s63, 9
    s_cselect_b32 s55, 18144, 0
    s_add_u32 s54, s54, s55
    v_add_u32 v114, s54, v4
    v_add_u32 v119, 53248, v114
    v_add_u32 v124, 106496, v114
    s_add_u32 s64, s31, 12
    s_lshl_b32 s54, s64, 5
    s_cmp_ge_u32 s64, 9
    s_cselect_b32 s55, 18144, 0
    s_add_u32 s54, s54, s55
    v_add_u32 v115, s54, v4
    v_add_u32 v120, 53248, v115
    v_add_u32 v125, 106496, v115
    s_and_b32 s65, s31, 1
    s_add_u32 s65, s65, 16
    s_lshl_b32 s54, s65, 5
    s_cmp_ge_u32 s65, 9
    s_cselect_b32 s55, 18144, 0
    s_add_u32 s54, s54, s55
    v_add_u32 v116, s54, v4
    v_add_u32 v121, 53248, v116
    v_add_u32 v126, 106496, v116
    v_mov_b32 v28, 0x3f803f80
    v_mov_b32 v29, 0x3f803f80
    v_mov_b32 v30, 0x3f803f80
    v_mov_b32 v31, 0x3f803f80
    s_lshl_b32 s54, s24, 13
    s_lshl_b32 s55, s31, 11
    s_add_u32 s54, s54, s55
    s_add_u32 s54, s54, 131072
    v_and_b32 v27, 15, v0
    v_lshlrev_b32 v26, 7, v27
    v_add_u32 v26, s54, v26
    s_lshl_b32 s3, s31, 7
    v_lshl_add_u32 v27, v27, 3, s3
    s_waitcnt lgkmcnt(0)
    s_mul_i32 s29, s30, 0x01010101
    s_add_u32 s29, s29, 0x5A3C96E1
    s_waitcnt vmcnt(6)
    s_barrier
    s_add_u32 m0, s57, 55296
    s_mov_b32 s58, 176128
    buffer_load_dwordx4 v16, s[40:43], s58 offen lds
    s_add_u32 m0, s57, 56320
    s_mov_b32 s58, 176128
    buffer_load_dwordx4 v17, s[40:43], s58 offen lds
    s_add_u32 m0, s57, 57344
    s_mov_b32 s58, 176128
    buffer_load_dwordx4 v18, s[40:43], s58 offen lds
    s_add_u32 m0, s57, 58368
    s_mov_b32 s58, 176128
    buffer_load_dwordx4 v19, s[40:43], s58 offen lds
    s_add_u32 m0, s57, 59392
    s_mov_b32 s58, 176128
    buffer_load_dwordx4 v20, s[40:43], s58 offen lds
    s_add_u32 m0, s57, 60416
    s_mov_b32 s58, 176128
    buffer_load_dwordx4 v21, s[40:43], s58 offen lds
    s_add_u32 m0, s57, 61440
    s_mov_b32 s58, 176128
    buffer_load_dwordx4 v22, s[40:43], s58 offen lds
    ds_read_b64_tr_b16 v[64:65], v112 offset:0
    ds_read_b64_tr_b16 v[66:67], v112 offset:4608
    ds_read_b64_tr_b16 v[68:69], v113 offset:0
    ds_read_b64_tr_b16 v[70:71], v113 offset:4608
    ds_read_b64_tr_b16 v[72:73], v114 offset:0
    ds_read_b64_tr_b16 v[74:75], v114 offset:4608
    ds_read_b64_tr_b16 v[76:77], v115 offset:0
    ds_read_b64_tr_b16 v[78:79], v115 offset:4608
    ds_read_b64_tr_b16 v[80:81], v116 offset:0
    ds_read_b64_tr_b16 v[82:83], v116 offset:4608
    s_add_u32 m0, s56, 106496
    s_movk_i32 s58, 256
    buffer_load_dwordx4 v10, s[36:39], s58 offen lds
    s_add_u32 m0, s56, 107520
    s_movk_i32 s58, 256
    buffer_load_dwordx4 v11, s[36:39], s58 offen lds
    s_waitcnt lgkmcnt(8)
    v_mfma_f32_16x16x32_bf16 v[44:47], v[64:67], v[28:31], 0
    s_waitcnt lgkmcnt(6)
    v_mfma_f32_16x16x32_bf16 v[48:51], v[68:71], v[28:31], 0
    s_waitcnt lgkmcnt(4)
    v_mfma_f32_16x16x32_bf16 v[52:55], v[72:75], v[28:31], 0
    s_waitcnt lgkmcnt(2)
    v_mfma_f32_16x16x32_bf16 v[56:59], v[76:79], v[28:31], 0
    s_waitcnt lgkmcnt(0)
    v_mfma_f32_16x16x32_bf16 v[60:63], v[80:83], v[28:31], 0
    ds_read_b64_tr_b16 v[84:85], v112 offset:9216
    ds_read_b64_tr_b16 v[86:87], v112 offset:13824
    ds_read_b64_tr_b16 v[88:89], v113 offset:9216
    ds_read_b64_tr_b16 v[90:91], v113 offset:13824
    ds_read_b64_tr_b16 v[92:93], v114 offset:9216
    ds_read_b64_tr_b16 v[94:95], v114 offset:13824
    ds_read_b64_tr_b16 v[96:97], v115 offset:9216
    ds_read_b64_tr_b16 v[98:99], v115 offset:13824
    ds_read_b64_tr_b16 v[100:101], v116 offset:9216
    ds_read_b64_tr_b16 v[102:103], v116 offset:13824
    s_add_u32 m0, s56, 108544
    s_movk_i32 s58, 256
    buffer_load_dwordx4 v12, s[36:39], s58 offen lds
    s_add_u32 m0, s56, 109568
    s_movk_i32 s58, 256
    buffer_load_dwordx4 v13, s[36:39], s58 offen lds
    s_waitcnt lgkmcnt(8)
    v_mfma_f32_16x16x32_bf16 v[44:47], v[84:87], v[28:31], v[44:47]
    s_waitcnt lgkmcnt(6)
    v_mfma_f32_16x16x32_bf16 v[48:51], v[88:91], v[28:31], v[48:51]
    s_waitcnt lgkmcnt(4)
    v_mfma_f32_16x16x32_bf16 v[52:55], v[92:95], v[28:31], v[52:55]
    s_waitcnt lgkmcnt(2)
    v_mfma_f32_16x16x32_bf16 v[56:59], v[96:99], v[28:31], v[56:59]
    s_waitcnt lgkmcnt(0)
    v_mfma_f32_16x16x32_bf16 v[60:63], v[100:103], v[28:31], v[60:63]
    s_add_u32 m0, s57, 106496
    s_mov_b32 s58, 352256
    buffer_load_dwordx4 v14, s[40:43], s58 offen lds
    s_add_u32 m0, s57, 107520
    s_mov_b32 s58, 352256
    buffer_load_dwordx4 v15, s[40:43], s58 offen lds
    s_add_u32 m0, s57, 108544
    s_mov_b32 s58, 352256
    buffer_load_dwordx4 v16, s[40:43], s58 offen lds
    s_add_u32 m0, s57, 109568
    s_mov_b32 s58, 352256
    buffer_load_dwordx4 v17, s[40:43], s58 offen lds
    s_add_u32 m0, s57, 110592
    s_mov_b32 s58, 352256
    buffer_load_dwordx4 v18, s[40:43], s58 offen lds
    s_add_u32 m0, s57, 111616
    s_mov_b32 s58, 352256
    buffer_load_dwordx4 v19, s[40:43], s58 offen lds
    s_add_u32 m0, s57, 112640
    s_mov_b32 s58, 352256
    buffer_load_dwordx4 v20, s[40:43], s58 offen lds
    s_add_u32 m0, s57, 113664
    s_mov_b32 s58, 352256
    buffer_load_dwordx4 v21, s[40:43], s58 offen lds
    s_add_u32 m0, s57, 114688
    s_mov_b32 s58, 352256
    buffer_load_dwordx4 v22, s[40:43], s58 offen lds
    s_waitcnt vmcnt(13)
    s_barrier
    ds_read_b64_tr_b16 v[64:65], v117 offset:0
    ds_read_b64_tr_b16 v[66:67], v117 offset:4608
    ds_read_b64_tr_b16 v[68:69], v118 offset:0
    ds_read_b64_tr_b16 v[70:71], v118 offset:4608
    ds_read_b64_tr_b16 v[72:73], v119 offset:0
    ds_read_b64_tr_b16 v[74:75], v119 offset:4608
    ds_read_b64_tr_b16 v[76:77], v120 offset:0
    ds_read_b64_tr_b16 v[78:79], v120 offset:4608
    ds_read_b64_tr_b16 v[80:81], v121 offset:0
    ds_read_b64_tr_b16 v[82:83], v121 offset:4608
    s_add_u32 m0, s56, 0
    s_movk_i32 s58, 384
    buffer_load_dwordx4 v10, s[36:39], s58 offen lds
    s_add_u32 m0, s56, 1024
    s_movk_i32 s58, 384
    buffer_load_dwordx4 v11, s[36:39], s58 offen lds
    s_waitcnt lgkmcnt(8)
    v_mfma_f32_16x16x32_bf16 v[44:47], v[64:67], v[28:31], v[44:47]
    s_waitcnt lgkmcnt(6)
    v_mfma_f32_16x16x32_bf16 v[48:51], v[68:71], v[28:31], v[48:51]
    s_waitcnt lgkmcnt(4)
    v_mfma_f32_16x16x32_bf16 v[52:55], v[72:75], v[28:31], v[52:55]
    s_waitcnt lgkmcnt(2)
    v_mfma_f32_16x16x32_bf16 v[56:59], v[76:79], v[28:31], v[56:59]
    s_waitcnt lgkmcnt(0)
    v_mfma_f32_16x16x32_bf16 v[60:63], v[80:83], v[28:31], v[60:63]
    ds_read_b64_tr_b16 v[84:85], v117 offset:9216
    ds_read_b64_tr_b16 v[86:87], v117 offset:13824
    ds_read_b64_tr_b16 v[88:89], v118 offset:9216
    ds_read_b64_tr_b16 v[90:91], v118 offset:13824
    ds_read_b64_tr_b16 v[92:93], v119 offset:9216
    ds_read_b64_tr_b16 v[94:95], v119 offset:13824
    ds_read_b64_tr_b16 v[96:97], v120 offset:9216
    ds_read_b64_tr_b16 v[98:99], v120 offset:13824
    ds_read_b64_tr_b16 v[100:101], v121 offset:9216
    ds_read_b64_tr_b16 v[102:103], v121 offset:13824
    s_add_u32 m0, s56, 2048
    s_movk_i32 s58, 384
    buffer_load_dwordx4 v12, s[36:39], s58 offen lds
    s_add_u32 m0, s56, 3072
    s_movk_i32 s58, 384
    buffer_load_dwordx4 v13, s[36:39], s58 offen lds
    s_waitcnt lgkmcnt(8)
    v_mfma_f32_16x16x32_bf16 v[44:47], v[84:87], v[28:31], v[44:47]
    s_waitcnt lgkmcnt(6)
    v_mfma_f32_16x16x32_bf16 v[48:51], v[88:91], v[28:31], v[48:51]
    s_waitcnt lgkmcnt(4)
    v_mfma_f32_16x16x32_bf16 v[52:55], v[92:95], v[28:31], v[52:55]
    s_waitcnt lgkmcnt(2)
    v_mfma_f32_16x16x32_bf16 v[56:59], v[96:99], v[28:31], v[56:59]
    s_waitcnt lgkmcnt(0)
    v_mfma_f32_16x16x32_bf16 v[60:63], v[100:103], v[28:31], v[60:63]
    s_add_u32 m0, s57, 0
    s_mov_b32 s58, 528384
    buffer_load_dwordx4 v14, s[40:43], s58 offen lds
    s_add_u32 m0, s57, 1024
    s_mov_b32 s58, 528384
    buffer_load_dwordx4 v15, s[40:43], s58 offen lds
    s_add_u32 m0, s57, 2048
    s_mov_b32 s58, 528384
    buffer_load_dwordx4 v16, s[40:43], s58 offen lds
    s_add_u32 m0, s57, 3072
    s_mov_b32 s58, 528384
    buffer_load_dwordx4 v17, s[40:43], s58 offen lds
    s_add_u32 m0, s57, 4096
    s_mov_b32 s58, 528384
    buffer_load_dwordx4 v18, s[40:43], s58 offen lds
    s_add_u32 m0, s57, 5120
    s_mov_b32 s58, 528384
    buffer_load_dwordx4 v19, s[40:43], s58 offen lds
    s_add_u32 m0, s57, 6144
    s_mov_b32 s58, 528384
    buffer_load_dwordx4 v20, s[40:43], s58 offen lds
    s_add_u32 m0, s57, 7168
    s_mov_b32 s58, 528384
    buffer_load_dwordx4 v21, s[40:43], s58 offen lds
    s_add_u32 m0, s57, 8192
    s_mov_b32 s58, 528384
    buffer_load_dwordx4 v22, s[40:43], s58 offen lds
    s_waitcnt vmcnt(13)
    s_barrier
    buffer_load_dwordx4 v[104:107], v26, s[32:35], 0 offen sc1
    ds_read_b64_tr_b16 v[64:65], v122 offset:0
    ds_read_b64_tr_b16 v[66:67], v122 offset:4608
    ds_read_b64_tr_b16 v[68:69], v123 offset:0
    ds_read_b64_tr_b16 v[70:71], v123 offset:4608
    ds_read_b64_tr_b16 v[72:73], v124 offset:0
    ds_read_b64_tr_b16 v[74:75], v124 offset:4608
    ds_read_b64_tr_b16 v[76:77], v125 offset:0
    ds_read_b64_tr_b16 v[78:79], v125 offset:4608
    ds_read_b64_tr_b16 v[80:81], v126 offset:0
    ds_read_b64_tr_b16 v[82:83], v126 offset:4608
    s_add_u32 m0, s56, 53248
    s_movk_i32 s58, 512
    buffer_load_dwordx4 v10, s[36:39], s58 offen lds
    s_add_u32 m0, s56, 54272
    s_movk_i32 s58, 512
    buffer_load_dwordx4 v11, s[36:39], s58 offen lds
    s_waitcnt lgkmcnt(8)
    v_mfma_f32_16x16x32_bf16 v[44:47], v[64:67], v[28:31], v[44:47]
    s_waitcnt lgkmcnt(6)
    v_mfma_f32_16x16x32_bf16 v[48:51], v[68:71], v[28:31], v[48:51]
    s_waitcnt lgkmcnt(4)
    v_mfma_f32_16x16x32_bf16 v[52:55], v[72:75], v[28:31], v[52:55]
    s_waitcnt lgkmcnt(2)
    v_mfma_f32_16x16x32_bf16 v[56:59], v[76:79], v[28:31], v[56:59]
    s_waitcnt lgkmcnt(0)
    v_mfma_f32_16x16x32_bf16 v[60:63], v[80:83], v[28:31], v[60:63]
    ds_read_b64_tr_b16 v[84:85], v122 offset:9216
    ds_read_b64_tr_b16 v[86:87], v122 offset:13824
    ds_read_b64_tr_b16 v[88:89], v123 offset:9216
    ds_read_b64_tr_b16 v[90:91], v123 offset:13824
    ds_read_b64_tr_b16 v[92:93], v124 offset:9216
    ds_read_b64_tr_b16 v[94:95], v124 offset:13824
    ds_read_b64_tr_b16 v[96:97], v125 offset:9216
    ds_read_b64_tr_b16 v[98:99], v125 offset:13824
    ds_read_b64_tr_b16 v[100:101], v126 offset:9216
    ds_read_b64_tr_b16 v[102:103], v126 offset:13824
    s_add_u32 m0, s56, 55296
    s_movk_i32 s58, 512
    buffer_load_dwordx4 v12, s[36:39], s58 offen lds
    s_add_u32 m0, s56, 56320
    s_movk_i32 s58, 512
    buffer_load_dwordx4 v13, s[36:39], s58 offen lds
    s_waitcnt lgkmcnt(8)
    v_mfma_f32_16x16x32_bf16 v[44:47], v[84:87], v[28:31], v[44:47]
    s_waitcnt lgkmcnt(6)
    v_mfma_f32_16x16x32_bf16 v[48:51], v[88:91], v[28:31], v[48:51]
    s_waitcnt lgkmcnt(4)
    v_mfma_f32_16x16x32_bf16 v[52:55], v[92:95], v[28:31], v[52:55]
    s_waitcnt lgkmcnt(2)
    v_mfma_f32_16x16x32_bf16 v[56:59], v[96:99], v[28:31], v[56:59]
    s_waitcnt lgkmcnt(0)
    v_mfma_f32_16x16x32_bf16 v[60:63], v[100:103], v[28:31], v[60:63]
    s_add_u32 m0, s57, 53248
    s_mov_b32 s58, 704512
    buffer_load_dwordx4 v14, s[40:43], s58 offen lds
    s_add_u32 m0, s57, 54272
    s_mov_b32 s58, 704512
    buffer_load_dwordx4 v15, s[40:43], s58 offen lds
    s_add_u32 m0, s57, 55296
    s_mov_b32 s58, 704512
    buffer_load_dwordx4 v16, s[40:43], s58 offen lds
    s_add_u32 m0, s57, 56320
    s_mov_b32 s58, 704512
    buffer_load_dwordx4 v17, s[40:43], s58 offen lds
    s_add_u32 m0, s57, 57344
    s_mov_b32 s58, 704512
    buffer_load_dwordx4 v18, s[40:43], s58 offen lds
    s_add_u32 m0, s57, 58368
    s_mov_b32 s58, 704512
    buffer_load_dwordx4 v19, s[40:43], s58 offen lds
    s_add_u32 m0, s57, 59392
    s_mov_b32 s58, 704512
    buffer_load_dwordx4 v20, s[40:43], s58 offen lds
    s_add_u32 m0, s57, 60416
    s_mov_b32 s58, 704512
    buffer_load_dwordx4 v21, s[40:43], s58 offen lds
    s_add_u32 m0, s57, 61440
    s_mov_b32 s58, 704512
    buffer_load_dwordx4 v22, s[40:43], s58 offen lds
    s_waitcnt vmcnt(14)
    s_barrier
    ds_read_b64_tr_b16 v[64:65], v112 offset:0
    ds_read_b64_tr_b16 v[66:67], v112 offset:4608
    ds_read_b64_tr_b16 v[68:69], v113 offset:0
    ds_read_b64_tr_b16 v[70:71], v113 offset:4608
    ds_read_b64_tr_b16 v[72:73], v114 offset:0
    ds_read_b64_tr_b16 v[74:75], v114 offset:4608
    ds_read_b64_tr_b16 v[76:77], v115 offset:0
    ds_read_b64_tr_b16 v[78:79], v115 offset:4608
    ds_read_b64_tr_b16 v[80:81], v116 offset:0
    ds_read_b64_tr_b16 v[82:83], v116 offset:4608
    s_add_u32 m0, s56, 106496
    s_movk_i32 s58, 640
    buffer_load_dwordx4 v10, s[36:39], s58 offen lds
    s_add_u32 m0, s56, 107520
    s_movk_i32 s58, 640
    buffer_load_dwordx4 v11, s[36:39], s58 offen lds
    s_waitcnt lgkmcnt(8)
    v_mfma_f32_16x16x32_bf16 v[44:47], v[64:67], v[28:31], v[44:47]
    s_waitcnt lgkmcnt(6)
    v_mfma_f32_16x16x32_bf16 v[48:51], v[68:71], v[28:31], v[48:51]
    s_waitcnt lgkmcnt(4)
    v_mfma_f32_16x16x32_bf16 v[52:55], v[72:75], v[28:31], v[52:55]
    s_waitcnt lgkmcnt(2)
    v_mfma_f32_16x16x32_bf16 v[56:59], v[76:79], v[28:31], v[56:59]
    s_waitcnt lgkmcnt(0)
    v_mfma_f32_16x16x32_bf16 v[60:63], v[80:83], v[28:31], v[60:63]
    ds_read_b64_tr_b16 v[84:85], v112 offset:9216
    ds_read_b64_tr_b16 v[86:87], v112 offset:13824
    ds_read_b64_tr_b16 v[88:89], v113 offset:9216
    ds_read_b64_tr_b16 v[90:91], v113 offset:13824
    ds_read_b64_tr_b16 v[92:93], v114 offset:9216
    ds_read_b64_tr_b16 v[94:95], v114 offset:13824
    ds_read_b64_tr_b16 v[96:97], v115 offset:9216
    ds_read_b64_tr_b16 v[98:99], v115 offset:13824
    ds_read_b64_tr_b16 v[100:101], v116 offset:9216
    ds_read_b64_tr_b16 v[102:103], v116 offset:13824
    s_add_u32 m0, s56, 108544
    s_movk_i32 s58, 640
    buffer_load_dwordx4 v12, s[36:39], s58 offen lds
    s_add_u32 m0, s56, 109568
    s_movk_i32 s58, 640
    buffer_load_dwordx4 v13, s[36:39], s58 offen lds
    s_waitcnt lgkmcnt(8)
    v_mfma_f32_16x16x32_bf16 v[44:47], v[84:87], v[28:31], v[44:47]
    s_waitcnt lgkmcnt(6)
    v_mfma_f32_16x16x32_bf16 v[48:51], v[88:91], v[28:31], v[48:51]
    s_waitcnt lgkmcnt(4)
    v_mfma_f32_16x16x32_bf16 v[52:55], v[92:95], v[28:31], v[52:55]
    s_waitcnt lgkmcnt(2)
    v_mfma_f32_16x16x32_bf16 v[56:59], v[96:99], v[28:31], v[56:59]
    s_waitcnt lgkmcnt(0)
    v_mfma_f32_16x16x32_bf16 v[60:63], v[100:103], v[28:31], v[60:63]
    s_add_u32 m0, s57, 106496
    s_mov_b32 s58, 880640
    buffer_load_dwordx4 v14, s[40:43], s58 offen lds
    s_add_u32 m0, s57, 107520
    s_mov_b32 s58, 880640
    buffer_load_dwordx4 v15, s[40:43], s58 offen lds
    s_add_u32 m0, s57, 108544
    s_mov_b32 s58, 880640
    buffer_load_dwordx4 v16, s[40:43], s58 offen lds
    s_add_u32 m0, s57, 109568
    s_mov_b32 s58, 880640
    buffer_load_dwordx4 v17, s[40:43], s58 offen lds
    s_add_u32 m0, s57, 110592
    s_mov_b32 s58, 880640
    buffer_load_dwordx4 v18, s[40:43], s58 offen lds
    s_add_u32 m0, s57, 111616
    s_mov_b32 s58, 880640
    buffer_load_dwordx4 v19, s[40:43], s58 offen lds
    s_add_u32 m0, s57, 112640
    s_mov_b32 s58, 880640
    buffer_load_dwordx4 v20, s[40:43], s58 offen lds
    s_add_u32 m0, s57, 113664
    s_mov_b32 s58, 880640
    buffer_load_dwordx4 v21, s[40:43], s58 offen lds
    s_add_u32 m0, s57, 114688
    s_mov_b32 s58, 880640
    buffer_load_dwordx4 v22, s[40:43], s58 offen lds
    s_waitcnt vmcnt(13)
    v_cmp_eq_u32 vcc, s29, v106
    s_nop 3
    s_cmp_eq_u64 vcc, -1
    s_cbranch_scc1 fz_valokF
    s_mov_b32 s3, 300000
fz_prF:
    buffer_load_dwordx4 v[104:107], v26, s[32:35], 0 offen sc1
    s_waitcnt vmcnt(0)
    v_cmp_eq_u32 vcc, s29, v106
    s_sub_u32 s3, s3, 1
    s_cmp_eq_u32 s3, 0
    s_cbranch_scc1 fz_prF_ok
    s_cmp_eq_u64 vcc, -1
    s_cbranch_scc1 fz_prF_ok
    s_sleep 2
    s_branch fz_prF
fz_prF_ok:
fz_valokF:
    s_barrier
    ds_read_b64_tr_b16 v[64:65], v117 offset:0
    ds_read_b64_tr_b16 v[66:67], v117 offset:4608
    ds_read_b64_tr_b16 v[68:69], v118 offset:0
    ds_read_b64_tr_b16 v[70:71], v118 offset:4608
    ds_read_b64_tr_b16 v[72:73], v119 offset:0
    ds_read_b64_tr_b16 v[74:75], v119 offset:4608
    ds_read_b64_tr_b16 v[76:77], v120 offset:0
    ds_read_b64_tr_b16 v[78:79], v120 offset:4608
    ds_read_b64_tr_b16 v[80:81], v121 offset:0
    ds_read_b64_tr_b16 v[82:83], v121 offset:4608
    s_add_u32 m0, s56, 0
    s_movk_i32 s58, 768
    buffer_load_dwordx4 v10, s[36:39], s58 offen lds
    s_add_u32 m0, s56, 1024
    s_movk_i32 s58, 768
    buffer_load_dwordx4 v11, s[36:39], s58 offen lds
    s_waitcnt lgkmcnt(8)
    v_mfma_f32_16x16x32_bf16 v[44:47], v[64:67], v[28:31], v[44:47]
    s_waitcnt lgkmcnt(6)
    v_mfma_f32_16x16x32_bf16 v[48:51], v[68:71], v[28:31], v[48:51]
    s_waitcnt lgkmcnt(4)
    v_mfma_f32_16x16x32_bf16 v[52:55], v[72:75], v[28:31], v[52:55]
    s_waitcnt lgkmcnt(2)
    v_mfma_f32_16x16x32_bf16 v[56:59], v[76:79], v[28:31], v[56:59]
    s_waitcnt lgkmcnt(0)
    v_mfma_f32_16x16x32_bf16 v[60:63], v[80:83], v[28:31], v[60:63]
    ds_read_b64_tr_b16 v[84:85], v117 offset:9216
    ds_read_b64_tr_b16 v[86:87], v117 offset:13824
    ds_read_b64_tr_b16 v[88:89], v118 offset:9216
    ds_read_b64_tr_b16 v[90:91], v118 offset:13824
    ds_read_b64_tr_b16 v[92:93], v119 offset:9216
    ds_read_b64_tr_b16 v[94:95], v119 offset:13824
    ds_read_b64_tr_b16 v[96:97], v120 offset:9216
    ds_read_b64_tr_b16 v[98:99], v120 offset:13824
    ds_read_b64_tr_b16 v[100:101], v121 offset:9216
    ds_read_b64_tr_b16 v[102:103], v121 offset:13824
    s_add_u32 m0, s56, 2048
    s_movk_i32 s58, 768
    buffer_load_dwordx4 v12, s[36:39], s58 offen lds
    s_add_u32 m0, s56, 3072
    s_movk_i32 s58, 768
    buffer_load_dwordx4 v13, s[36:39], s58 offen lds
    s_waitcnt lgkmcnt(8)
    v_mfma_f32_16x16x32_bf16 v[44:47], v[84:87], v[28:31], v[44:47]
    s_waitcnt lgkmcnt(6)
    v_mfma_f32_16x16x32_bf16 v[48:51], v[88:91], v[28:31], v[48:51]
    s_waitcnt lgkmcnt(4)
    v_mfma_f32_16x16x32_bf16 v[52:55], v[92:95], v[28:31], v[52:55]
    s_waitcnt lgkmcnt(2)
    v_mfma_f32_16x16x32_bf16 v[56:59], v[96:99], v[28:31], v[56:59]
    s_waitcnt lgkmcnt(0)
    v_mfma_f32_16x16x32_bf16 v[60:63], v[100:103], v[28:31], v[60:63]
    s_add_u32 m0, s57, 0
    s_mov_b32 s58, 1056768
    buffer_load_dwordx4 v14, s[40:43], s58 offen lds
    s_add_u32 m0, s57, 1024
    s_mov_b32 s58, 1056768
    buffer_load_dwordx4 v15, s[40:43], s58 offen lds
    s_add_u32 m0, s57, 2048
    s_mov_b32 s58, 1056768
    buffer_load_dwordx4 v16, s[40:43], s58 offen lds
    s_add_u32 m0, s57, 3072
    s_mov_b32 s58, 1056768
    buffer_load_dwordx4 v17, s[40:43], s58 offen lds
    s_add_u32 m0, s57, 4096
    s_mov_b32 s58, 1056768
    buffer_load_dwordx4 v18, s[40:43], s58 offen lds
    s_add_u32 m0, s57, 5120
    s_mov_b32 s58, 1056768
    buffer_load_dwordx4 v19, s[40:43], s58 offen lds
    s_add_u32 m0, s57, 6144
    s_mov_b32 s58, 1056768
    buffer_load_dwordx4 v20, s[40:43], s58 offen lds
    s_add_u32 m0, s57, 7168
    s_mov_b32 s58, 1056768
    buffer_load_dwordx4 v21, s[40:43], s58 offen lds
    s_add_u32 m0, s57, 8192
    s_mov_b32 s58, 1056768
    buffer_load_dwordx4 v22, s[40:43], s58 offen lds
    v_lshlrev_b32 v108, 16, v104
    v_xor_b32 v108, 0x80000000, v108
    v_and_b32 v110, 0xffff0000, v104
    v_rcp_f32 v110, v110
    v_lshlrev_b32 v109, 16, v105
    v_xor_b32 v109, 0x80000000, v109
    v_and_b32 v111, 0xffff0000, v105
    v_rcp_f32 v111, v111
    s_nop 0
    ds_write_b64 v27, v[108:109] offset:0
    ds_write_b64 v27, v[110:111] offset:512
    s_waitcnt vmcnt(13)
    s_barrier
    ds_read_b64_tr_b16 v[64:65], v122 offset:0
    ds_read_b64_tr_b16 v[66:67], v122 offset:4608
    ds_read_b64_tr_b16 v[68:69], v123 offset:0
    ds_read_b64_tr_b16 v[70:71], v123 offset:4608
    ds_read_b64_tr_b16 v[72:73], v124 offset:0
    ds_read_b64_tr_b16 v[74:75], v124 offset:4608
    ds_read_b64_tr_b16 v[76:77], v125 offset:0
    ds_read_b64_tr_b16 v[78:79], v125 offset:4608
    ds_read_b64_tr_b16 v[80:81], v126 offset:0
    ds_read_b64_tr_b16 v[82:83], v126 offset:4608
    s_add_u32 m0, s56, 53248
    s_movk_i32 s58, 896
    buffer_load_dwordx4 v10, s[36:39], s58 offen lds
    s_add_u32 m0, s56, 54272
    s_movk_i32 s58, 896
    buffer_load_dwordx4 v11, s[36:39], s58 offen lds
    s_waitcnt lgkmcnt(8)
    v_mfma_f32_16x16x32_bf16 v[44:47], v[64:67], v[28:31], v[44:47]
    s_waitcnt lgkmcnt(6)
    v_mfma_f32_16x16x32_bf16 v[48:51], v[68:71], v[28:31], v[48:51]
    s_waitcnt lgkmcnt(4)
    v_mfma_f32_16x16x32_bf16 v[52:55], v[72:75], v[28:31], v[52:55]
    s_waitcnt lgkmcnt(2)
    v_mfma_f32_16x16x32_bf16 v[56:59], v[76:79], v[28:31], v[56:59]
    s_waitcnt lgkmcnt(0)
    v_mfma_f32_16x16x32_bf16 v[60:63], v[80:83], v[28:31], v[60:63]
    ds_read_b64_tr_b16 v[84:85], v122 offset:9216
    ds_read_b64_tr_b16 v[86:87], v122 offset:13824
    ds_read_b64_tr_b16 v[88:89], v123 offset:9216
    ds_read_b64_tr_b16 v[90:91], v123 offset:13824
    ds_read_b64_tr_b16 v[92:93], v124 offset:9216
    ds_read_b64_tr_b16 v[94:95], v124 offset:13824
    ds_read_b64_tr_b16 v[96:97], v125 offset:9216
    ds_read_b64_tr_b16 v[98:99], v125 offset:13824
    ds_read_b64_tr_b16 v[100:101], v126 offset:9216
    ds_read_b64_tr_b16 v[102:103], v126 offset:13824
    s_add_u32 m0, s56, 55296
    s_movk_i32 s58, 896
    buffer_load_dwordx4 v12, s[36:39], s58 offen lds
    s_add_u32 m0, s56, 56320
    s_movk_i32 s58, 896
    buffer_load_dwordx4 v13, s[36:39], s58 offen lds
    s_waitcnt lgkmcnt(8)
    v_mfma_f32_16x16x32_bf16 v[44:47], v[84:87], v[28:31], v[44:47]
    s_waitcnt lgkmcnt(6)
    v_mfma_f32_16x16x32_bf16 v[48:51], v[88:91], v[28:31], v[48:51]
    s_waitcnt lgkmcnt(4)
    v_mfma_f32_16x16x32_bf16 v[52:55], v[92:95], v[28:31], v[52:55]
    s_waitcnt lgkmcnt(2)
    v_mfma_f32_16x16x32_bf16 v[56:59], v[96:99], v[28:31], v[56:59]
    s_waitcnt lgkmcnt(0)
    v_mfma_f32_16x16x32_bf16 v[60:63], v[100:103], v[28:31], v[60:63]
    s_add_u32 m0, s57, 53248
    s_mov_b32 s58, 1232896
    buffer_load_dwordx4 v14, s[40:43], s58 offen lds
    s_add_u32 m0, s57, 54272
    s_mov_b32 s58, 1232896
    buffer_load_dwordx4 v15, s[40:43], s58 offen lds
    s_add_u32 m0, s57, 55296
    s_mov_b32 s58, 1232896
    buffer_load_dwordx4 v16, s[40:43], s58 offen lds
    s_add_u32 m0, s57, 56320
    s_mov_b32 s58, 1232896
    buffer_load_dwordx4 v17, s[40:43], s58 offen lds
    s_add_u32 m0, s57, 57344
    s_mov_b32 s58, 1232896
    buffer_load_dwordx4 v18, s[40:43], s58 offen lds
    s_add_u32 m0, s57, 58368
    s_mov_b32 s58, 1232896
    buffer_load_dwordx4 v19, s[40:43], s58 offen lds
    s_add_u32 m0, s57, 59392
    s_mov_b32 s58, 1232896
    buffer_load_dwordx4 v20, s[40:43], s58 offen lds
    s_add_u32 m0, s57, 60416
    s_mov_b32 s58, 1232896
    buffer_load_dwordx4 v21, s[40:43], s58 offen lds
    s_add_u32 m0, s57, 61440
    s_mov_b32 s58, 1232896
    buffer_load_dwordx4 v22, s[40:43], s58 offen lds
    s_mov_b32 s40, s16
    s_mov_b32 s41, s17
    s_mov_b32 s42, 0x158000
    s_mov_b32 s43, 0x00020000
    s_mov_b32 s44, s8
    s_mov_b32 s45, s9
    s_mov_b32 s46, 0x80000
    s_mov_b32 s47, 0x00020000
    v_lshrrev_b32 v3, 3, v0
    v_and_b32 v4, 7, v0
    v_and_b32 v5, 6, v3
    v_xor_b32 v4, v4, v5
    v_lshlrev_b32 v4, 4, v4
    v_and_b32 v5, 4, v3
    v_add_u32 v3, v3, v5
    v_lshl_add_u32 v4, v3, 10, v4
    s_lshl_b32 s3, s28, 7
    v_add_u32 v2, s3, v4
    s_mul_i32 s56, s31, 12288
    s_add_u32 s56, s56, 4096
    s_lshl_b32 s57, s31, 15
    s_mul_i32 s59, s31, 131072
    s_waitcnt lgkmcnt(0)
    s_waitcnt vmcnt(13)
    s_barrier
    ds_read_b64_tr_b16 v[64:65], v112 offset:0
    ds_read_b64_tr_b16 v[66:67], v112 offset:4608
    ds_read_b64_tr_b16 v[68:69], v113 offset:0
    ds_read_b64_tr_b16 v[70:71], v113 offset:4608
    ds_read_b64_tr_b16 v[72:73], v114 offset:0
    ds_read_b64_tr_b16 v[74:75], v114 offset:4608
    ds_read_b64_tr_b16 v[76:77], v115 offset:0
    ds_read_b64_tr_b16 v[78:79], v115 offset:4608
    ds_read_b64_tr_b16 v[80:81], v116 offset:0
    ds_read_b64_tr_b16 v[82:83], v116 offset:4608
    s_add_u32 m0, s56, 106496
    s_add_u32 s58, s57, 0
    buffer_load_dwordx4 v2, s[40:43], s58 offen lds
    s_add_u32 m0, s56, 107520
    s_add_u32 s58, s57, 16384
    buffer_load_dwordx4 v2, s[40:43], s58 offen lds
    s_waitcnt lgkmcnt(8)
    v_mfma_f32_16x16x32_bf16 v[44:47], v[64:67], v[28:31], v[44:47]
    s_waitcnt lgkmcnt(6)
    v_mfma_f32_16x16x32_bf16 v[48:51], v[68:71], v[28:31], v[48:51]
    s_waitcnt lgkmcnt(4)
    v_mfma_f32_16x16x32_bf16 v[52:55], v[72:75], v[28:31], v[52:55]
    s_waitcnt lgkmcnt(2)
    v_mfma_f32_16x16x32_bf16 v[56:59], v[76:79], v[28:31], v[56:59]
    s_waitcnt lgkmcnt(0)
    v_mfma_f32_16x16x32_bf16 v[60:63], v[80:83], v[28:31], v[60:63]
    ds_read_b64_tr_b16 v[84:85], v112 offset:9216
    ds_read_b64_tr_b16 v[86:87], v112 offset:13824
    ds_read_b64_tr_b16 v[88:89], v113 offset:9216
    ds_read_b64_tr_b16 v[90:91], v113 offset:13824
    ds_read_b64_tr_b16 v[92:93], v114 offset:9216
    ds_read_b64_tr_b16 v[94:95], v114 offset:13824
    ds_read_b64_tr_b16 v[96:97], v115 offset:9216
    ds_read_b64_tr_b16 v[98:99], v115 offset:13824
    ds_read_b64_tr_b16 v[100:101], v116 offset:9216
    ds_read_b64_tr_b16 v[102:103], v116 offset:13824
    s_add_u32 m0, s56, 108544
    s_add_u32 s58, s57, 4096
    buffer_load_dwordx4 v2, s[40:43], s58 offen lds
    s_add_u32 m0, s56, 109568
    s_add_u32 s58, s57, 20480
    buffer_load_dwordx4 v2, s[40:43], s58 offen lds
    s_waitcnt lgkmcnt(8)
    v_mfma_f32_16x16x32_bf16 v[44:47], v[84:87], v[28:31], v[44:47]
    s_waitcnt lgkmcnt(6)
    v_mfma_f32_16x16x32_bf16 v[48:51], v[88:91], v[28:31], v[48:51]
    s_waitcnt lgkmcnt(4)
    v_mfma_f32_16x16x32_bf16 v[52:55], v[92:95], v[28:31], v[52:55]
    s_waitcnt lgkmcnt(2)
    v_mfma_f32_16x16x32_bf16 v[56:59], v[96:99], v[28:31], v[56:59]
    s_waitcnt lgkmcnt(0)
    v_mfma_f32_16x16x32_bf16 v[60:63], v[100:103], v[28:31], v[60:63]
    s_add_u32 m0, s56, 110592
    s_add_u32 s58, s57, 131072
    buffer_load_dwordx4 v2, s[40:43], s58 offen lds
    s_add_u32 m0, s56, 111616
    s_add_u32 s58, s57, 147456
    buffer_load_dwordx4 v2, s[40:43], s58 offen lds
    s_add_u32 m0, s56, 112640
    s_add_u32 s58, s57, 135168
    buffer_load_dwordx4 v2, s[40:43], s58 offen lds
    s_add_u32 m0, s56, 113664
    s_add_u32 s58, s57, 151552
    buffer_load_dwordx4 v2, s[40:43], s58 offen lds
    s_add_u32 m0, s56, 114688
    s_add_u32 s58, s57, 262144
    buffer_load_dwordx4 v2, s[40:43], s58 offen lds
    s_add_u32 m0, s56, 115712
    s_add_u32 s58, s57, 278528
    buffer_load_dwordx4 v2, s[40:43], s58 offen lds
    s_add_u32 m0, s56, 116736
    s_add_u32 s58, s57, 266240
    buffer_load_dwordx4 v2, s[40:43], s58 offen lds
    s_add_u32 m0, s56, 117760
    s_add_u32 s58, s57, 282624
    buffer_load_dwordx4 v2, s[40:43], s58 offen lds
    s_waitcnt vmcnt(12)
    s_barrier
    ds_read_b64_tr_b16 v[64:65], v117 offset:0
    ds_read_b64_tr_b16 v[66:67], v117 offset:4608
    ds_read_b64_tr_b16 v[68:69], v118 offset:0
    ds_read_b64_tr_b16 v[70:71], v118 offset:4608
    ds_read_b64_tr_b16 v[72:73], v119 offset:0
    ds_read_b64_tr_b16 v[74:75], v119 offset:4608
    ds_read_b64_tr_b16 v[76:77], v120 offset:0
    ds_read_b64_tr_b16 v[78:79], v120 offset:4608
    ds_read_b64_tr_b16 v[80:81], v121 offset:0
    ds_read_b64_tr_b16 v[82:83], v121 offset:4608
    s_waitcnt lgkmcnt(8)
    v_mfma_f32_16x16x32_bf16 v[44:47], v[64:67], v[28:31], v[44:47]
    s_waitcnt lgkmcnt(6)
    v_mfma_f32_16x16x32_bf16 v[48:51], v[68:71], v[28:31], v[48:51]
    s_waitcnt lgkmcnt(4)
    v_mfma_f32_16x16x32_bf16 v[52:55], v[72:75], v[28:31], v[52:55]
    s_waitcnt lgkmcnt(2)
    v_mfma_f32_16x16x32_bf16 v[56:59], v[76:79], v[28:31], v[56:59]
    s_waitcnt lgkmcnt(0)
    v_mfma_f32_16x16x32_bf16 v[60:63], v[80:83], v[28:31], v[60:63]
    ds_read_b64_tr_b16 v[84:85], v117 offset:9216
    ds_read_b64_tr_b16 v[86:87], v117 offset:13824
    ds_read_b64_tr_b16 v[88:89], v118 offset:9216
    ds_read_b64_tr_b16 v[90:91], v118 offset:13824
    ds_read_b64_tr_b16 v[92:93], v119 offset:9216
    ds_read_b64_tr_b16 v[94:95], v119 offset:13824
    ds_read_b64_tr_b16 v[96:97], v120 offset:9216
    ds_read_b64_tr_b16 v[98:99], v120 offset:13824
    ds_read_b64_tr_b16 v[100:101], v121 offset:9216
    ds_read_b64_tr_b16 v[102:103], v121 offset:13824
    s_waitcnt lgkmcnt(8)
    v_mfma_f32_16x16x32_bf16 v[44:47], v[84:87], v[28:31], v[44:47]
    s_waitcnt lgkmcnt(6)
    v_mfma_f32_16x16x32_bf16 v[48:51], v[88:91], v[28:31], v[48:51]
    s_waitcnt lgkmcnt(4)
    v_mfma_f32_16x16x32_bf16 v[52:55], v[92:95], v[28:31], v[52:55]
    s_waitcnt lgkmcnt(2)
    v_mfma_f32_16x16x32_bf16 v[56:59], v[96:99], v[28:31], v[56:59]
    s_waitcnt lgkmcnt(0)
    v_mfma_f32_16x16x32_bf16 v[60:63], v[100:103], v[28:31], v[60:63]
    v_lshrrev_b32 v3, 4, v0
    v_lshlrev_b32 v6, 4, v3
    s_nop 5
    s_lshl_b32 s3, s61, 6
    v_add_u32 v7, s3, v6
    ds_write_b128 v7, v[44:47] offset:1024
    s_lshl_b32 s3, s62, 6
    v_add_u32 v7, s3, v6
    ds_write_b128 v7, v[48:51] offset:1024
    s_lshl_b32 s3, s63, 6
    v_add_u32 v7, s3, v6
    ds_write_b128 v7, v[52:55] offset:1024
    s_lshl_b32 s3, s64, 6
    v_add_u32 v7, s3, v6
    ds_write_b128 v7, v[56:59] offset:1024
    s_lshl_b32 s3, s65, 6
    v_add_u32 v7, s3, v6
    ds_write_b128 v7, v[60:63] offset:1024
    s_add_u32 m0, s56, 0
    s_add_u32 s58, s57, 393216
    buffer_load_dwordx4 v2, s[40:43], s58 offen lds
    s_add_u32 m0, s56, 1024
    s_add_u32 s58, s57, 409600
    buffer_load_dwordx4 v2, s[40:43], s58 offen lds
    s_add_u32 m0, s56, 2048
    s_add_u32 s58, s57, 397312
    buffer_load_dwordx4 v2, s[40:43], s58 offen lds
    s_add_u32 m0, s56, 3072
    s_add_u32 s58, s57, 413696
    buffer_load_dwordx4 v2, s[40:43], s58 offen lds
    s_add_u32 m0, s56, 4096
    s_add_u32 s58, s57, 524288
    buffer_load_dwordx4 v2, s[40:43], s58 offen lds
    s_add_u32 m0, s56, 5120
    s_add_u32 s58, s57, 540672
    buffer_load_dwordx4 v2, s[40:43], s58 offen lds
    s_add_u32 m0, s56, 6144
    s_add_u32 s58, s57, 528384
    buffer_load_dwordx4 v2, s[40:43], s58 offen lds
    s_add_u32 m0, s56, 7168
    s_add_u32 s58, s57, 544768
    buffer_load_dwordx4 v2, s[40:43], s58 offen lds
    s_add_u32 m0, s56, 8192
    s_add_u32 s58, s57, 655360
    buffer_load_dwordx4 v2, s[40:43], s58 offen lds
    s_add_u32 m0, s56, 9216
    s_add_u32 s58, s57, 671744
    buffer_load_dwordx4 v2, s[40:43], s58 offen lds
    s_add_u32 m0, s56, 10240
    s_add_u32 s58, s57, 659456
    buffer_load_dwordx4 v2, s[40:43], s58 offen lds
    s_add_u32 m0, s56, 11264
    s_add_u32 s58, s57, 675840
    buffer_load_dwordx4 v2, s[40:43], s58 offen lds
fz_ldone:
    v_lshrrev_b32 v3, 4, v0
    v_lshrrev_b32 v5, 2, v0
    v_bfe_u32 v6, v5, 1, 2
    v_and_b32 v7, 3, v0
    v_lshlrev_b32 v7, 3, v7
    v_lshl_add_u32 v7, v5, 7, v7
    v_add_u32 v7, s56, v7
    v_xor_b32 v8, 0, v6
    v_lshl_add_u32 v10, v8, 5, v7
    v_add_u32 v18, 106496, v10
    v_xor_b32 v8, 1, v6
    v_lshl_add_u32 v11, v8, 5, v7
    v_add_u32 v19, 106496, v11
    v_xor_b32 v8, 2, v6
    v_lshl_add_u32 v12, v8, 5, v7
    v_add_u32 v20, 106496, v12
    v_xor_b32 v8, 3, v6
    v_lshl_add_u32 v13, v8, 5, v7
    v_add_u32 v21, 106496, v13
    s_waitcnt lgkmcnt(0)
    s_barrier
    s_setprio 0
    s_cmp_lt_u32 s25, 10
    s_cbranch_scc1 fz_nqd
    v_and_b32 v4, 3, v0
    v_lshlrev_b32 v4, 2, v4
    s_mov_b32 s3, 6000000
fz_qd:
    ds_read_b32 v5, v4 offset:2320
    s_waitcnt lgkmcnt(0)
    v_cmp_eq_u32 vcc, s29, v5
    s_sub_u32 s3, s3, 1
    s_cmp_eq_u32 s3, 0
    s_cbranch_scc1 fz_qd_ok
    s_cmp_eq_u64 vcc, -1
    s_cbranch_scc1 fz_qd_ok
    s_sleep 2
    s_branch fz_qd
fz_qd_ok:
    s_add_u32 m0, s56, 0
    s_add_u32 s58, s57, 393216
    buffer_load_dwordx4 v2, s[40:43], s58 offen lds
    s_add_u32 m0, s56, 1024
    s_add_u32 s58, s57, 409600
    buffer_load_dwordx4 v2, s[40:43], s58 offen lds
    s_add_u32 m0, s56, 2048
    s_add_u32 s58, s57, 397312
    buffer_load_dwordx4 v2, s[40:43], s58 offen lds
    s_add_u32 m0, s56, 3072
    s_add_u32 s58, s57, 413696
    buffer_load_dwordx4 v2, s[40:43], s58 offen lds
    s_add_u32 m0, s56, 4096
    s_add_u32 s58, s57, 524288
    buffer_load_dwordx4 v2, s[40:43], s58 offen lds
    s_add_u32 m0, s56, 5120
    s_add_u32 s58, s57, 540672
    buffer_load_dwordx4 v2, s[40:43], s58 offen lds
    s_add_u32 m0, s56, 6144
    s_add_u32 s58, s57, 528384
    buffer_load_dwordx4 v2, s[40:43], s58 offen lds
    s_add_u32 m0, s56, 7168
    s_add_u32 s58, s57, 544768
    buffer_load_dwordx4 v2, s[40:43], s58 offen lds
    s_add_u32 m0, s56, 8192
    s_add_u32 s58, s57, 655360
    buffer_load_dwordx4 v2, s[40:43], s58 offen lds
    s_add_u32 m0, s56, 9216
    s_add_u32 s58, s57, 671744
    buffer_load_dwordx4 v2, s[40:43], s58 offen lds
    s_add_u32 m0, s56, 10240
    s_add_u32 s58, s57, 659456
    buffer_load_dwordx4 v2, s[40:43], s58 offen lds
    s_add_u32 m0, s56, 11264
    s_add_u32 s58, s57, 675840
    buffer_load_dwordx4 v2, s[40:43], s58 offen lds
fz_nqd:
    s_mov_b32 s48, s22
    s_mov_b32 s49, s23
    s_mov_b32 s50, 0x600000
    s_mov_b32 s51, 0x00020000
    s_lshl_b32 s0, s10, 8
    s_lshl_b32 s1, s31, 7
    s_add_u32 s1, s1, s0
    s_sub_u32 s1, s1, 256
    v_and_b32 v128, 31, v0
    v_lshrrev_b32 v129, 5, v0
    v_lshlrev_b32 v129, 4, v129
    v_and_b32 v130, 0x13, v128
    v_bfe_u32 v131, v128, 2, 1
    v_lshl_or_b32 v130, v131, 3, v130
    v_bfe_u32 v131, v128, 3, 1
    v_lshl_or_b32 v130, v131, 2, v130
    v_add_u32 v130, s1, v130
    v_add_u32 v132, 0, v130
    v_max_i32 v132, 0, v132
    v_lshl_add_u32 v132, v132, 5, v129
    v_add_u32 v133, 32, v130
    v_max_i32 v133, 0, v133
    v_lshl_add_u32 v133, v133, 5, v129
    v_add_u32 v134, 64, v130
    v_max_i32 v134, 0, v134
    v_lshl_add_u32 v134, v134, 5, v129
    v_add_u32 v135, 96, v130
    v_max_i32 v135, 0, v135
    v_lshl_add_u32 v135, v135, 5, v129
    s_lshl_b32 s3, s31, 6
    s_add_u32 s3, s3, s0
    v_add_u32 v136, s3, v128
    v_lshl_add_u32 v136, v136, 5, v129
    v_lshlrev_b32 v137, 4, v0
    s_lshr_b32 s5, s11, 3
    s_lshl_b32 s5, s5, 8
    s_add_u32 s5, s5, 267264
    s_lshl_b32 s3, s10, 1
    s_add_u32 s4, s3, s31
    s_sub_u32 s4, s4, 2
    s_max_i32 s4, s4, 0
    s_lshl_b32 s4, s4, 13
    s_add_u32 s6, s4, s5
    s_add_u32 s6, s6, 1024
    s_lshr_b32 s4, s31, 1
    s_add_u32 s4, s4, s3
    s_lshl_b32 s4, s4, 13
    s_add_u32 s4, s4, s5
    s_and_b32 s5, s31, 1
    s_lshl_b32 s5, s5, 7
    s_add_u32 s4, s4, s5
    v_and_b32 v138, 1, v0
    v_lshlrev_b32 v138, 7, v138
    v_bfe_u32 v139, v0, 1, 1
    v_lshl_add_u32 v138, v139, 10, v138
    v_add_u32 v138, s6, v138
    v_mov_b32 v139, s4
    v_and_b32 v140, 4, v0
    v_cmp_eq_u32 vcc, 0, v140
    s_nop 1
    v_cndmask_b32 v138, v139, v138, vcc
    s_mul_i32 s4, s11, 65536
    s_add_u32 s5, s4, 2097152
    s_lshl_b32 s6, s1, 5
    s_add_u32 s6, s6, s4
    s_add_u32 s6, s6, 4194304
    s_cmp_ge_i32 s1, 0
    s_cselect_b32 s6, s6, 0x7fff0000
    s_lshl_b32 s7, s31, 12
    s_add_u32 s7, s7, 57344
    s_lshl_b32 s0, s31, 11
    s_add_u32 s0, s0, 90112
    s_mov_b32 s3, 300000
fz_pq:
    buffer_load_dword v4, v138, s[32:35], 0 offen sc1
    s_waitcnt vmcnt(0)
    v_cmp_eq_u32 vcc, s29, v4
    s_sub_u32 s3, s3, 1
    s_cmp_eq_u32 s3, 0
    s_cbranch_scc1 fz_pq_ok
    s_cmp_eq_u64 vcc, -1
    s_cbranch_scc1 fz_pq_ok
    s_sleep 2
    s_branch fz_pq
fz_pq_ok:
    s_mov_b32 m0, s0
    s_nop 0
    buffer_load_dwordx4 v136, s[48:51], s4 offen offset:0 sc1 lds
    buffer_load_dwordx4 v136, s[48:51], s4 offen offset:1024 sc1 lds
    s_add_u32 m0, s7, 0
    s_nop 0
    buffer_load_dwordx4 v132, s[48:51], s5 offen sc1 lds
    s_add_u32 m0, s7, 1024
    s_nop 0
    buffer_load_dwordx4 v133, s[48:51], s5 offen sc1 lds
    s_add_u32 m0, s7, 2048
    s_nop 0
    buffer_load_dwordx4 v134, s[48:51], s5 offen sc1 lds
    s_add_u32 m0, s7, 3072
    s_nop 0
    buffer_load_dwordx4 v135, s[48:51], s5 offen sc1 lds
    s_add_u32 m0, s7, 16384
    s_nop 0
    buffer_load_dwordx4 v137, s[48:51], s6 offen offset:0 sc1 lds
    buffer_load_dwordx4 v137, s[48:51], s6 offen offset:1024 sc1 lds
    buffer_load_dwordx4 v137, s[48:51], s6 offen offset:2048 sc1 lds
    buffer_load_dwordx4 v137, s[48:51], s6 offen offset:3072 sc1 lds
    ds_read_b64_tr_b16 v[32:33], v18 offset:0
    ds_read_b64_tr_b16 v[34:35], v18 offset:2048
    ds_read_b64_tr_b16 v[36:37], v19 offset:0
    ds_read_b64_tr_b16 v[38:39], v19 offset:2048
    ds_read_b64_tr_b16 v[40:41], v20 offset:0
    ds_read_b64_tr_b16 v[42:43], v20 offset:2048
    ds_read_b64_tr_b16 v[44:45], v21 offset:0
    ds_read_b64_tr_b16 v[46:47], v21 offset:2048
    s_waitcnt lgkmcnt(4)
    ds_read_b64_tr_b16 v[48:49], v18 offset:4096
    ds_read_b64_tr_b16 v[50:51], v18 offset:6144
    ds_read_b64_tr_b16 v[52:53], v19 offset:4096
    ds_read_b64_tr_b16 v[54:55], v19 offset:6144
    ds_read_b64_tr_b16 v[56:57], v20 offset:4096
    ds_read_b64_tr_b16 v[58:59], v20 offset:6144
    ds_read_b64_tr_b16 v[60:61], v21 offset:4096
    ds_read_b64_tr_b16 v[62:63], v21 offset:6144
    s_waitcnt lgkmcnt(4)
    ds_read_b64_tr_b16 v[64:65], v18 offset:8192
    ds_read_b64_tr_b16 v[66:67], v18 offset:10240
    ds_read_b64_tr_b16 v[68:69], v19 offset:8192
    ds_read_b64_tr_b16 v[70:71], v19 offset:10240
    ds_read_b64_tr_b16 v[72:73], v20 offset:8192
    ds_read_b64_tr_b16 v[74:75], v20 offset:10240
    ds_read_b64_tr_b16 v[76:77], v21 offset:8192
    ds_read_b64_tr_b16 v[78:79], v21 offset:10240
    s_waitcnt lgkmcnt(4)
    ds_read_b64_tr_b16 v[80:81], v10 offset:0
    ds_read_b64_tr_b16 v[82:83], v10 offset:2048
    ds_read_b64_tr_b16 v[84:85], v11 offset:0
    ds_read_b64_tr_b16 v[86:87], v11 offset:2048
    ds_read_b64_tr_b16 v[88:89], v12 offset:0
    ds_read_b64_tr_b16 v[90:91], v12 offset:2048
    ds_read_b64_tr_b16 v[92:93], v13 offset:0
    ds_read_b64_tr_b16 v[94:95], v13 offset:2048
    s_waitcnt lgkmcnt(4)
    ds_read_b64_tr_b16 v[96:97], v10 offset:4096
    ds_read_b64_tr_b16 v[98:99], v10 offset:6144
    ds_read_b64_tr_b16 v[100:101], v11 offset:4096
    ds_read_b64_tr_b16 v[102:103], v11 offset:6144
    ds_read_b64_tr_b16 v[104:105], v12 offset:4096
    ds_read_b64_tr_b16 v[106:107], v12 offset:6144
    ds_read_b64_tr_b16 v[108:109], v13 offset:4096
    ds_read_b64_tr_b16 v[110:111], v13 offset:6144
    s_waitcnt lgkmcnt(4)
    ds_read_b64_tr_b16 v[112:113], v10 offset:8192
    ds_read_b64_tr_b16 v[114:115], v10 offset:10240
    ds_read_b64_tr_b16 v[116:117], v11 offset:8192
    ds_read_b64_tr_b16 v[118:119], v11 offset:10240
    ds_read_b64_tr_b16 v[120:121], v12 offset:8192
    ds_read_b64_tr_b16 v[122:123], v12 offset:10240
    ds_read_b64_tr_b16 v[124:125], v13 offset:8192
    ds_read_b64_tr_b16 v[126:127], v13 offset:10240
    s_lshl_b32 s3, s31, 2
    v_mov_b32 v4, s3
    v_mov_b32 v5, s29
    s_waitcnt vmcnt(0)
    ds_write_b32 v4, v5 offset:2304
    s_add_u32 s48, s22, 0x1200000
    s_addc_u32 s49, s23, 0
    s_mov_b32 s50, 0x560000
    s_mov_b32 s51, 0x00020000
    s_add_u32 s52, s22, 0x1a00000
    s_addc_u32 s53, s23, 0
    s_mov_b32 s54, 0x200000
    s_mov_b32 s55, 0x00020000
    s_lshl_b32 s3, s27, 12
    v_lshl_add_u32 v1, v0, 4, s3
    v_and_b32 v8, 15, v0
    v_lshlrev_b32 v9, 10, v8
    s_lshl_b32 s3, s27, 16
    s_lshl_b32 s61, s31, 14
    s_add_u32 s3, s3, s61
    s_lshl_b32 s61, s28, 7
    s_add_u32 s3, s3, s61
    v_add_u32 v9, s3, v9
    v_and_b32 v4, 1, v3
    v_lshl_add_u32 v8, v4, 5, v9
    v_lshrrev_b32 v4, 1, v3
    v_lshl_add_u32 v8, v4, 4, v8
    v_lshl_add_u32 v9, v3, 3, v9
    v_lshrrev_b32 v4, 1, v0
    v_min_u32 v4, 9, v4
    v_lshlrev_b32 v4, 9, v4
    v_and_b32 v5, 1, v0
    v_lshl_add_u32 v4, v5, 8, v4
    s_lshr_b32 s3, s27, 1
    s_lshl_b32 s3, s3, 13
    s_and_b32 s61, s27, 1
    s_lshl_b32 s61, s61, 7
    s_add_u32 s3, s3, s61
    s_add_u32 s3, s3, 262144
    v_add_u32 v22, s3, v4
    v_and_b32 v4, 31, v0
    v_lshlrev_b32 v4, 7, v4
    s_lshl_b32 s3, s27, 12
    s_add_u32 s3, s3, 524288
    v_add_u32 v23, s3, v4
    s_setprio 0
    v_and_b32 v4, 3, v0
    v_lshlrev_b32 v4, 2, v4
    s_mov_b32 s3, 6000000
fz_lsync0:
    ds_read_b32 v5, v4 offset:2304
    s_waitcnt lgkmcnt(0)
    v_cmp_eq_u32 vcc, s29, v5
    s_sub_u32 s3, s3, 1
    s_cmp_eq_u32 s3, 0
    s_cbranch_scc1 fz_lsync0_ok
    s_cmp_eq_u64 vcc, -1
    s_cbranch_scc1 fz_lsync0_ok
    s_sleep 2
    s_branch fz_lsync0
fz_lsync0_ok:
    v_and_b32 v4, 3, v0
    v_lshlrev_b32 v4, 2, v4
    s_mov_b32 s3, 6000000
fz_lsync:
    ds_read_b32 v5, v4 offset:2320
    s_waitcnt lgkmcnt(0)
    v_cmp_eq_u32 vcc, s29, v5
    s_sub_u32 s3, s3, 1
    s_cmp_eq_u32 s3, 0
    s_cbranch_scc1 fz_lsync_ok
    s_cmp_eq_u64 vcc, -1
    s_cbranch_scc1 fz_lsync_ok
    s_sleep 2
    s_branch fz_lsync
fz_lsync_ok:
    s_waitcnt lgkmcnt(0)
    s_add_u32 m0, s56, 106496
    s_add_u32 s58, s57, 786432
    buffer_load_dwordx4 v2, s[40:43], s58 offen lds
    s_add_u32 m0, s56, 107520
    s_add_u32 s58, s57, 802816
    buffer_load_dwordx4 v2, s[40:43], s58 offen lds
    s_add_u32 m0, s56, 108544
    s_add_u32 s58, s57, 790528
    buffer_load_dwordx4 v2, s[40:43], s58 offen lds
    s_add_u32 m0, s56, 109568
    s_add_u32 s58, s57, 806912
    buffer_load_dwordx4 v2, s[40:43], s58 offen lds
    s_add_u32 m0, s56, 110592
    s_add_u32 s58, s57, 917504
    buffer_load_dwordx4 v2, s[40:43], s58 offen lds
    s_add_u32 m0, s56, 111616
    s_add_u32 s58, s57, 933888
    buffer_load_dwordx4 v2, s[40:43], s58 offen lds
    s_add_u32 m0, s56, 112640
    s_add_u32 s58, s57, 921600
    buffer_load_dwordx4 v2, s[40:43], s58 offen lds
    s_add_u32 m0, s56, 113664
    s_add_u32 s58, s57, 937984
    buffer_load_dwordx4 v2, s[40:43], s58 offen lds
    s_add_u32 m0, s56, 114688
    s_add_u32 s58, s57, 1048576
    buffer_load_dwordx4 v2, s[40:43], s58 offen lds
    s_add_u32 m0, s56, 115712
    s_add_u32 s58, s57, 1064960
    buffer_load_dwordx4 v2, s[40:43], s58 offen lds
    s_add_u32 m0, s56, 116736
    s_add_u32 s58, s57, 1052672
    buffer_load_dwordx4 v2, s[40:43], s58 offen lds
    s_add_u32 m0, s56, 117760
    s_add_u32 s58, s57, 1069056
    buffer_load_dwordx4 v2, s[40:43], s58 offen lds
    s_add_u32 m0, s56, 0
    s_add_u32 s58, s57, 1179648
    buffer_load_dwordx4 v2, s[40:43], s58 offen lds
    s_add_u32 m0, s56, 1024
    s_add_u32 s58, s57, 1196032
    buffer_load_dwordx4 v2, s[40:43], s58 offen lds
    s_add_u32 m0, s56, 2048
    s_add_u32 s58, s57, 1183744
    buffer_load_dwordx4 v2, s[40:43], s58 offen lds
    s_add_u32 m0, s56, 3072
    s_add_u32 s58, s57, 1200128
    buffer_load_dwordx4 v2, s[40:43], s58 offen lds
    s_add_u32 m0, s56, 4096
    s_add_u32 s58, s57, 1310720
    buffer_load_dwordx4 v2, s[40:43], s58 offen lds
    s_add_u32 m0, s56, 5120
    s_add_u32 s58, s57, 1327104
    buffer_load_dwordx4 v2, s[40:43], s58 offen lds
    s_add_u32 m0, s56, 6144
    s_add_u32 s58, s57, 1314816
    buffer_load_dwordx4 v2, s[40:43], s58 offen lds
    s_add_u32 m0, s56, 7168
    s_add_u32 s58, s57, 1331200
    buffer_load_dwordx4 v2, s[40:43], s58 offen lds
    s_add_u32 m0, s56, 8192
    s_add_u32 s58, s57, 0
    buffer_load_dwordx4 v2, s[44:47], s58 offen lds
    s_add_u32 m0, s56, 9216
    s_add_u32 s58, s57, 16384
    buffer_load_dwordx4 v2, s[44:47], s58 offen lds
    s_add_u32 m0, s56, 10240
    s_add_u32 s58, s57, 4096
    buffer_load_dwordx4 v2, s[44:47], s58 offen lds
    s_add_u32 m0, s56, 11264
    s_add_u32 s58, s57, 20480
    buffer_load_dwordx4 v2, s[44:47], s58 offen lds
    s_mov_b32 s3, 300000
fz_ph:
    buffer_load_dword v4, v22, s[32:35], 0 offen sc1
    s_waitcnt vmcnt(0)
    v_cmp_eq_u32 vcc, s29, v4
    s_sub_u32 s3, s3, 1
    s_cmp_eq_u32 s3, 0
    s_cbranch_scc1 fz_ph_ok
    s_cmp_eq_u64 vcc, -1
    s_cbranch_scc1 fz_ph_ok
    s_sleep 2
    s_branch fz_ph
fz_ph_ok:
    s_add_u32 s60, s59, 0
    buffer_load_dwordx4 v[128:131], v1, s[48:51], s60 offen offset:0 sc1
    buffer_load_dwordx4 v[132:135], v1, s[48:51], s60 offen offset:1024 sc1
    buffer_load_dwordx4 v[136:139], v1, s[48:51], s60 offen offset:2048 sc1
    buffer_load_dwordx4 v[140:143], v1, s[48:51], s60 offen offset:3072 sc1
    s_add_u32 s60, s59, 524288
    buffer_load_dwordx4 v[144:147], v1, s[48:51], s60 offen offset:0 sc1
    buffer_load_dwordx4 v[148:151], v1, s[48:51], s60 offen offset:1024 sc1
    buffer_load_dwordx4 v[152:155], v1, s[48:51], s60 offen offset:2048 sc1
    buffer_load_dwordx4 v[156:159], v1, s[48:51], s60 offen offset:3072 sc1
    s_add_u32 s60, s59, 1048576
    buffer_load_dwordx4 v[160:163], v1, s[48:51], s60 offen offset:0 sc1
    buffer_load_dwordx4 v[164:167], v1, s[48:51], s60 offen offset:1024 sc1
    buffer_load_dwordx4 v[168:171], v1, s[48:51], s60 offen offset:2048 sc1
    buffer_load_dwordx4 v[172:175], v1, s[48:51], s60 offen offset:3072 sc1
    s_add_u32 s60, s59, 1572864
    buffer_load_dwordx4 v[176:179], v1, s[48:51], s60 offen offset:0 sc1
    buffer_load_dwordx4 v[180:183], v1, s[48:51], s60 offen offset:1024 sc1
    buffer_load_dwordx4 v[184:187], v1, s[48:51], s60 offen offset:2048 sc1
    buffer_load_dwordx4 v[188:191], v1, s[48:51], s60 offen offset:3072 sc1
    s_waitcnt vmcnt(12)
    v_mfma_f32_16x16x32_bf16 v[192:195], v[32:35], v[128:131], 0
    v_mfma_f32_16x16x32_bf16 v[196:199], v[32:35], v[132:135], 0
    v_mfma_f32_16x16x32_bf16 v[200:203], v[32:35], v[136:139], 0
    v_mfma_f32_16x16x32_bf16 v[204:207], v[32:35], v[140:143], 0
    v_mfma_f32_16x16x32_bf16 v[208:211], v[36:39], v[128:131], 0
    v_mfma_f32_16x16x32_bf16 v[212:215], v[36:39], v[132:135], 0
    v_mfma_f32_16x16x32_bf16 v[216:219], v[36:39], v[136:139], 0
    v_mfma_f32_16x16x32_bf16 v[220:223], v[36:39], v[140:143], 0
    v_mfma_f32_16x16x32_bf16 v[224:227], v[40:43], v[128:131], 0
    v_mfma_f32_16x16x32_bf16 v[228:231], v[40:43], v[132:135], 0
    v_mfma_f32_16x16x32_bf16 v[232:235], v[40:43], v[136:139], 0
    v_mfma_f32_16x16x32_bf16 v[236:239], v[40:43], v[140:143], 0
    v_mfma_f32_16x16x32_bf16 v[240:243], v[44:47], v[128:131], 0
    v_mfma_f32_16x16x32_bf16 v[244:247], v[44:47], v[132:135], 0
    v_mfma_f32_16x16x32_bf16 v[248:251], v[44:47], v[136:139], 0
    v_mfma_f32_16x16x32_bf16 v[252:255], v[44:47], v[140:143], 0
    s_add_u32 s60, s59, 2097152
    buffer_load_dwordx4 v[128:131], v1, s[48:51], s60 offen offset:0 sc1
    buffer_load_dwordx4 v[132:135], v1, s[48:51], s60 offen offset:1024 sc1
    buffer_load_dwordx4 v[136:139], v1, s[48:51], s60 offen offset:2048 sc1
    buffer_load_dwordx4 v[140:143], v1, s[48:51], s60 offen offset:3072 sc1
    s_add_u32 s60, s59, 2621440
    buffer_load_dwordx4 v[32:35], v1, s[48:51], s60 offen offset:0 sc1
    buffer_load_dwordx4 v[36:39], v1, s[48:51], s60 offen offset:1024 sc1
    buffer_load_dwordx4 v[40:43], v1, s[48:51], s60 offen offset:2048 sc1
    buffer_load_dwordx4 v[44:47], v1, s[48:51], s60 offen offset:3072 sc1
    s_waitcnt vmcnt(16)
    v_mfma_f32_16x16x32_bf16 v[192:195], v[48:51], v[144:147], v[192:195]
    v_mfma_f32_16x16x32_bf16 v[196:199], v[48:51], v[148:151], v[196:199]
    v_mfma_f32_16x16x32_bf16 v[200:203], v[48:51], v[152:155], v[200:203]
    v_mfma_f32_16x16x32_bf16 v[204:207], v[48:51], v[156:159], v[204:207]
    v_mfma_f32_16x16x32_bf16 v[208:211], v[52:55], v[144:147], v[208:211]
    v_mfma_f32_16x16x32_bf16 v[212:215], v[52:55], v[148:151], v[212:215]
    v_mfma_f32_16x16x32_bf16 v[216:219], v[52:55], v[152:155], v[216:219]
    v_mfma_f32_16x16x32_bf16 v[220:223], v[52:55], v[156:159], v[220:223]
    v_mfma_f32_16x16x32_bf16 v[224:227], v[56:59], v[144:147], v[224:227]
    v_mfma_f32_16x16x32_bf16 v[228:231], v[56:59], v[148:151], v[228:231]
    v_mfma_f32_16x16x32_bf16 v[232:235], v[56:59], v[152:155], v[232:235]
    v_mfma_f32_16x16x32_bf16 v[236:239], v[56:59], v[156:159], v[236:239]
    v_mfma_f32_16x16x32_bf16 v[240:243], v[60:63], v[144:147], v[240:243]
    v_mfma_f32_16x16x32_bf16 v[244:247], v[60:63], v[148:151], v[244:247]
    v_mfma_f32_16x16x32_bf16 v[248:251], v[60:63], v[152:155], v[248:251]
    v_mfma_f32_16x16x32_bf16 v[252:255], v[60:63], v[156:159], v[252:255]
    s_add_u32 s60, s59, 3145728
    buffer_load_dwordx4 v[144:147], v1, s[48:51], s60 offen offset:0 sc1
    buffer_load_dwordx4 v[148:151], v1, s[48:51], s60 offen offset:1024 sc1
    buffer_load_dwordx4 v[152:155], v1, s[48:51], s60 offen offset:2048 sc1
    buffer_load_dwordx4 v[156:159], v1, s[48:51], s60 offen offset:3072 sc1
    s_add_u32 s60, s59, 3670016
    buffer_load_dwordx4 v[48:51], v1, s[48:51], s60 offen offset:0 sc1
    buffer_load_dwordx4 v[52:55], v1, s[48:51], s60 offen offset:1024 sc1
    buffer_load_dwordx4 v[56:59], v1, s[48:51], s60 offen offset:2048 sc1
    buffer_load_dwordx4 v[60:63], v1, s[48:51], s60 offen offset:3072 sc1
    s_waitcnt vmcnt(20)
    v_mfma_f32_16x16x32_bf16 v[192:195], v[64:67], v[160:163], v[192:195]
    v_mfma_f32_16x16x32_bf16 v[196:199], v[64:67], v[164:167], v[196:199]
    v_mfma_f32_16x16x32_bf16 v[200:203], v[64:67], v[168:171], v[200:203]
    v_mfma_f32_16x16x32_bf16 v[204:207], v[64:67], v[172:175], v[204:207]
    v_mfma_f32_16x16x32_bf16 v[208:211], v[68:71], v[160:163], v[208:211]
    v_mfma_f32_16x16x32_bf16 v[212:215], v[68:71], v[164:167], v[212:215]
    v_mfma_f32_16x16x32_bf16 v[216:219], v[68:71], v[168:171], v[216:219]
    v_mfma_f32_16x16x32_bf16 v[220:223], v[68:71], v[172:175], v[220:223]
    v_mfma_f32_16x16x32_bf16 v[224:227], v[72:75], v[160:163], v[224:227]
    v_mfma_f32_16x16x32_bf16 v[228:231], v[72:75], v[164:167], v[228:231]
    v_mfma_f32_16x16x32_bf16 v[232:235], v[72:75], v[168:171], v[232:235]
    v_mfma_f32_16x16x32_bf16 v[236:239], v[72:75], v[172:175], v[236:239]
    v_mfma_f32_16x16x32_bf16 v[240:243], v[76:79], v[160:163], v[240:243]
    v_mfma_f32_16x16x32_bf16 v[244:247], v[76:79], v[164:167], v[244:247]
    v_mfma_f32_16x16x32_bf16 v[248:251], v[76:79], v[168:171], v[248:251]
    v_mfma_f32_16x16x32_bf16 v[252:255], v[76:79], v[172:175], v[252:255]
    s_add_u32 s60, s59, 4194304
    buffer_load_dwordx4 v[160:163], v1, s[48:51], s60 offen offset:0 sc1
    buffer_load_dwordx4 v[164:167], v1, s[48:51], s60 offen offset:1024 sc1
    buffer_load_dwordx4 v[168:171], v1, s[48:51], s60 offen offset:2048 sc1
    buffer_load_dwordx4 v[172:175], v1, s[48:51], s60 offen offset:3072 sc1
    s_add_u32 s60, s59, 4718592
    buffer_load_dwordx4 v[64:67], v1, s[48:51], s60 offen offset:0 sc1
    buffer_load_dwordx4 v[68:71], v1, s[48:51], s60 offen offset:1024 sc1
    buffer_load_dwordx4 v[72:75], v1, s[48:51], s60 offen offset:2048 sc1
    buffer_load_dwordx4 v[76:79], v1, s[48:51], s60 offen offset:3072 sc1
    s_waitcnt vmcnt(24)
    v_mfma_f32_16x16x32_bf16 v[192:195], v[80:83], v[176:179], v[192:195]
    v_mfma_f32_16x16x32_bf16 v[196:199], v[80:83], v[180:183], v[196:199]
    v_mfma_f32_16x16x32_bf16 v[200:203], v[80:83], v[184:187], v[200:203]
    v_mfma_f32_16x16x32_bf16 v[204:207], v[80:83], v[188:191], v[204:207]
    v_mfma_f32_16x16x32_bf16 v[208:211], v[84:87], v[176:179], v[208:211]
    v_mfma_f32_16x16x32_bf16 v[212:215], v[84:87], v[180:183], v[212:215]
    v_mfma_f32_16x16x32_bf16 v[216:219], v[84:87], v[184:187], v[216:219]
    v_mfma_f32_16x16x32_bf16 v[220:223], v[84:87], v[188:191], v[220:223]
    v_mfma_f32_16x16x32_bf16 v[224:227], v[88:91], v[176:179], v[224:227]
    v_mfma_f32_16x16x32_bf16 v[228:231], v[88:91], v[180:183], v[228:231]
    v_mfma_f32_16x16x32_bf16 v[232:235], v[88:91], v[184:187], v[232:235]
    v_mfma_f32_16x16x32_bf16 v[236:239], v[88:91], v[188:191], v[236:239]
    v_mfma_f32_16x16x32_bf16 v[240:243], v[92:95], v[176:179], v[240:243]
    v_mfma_f32_16x16x32_bf16 v[244:247], v[92:95], v[180:183], v[244:247]
    v_mfma_f32_16x16x32_bf16 v[248:251], v[92:95], v[184:187], v[248:251]
    v_mfma_f32_16x16x32_bf16 v[252:255], v[92:95], v[188:191], v[252:255]
    s_add_u32 s60, s59, 5242880
    buffer_load_dwordx4 v[176:179], v1, s[48:51], s60 offen offset:0 sc1
    buffer_load_dwordx4 v[180:183], v1, s[48:51], s60 offen offset:1024 sc1
    buffer_load_dwordx4 v[184:187], v1, s[48:51], s60 offen offset:2048 sc1
    buffer_load_dwordx4 v[188:191], v1, s[48:51], s60 offen offset:3072 sc1
    s_waitcnt vmcnt(24)
    v_mfma_f32_16x16x32_bf16 v[192:195], v[96:99], v[128:131], v[192:195]
    v_mfma_f32_16x16x32_bf16 v[196:199], v[96:99], v[132:135], v[196:199]
    v_mfma_f32_16x16x32_bf16 v[200:203], v[96:99], v[136:139], v[200:203]
    v_mfma_f32_16x16x32_bf16 v[204:207], v[96:99], v[140:143], v[204:207]
    v_mfma_f32_16x16x32_bf16 v[208:211], v[100:103], v[128:131], v[208:211]
    v_mfma_f32_16x16x32_bf16 v[212:215], v[100:103], v[132:135], v[212:215]
    v_mfma_f32_16x16x32_bf16 v[216:219], v[100:103], v[136:139], v[216:219]
    v_mfma_f32_16x16x32_bf16 v[220:223], v[100:103], v[140:143], v[220:223]
    v_mfma_f32_16x16x32_bf16 v[224:227], v[104:107], v[128:131], v[224:227]
    v_mfma_f32_16x16x32_bf16 v[228:231], v[104:107], v[132:135], v[228:231]
    v_mfma_f32_16x16x32_bf16 v[232:235], v[104:107], v[136:139], v[232:235]
    v_mfma_f32_16x16x32_bf16 v[236:239], v[104:107], v[140:143], v[236:239]
    v_mfma_f32_16x16x32_bf16 v[240:243], v[108:111], v[128:131], v[240:243]
    v_mfma_f32_16x16x32_bf16 v[244:247], v[108:111], v[132:135], v[244:247]
    v_mfma_f32_16x16x32_bf16 v[248:251], v[108:111], v[136:139], v[248:251]
    v_mfma_f32_16x16x32_bf16 v[252:255], v[108:111], v[140:143], v[252:255]
    ds_read_b64_tr_b16 v[80:81], v18 offset:0
    ds_read_b64_tr_b16 v[82:83], v18 offset:2048
    ds_read_b64_tr_b16 v[84:85], v19 offset:0
    ds_read_b64_tr_b16 v[86:87], v19 offset:2048
    ds_read_b64_tr_b16 v[88:89], v20 offset:0
    ds_read_b64_tr_b16 v[90:91], v20 offset:2048
    ds_read_b64_tr_b16 v[92:93], v21 offset:0
    ds_read_b64_tr_b16 v[94:95], v21 offset:2048
    s_waitcnt vmcnt(20)
    v_mfma_f32_16x16x32_bf16 v[192:195], v[112:115], v[32:35], v[192:195]
    v_mfma_f32_16x16x32_bf16 v[196:199], v[112:115], v[36:39], v[196:199]
    v_mfma_f32_16x16x32_bf16 v[200:203], v[112:115], v[40:43], v[200:203]
    v_mfma_f32_16x16x32_bf16 v[204:207], v[112:115], v[44:47], v[204:207]
    v_mfma_f32_16x16x32_bf16 v[208:211], v[116:119], v[32:35], v[208:211]
    v_mfma_f32_16x16x32_bf16 v[212:215], v[116:119], v[36:39], v[212:215]
    v_mfma_f32_16x16x32_bf16 v[216:219], v[116:119], v[40:43], v[216:219]
    v_mfma_f32_16x16x32_bf16 v[220:223], v[116:119], v[44:47], v[220:223]
    v_mfma_f32_16x16x32_bf16 v[224:227], v[120:123], v[32:35], v[224:227]
    v_mfma_f32_16x16x32_bf16 v[228:231], v[120:123], v[36:39], v[228:231]
    v_mfma_f32_16x16x32_bf16 v[232:235], v[120:123], v[40:43], v[232:235]
    v_mfma_f32_16x16x32_bf16 v[236:239], v[120:123], v[44:47], v[236:239]
    v_mfma_f32_16x16x32_bf16 v[240:243], v[124:127], v[32:35], v[240:243]
    v_mfma_f32_16x16x32_bf16 v[244:247], v[124:127], v[36:39], v[244:247]
    v_mfma_f32_16x16x32_bf16 v[248:251], v[124:127], v[40:43], v[248:251]
    v_mfma_f32_16x16x32_bf16 v[252:255], v[124:127], v[44:47], v[252:255]
    buffer_load_dwordx2 v[24:25], v9, s[36:39], 0 offen offset:0
    buffer_load_dwordx2 v[26:27], v9, s[36:39], 0 offen offset:32
    buffer_load_dwordx2 v[28:29], v9, s[36:39], 0 offen offset:64
    buffer_load_dwordx2 v[30:31], v9, s[36:39], 0 offen offset:96
    ds_read_b64_tr_b16 v[128:129], v18 offset:4096
    ds_read_b64_tr_b16 v[130:131], v18 offset:6144
    ds_read_b64_tr_b16 v[132:133], v19 offset:4096
    ds_read_b64_tr_b16 v[134:135], v19 offset:6144
    ds_read_b64_tr_b16 v[136:137], v20 offset:4096
    ds_read_b64_tr_b16 v[138:139], v20 offset:6144
    ds_read_b64_tr_b16 v[140:141], v21 offset:4096
    ds_read_b64_tr_b16 v[142:143], v21 offset:6144
    s_waitcnt vmcnt(20)
    s_waitcnt lgkmcnt(12)
    v_mfma_f32_16x16x32_bf16 v[192:195], v[80:83], v[144:147], v[192:195]
    v_mfma_f32_16x16x32_bf16 v[196:199], v[80:83], v[148:151], v[196:199]
    v_mfma_f32_16x16x32_bf16 v[200:203], v[80:83], v[152:155], v[200:203]
    v_mfma_f32_16x16x32_bf16 v[204:207], v[80:83], v[156:159], v[204:207]
    v_mfma_f32_16x16x32_bf16 v[208:211], v[84:87], v[144:147], v[208:211]
    v_mfma_f32_16x16x32_bf16 v[212:215], v[84:87], v[148:151], v[212:215]
    v_mfma_f32_16x16x32_bf16 v[216:219], v[84:87], v[152:155], v[216:219]
    v_mfma_f32_16x16x32_bf16 v[220:223], v[84:87], v[156:159], v[220:223]
    s_waitcnt lgkmcnt(10)
    v_mfma_f32_16x16x32_bf16 v[224:227], v[88:91], v[144:147], v[224:227]
    v_mfma_f32_16x16x32_bf16 v[228:231], v[88:91], v[148:151], v[228:231]
    v_mfma_f32_16x16x32_bf16 v[232:235], v[88:91], v[152:155], v[232:235]
    v_mfma_f32_16x16x32_bf16 v[236:239], v[88:91], v[156:159], v[236:239]
    s_waitcnt lgkmcnt(8)
    v_mfma_f32_16x16x32_bf16 v[240:243], v[92:95], v[144:147], v[240:243]
    v_mfma_f32_16x16x32_bf16 v[244:247], v[92:95], v[148:151], v[244:247]
    v_mfma_f32_16x16x32_bf16 v[248:251], v[92:95], v[152:155], v[248:251]
    v_mfma_f32_16x16x32_bf16 v[252:255], v[92:95], v[156:159], v[252:255]
    s_add_u32 m0, s56, 106496
    s_add_u32 s58, s57, 131072
    buffer_load_dwordx4 v2, s[44:47], s58 offen lds
    s_add_u32 m0, s56, 107520
    s_add_u32 s58, s57, 147456
    buffer_load_dwordx4 v2, s[44:47], s58 offen lds
    s_add_u32 m0, s56, 108544
    s_add_u32 s58, s57, 135168
    buffer_load_dwordx4 v2, s[44:47], s58 offen lds
    s_add_u32 m0, s56, 109568
    s_add_u32 s58, s57, 151552
    buffer_load_dwordx4 v2, s[44:47], s58 offen lds
    ds_read_b64_tr_b16 v[96:97], v18 offset:8192
    ds_read_b64_tr_b16 v[98:99], v18 offset:10240
    ds_read_b64_tr_b16 v[100:101], v19 offset:8192
    ds_read_b64_tr_b16 v[102:103], v19 offset:10240
    ds_read_b64_tr_b16 v[104:105], v20 offset:8192
    ds_read_b64_tr_b16 v[106:107], v20 offset:10240
    ds_read_b64_tr_b16 v[108:109], v21 offset:8192
    ds_read_b64_tr_b16 v[110:111], v21 offset:10240
    s_waitcnt vmcnt(20)
    s_waitcnt lgkmcnt(12)
    v_mfma_f32_16x16x32_bf16 v[192:195], v[128:131], v[48:51], v[192:195]
    v_mfma_f32_16x16x32_bf16 v[196:199], v[128:131], v[52:55], v[196:199]
    v_mfma_f32_16x16x32_bf16 v[200:203], v[128:131], v[56:59], v[200:203]
    v_mfma_f32_16x16x32_bf16 v[204:207], v[128:131], v[60:63], v[204:207]
    v_mfma_f32_16x16x32_bf16 v[208:211], v[132:135], v[48:51], v[208:211]
    v_mfma_f32_16x16x32_bf16 v[212:215], v[132:135], v[52:55], v[212:215]
    v_mfma_f32_16x16x32_bf16 v[216:219], v[132:135], v[56:59], v[216:219]
    v_mfma_f32_16x16x32_bf16 v[220:223], v[132:135], v[60:63], v[220:223]
    s_waitcnt lgkmcnt(10)
    v_mfma_f32_16x16x32_bf16 v[224:227], v[136:139], v[48:51], v[224:227]
    v_mfma_f32_16x16x32_bf16 v[228:231], v[136:139], v[52:55], v[228:231]
    v_mfma_f32_16x16x32_bf16 v[232:235], v[136:139], v[56:59], v[232:235]
    v_mfma_f32_16x16x32_bf16 v[236:239], v[136:139], v[60:63], v[236:239]
    s_waitcnt lgkmcnt(8)
    v_mfma_f32_16x16x32_bf16 v[240:243], v[140:143], v[48:51], v[240:243]
    v_mfma_f32_16x16x32_bf16 v[244:247], v[140:143], v[52:55], v[244:247]
    v_mfma_f32_16x16x32_bf16 v[248:251], v[140:143], v[56:59], v[248:251]
    v_mfma_f32_16x16x32_bf16 v[252:255], v[140:143], v[60:63], v[252:255]
    s_add_u32 m0, s56, 110592
    s_add_u32 s58, s57, 262144
    buffer_load_dwordx4 v2, s[44:47], s58 offen lds
    s_add_u32 m0, s56, 111616
    s_add_u32 s58, s57, 278528
    buffer_load_dwordx4 v2, s[44:47], s58 offen lds
    s_add_u32 m0, s56, 112640
    s_add_u32 s58, s57, 266240
    buffer_load_dwordx4 v2, s[44:47], s58 offen lds
    s_add_u32 m0, s56, 113664
    s_add_u32 s58, s57, 282624
    buffer_load_dwordx4 v2, s[44:47], s58 offen lds
    ds_read_b64_tr_b16 v[32:33], v10 offset:0
    ds_read_b64_tr_b16 v[34:35], v10 offset:2048
    ds_read_b64_tr_b16 v[36:37], v11 offset:0
    ds_read_b64_tr_b16 v[38:39], v11 offset:2048
    ds_read_b64_tr_b16 v[40:41], v12 offset:0
    ds_read_b64_tr_b16 v[42:43], v12 offset:2048
    ds_read_b64_tr_b16 v[44:45], v13 offset:0
    ds_read_b64_tr_b16 v[46:47], v13 offset:2048
    s_waitcnt vmcnt(20)
    s_waitcnt lgkmcnt(12)
    v_mfma_f32_16x16x32_bf16 v[192:195], v[96:99], v[160:163], v[192:195]
    v_mfma_f32_16x16x32_bf16 v[196:199], v[96:99], v[164:167], v[196:199]
    v_mfma_f32_16x16x32_bf16 v[200:203], v[96:99], v[168:171], v[200:203]
    v_mfma_f32_16x16x32_bf16 v[204:207], v[96:99], v[172:175], v[204:207]
    v_mfma_f32_16x16x32_bf16 v[208:211], v[100:103], v[160:163], v[208:211]
    v_mfma_f32_16x16x32_bf16 v[212:215], v[100:103], v[164:167], v[212:215]
    v_mfma_f32_16x16x32_bf16 v[216:219], v[100:103], v[168:171], v[216:219]
    v_mfma_f32_16x16x32_bf16 v[220:223], v[100:103], v[172:175], v[220:223]
    s_waitcnt lgkmcnt(10)
    v_mfma_f32_16x16x32_bf16 v[224:227], v[104:107], v[160:163], v[224:227]
    v_mfma_f32_16x16x32_bf16 v[228:231], v[104:107], v[164:167], v[228:231]
    v_mfma_f32_16x16x32_bf16 v[232:235], v[104:107], v[168:171], v[232:235]
    v_mfma_f32_16x16x32_bf16 v[236:239], v[104:107], v[172:175], v[236:239]
    s_waitcnt lgkmcnt(8)
    v_mfma_f32_16x16x32_bf16 v[240:243], v[108:111], v[160:163], v[240:243]
    v_mfma_f32_16x16x32_bf16 v[244:247], v[108:111], v[164:167], v[244:247]
    v_mfma_f32_16x16x32_bf16 v[248:251], v[108:111], v[168:171], v[248:251]
    v_mfma_f32_16x16x32_bf16 v[252:255], v[108:111], v[172:175], v[252:255]
    s_add_u32 m0, s56, 114688
    s_add_u32 s58, s57, 393216
    buffer_load_dwordx4 v2, s[44:47], s58 offen lds
    s_add_u32 m0, s56, 115712
    s_add_u32 s58, s57, 409600
    buffer_load_dwordx4 v2, s[44:47], s58 offen lds
    s_add_u32 m0, s56, 116736
    s_add_u32 s58, s57, 397312
    buffer_load_dwordx4 v2, s[44:47], s58 offen lds
    s_add_u32 m0, s56, 117760
    s_add_u32 s58, s57, 413696
    buffer_load_dwordx4 v2, s[44:47], s58 offen lds
    ds_read_b64_tr_b16 v[112:113], v10 offset:4096
    ds_read_b64_tr_b16 v[114:115], v10 offset:6144
    ds_read_b64_tr_b16 v[116:117], v11 offset:4096
    ds_read_b64_tr_b16 v[118:119], v11 offset:6144
    ds_read_b64_tr_b16 v[120:121], v12 offset:4096
    ds_read_b64_tr_b16 v[122:123], v12 offset:6144
    ds_read_b64_tr_b16 v[124:125], v13 offset:4096
    ds_read_b64_tr_b16 v[126:127], v13 offset:6144
    s_waitcnt vmcnt(20)
    s_waitcnt lgkmcnt(12)
    v_mfma_f32_16x16x32_bf16 v[192:195], v[32:35], v[64:67], v[192:195]
    v_mfma_f32_16x16x32_bf16 v[196:199], v[32:35], v[68:71], v[196:199]
    v_mfma_f32_16x16x32_bf16 v[200:203], v[32:35], v[72:75], v[200:203]
    v_mfma_f32_16x16x32_bf16 v[204:207], v[32:35], v[76:79], v[204:207]
    v_mfma_f32_16x16x32_bf16 v[208:211], v[36:39], v[64:67], v[208:211]
    v_mfma_f32_16x16x32_bf16 v[212:215], v[36:39], v[68:71], v[212:215]
    v_mfma_f32_16x16x32_bf16 v[216:219], v[36:39], v[72:75], v[216:219]
    v_mfma_f32_16x16x32_bf16 v[220:223], v[36:39], v[76:79], v[220:223]
    s_waitcnt lgkmcnt(10)
    v_mfma_f32_16x16x32_bf16 v[224:227], v[40:43], v[64:67], v[224:227]
    v_mfma_f32_16x16x32_bf16 v[228:231], v[40:43], v[68:71], v[228:231]
    v_mfma_f32_16x16x32_bf16 v[232:235], v[40:43], v[72:75], v[232:235]
    v_mfma_f32_16x16x32_bf16 v[236:239], v[40:43], v[76:79], v[236:239]
    s_waitcnt lgkmcnt(8)
    v_mfma_f32_16x16x32_bf16 v[240:243], v[44:47], v[64:67], v[240:243]
    v_mfma_f32_16x16x32_bf16 v[244:247], v[44:47], v[68:71], v[244:247]
    v_mfma_f32_16x16x32_bf16 v[248:251], v[44:47], v[72:75], v[248:251]
    v_mfma_f32_16x16x32_bf16 v[252:255], v[44:47], v[76:79], v[252:255]
    s_waitcnt vmcnt(16)
    s_waitcnt lgkmcnt(6)
    v_mfma_f32_16x16x32_bf16 v[192:195], v[112:115], v[176:179], v[192:195]
    v_mfma_f32_16x16x32_bf16 v[196:199], v[112:115], v[180:183], v[196:199]
    v_mfma_f32_16x16x32_bf16 v[200:203], v[112:115], v[184:187], v[200:203]
    v_mfma_f32_16x16x32_bf16 v[204:207], v[112:115], v[188:191], v[204:207]
    s_waitcnt lgkmcnt(4)
    v_mfma_f32_16x16x32_bf16 v[208:211], v[116:119], v[176:179], v[208:211]
    v_mfma_f32_16x16x32_bf16 v[212:215], v[116:119], v[180:183], v[212:215]
    v_mfma_f32_16x16x32_bf16 v[216:219], v[116:119], v[184:187], v[216:219]
    v_mfma_f32_16x16x32_bf16 v[220:223], v[116:119], v[188:191], v[220:223]
    s_waitcnt lgkmcnt(2)
    v_mfma_f32_16x16x32_bf16 v[224:227], v[120:123], v[176:179], v[224:227]
    v_mfma_f32_16x16x32_bf16 v[228:231], v[120:123], v[180:183], v[228:231]
    v_mfma_f32_16x16x32_bf16 v[232:235], v[120:123], v[184:187], v[232:235]
    v_mfma_f32_16x16x32_bf16 v[236:239], v[120:123], v[188:191], v[236:239]
    s_waitcnt lgkmcnt(0)
    v_mfma_f32_16x16x32_bf16 v[240:243], v[124:127], v[176:179], v[240:243]
    v_mfma_f32_16x16x32_bf16 v[244:247], v[124:127], v[180:183], v[244:247]
    v_mfma_f32_16x16x32_bf16 v[248:251], v[124:127], v[184:187], v[248:251]
    v_mfma_f32_16x16x32_bf16 v[252:255], v[124:127], v[188:191], v[252:255]
    v_and_b32 v4, 3, v0
    v_lshlrev_b32 v4, 2, v4
    s_mov_b32 s3, 6000000
fz_msr:
    ds_read_b32 v5, v4 offset:2336
    s_waitcnt lgkmcnt(0)
    v_cmp_eq_u32 vcc, s29, v5
    s_sub_u32 s3, s3, 1
    s_cmp_eq_u32 s3, 0
    s_cbranch_scc1 fz_msr_ok
    s_cmp_eq_u64 vcc, -1
    s_cbranch_scc1 fz_msr_ok
    s_branch fz_msr
fz_msr_ok:
    v_lshlrev_b32 v4, 4, v0
    s_sub_u32 s3, s31, 1
    s_and_b32 s3, s3, 3
    s_cmp_eq_u32 s3, 3
    s_cbranch_scc1 fz_skw0
    s_add_u32 s3, s3, 0
    s_lshl_b32 s3, s3, 12
    s_add_u32 s3, s3, 57344
    v_add_u32 v5, s3, v4
    ds_write_b128 v5, v[192:195] offset:0
    ds_write_b128 v5, v[208:211] offset:1024
    ds_write_b128 v5, v[224:227] offset:2048
    ds_write_b128 v5, v[240:243] offset:3072
    s_branch fz_dnw0
fz_skw0:
    v_pk_mov_b32 v[32:33], v[192:193], v[192:193] op_sel:[0,1]
    v_pk_mov_b32 v[34:35], v[194:195], v[194:195] op_sel:[0,1]
    v_pk_mov_b32 v[36:37], v[208:209], v[208:209] op_sel:[0,1]
    v_pk_mov_b32 v[38:39], v[210:211], v[210:211] op_sel:[0,1]
    v_pk_mov_b32 v[40:41], v[224:225], v[224:225] op_sel:[0,1]
    v_pk_mov_b32 v[42:43], v[226:227], v[226:227] op_sel:[0,1]
    v_pk_mov_b32 v[44:45], v[240:241], v[240:241] op_sel:[0,1]
    v_pk_mov_b32 v[46:47], v[242:243], v[242:243] op_sel:[0,1]
fz_dnw0:
    s_sub_u32 s3, s31, 2
    s_and_b32 s3, s3, 3
    s_cmp_eq_u32 s3, 3
    s_cbranch_scc1 fz_skw1
    s_add_u32 s3, s3, 3
    s_lshl_b32 s3, s3, 12
    s_add_u32 s3, s3, 57344
    v_add_u32 v5, s3, v4
    ds_write_b128 v5, v[196:199] offset:0
    ds_write_b128 v5, v[212:215] offset:1024
    ds_write_b128 v5, v[228:231] offset:2048
    ds_write_b128 v5, v[244:247] offset:3072
    s_branch fz_dnw1
fz_skw1:
    v_pk_mov_b32 v[32:33], v[196:197], v[196:197] op_sel:[0,1]
    v_pk_mov_b32 v[34:35], v[198:199], v[198:199] op_sel:[0,1]
    v_pk_mov_b32 v[36:37], v[212:213], v[212:213] op_sel:[0,1]
    v_pk_mov_b32 v[38:39], v[214:215], v[214:215] op_sel:[0,1]
    v_pk_mov_b32 v[40:41], v[228:229], v[228:229] op_sel:[0,1]
    v_pk_mov_b32 v[42:43], v[230:231], v[230:231] op_sel:[0,1]
    v_pk_mov_b32 v[44:45], v[244:245], v[244:245] op_sel:[0,1]
    v_pk_mov_b32 v[46:47], v[246:247], v[246:247] op_sel:[0,1]
fz_dnw1:
    s_sub_u32 s3, s31, 3
    s_and_b32 s3, s3, 3
    s_cmp_eq_u32 s3, 3
    s_cbranch_scc1 fz_skw2
    s_add_u32 s3, s3, 6
    s_lshl_b32 s3, s3, 12
    s_add_u32 s3, s3, 57344
    v_add_u32 v5, s3, v4
    ds_write_b128 v5, v[200:203] offset:0
    ds_write_b128 v5, v[216:219] offset:1024
    ds_write_b128 v5, v[232:235] offset:2048
    ds_write_b128 v5, v[248:251] offset:3072
    s_branch fz_dnw2
fz_skw2:
    v_pk_mov_b32 v[32:33], v[200:201], v[200:201] op_sel:[0,1]
    v_pk_mov_b32 v[34:35], v[202:203], v[202:203] op_sel:[0,1]
    v_pk_mov_b32 v[36:37], v[216:217], v[216:217] op_sel:[0,1]
    v_pk_mov_b32 v[38:39], v[218:219], v[218:219] op_sel:[0,1]
    v_pk_mov_b32 v[40:41], v[232:233], v[232:233] op_sel:[0,1]
    v_pk_mov_b32 v[42:43], v[234:235], v[234:235] op_sel:[0,1]
    v_pk_mov_b32 v[44:45], v[248:249], v[248:249] op_sel:[0,1]
    v_pk_mov_b32 v[46:47], v[250:251], v[250:251] op_sel:[0,1]
fz_dnw2:
    s_sub_u32 s3, s31, 4
    s_and_b32 s3, s3, 3
    s_cmp_eq_u32 s3, 3
    s_cbranch_scc1 fz_skw3
    s_add_u32 s3, s3, 9
    s_lshl_b32 s3, s3, 12
    s_add_u32 s3, s3, 57344
    v_add_u32 v5, s3, v4
    ds_write_b128 v5, v[204:207] offset:0
    ds_write_b128 v5, v[220:223] offset:1024
    ds_write_b128 v5, v[236:239] offset:2048
    ds_write_b128 v5, v[252:255] offset:3072
    s_branch fz_dnw3
fz_skw3:
    v_pk_mov_b32 v[32:33], v[204:205], v[204:205] op_sel:[0,1]
    v_pk_mov_b32 v[34:35], v[206:207], v[206:207] op_sel:[0,1]
    v_pk_mov_b32 v[36:37], v[220:221], v[220:221] op_sel:[0,1]
    v_pk_mov_b32 v[38:39], v[222:223], v[222:223] op_sel:[0,1]
    v_pk_mov_b32 v[40:41], v[236:237], v[236:237] op_sel:[0,1]
    v_pk_mov_b32 v[42:43], v[238:239], v[238:239] op_sel:[0,1]
    v_pk_mov_b32 v[44:45], v[252:253], v[252:253] op_sel:[0,1]
    v_pk_mov_b32 v[46:47], v[254:255], v[254:255] op_sel:[0,1]
fz_dnw3:
    s_lshl_b32 s3, s31, 2
    v_mov_b32 v5, s3
    v_mov_b32 v6, s29
    s_waitcnt vmcnt(0) lgkmcnt(0)
    ds_write_b32 v5, v6 offset:2352
    v_lshlrev_b32 v6, 16, v24
    v_and_b32 v7, 0xffff0000, v24
    v_pk_add_f32 v[32:33], v[32:33], v[6:7]
    v_lshlrev_b32 v6, 16, v25
    v_and_b32 v7, 0xffff0000, v25
    v_pk_add_f32 v[34:35], v[34:35], v[6:7]
    v_lshlrev_b32 v6, 16, v26
    v_and_b32 v7, 0xffff0000, v26
    v_pk_add_f32 v[36:37], v[36:37], v[6:7]
    v_lshlrev_b32 v6, 16, v27
    v_and_b32 v7, 0xffff0000, v27
    v_pk_add_f32 v[38:39], v[38:39], v[6:7]
    v_lshlrev_b32 v6, 16, v28
    v_and_b32 v7, 0xffff0000, v28
    v_pk_add_f32 v[40:41], v[40:41], v[6:7]
    v_lshlrev_b32 v6, 16, v29
    v_and_b32 v7, 0xffff0000, v29
    v_pk_add_f32 v[42:43], v[42:43], v[6:7]
    v_lshlrev_b32 v6, 16, v30
    v_and_b32 v7, 0xffff0000, v30
    v_pk_add_f32 v[44:45], v[44:45], v[6:7]
    v_lshlrev_b32 v6, 16, v31
    v_and_b32 v7, 0xffff0000, v31
    v_pk_add_f32 v[46:47], v[46:47], v[6:7]
    s_mul_i32 s3, s31, 12288
    s_add_u32 s0, s3, 57344
    v_add_u32 v14, s0, v4
    v_subrev_u32 v10, s3, v10
    v_subrev_u32 v18, s3, v18
    v_subrev_u32 v11, s3, v11
    v_subrev_u32 v19, s3, v19
    v_subrev_u32 v12, s3, v12
    v_subrev_u32 v20, s3, v20
    v_subrev_u32 v13, s3, v13
    v_subrev_u32 v21, s3, v21
    s_lshl_b32 s3, s31, 10
    v_add_u32 v1, s3, v1
    s_mov_b32 s40, s18
    s_mov_b32 s41, s19
    s_mov_b32 s42, 0x200000
    s_mov_b32 s43, 0x00020000
    buffer_load_dword v15, v23, s[32:35], 0 offen sc1
    v_and_b32 v5, 3, v0
    v_lshlrev_b32 v5, 2, v5
    s_mov_b32 s3, 6000000
fz_lsr:
    ds_read_b32 v6, v5 offset:2352
    s_waitcnt lgkmcnt(0)
    v_cmp_eq_u32 vcc, s29, v6
    s_sub_u32 s3, s3, 1
    s_cmp_eq_u32 s3, 0
    s_cbranch_scc1 fz_lsr_ok
    s_cmp_eq_u64 vcc, -1
    s_cbranch_scc1 fz_lsr_ok
    s_branch fz_lsr
fz_lsr_ok:
    ds_read_b128 v[192:195], v14 offset:0
    ds_read_b128 v[196:199], v14 offset:1024
    ds_read_b128 v[200:203], v14 offset:2048
    ds_read_b128 v[204:207], v14 offset:3072
    ds_read_b128 v[208:211], v14 offset:4096
    ds_read_b128 v[212:215], v14 offset:5120
    ds_read_b128 v[216:219], v14 offset:6144
    ds_read_b128 v[220:223], v14 offset:7168
    ds_read_b128 v[224:227], v14 offset:8192
    ds_read_b128 v[228:231], v14 offset:9216
    ds_read_b128 v[232:235], v14 offset:10240
    ds_read_b128 v[236:239], v14 offset:11264
    s_waitcnt vmcnt(0)
    v_cmp_eq_u32 vcc, s29, v15
    s_nop 3
    s_cmp_eq_u64 vcc, -1
    s_cbranch_scc1 fz_pook
    s_mov_b32 s3, 300000
fz_po:
    buffer_load_dword v15, v23, s[32:35], 0 offen sc1
    s_waitcnt vmcnt(0)
    v_cmp_eq_u32 vcc, s29, v15
    s_sub_u32 s3, s3, 1
    s_cmp_eq_u32 s3, 0
    s_cbranch_scc1 fz_po_ok
    s_cmp_eq_u64 vcc, -1
    s_cbranch_scc1 fz_po_ok
    s_sleep 2
    s_branch fz_po
fz_po_ok:
fz_pook:
    s_mov_b32 s60, 0
    buffer_load_dwordx4 v[128:131], v1, s[52:55], s60 offen sc1
    s_mov_b32 s60, 131072
    buffer_load_dwordx4 v[132:135], v1, s[52:55], s60 offen sc1
    s_mov_b32 s60, 262144
    buffer_load_dwordx4 v[136:139], v1, s[52:55], s60 offen sc1
    s_mov_b32 s60, 393216
    buffer_load_dwordx4 v[140:143], v1, s[52:55], s60 offen sc1
    s_mov_b32 s60, 524288
    buffer_load_dwordx4 v[144:147], v1, s[52:55], s60 offen sc1
    s_mov_b32 s60, 655360
    buffer_load_dwordx4 v[148:151], v1, s[52:55], s60 offen sc1
    s_mov_b32 s60, 786432
    buffer_load_dwordx4 v[152:155], v1, s[52:55], s60 offen sc1
    s_mov_b32 s60, 917504
    buffer_load_dwordx4 v[156:159], v1, s[52:55], s60 offen sc1
    s_mov_b32 s60, 1048576
    buffer_load_dwordx4 v[160:163], v1, s[52:55], s60 offen sc1
    s_mov_b32 s60, 1179648
    buffer_load_dwordx4 v[164:167], v1, s[52:55], s60 offen sc1
    s_mov_b32 s60, 1310720
    buffer_load_dwordx4 v[168:171], v1, s[52:55], s60 offen sc1
    s_mov_b32 s60, 1441792
    buffer_load_dwordx4 v[172:175], v1, s[52:55], s60 offen sc1
    s_mov_b32 s60, 1572864
    buffer_load_dwordx4 v[176:179], v1, s[52:55], s60 offen sc1
    s_mov_b32 s60, 1703936
    buffer_load_dwordx4 v[180:183], v1, s[52:55], s60 offen sc1
    s_mov_b32 s60, 1835008
    buffer_load_dwordx4 v[184:187], v1, s[52:55], s60 offen sc1
    s_mov_b32 s60, 1966080
    buffer_load_dwordx4 v[188:191], v1, s[52:55], s60 offen sc1
fz_eosk:
    s_waitcnt lgkmcnt(8)
    v_pk_add_f32 v[32:33], v[32:33], v[192:193]
    v_pk_add_f32 v[34:35], v[34:35], v[194:195]
    v_pk_add_f32 v[36:37], v[36:37], v[196:197]
    v_pk_add_f32 v[38:39], v[38:39], v[198:199]
    v_pk_add_f32 v[40:41], v[40:41], v[200:201]
    v_pk_add_f32 v[42:43], v[42:43], v[202:203]
    v_pk_add_f32 v[44:45], v[44:45], v[204:205]
    v_pk_add_f32 v[46:47], v[46:47], v[206:207]
    ds_read_b64_tr_b16 v[48:49], v10 offset:8192
    ds_read_b64_tr_b16 v[50:51], v10 offset:10240
    ds_read_b64_tr_b16 v[52:53], v11 offset:8192
    ds_read_b64_tr_b16 v[54:55], v11 offset:10240
    ds_read_b64_tr_b16 v[56:57], v12 offset:8192
    ds_read_b64_tr_b16 v[58:59], v12 offset:10240
    ds_read_b64_tr_b16 v[60:61], v13 offset:8192
    ds_read_b64_tr_b16 v[62:63], v13 offset:10240
    s_waitcnt lgkmcnt(12)
    v_pk_add_f32 v[32:33], v[32:33], v[208:209]
    v_pk_add_f32 v[34:35], v[34:35], v[210:211]
    v_pk_add_f32 v[36:37], v[36:37], v[212:213]
    v_pk_add_f32 v[38:39], v[38:39], v[214:215]
    v_pk_add_f32 v[40:41], v[40:41], v[216:217]
    v_pk_add_f32 v[42:43], v[42:43], v[218:219]
    v_pk_add_f32 v[44:45], v[44:45], v[220:221]
    v_pk_add_f32 v[46:47], v[46:47], v[222:223]
    ds_read_b64_tr_b16 v[64:65], v10 offset:20480
    ds_read_b64_tr_b16 v[66:67], v10 offset:22528
    ds_read_b64_tr_b16 v[68:69], v11 offset:20480
    ds_read_b64_tr_b16 v[70:71], v11 offset:22528
    ds_read_b64_tr_b16 v[72:73], v12 offset:20480
    ds_read_b64_tr_b16 v[74:75], v12 offset:22528
    ds_read_b64_tr_b16 v[76:77], v13 offset:20480
    ds_read_b64_tr_b16 v[78:79], v13 offset:22528
    s_waitcnt lgkmcnt(12)
    v_pk_add_f32 v[32:33], v[32:33], v[224:225]
    v_pk_add_f32 v[34:35], v[34:35], v[226:227]
    v_pk_add_f32 v[36:37], v[36:37], v[228:229]
    v_pk_add_f32 v[38:39], v[38:39], v[230:231]
    v_pk_add_f32 v[40:41], v[40:41], v[232:233]
    v_pk_add_f32 v[42:43], v[42:43], v[234:235]
    v_pk_add_f32 v[44:45], v[44:45], v[236:237]
    v_pk_add_f32 v[46:47], v[46:47], v[238:239]
    ds_read_b64_tr_b16 v[80:81], v10 offset:32768
    ds_read_b64_tr_b16 v[82:83], v10 offset:34816
    ds_read_b64_tr_b16 v[84:85], v11 offset:32768
    ds_read_b64_tr_b16 v[86:87], v11 offset:34816
    ds_read_b64_tr_b16 v[88:89], v12 offset:32768
    ds_read_b64_tr_b16 v[90:91], v12 offset:34816
    ds_read_b64_tr_b16 v[92:93], v13 offset:32768
    ds_read_b64_tr_b16 v[94:95], v13 offset:34816
    s_waitcnt vmcnt(15)
    s_waitcnt lgkmcnt(14)
    v_mfma_f32_16x16x32_bf16 v[32:35], v[48:51], v[128:131], v[32:35]
    s_waitcnt lgkmcnt(6)
    ds_read_b64_tr_b16 v[96:97], v10 offset:45056
    ds_read_b64_tr_b16 v[98:99], v10 offset:47104
    v_mfma_f32_16x16x32_bf16 v[36:39], v[52:55], v[128:131], v[36:39]
    ds_read_b64_tr_b16 v[100:101], v11 offset:45056
    ds_read_b64_tr_b16 v[102:103], v11 offset:47104
    v_mfma_f32_16x16x32_bf16 v[40:43], v[56:59], v[128:131], v[40:43]
    ds_read_b64_tr_b16 v[104:105], v12 offset:45056
    ds_read_b64_tr_b16 v[106:107], v12 offset:47104
    v_mfma_f32_16x16x32_bf16 v[44:47], v[60:63], v[128:131], v[44:47]
    ds_read_b64_tr_b16 v[108:109], v13 offset:45056
    ds_read_b64_tr_b16 v[110:111], v13 offset:47104
    s_waitcnt vmcnt(14)
    v_mfma_f32_16x16x32_bf16 v[32:35], v[64:67], v[132:135], v[32:35]
    s_waitcnt lgkmcnt(6)
    ds_read_b64_tr_b16 v[112:113], v18 offset:0
    ds_read_b64_tr_b16 v[114:115], v18 offset:2048
    v_mfma_f32_16x16x32_bf16 v[36:39], v[68:71], v[132:135], v[36:39]
    ds_read_b64_tr_b16 v[116:117], v19 offset:0
    ds_read_b64_tr_b16 v[118:119], v19 offset:2048
    v_mfma_f32_16x16x32_bf16 v[40:43], v[72:75], v[132:135], v[40:43]
    ds_read_b64_tr_b16 v[120:121], v20 offset:0
    ds_read_b64_tr_b16 v[122:123], v20 offset:2048
    v_mfma_f32_16x16x32_bf16 v[44:47], v[76:79], v[132:135], v[44:47]
    ds_read_b64_tr_b16 v[124:125], v21 offset:0
    ds_read_b64_tr_b16 v[126:127], v21 offset:2048
    s_waitcnt vmcnt(13)
    v_mfma_f32_16x16x32_bf16 v[32:35], v[80:83], v[136:139], v[32:35]
    s_waitcnt lgkmcnt(6)
    ds_read_b64_tr_b16 v[48:49], v18 offset:12288
    ds_read_b64_tr_b16 v[50:51], v18 offset:14336
    v_mfma_f32_16x16x32_bf16 v[36:39], v[84:87], v[136:139], v[36:39]
    ds_read_b64_tr_b16 v[52:53], v19 offset:12288
    ds_read_b64_tr_b16 v[54:55], v19 offset:14336
    v_mfma_f32_16x16x32_bf16 v[40:43], v[88:91], v[136:139], v[40:43]
    ds_read_b64_tr_b16 v[56:57], v20 offset:12288
    ds_read_b64_tr_b16 v[58:59], v20 offset:14336
    v_mfma_f32_16x16x32_bf16 v[44:47], v[92:95], v[136:139], v[44:47]
    ds_read_b64_tr_b16 v[60:61], v21 offset:12288
    ds_read_b64_tr_b16 v[62:63], v21 offset:14336
    s_waitcnt vmcnt(12)
    v_mfma_f32_16x16x32_bf16 v[32:35], v[96:99], v[140:143], v[32:35]
    s_waitcnt lgkmcnt(6)
    ds_read_b64_tr_b16 v[64:65], v18 offset:24576
    ds_read_b64_tr_b16 v[66:67], v18 offset:26624
    v_mfma_f32_16x16x32_bf16 v[36:39], v[100:103], v[140:143], v[36:39]
    ds_read_b64_tr_b16 v[68:69], v19 offset:24576
    ds_read_b64_tr_b16 v[70:71], v19 offset:26624
    v_mfma_f32_16x16x32_bf16 v[40:43], v[104:107], v[140:143], v[40:43]
    ds_read_b64_tr_b16 v[72:73], v20 offset:24576
    ds_read_b64_tr_b16 v[74:75], v20 offset:26624
    v_mfma_f32_16x16x32_bf16 v[44:47], v[108:111], v[140:143], v[44:47]
    ds_read_b64_tr_b16 v[76:77], v21 offset:24576
    ds_read_b64_tr_b16 v[78:79], v21 offset:26624
    s_waitcnt vmcnt(11)
    v_mfma_f32_16x16x32_bf16 v[32:35], v[112:115], v[144:147], v[32:35]
    s_waitcnt lgkmcnt(6)
    ds_read_b64_tr_b16 v[80:81], v18 offset:36864
    ds_read_b64_tr_b16 v[82:83], v18 offset:38912
    v_mfma_f32_16x16x32_bf16 v[36:39], v[116:119], v[144:147], v[36:39]
    ds_read_b64_tr_b16 v[84:85], v19 offset:36864
    ds_read_b64_tr_b16 v[86:87], v19 offset:38912
    v_mfma_f32_16x16x32_bf16 v[40:43], v[120:123], v[144:147], v[40:43]
    ds_read_b64_tr_b16 v[88:89], v20 offset:36864
    ds_read_b64_tr_b16 v[90:91], v20 offset:38912
    v_mfma_f32_16x16x32_bf16 v[44:47], v[124:127], v[144:147], v[44:47]
    ds_read_b64_tr_b16 v[92:93], v21 offset:36864
    ds_read_b64_tr_b16 v[94:95], v21 offset:38912
    s_waitcnt vmcnt(10)
    v_mfma_f32_16x16x32_bf16 v[32:35], v[48:51], v[148:151], v[32:35]
    s_waitcnt lgkmcnt(6)
    ds_read_b64_tr_b16 v[96:97], v18 offset:4096
    ds_read_b64_tr_b16 v[98:99], v18 offset:6144
    v_mfma_f32_16x16x32_bf16 v[36:39], v[52:55], v[148:151], v[36:39]
    ds_read_b64_tr_b16 v[100:101], v19 offset:4096
    ds_read_b64_tr_b16 v[102:103], v19 offset:6144
    v_mfma_f32_16x16x32_bf16 v[40:43], v[56:59], v[148:151], v[40:43]
    ds_read_b64_tr_b16 v[104:105], v20 offset:4096
    ds_read_b64_tr_b16 v[106:107], v20 offset:6144
    v_mfma_f32_16x16x32_bf16 v[44:47], v[60:63], v[148:151], v[44:47]
    ds_read_b64_tr_b16 v[108:109], v21 offset:4096
    ds_read_b64_tr_b16 v[110:111], v21 offset:6144
    s_waitcnt vmcnt(9)
    v_mfma_f32_16x16x32_bf16 v[32:35], v[64:67], v[152:155], v[32:35]
    s_waitcnt lgkmcnt(6)
    ds_read_b64_tr_b16 v[112:113], v18 offset:16384
    ds_read_b64_tr_b16 v[114:115], v18 offset:18432
    v_mfma_f32_16x16x32_bf16 v[36:39], v[68:71], v[152:155], v[36:39]
    ds_read_b64_tr_b16 v[116:117], v19 offset:16384
    ds_read_b64_tr_b16 v[118:119], v19 offset:18432
    v_mfma_f32_16x16x32_bf16 v[40:43], v[72:75], v[152:155], v[40:43]
    ds_read_b64_tr_b16 v[120:121], v20 offset:16384
    ds_read_b64_tr_b16 v[122:123], v20 offset:18432
    v_mfma_f32_16x16x32_bf16 v[44:47], v[76:79], v[152:155], v[44:47]
    ds_read_b64_tr_b16 v[124:125], v21 offset:16384
    ds_read_b64_tr_b16 v[126:127], v21 offset:18432
    s_waitcnt vmcnt(8)
    v_mfma_f32_16x16x32_bf16 v[32:35], v[80:83], v[156:159], v[32:35]
    s_waitcnt lgkmcnt(6)
    ds_read_b64_tr_b16 v[48:49], v18 offset:28672
    ds_read_b64_tr_b16 v[50:51], v18 offset:30720
    v_mfma_f32_16x16x32_bf16 v[36:39], v[84:87], v[156:159], v[36:39]
    ds_read_b64_tr_b16 v[52:53], v19 offset:28672
    ds_read_b64_tr_b16 v[54:55], v19 offset:30720
    v_mfma_f32_16x16x32_bf16 v[40:43], v[88:91], v[156:159], v[40:43]
    ds_read_b64_tr_b16 v[56:57], v20 offset:28672
    ds_read_b64_tr_b16 v[58:59], v20 offset:30720
    v_mfma_f32_16x16x32_bf16 v[44:47], v[92:95], v[156:159], v[44:47]
    ds_read_b64_tr_b16 v[60:61], v21 offset:28672
    ds_read_b64_tr_b16 v[62:63], v21 offset:30720
    s_waitcnt vmcnt(7)
    v_mfma_f32_16x16x32_bf16 v[32:35], v[96:99], v[160:163], v[32:35]
    s_waitcnt lgkmcnt(6)
    ds_read_b64_tr_b16 v[64:65], v18 offset:40960
    ds_read_b64_tr_b16 v[66:67], v18 offset:43008
    v_mfma_f32_16x16x32_bf16 v[36:39], v[100:103], v[160:163], v[36:39]
    ds_read_b64_tr_b16 v[68:69], v19 offset:40960
    ds_read_b64_tr_b16 v[70:71], v19 offset:43008
    v_mfma_f32_16x16x32_bf16 v[40:43], v[104:107], v[160:163], v[40:43]
    ds_read_b64_tr_b16 v[72:73], v20 offset:40960
    ds_read_b64_tr_b16 v[74:75], v20 offset:43008
    v_mfma_f32_16x16x32_bf16 v[44:47], v[108:111], v[160:163], v[44:47]
    ds_read_b64_tr_b16 v[76:77], v21 offset:40960
    ds_read_b64_tr_b16 v[78:79], v21 offset:43008
    s_waitcnt vmcnt(6)
    v_mfma_f32_16x16x32_bf16 v[32:35], v[112:115], v[164:167], v[32:35]
    s_waitcnt lgkmcnt(6)
    ds_read_b64_tr_b16 v[80:81], v18 offset:8192
    ds_read_b64_tr_b16 v[82:83], v18 offset:10240
    v_mfma_f32_16x16x32_bf16 v[36:39], v[116:119], v[164:167], v[36:39]
    ds_read_b64_tr_b16 v[84:85], v19 offset:8192
    ds_read_b64_tr_b16 v[86:87], v19 offset:10240
    v_mfma_f32_16x16x32_bf16 v[40:43], v[120:123], v[164:167], v[40:43]
    ds_read_b64_tr_b16 v[88:89], v20 offset:8192
    ds_read_b64_tr_b16 v[90:91], v20 offset:10240
    v_mfma_f32_16x16x32_bf16 v[44:47], v[124:127], v[164:167], v[44:47]
    ds_read_b64_tr_b16 v[92:93], v21 offset:8192
    ds_read_b64_tr_b16 v[94:95], v21 offset:10240
    s_waitcnt vmcnt(5)
    v_mfma_f32_16x16x32_bf16 v[32:35], v[48:51], v[168:171], v[32:35]
    s_waitcnt lgkmcnt(6)
    ds_read_b64_tr_b16 v[96:97], v18 offset:20480
    ds_read_b64_tr_b16 v[98:99], v18 offset:22528
    v_mfma_f32_16x16x32_bf16 v[36:39], v[52:55], v[168:171], v[36:39]
    ds_read_b64_tr_b16 v[100:101], v19 offset:20480
    ds_read_b64_tr_b16 v[102:103], v19 offset:22528
    v_mfma_f32_16x16x32_bf16 v[40:43], v[56:59], v[168:171], v[40:43]
    ds_read_b64_tr_b16 v[104:105], v20 offset:20480
    ds_read_b64_tr_b16 v[106:107], v20 offset:22528
    v_mfma_f32_16x16x32_bf16 v[44:47], v[60:63], v[168:171], v[44:47]
    ds_read_b64_tr_b16 v[108:109], v21 offset:20480
    ds_read_b64_tr_b16 v[110:111], v21 offset:22528
    s_waitcnt vmcnt(4)
    v_mfma_f32_16x16x32_bf16 v[32:35], v[64:67], v[172:175], v[32:35]
    s_waitcnt lgkmcnt(6)
    ds_read_b64_tr_b16 v[112:113], v18 offset:32768
    ds_read_b64_tr_b16 v[114:115], v18 offset:34816
    v_mfma_f32_16x16x32_bf16 v[36:39], v[68:71], v[172:175], v[36:39]
    ds_read_b64_tr_b16 v[116:117], v19 offset:32768
    ds_read_b64_tr_b16 v[118:119], v19 offset:34816
    v_mfma_f32_16x16x32_bf16 v[40:43], v[72:75], v[172:175], v[40:43]
    ds_read_b64_tr_b16 v[120:121], v20 offset:32768
    ds_read_b64_tr_b16 v[122:123], v20 offset:34816
    v_mfma_f32_16x16x32_bf16 v[44:47], v[76:79], v[172:175], v[44:47]
    ds_read_b64_tr_b16 v[124:125], v21 offset:32768
    ds_read_b64_tr_b16 v[126:127], v21 offset:34816
    s_waitcnt vmcnt(3)
    v_mfma_f32_16x16x32_bf16 v[32:35], v[80:83], v[176:179], v[32:35]
    s_waitcnt lgkmcnt(6)
    ds_read_b64_tr_b16 v[48:49], v18 offset:45056
    ds_read_b64_tr_b16 v[50:51], v18 offset:47104
    v_mfma_f32_16x16x32_bf16 v[36:39], v[84:87], v[176:179], v[36:39]
    ds_read_b64_tr_b16 v[52:53], v19 offset:45056
    ds_read_b64_tr_b16 v[54:55], v19 offset:47104
    v_mfma_f32_16x16x32_bf16 v[40:43], v[88:91], v[176:179], v[40:43]
    ds_read_b64_tr_b16 v[56:57], v20 offset:45056
    ds_read_b64_tr_b16 v[58:59], v20 offset:47104
    v_mfma_f32_16x16x32_bf16 v[44:47], v[92:95], v[176:179], v[44:47]
    ds_read_b64_tr_b16 v[60:61], v21 offset:45056
    ds_read_b64_tr_b16 v[62:63], v21 offset:47104
    s_waitcnt vmcnt(2)
    v_mfma_f32_16x16x32_bf16 v[32:35], v[96:99], v[180:183], v[32:35]
    v_mfma_f32_16x16x32_bf16 v[36:39], v[100:103], v[180:183], v[36:39]
    v_mfma_f32_16x16x32_bf16 v[40:43], v[104:107], v[180:183], v[40:43]
    v_mfma_f32_16x16x32_bf16 v[44:47], v[108:111], v[180:183], v[44:47]
    s_waitcnt vmcnt(1)
    s_waitcnt lgkmcnt(8)
    v_mfma_f32_16x16x32_bf16 v[32:35], v[112:115], v[184:187], v[32:35]
    v_mfma_f32_16x16x32_bf16 v[36:39], v[116:119], v[184:187], v[36:39]
    v_mfma_f32_16x16x32_bf16 v[40:43], v[120:123], v[184:187], v[40:43]
    v_mfma_f32_16x16x32_bf16 v[44:47], v[124:127], v[184:187], v[44:47]
    s_waitcnt vmcnt(0)
    s_waitcnt lgkmcnt(0)
    v_mfma_f32_16x16x32_bf16 v[32:35], v[48:51], v[188:191], v[32:35]
    v_mfma_f32_16x16x32_bf16 v[36:39], v[52:55], v[188:191], v[36:39]
    v_mfma_f32_16x16x32_bf16 v[40:43], v[56:59], v[188:191], v[40:43]
    v_mfma_f32_16x16x32_bf16 v[44:47], v[60:63], v[188:191], v[44:47]
    s_nop 7
    v_cvt_pk_bf16_f32 v32, v32, v33
    v_cvt_pk_bf16_f32 v33, v34, v35
    v_cvt_pk_bf16_f32 v34, v36, v37
    v_cvt_pk_bf16_f32 v35, v38, v39
    s_nop 0
    v_permlane16_swap_b32 v32, v34
    v_permlane16_swap_b32 v33, v35
    buffer_store_dwordx4 v[32:35], v8, s[40:43], 0 offen offset:0
    v_cvt_pk_bf16_f32 v40, v40, v41
    v_cvt_pk_bf16_f32 v41, v42, v43
    v_cvt_pk_bf16_f32 v42, v44, v45
    v_cvt_pk_bf16_f32 v43, v46, v47
    s_nop 0
    v_permlane16_swap_b32 v40, v42
    v_permlane16_swap_b32 v41, v43
    buffer_store_dwordx4 v[40:43], v8, s[40:43], 0 offen offset:64
fz_end:
    s_endpgm
.section .rodata,"a"
.p2align 6
.amdhsa_kernel parallel_sum__sliding_block__glu_gated_reglu__prompt_kernel
  .amdhsa_next_free_vgpr 256
  .amdhsa_next_free_sgpr 102
  .amdhsa_accum_offset 256
  .amdhsa_group_segment_fixed_size 0
  .amdhsa_kernarg_size 80
  .amdhsa_user_sgpr_count 2
  .amdhsa_user_sgpr_kernarg_segment_ptr 1
  .amdhsa_system_sgpr_workgroup_id_x 1
.end_amdhsa_kernel
```
